```python
import torch

def _softmax(x, axis=-1):
    return torch.softmax(x, dim=axis)
def _gelu(x):
    return torch.nn.functional.gelu(x, approximate="tanh")
def _silu(x):
    return torch.nn.functional.silu(x)
def _sigmoid(x):
    return torch.sigmoid(x)
def _layernorm(x, axis=-1, eps=1e-5):
    m = x.mean(dim=axis, keepdim=True)
    v = x.var(dim=axis, keepdim=True, unbiased=False)
    return (x - m) / torch.sqrt(v + eps)
def _scatter_add(tgt, idx, src, axis=0):
    return tgt.clone().index_add_(axis, idx, src)
def _segment_sum(src, seg, n):
    out = torch.zeros((n,) + src.shape[1:], dtype=src.dtype)
    return out.index_add_(0, seg, src)
def _pad(x, pw):
    flat = tuple(v for pair in reversed(pw) for v in pair)
    return torch.nn.functional.pad(x, flat)

kernel_name = 'concat_heads__gqa_block_cached__gqa_block_cached__near_ridge'

def setup_inputs():

    _w = (lambda a: (lambda t: t.to(torch.bfloat16) if t.is_floating_point() else t)(torch.as_tensor(a)))
    def _A_setup():
        B, Sq, D = 8, 192, 512
        Hq, Hkv, Sk, Dh = 32, 32, 1024, 128
        assert Hq % Hkv == 0, (Hq, Hkv)
        return {
            "x": _w((lambda *s: torch.randn(*s, dtype=torch.bfloat16) * 0.8)(B, Sq, D)),
            "k_cache": _w((lambda *s: torch.randn(*s, dtype=torch.bfloat16) * 0.8)(B, Hkv, Sk, Dh)),
            "v_cache": _w((lambda *s: torch.randn(*s, dtype=torch.bfloat16) * 0.05)(B, Hkv, Sk, Dh)),
            "wq": _w((lambda *s: torch.randn(*s, dtype=torch.bfloat16) * 0.8)(D, Hq * Dh) * (D ** -0.5)),
            "wo": _w((lambda *s: torch.randn(*s, dtype=torch.bfloat16) * 0.05)(Hq * Dh, D) * ((Hq * Dh) ** -0.5)),
        }
    _A_in = _A_setup()

    def _B_setup():
        B, Sq, D = 8, 192, 512
        Hq, Hkv, Sk, Dh = 32, 32, 1024, 128
        assert Hq % Hkv == 0, (Hq, Hkv)
        return {
            "x": _w((lambda *s: torch.randn(*s, dtype=torch.bfloat16) * 0.8)(B, Sq, D)),
            "k_cache": _w((lambda *s: torch.randn(*s, dtype=torch.bfloat16) * 0.8)(B, Hkv, Sk, Dh)),
            "v_cache": _w((lambda *s: torch.randn(*s, dtype=torch.bfloat16) * 0.05)(B, Hkv, Sk, Dh)),
            "wq": _w((lambda *s: torch.randn(*s, dtype=torch.bfloat16) * 0.8)(D, Hq * Dh) * (D ** -0.5)),
            "wo": _w((lambda *s: torch.randn(*s, dtype=torch.bfloat16) * 0.05)(Hq * Dh, D) * ((Hq * Dh) ** -0.5)),
        }
    _B_in = _B_setup()

    return {
        "A_x": _A_in["x"],
        "A_k_cache": _A_in["k_cache"],
        "A_v_cache": _A_in["v_cache"],
        "A_wq": _A_in["wq"],
        "A_wo": _A_in["wo"],
        "B_x": _B_in["x"],
        "B_k_cache": _B_in["k_cache"],
        "B_v_cache": _B_in["v_cache"],
        "B_wq": _B_in["wq"],
        "B_wo": _B_in["wo"],
    }

def reference(A_x, A_k_cache, A_v_cache, A_wq, A_wo, B_x, B_k_cache, B_v_cache, B_wq, B_wo):
    def _A_ref(x, k_cache, v_cache, wq, wo):
        B, Sq, D = x.shape
        Hq, Dh = 32, 128
        Hkv = k_cache.shape[1]
        rep = Hq // Hkv
        q = (lambda x, *d: x.permute(*d))((x @ wq).reshape(B, Sq, Hq, Dh), 0, 2, 1, 3)
        k = (lambda x, n, axis: torch.repeat_interleave(x, n, dim=axis))(k_cache, rep, axis=1)
        v = (lambda x, n, axis: torch.repeat_interleave(x, n, dim=axis))(v_cache, rep, axis=1)
        scores = torch.einsum("bhqd,bhkd->bhqk", q, k) * (Dh ** -0.5)
        p = _softmax(scores, axis=-1)
        o = torch.einsum("bhqk,bhkd->bhqd", p, v)
        return (lambda x, *d: x.permute(*d))(o, 0, 2, 1, 3).reshape(B, Sq, Hq * Dh) @ wo

    def _B_ref(x, k_cache, v_cache, wq, wo):
        B, Sq, D = x.shape
        Hq, Dh = 32, 128
        Hkv = k_cache.shape[1]
        rep = Hq // Hkv
        q = (lambda x, *d: x.permute(*d))((x @ wq).reshape(B, Sq, Hq, Dh), 0, 2, 1, 3)
        k = (lambda x, n, axis: torch.repeat_interleave(x, n, dim=axis))(k_cache, rep, axis=1)
        v = (lambda x, n, axis: torch.repeat_interleave(x, n, dim=axis))(v_cache, rep, axis=1)
        scores = torch.einsum("bhqd,bhkd->bhqk", q, k) * (Dh ** -0.5)
        p = _softmax(scores, axis=-1)
        o = torch.einsum("bhqk,bhkd->bhqd", p, v)
        return (lambda x, *d: x.permute(*d))(o, 0, 2, 1, 3).reshape(B, Sq, Hq * Dh) @ wo

    a = _A_ref(A_x, A_k_cache, A_v_cache, A_wq, A_wo)
    b = _B_ref(B_x, B_k_cache, B_v_cache, B_wq, B_wo)
    return torch.concatenate([a, b], axis=-1)
```

```asm
; @launch kernel=attn_kernel grid=(256,1,1) block=(256,1,1) lds=163840
; @launch kernel=reduce_kernel grid=(256,1,1) block=(768,1,1) lds=0
.amdgcn_target "amdgcn-amd-amdhsa--gfx950"
.text
    .globl attn_kernel
    .p2align 8
    .type attn_kernel,@function
attn_kernel:
    s_cmp_ge_u32 s2, 256
    s_cbranch_scc1 L_k1_end
    s_getpc_b64 s[48:49]
L_k1_pc:
    v_lshlrev_b32 v248, 7, v0
    s_mov_b32 s46, L_k1_hot_end - L_k1_pc - 4
    global_load_dword v250, v248, s[48:49]
    v_add_u32 v248, 32768, v248
    v_min_u32 v249, s46, v248
    global_load_dword v251, v249, s[48:49]
    s_and_b32 s44, s2, 7
    s_lshr_b32 s45, s2, 3
    s_lshr_b32 s35, s44, 2
    s_and_b32 s46, s44, 3
    s_lshl_b32 s46, s46, 2
    s_and_b32 s47, s45, 3
    s_add_u32 s37, s46, s47
    s_lshr_b32 s36, s45, 2
    s_mul_i32 s46, s35, 40
    s_load_dwordx8 s[4:11], s[0:1], s46
    s_add_u32 s46, s46, 32
    s_load_dwordx2 s[14:15], s[0:1], s46
    s_load_dwordx2 s[12:13], s[0:1], 96
    s_lshr_b32 s46, s2, 7
    s_mul_i32 s46, s46, 40
    s_add_u32 s46, s46, 32
    s_load_dwordx2 s[56:57], s[0:1], s46
    v_lshrrev_b32 v16, 6, v0
    v_and_b32 v1, 63, v0
    v_readfirstlane_b32 s32, v16
    v_lshrrev_b32 v20, 4, v1
    v_and_b32 v16, 3, v1
    v_bfe_u32 v17, v1, 2, 2
    s_lshr_b32 s33, s32, 1
    s_and_b32 s34, s32, 1
    s_mul_i32 s38, s32, 2112
    v_lshlrev_b32 v7, 4, v1
    v_add_u32 v6, 32, v7
    v_lshrrev_b32 v19, 5, v1
    v_and_b32 v18, 31, v1
    v_or_b32 v21, 0, v19
    v_lshlrev_b32 v21, 2, v21
    v_xor_b32 v21, v21, v18
    v_lshlrev_b32 v21, 4, v21
    v_lshl_add_u32 v29, v19, 13, v21
    v_or_b32 v21, 2, v19
    v_lshlrev_b32 v21, 2, v21
    v_xor_b32 v21, v21, v18
    v_lshlrev_b32 v21, 4, v21
    v_lshl_add_u32 v30, v19, 13, v21
    v_lshlrev_b32 v21, 1, v19
    v_xor_b32 v21, v21, v16
    v_lshlrev_b32 v21, 4, v21
    v_lshrrev_b32 v18, 2, v1
    v_lshl_add_u32 v27, v18, 10, v21
    s_waitcnt lgkmcnt(0)
    s_mul_i32 s47, s36, 196608
    s_add_u32 s20, s4, s47
    s_addc_u32 s21, s5, 0
    s_and_b32 s21, s21, 0xffff
    s_mov_b32 s22, 196608
    s_mov_b32 s23, 0x20000
    s_lshl_b32 s47, s37, 9
    s_add_u32 s24, s10, s47
    s_addc_u32 s25, s11, 0
    s_and_b32 s25, s25, 0xffff
    s_sub_u32 s26, 4194304, s47
    s_mov_b32 s27, 0x20000
    s_lshl_b32 s50, s32, 12
    s_add_u32 s50, s50, 68608
    s_mul_i32 s51, s32, 3072
    s_add_u32 s51, s51, 117760
    s_lshl_b32 s52, s32, 16
    s_mul_i32 s53, s32, 49152
    s_lshl_b32 s54, s36, 1
    s_and_b32 s46, s37, 3
    s_lshl_b32 s46, s46, 2
    s_add_u32 s54, s54, s46
    s_and_b32 s54, s54, 15
    v_add_u32 v224, 0, v29
    v_add_u32 v225, 15360, v30
    v_add_u32 v226, 30720, v29
    v_add_u32 v227, 46080, v30
    v_add_u32 v228, 0, v27
    v_add_u32 v229, 15360, v27
    v_add_u32 v230, 30720, v27
    s_lshl_b32 s55, s54, 18
    s_lshl_b32 s49, s54, 6
    s_add_u32 m0, s50, 32768
    s_add_u32 s47, s55, s52
    buffer_load_dwordx4 v224, s[24:27], s47 offen offset:0  lds
    buffer_load_dwordx4 v225, s[24:27], s47 offen offset:1024  lds
    s_add_u32 s55, s55, 0x40000
    buffer_load_dwordx4 v226, s[24:27], s47 offen offset:2048  lds
    s_and_b32 s55, s55, 0x3fffff
    buffer_load_dwordx4 v227, s[24:27], s47 offen offset:3072  lds
    s_add_u32 m0, s51, 24576
    s_add_u32 s47, s49, s53
    buffer_load_dwordx4 v228, s[20:23], s47 offen offset:0  lds
    s_add_u32 s49, s49, 64
    buffer_load_dwordx4 v229, s[20:23], s47 offen offset:1024  lds
    s_and_b32 s49, s49, 0x3ff
    buffer_load_dwordx4 v230, s[20:23], s47 offen offset:2048  lds
    s_add_u32 m0, s50, 0
    s_add_u32 s47, s55, s52
    buffer_load_dwordx4 v224, s[24:27], s47 offen offset:0  lds
    buffer_load_dwordx4 v225, s[24:27], s47 offen offset:1024  lds
    s_add_u32 s55, s55, 0x40000
    buffer_load_dwordx4 v226, s[24:27], s47 offen offset:2048  lds
    s_and_b32 s55, s55, 0x3fffff
    buffer_load_dwordx4 v227, s[24:27], s47 offen offset:3072  lds
    s_add_u32 m0, s51, 0
    s_add_u32 s47, s49, s53
    buffer_load_dwordx4 v228, s[20:23], s47 offen offset:0  lds
    s_add_u32 s49, s49, 64
    buffer_load_dwordx4 v229, s[20:23], s47 offen offset:1024  lds
    s_and_b32 s49, s49, 0x3ff
    buffer_load_dwordx4 v230, s[20:23], s47 offen offset:2048  lds
    s_add_u32 m0, s50, 16384
    s_add_u32 s47, s55, s52
    buffer_load_dwordx4 v224, s[24:27], s47 offen offset:0  lds
    buffer_load_dwordx4 v225, s[24:27], s47 offen offset:1024  lds
    s_add_u32 s55, s55, 0x40000
    buffer_load_dwordx4 v226, s[24:27], s47 offen offset:2048  lds
    s_and_b32 s55, s55, 0x3fffff
    buffer_load_dwordx4 v227, s[24:27], s47 offen offset:3072  lds
    s_add_u32 m0, s51, 12288
    s_add_u32 s47, s49, s53
    buffer_load_dwordx4 v228, s[20:23], s47 offen offset:0  lds
    s_add_u32 s49, s49, 64
    buffer_load_dwordx4 v229, s[20:23], s47 offen offset:1024  lds
    s_and_b32 s49, s49, 0x3ff
    buffer_load_dwordx4 v230, s[20:23], s47 offen offset:2048  lds
    s_lshl_b32 s46, s36, 5
    s_lshl_b32 s47, s37, 1
    s_add_u32 s46, s46, s47
    s_lshl_b32 s47, s46, 18
    s_add_u32 s16, s6, s47
    s_addc_u32 s17, s7, 0
    s_sub_u32 s16, s16, 32
    s_subb_u32 s17, s17, 0
    s_and_b32 s17, s17, 0xffff
    s_mov_b32 s18, 524320
    s_mov_b32 s19, 0x20000
    s_add_u32 s96, s8, s47
    s_addc_u32 s97, s9, 0
    s_sub_u32 s96, s96, 32
    s_subb_u32 s97, s97, 0
    s_and_b32 s97, s97, 0xffff
    s_mov_b32 s98, 524320
    s_mov_b32 s99, 0x20000
    s_lshl_b32 s39, s32, 11
    s_lshl_b32 s40, s32, 11
    v_and_b32 v18, 1, v17
    v_lshl_add_u32 v18, v18, 2, v16
    v_mul_u32_u24 v18, 1056, v18
    v_lshrrev_b32 v21, 1, v17
    v_lshl_add_u32 v18, v21, 8, v18
    v_lshl_add_u32 v18, v20, 4, v18
    s_mul_i32 s46, s33, 16896
    v_add_u32 v2, s46, v18
    v_add_u32 v3, 67584, v2
    v_and_b32 v18, 1, v20
    v_lshl_add_u32 v18, v18, 2, v17
    v_mul_u32_u24 v18, 1056, v18
    v_lshl_add_u32 v18, v19, 8, v18
    v_lshl_add_u32 v18, v16, 3, v18
    s_add_u32 s46, s46, 8448
    v_add_u32 v4, s46, v18
    v_add_u32 v5, 67584, v4
    v_lshl_add_u32 v18, v20, 3, v17
    v_lshlrev_b32 v18, 9, v18
    v_lshl_add_u32 v18, v16, 4, v18
    s_lshl_b32 s46, s33, 8
    s_add_u32 s46, s46, 68608
    v_add_u32 v18, s46, v18
    v_xor_b32 v21, 0, v17
    v_lshl_add_u32 v23, v21, 6, v18
    v_xor_b32 v21, 1, v17
    v_lshl_add_u32 v24, v21, 6, v18
    v_xor_b32 v21, 2, v17
    v_lshl_add_u32 v25, v21, 6, v18
    v_xor_b32 v21, 3, v17
    v_lshl_add_u32 v26, v21, 6, v18
    v_and_b32 v18, 15, v1
    v_lshlrev_b32 v18, 6, v18
    v_bfe_u32 v21, v1, 3, 1
    v_lshlrev_b32 v21, 1, v21
    v_xor_b32 v21, v21, v20
    v_lshl_add_u32 v18, v21, 4, v18
    s_mul_i32 s46, s34, 6144
    s_add_u32 s46, s46, 117760
    v_add_u32 v22, s46, v18
    s_waitcnt vmcnt(14)
    s_barrier
    ds_read_b128 a[32:35], v22 offset:24576
    ds_read_b128 a[36:39], v22 offset:25600
    ds_read_b128 a[40:43], v22 offset:26624
    ds_read_b128 a[44:47], v22 offset:27648
    ds_read_b128 a[48:51], v22 offset:28672
    ds_read_b128 a[52:55], v22 offset:29696
    ds_read_b64_tr_b16 a[0:1], v23 offset:32768
    ds_read_b64_tr_b16 a[2:3], v23 offset:34816
    ds_read_b64_tr_b16 a[4:5], v23 offset:32776
    ds_read_b64_tr_b16 a[6:7], v23 offset:34824
    ds_read_b64_tr_b16 a[8:9], v24 offset:32768
    ds_read_b64_tr_b16 a[10:11], v24 offset:34816
    ds_read_b64_tr_b16 a[12:13], v24 offset:32776
    ds_read_b64_tr_b16 a[14:15], v24 offset:34824
    ds_read_b64_tr_b16 a[16:17], v25 offset:32768
    ds_read_b64_tr_b16 a[18:19], v25 offset:34816
    ds_read_b64_tr_b16 a[20:21], v25 offset:32776
    ds_read_b64_tr_b16 a[22:23], v25 offset:34824
    ds_read_b64_tr_b16 a[24:25], v26 offset:32768
    ds_read_b64_tr_b16 a[26:27], v26 offset:34816
    ds_read_b64_tr_b16 a[28:29], v26 offset:32776
    ds_read_b64_tr_b16 a[30:31], v26 offset:34824
    s_waitcnt lgkmcnt(0)
    s_waitcnt vmcnt(7)
    s_barrier
    v_mfma_f32_16x16x32_bf16 v[32:35], a[0:3], a[32:35], 0
    ds_read_b128 a[88:91], v22 offset:0
    ds_read_b128 a[92:95], v22 offset:1024
    v_mfma_f32_16x16x32_bf16 v[64:67], a[0:3], a[36:39], 0
    s_add_u32 m0, s50, 32768
    ds_read_b128 a[96:99], v22 offset:2048
    ds_read_b128 a[100:103], v22 offset:3072
    v_mfma_f32_16x16x32_bf16 v[96:99], a[0:3], a[40:43], 0
    s_add_u32 s47, s55, s52
    ds_read_b128 a[104:107], v22 offset:4096
    ds_read_b128 a[108:111], v22 offset:5120
    v_mfma_f32_16x16x32_bf16 v[128:131], a[0:3], a[44:47], 0
    buffer_load_dwordx4 v224, s[24:27], s47 offen offset:0  lds
    buffer_load_dwordx4 v225, s[24:27], s47 offen offset:1024  lds
    v_mfma_f32_16x16x32_bf16 v[160:163], a[0:3], a[48:51], 0
    ds_read_b64_tr_b16 a[56:57], v23 offset:0
    ds_read_b64_tr_b16 a[58:59], v23 offset:2048
    v_mfma_f32_16x16x32_bf16 v[192:195], a[0:3], a[52:55], 0
    ds_read_b64_tr_b16 a[60:61], v23 offset:8
    ds_read_b64_tr_b16 a[62:63], v23 offset:2056
    v_mfma_f32_16x16x32_bf16 v[36:39], a[4:7], a[32:35], 0
    v_mfma_f32_16x16x32_bf16 v[68:71], a[4:7], a[36:39], 0
    ds_read_b64_tr_b16 a[64:65], v24 offset:0
    ds_read_b64_tr_b16 a[66:67], v24 offset:2048
    v_mfma_f32_16x16x32_bf16 v[100:103], a[4:7], a[40:43], 0
    v_mfma_f32_16x16x32_bf16 v[132:135], a[4:7], a[44:47], 0
    v_mfma_f32_16x16x32_bf16 v[164:167], a[4:7], a[48:51], 0
    ds_read_b64_tr_b16 a[68:69], v24 offset:8
    ds_read_b64_tr_b16 a[70:71], v24 offset:2056
    v_mfma_f32_16x16x32_bf16 v[196:199], a[4:7], a[52:55], 0
    v_mfma_f32_16x16x32_bf16 v[40:43], a[8:11], a[32:35], 0
    s_add_u32 s55, s55, 0x40000
    ds_read_b64_tr_b16 a[72:73], v25 offset:0
    ds_read_b64_tr_b16 a[74:75], v25 offset:2048
    v_mfma_f32_16x16x32_bf16 v[72:75], a[8:11], a[36:39], 0
    buffer_load_dwordx4 v226, s[24:27], s47 offen offset:2048  lds
    v_mfma_f32_16x16x32_bf16 v[104:107], a[8:11], a[40:43], 0
    ds_read_b64_tr_b16 a[76:77], v25 offset:8
    ds_read_b64_tr_b16 a[78:79], v25 offset:2056
    v_mfma_f32_16x16x32_bf16 v[136:139], a[8:11], a[44:47], 0
    v_mfma_f32_16x16x32_bf16 v[168:171], a[8:11], a[48:51], 0
    ds_read_b64_tr_b16 a[80:81], v26 offset:0
    ds_read_b64_tr_b16 a[82:83], v26 offset:2048
    v_mfma_f32_16x16x32_bf16 v[200:203], a[8:11], a[52:55], 0
    v_mfma_f32_16x16x32_bf16 v[44:47], a[12:15], a[32:35], 0
    s_and_b32 s55, s55, 0x3fffff
    ds_read_b64_tr_b16 a[84:85], v26 offset:8
    ds_read_b64_tr_b16 a[86:87], v26 offset:2056
    v_mfma_f32_16x16x32_bf16 v[76:79], a[12:15], a[36:39], 0
    buffer_load_dwordx4 v227, s[24:27], s47 offen offset:3072  lds
    v_mfma_f32_16x16x32_bf16 v[108:111], a[12:15], a[40:43], 0
    v_mfma_f32_16x16x32_bf16 v[140:143], a[12:15], a[44:47], 0
    v_mfma_f32_16x16x32_bf16 v[172:175], a[12:15], a[48:51], 0
    v_mfma_f32_16x16x32_bf16 v[204:207], a[12:15], a[52:55], 0
    s_add_u32 m0, s51, 24576
    v_mfma_f32_16x16x32_bf16 v[48:51], a[16:19], a[32:35], 0
    s_add_u32 s47, s49, s53
    v_mfma_f32_16x16x32_bf16 v[80:83], a[16:19], a[36:39], 0
    buffer_load_dwordx4 v228, s[20:23], s47 offen offset:0  lds
    v_mfma_f32_16x16x32_bf16 v[112:115], a[16:19], a[40:43], 0
    v_mfma_f32_16x16x32_bf16 v[144:147], a[16:19], a[44:47], 0
    v_mfma_f32_16x16x32_bf16 v[176:179], a[16:19], a[48:51], 0
    v_mfma_f32_16x16x32_bf16 v[208:211], a[16:19], a[52:55], 0
    v_mfma_f32_16x16x32_bf16 v[52:55], a[20:23], a[32:35], 0
    s_add_u32 s49, s49, 64
    v_mfma_f32_16x16x32_bf16 v[84:87], a[20:23], a[36:39], 0
    buffer_load_dwordx4 v229, s[20:23], s47 offen offset:1024  lds
    v_mfma_f32_16x16x32_bf16 v[116:119], a[20:23], a[40:43], 0
    v_mfma_f32_16x16x32_bf16 v[148:151], a[20:23], a[44:47], 0
    v_mfma_f32_16x16x32_bf16 v[180:183], a[20:23], a[48:51], 0
    v_mfma_f32_16x16x32_bf16 v[212:215], a[20:23], a[52:55], 0
    v_mfma_f32_16x16x32_bf16 v[56:59], a[24:27], a[32:35], 0
    v_mfma_f32_16x16x32_bf16 v[88:91], a[24:27], a[36:39], 0
    s_and_b32 s49, s49, 0x3ff
    v_mfma_f32_16x16x32_bf16 v[120:123], a[24:27], a[40:43], 0
    buffer_load_dwordx4 v230, s[20:23], s47 offen offset:2048  lds
    v_mfma_f32_16x16x32_bf16 v[152:155], a[24:27], a[44:47], 0
    v_mfma_f32_16x16x32_bf16 v[184:187], a[24:27], a[48:51], 0
    v_mfma_f32_16x16x32_bf16 v[216:219], a[24:27], a[52:55], 0
    v_mfma_f32_16x16x32_bf16 v[60:63], a[28:31], a[32:35], 0
    v_mfma_f32_16x16x32_bf16 v[92:95], a[28:31], a[36:39], 0
    v_mfma_f32_16x16x32_bf16 v[124:127], a[28:31], a[40:43], 0
    v_mfma_f32_16x16x32_bf16 v[156:159], a[28:31], a[44:47], 0
    v_mfma_f32_16x16x32_bf16 v[188:191], a[28:31], a[48:51], 0
    v_mfma_f32_16x16x32_bf16 v[220:223], a[28:31], a[52:55], 0
    s_waitcnt lgkmcnt(0)
    s_waitcnt vmcnt(7)
    s_barrier
    v_mfma_f32_16x16x32_bf16 v[32:35], a[56:59], a[88:91], v[32:35]
    ds_read_b128 a[32:35], v22 offset:12288
    ds_read_b128 a[36:39], v22 offset:13312
    v_mfma_f32_16x16x32_bf16 v[64:67], a[56:59], a[92:95], v[64:67]
    s_add_u32 m0, s50, 0
    ds_read_b128 a[40:43], v22 offset:14336
    ds_read_b128 a[44:47], v22 offset:15360
    v_mfma_f32_16x16x32_bf16 v[96:99], a[56:59], a[96:99], v[96:99]
    s_add_u32 s47, s55, s52
    ds_read_b128 a[48:51], v22 offset:16384
    ds_read_b128 a[52:55], v22 offset:17408
    v_mfma_f32_16x16x32_bf16 v[128:131], a[56:59], a[100:103], v[128:131]
    buffer_load_dwordx4 v224, s[24:27], s47 offen offset:0  lds
    buffer_load_dwordx4 v225, s[24:27], s47 offen offset:1024  lds
    v_mfma_f32_16x16x32_bf16 v[160:163], a[56:59], a[104:107], v[160:163]
    ds_read_b64_tr_b16 a[0:1], v23 offset:16384
    ds_read_b64_tr_b16 a[2:3], v23 offset:18432
    v_mfma_f32_16x16x32_bf16 v[192:195], a[56:59], a[108:111], v[192:195]
    ds_read_b64_tr_b16 a[4:5], v23 offset:16392
    ds_read_b64_tr_b16 a[6:7], v23 offset:18440
    v_mfma_f32_16x16x32_bf16 v[36:39], a[60:63], a[88:91], v[36:39]
    v_mfma_f32_16x16x32_bf16 v[68:71], a[60:63], a[92:95], v[68:71]
    ds_read_b64_tr_b16 a[8:9], v24 offset:16384
    ds_read_b64_tr_b16 a[10:11], v24 offset:18432
    v_mfma_f32_16x16x32_bf16 v[100:103], a[60:63], a[96:99], v[100:103]
    v_mfma_f32_16x16x32_bf16 v[132:135], a[60:63], a[100:103], v[132:135]
    v_mfma_f32_16x16x32_bf16 v[164:167], a[60:63], a[104:107], v[164:167]
    ds_read_b64_tr_b16 a[12:13], v24 offset:16392
    ds_read_b64_tr_b16 a[14:15], v24 offset:18440
    v_mfma_f32_16x16x32_bf16 v[196:199], a[60:63], a[108:111], v[196:199]
    v_mfma_f32_16x16x32_bf16 v[40:43], a[64:67], a[88:91], v[40:43]
    s_add_u32 s55, s55, 0x40000
    ds_read_b64_tr_b16 a[16:17], v25 offset:16384
    ds_read_b64_tr_b16 a[18:19], v25 offset:18432
    v_mfma_f32_16x16x32_bf16 v[72:75], a[64:67], a[92:95], v[72:75]
    buffer_load_dwordx4 v226, s[24:27], s47 offen offset:2048  lds
    v_mfma_f32_16x16x32_bf16 v[104:107], a[64:67], a[96:99], v[104:107]
    ds_read_b64_tr_b16 a[20:21], v25 offset:16392
    ds_read_b64_tr_b16 a[22:23], v25 offset:18440
    v_mfma_f32_16x16x32_bf16 v[136:139], a[64:67], a[100:103], v[136:139]
    v_mfma_f32_16x16x32_bf16 v[168:171], a[64:67], a[104:107], v[168:171]
    ds_read_b64_tr_b16 a[24:25], v26 offset:16384
    ds_read_b64_tr_b16 a[26:27], v26 offset:18432
    v_mfma_f32_16x16x32_bf16 v[200:203], a[64:67], a[108:111], v[200:203]
    v_mfma_f32_16x16x32_bf16 v[44:47], a[68:71], a[88:91], v[44:47]
    s_and_b32 s55, s55, 0x3fffff
    ds_read_b64_tr_b16 a[28:29], v26 offset:16392
    ds_read_b64_tr_b16 a[30:31], v26 offset:18440
    v_mfma_f32_16x16x32_bf16 v[76:79], a[68:71], a[92:95], v[76:79]
    buffer_load_dwordx4 v227, s[24:27], s47 offen offset:3072  lds
    v_mfma_f32_16x16x32_bf16 v[108:111], a[68:71], a[96:99], v[108:111]
    v_mfma_f32_16x16x32_bf16 v[140:143], a[68:71], a[100:103], v[140:143]
    v_mfma_f32_16x16x32_bf16 v[172:175], a[68:71], a[104:107], v[172:175]
    v_mfma_f32_16x16x32_bf16 v[204:207], a[68:71], a[108:111], v[204:207]
    s_add_u32 m0, s51, 0
    v_mfma_f32_16x16x32_bf16 v[48:51], a[72:75], a[88:91], v[48:51]
    s_add_u32 s47, s49, s53
    v_mfma_f32_16x16x32_bf16 v[80:83], a[72:75], a[92:95], v[80:83]
    buffer_load_dwordx4 v228, s[20:23], s47 offen offset:0  lds
    v_mfma_f32_16x16x32_bf16 v[112:115], a[72:75], a[96:99], v[112:115]
    v_mfma_f32_16x16x32_bf16 v[144:147], a[72:75], a[100:103], v[144:147]
    v_mfma_f32_16x16x32_bf16 v[176:179], a[72:75], a[104:107], v[176:179]
    v_mfma_f32_16x16x32_bf16 v[208:211], a[72:75], a[108:111], v[208:211]
    v_mfma_f32_16x16x32_bf16 v[52:55], a[76:79], a[88:91], v[52:55]
    s_add_u32 s49, s49, 64
    v_mfma_f32_16x16x32_bf16 v[84:87], a[76:79], a[92:95], v[84:87]
    buffer_load_dwordx4 v229, s[20:23], s47 offen offset:1024  lds
    v_mfma_f32_16x16x32_bf16 v[116:119], a[76:79], a[96:99], v[116:119]
    v_mfma_f32_16x16x32_bf16 v[148:151], a[76:79], a[100:103], v[148:151]
    v_mfma_f32_16x16x32_bf16 v[180:183], a[76:79], a[104:107], v[180:183]
    v_mfma_f32_16x16x32_bf16 v[212:215], a[76:79], a[108:111], v[212:215]
    v_mfma_f32_16x16x32_bf16 v[56:59], a[80:83], a[88:91], v[56:59]
    v_mfma_f32_16x16x32_bf16 v[88:91], a[80:83], a[92:95], v[88:91]
    s_and_b32 s49, s49, 0x3ff
    v_mfma_f32_16x16x32_bf16 v[120:123], a[80:83], a[96:99], v[120:123]
    buffer_load_dwordx4 v230, s[20:23], s47 offen offset:2048  lds
    v_mfma_f32_16x16x32_bf16 v[152:155], a[80:83], a[100:103], v[152:155]
    v_mfma_f32_16x16x32_bf16 v[184:187], a[80:83], a[104:107], v[184:187]
    v_mfma_f32_16x16x32_bf16 v[216:219], a[80:83], a[108:111], v[216:219]
    v_mfma_f32_16x16x32_bf16 v[60:63], a[84:87], a[88:91], v[60:63]
    v_mfma_f32_16x16x32_bf16 v[92:95], a[84:87], a[92:95], v[92:95]
    v_mfma_f32_16x16x32_bf16 v[124:127], a[84:87], a[96:99], v[124:127]
    v_mfma_f32_16x16x32_bf16 v[156:159], a[84:87], a[100:103], v[156:159]
    v_mfma_f32_16x16x32_bf16 v[188:191], a[84:87], a[104:107], v[188:191]
    v_mfma_f32_16x16x32_bf16 v[220:223], a[84:87], a[108:111], v[220:223]
    s_waitcnt lgkmcnt(0)
    s_waitcnt vmcnt(7)
    s_barrier
    v_mfma_f32_16x16x32_bf16 v[32:35], a[0:3], a[32:35], v[32:35]
    ds_read_b128 a[88:91], v22 offset:24576
    ds_read_b128 a[92:95], v22 offset:25600
    v_mfma_f32_16x16x32_bf16 v[64:67], a[0:3], a[36:39], v[64:67]
    s_add_u32 m0, s50, 16384
    ds_read_b128 a[96:99], v22 offset:26624
    ds_read_b128 a[100:103], v22 offset:27648
    v_mfma_f32_16x16x32_bf16 v[96:99], a[0:3], a[40:43], v[96:99]
    s_add_u32 s47, s55, s52
    ds_read_b128 a[104:107], v22 offset:28672
    ds_read_b128 a[108:111], v22 offset:29696
    v_mfma_f32_16x16x32_bf16 v[128:131], a[0:3], a[44:47], v[128:131]
    buffer_load_dwordx4 v224, s[24:27], s47 offen offset:0  lds
    buffer_load_dwordx4 v225, s[24:27], s47 offen offset:1024  lds
    v_mfma_f32_16x16x32_bf16 v[160:163], a[0:3], a[48:51], v[160:163]
    ds_read_b64_tr_b16 a[56:57], v23 offset:32768
    ds_read_b64_tr_b16 a[58:59], v23 offset:34816
    v_mfma_f32_16x16x32_bf16 v[192:195], a[0:3], a[52:55], v[192:195]
    ds_read_b64_tr_b16 a[60:61], v23 offset:32776
    ds_read_b64_tr_b16 a[62:63], v23 offset:34824
    v_mfma_f32_16x16x32_bf16 v[36:39], a[4:7], a[32:35], v[36:39]
    v_mfma_f32_16x16x32_bf16 v[68:71], a[4:7], a[36:39], v[68:71]
    ds_read_b64_tr_b16 a[64:65], v24 offset:32768
    ds_read_b64_tr_b16 a[66:67], v24 offset:34816
    v_mfma_f32_16x16x32_bf16 v[100:103], a[4:7], a[40:43], v[100:103]
    v_mfma_f32_16x16x32_bf16 v[132:135], a[4:7], a[44:47], v[132:135]
    v_mfma_f32_16x16x32_bf16 v[164:167], a[4:7], a[48:51], v[164:167]
    s_add_u32 s55, s55, 0x40000
    ds_read_b64_tr_b16 a[68:69], v24 offset:32776
    ds_read_b64_tr_b16 a[70:71], v24 offset:34824
    v_mfma_f32_16x16x32_bf16 v[196:199], a[4:7], a[52:55], v[196:199]
    buffer_load_dwordx4 v226, s[24:27], s47 offen offset:2048  lds
    v_mfma_f32_16x16x32_bf16 v[40:43], a[8:11], a[32:35], v[40:43]
    ds_read_b64_tr_b16 a[72:73], v25 offset:32768
    ds_read_b64_tr_b16 a[74:75], v25 offset:34816
    v_mfma_f32_16x16x32_bf16 v[72:75], a[8:11], a[36:39], v[72:75]
    v_mfma_f32_16x16x32_bf16 v[104:107], a[8:11], a[40:43], v[104:107]
    s_and_b32 s55, s55, 0x3fffff
    ds_read_b64_tr_b16 a[76:77], v25 offset:32776
    ds_read_b64_tr_b16 a[78:79], v25 offset:34824
    v_mfma_f32_16x16x32_bf16 v[136:139], a[8:11], a[44:47], v[136:139]
    buffer_load_dwordx4 v227, s[24:27], s47 offen offset:3072  lds
    v_mfma_f32_16x16x32_bf16 v[168:171], a[8:11], a[48:51], v[168:171]
    ds_read_b64_tr_b16 a[80:81], v26 offset:32768
    ds_read_b64_tr_b16 a[82:83], v26 offset:34816
    v_mfma_f32_16x16x32_bf16 v[200:203], a[8:11], a[52:55], v[200:203]
    v_mfma_f32_16x16x32_bf16 v[44:47], a[12:15], a[32:35], v[44:47]
    s_add_u32 m0, s51, 12288
    ds_read_b64_tr_b16 a[84:85], v26 offset:32776
    ds_read_b64_tr_b16 a[86:87], v26 offset:34824
    v_mfma_f32_16x16x32_bf16 v[76:79], a[12:15], a[36:39], v[76:79]
    s_add_u32 s47, s49, s53
    v_mfma_f32_16x16x32_bf16 v[108:111], a[12:15], a[40:43], v[108:111]
    buffer_load_dwordx4 v228, s[20:23], s47 offen offset:0  lds
    v_mfma_f32_16x16x32_bf16 v[140:143], a[12:15], a[44:47], v[140:143]
    v_mfma_f32_16x16x32_bf16 v[172:175], a[12:15], a[48:51], v[172:175]
    v_mfma_f32_16x16x32_bf16 v[204:207], a[12:15], a[52:55], v[204:207]
    v_mfma_f32_16x16x32_bf16 v[48:51], a[16:19], a[32:35], v[48:51]
    s_add_u32 s49, s49, 64
    v_mfma_f32_16x16x32_bf16 v[80:83], a[16:19], a[36:39], v[80:83]
    buffer_load_dwordx4 v229, s[20:23], s47 offen offset:1024  lds
    v_mfma_f32_16x16x32_bf16 v[112:115], a[16:19], a[40:43], v[112:115]
    v_mfma_f32_16x16x32_bf16 v[144:147], a[16:19], a[44:47], v[144:147]
    v_mfma_f32_16x16x32_bf16 v[176:179], a[16:19], a[48:51], v[176:179]
    v_mfma_f32_16x16x32_bf16 v[208:211], a[16:19], a[52:55], v[208:211]
    s_and_b32 s49, s49, 0x3ff
    v_mfma_f32_16x16x32_bf16 v[52:55], a[20:23], a[32:35], v[52:55]
    buffer_load_dwordx4 v230, s[20:23], s47 offen offset:2048  lds
    v_mfma_f32_16x16x32_bf16 v[84:87], a[20:23], a[36:39], v[84:87]
    v_mfma_f32_16x16x32_bf16 v[116:119], a[20:23], a[40:43], v[116:119]
    v_mfma_f32_16x16x32_bf16 v[148:151], a[20:23], a[44:47], v[148:151]
    s_add_u32 m0, s38, 0
    v_mfma_f32_16x16x32_bf16 v[180:183], a[20:23], a[48:51], v[180:183]
    s_add_u32 s46, s39, 0
    v_mfma_f32_16x16x32_bf16 v[212:215], a[20:23], a[52:55], v[212:215]
    buffer_load_dwordx4 v6, s[16:19], s46 offen offset:0 nt lds
    buffer_load_dwordx4 v7, s[16:19], s46 offen offset:1056 nt lds
    v_mfma_f32_16x16x32_bf16 v[56:59], a[24:27], a[32:35], v[56:59]
    v_mfma_f32_16x16x32_bf16 v[88:91], a[24:27], a[36:39], v[88:91]
    v_mfma_f32_16x16x32_bf16 v[120:123], a[24:27], a[40:43], v[120:123]
    v_mfma_f32_16x16x32_bf16 v[152:155], a[24:27], a[44:47], v[152:155]
    v_mfma_f32_16x16x32_bf16 v[184:187], a[24:27], a[48:51], v[184:187]
    v_mfma_f32_16x16x32_bf16 v[216:219], a[24:27], a[52:55], v[216:219]
    v_mfma_f32_16x16x32_bf16 v[60:63], a[28:31], a[32:35], v[60:63]
    v_mfma_f32_16x16x32_bf16 v[92:95], a[28:31], a[36:39], v[92:95]
    v_mfma_f32_16x16x32_bf16 v[124:127], a[28:31], a[40:43], v[124:127]
    v_mfma_f32_16x16x32_bf16 v[156:159], a[28:31], a[44:47], v[156:159]
    v_mfma_f32_16x16x32_bf16 v[188:191], a[28:31], a[48:51], v[188:191]
    v_mfma_f32_16x16x32_bf16 v[220:223], a[28:31], a[52:55], v[220:223]
    s_waitcnt lgkmcnt(0)
    s_waitcnt vmcnt(9)
    s_barrier
    v_mfma_f32_16x16x32_bf16 v[32:35], a[56:59], a[88:91], v[32:35]
    ds_read_b128 a[32:35], v22 offset:0
    ds_read_b128 a[36:39], v22 offset:1024
    v_mfma_f32_16x16x32_bf16 v[64:67], a[56:59], a[92:95], v[64:67]
    s_add_u32 m0, s50, 32768
    ds_read_b128 a[40:43], v22 offset:2048
    ds_read_b128 a[44:47], v22 offset:3072
    v_mfma_f32_16x16x32_bf16 v[96:99], a[56:59], a[96:99], v[96:99]
    s_add_u32 s47, s55, s52
    ds_read_b128 a[48:51], v22 offset:4096
    ds_read_b128 a[52:55], v22 offset:5120
    v_mfma_f32_16x16x32_bf16 v[128:131], a[56:59], a[100:103], v[128:131]
    buffer_load_dwordx4 v224, s[24:27], s47 offen offset:0  lds
    buffer_load_dwordx4 v225, s[24:27], s47 offen offset:1024  lds
    v_mfma_f32_16x16x32_bf16 v[160:163], a[56:59], a[104:107], v[160:163]
    ds_read_b64_tr_b16 a[0:1], v23 offset:0
    ds_read_b64_tr_b16 a[2:3], v23 offset:2048
    v_mfma_f32_16x16x32_bf16 v[192:195], a[56:59], a[108:111], v[192:195]
    ds_read_b64_tr_b16 a[4:5], v23 offset:8
    ds_read_b64_tr_b16 a[6:7], v23 offset:2056
    v_mfma_f32_16x16x32_bf16 v[36:39], a[60:63], a[88:91], v[36:39]
    v_mfma_f32_16x16x32_bf16 v[68:71], a[60:63], a[92:95], v[68:71]
    ds_read_b64_tr_b16 a[8:9], v24 offset:0
    ds_read_b64_tr_b16 a[10:11], v24 offset:2048
    v_mfma_f32_16x16x32_bf16 v[100:103], a[60:63], a[96:99], v[100:103]
    v_mfma_f32_16x16x32_bf16 v[132:135], a[60:63], a[100:103], v[132:135]
    v_mfma_f32_16x16x32_bf16 v[164:167], a[60:63], a[104:107], v[164:167]
    s_add_u32 s55, s55, 0x40000
    ds_read_b64_tr_b16 a[12:13], v24 offset:8
    ds_read_b64_tr_b16 a[14:15], v24 offset:2056
    v_mfma_f32_16x16x32_bf16 v[196:199], a[60:63], a[108:111], v[196:199]
    buffer_load_dwordx4 v226, s[24:27], s47 offen offset:2048  lds
    v_mfma_f32_16x16x32_bf16 v[40:43], a[64:67], a[88:91], v[40:43]
    ds_read_b64_tr_b16 a[16:17], v25 offset:0
    ds_read_b64_tr_b16 a[18:19], v25 offset:2048
    v_mfma_f32_16x16x32_bf16 v[72:75], a[64:67], a[92:95], v[72:75]
    v_mfma_f32_16x16x32_bf16 v[104:107], a[64:67], a[96:99], v[104:107]
    s_and_b32 s55, s55, 0x3fffff
    ds_read_b64_tr_b16 a[20:21], v25 offset:8
    ds_read_b64_tr_b16 a[22:23], v25 offset:2056
    v_mfma_f32_16x16x32_bf16 v[136:139], a[64:67], a[100:103], v[136:139]
    buffer_load_dwordx4 v227, s[24:27], s47 offen offset:3072  lds
    v_mfma_f32_16x16x32_bf16 v[168:171], a[64:67], a[104:107], v[168:171]
    ds_read_b64_tr_b16 a[24:25], v26 offset:0
    ds_read_b64_tr_b16 a[26:27], v26 offset:2048
    v_mfma_f32_16x16x32_bf16 v[200:203], a[64:67], a[108:111], v[200:203]
    v_mfma_f32_16x16x32_bf16 v[44:47], a[68:71], a[88:91], v[44:47]
    s_add_u32 m0, s51, 24576
    ds_read_b64_tr_b16 a[28:29], v26 offset:8
    ds_read_b64_tr_b16 a[30:31], v26 offset:2056
    v_mfma_f32_16x16x32_bf16 v[76:79], a[68:71], a[92:95], v[76:79]
    s_add_u32 s47, s49, s53
    v_mfma_f32_16x16x32_bf16 v[108:111], a[68:71], a[96:99], v[108:111]
    buffer_load_dwordx4 v228, s[20:23], s47 offen offset:0  lds
    v_mfma_f32_16x16x32_bf16 v[140:143], a[68:71], a[100:103], v[140:143]
    v_mfma_f32_16x16x32_bf16 v[172:175], a[68:71], a[104:107], v[172:175]
    v_mfma_f32_16x16x32_bf16 v[204:207], a[68:71], a[108:111], v[204:207]
    v_mfma_f32_16x16x32_bf16 v[48:51], a[72:75], a[88:91], v[48:51]
    s_add_u32 s49, s49, 64
    v_mfma_f32_16x16x32_bf16 v[80:83], a[72:75], a[92:95], v[80:83]
    buffer_load_dwordx4 v229, s[20:23], s47 offen offset:1024  lds
    v_mfma_f32_16x16x32_bf16 v[112:115], a[72:75], a[96:99], v[112:115]
    v_mfma_f32_16x16x32_bf16 v[144:147], a[72:75], a[100:103], v[144:147]
    v_mfma_f32_16x16x32_bf16 v[176:179], a[72:75], a[104:107], v[176:179]
    v_mfma_f32_16x16x32_bf16 v[208:211], a[72:75], a[108:111], v[208:211]
    s_and_b32 s49, s49, 0x3ff
    v_mfma_f32_16x16x32_bf16 v[52:55], a[76:79], a[88:91], v[52:55]
    buffer_load_dwordx4 v230, s[20:23], s47 offen offset:2048  lds
    v_mfma_f32_16x16x32_bf16 v[84:87], a[76:79], a[92:95], v[84:87]
    v_mfma_f32_16x16x32_bf16 v[116:119], a[76:79], a[96:99], v[116:119]
    v_mfma_f32_16x16x32_bf16 v[148:151], a[76:79], a[100:103], v[148:151]
    s_add_u32 m0, s38, 33792
    v_mfma_f32_16x16x32_bf16 v[180:183], a[76:79], a[104:107], v[180:183]
    s_add_u32 s46, s39, 8192
    v_mfma_f32_16x16x32_bf16 v[212:215], a[76:79], a[108:111], v[212:215]
    buffer_load_dwordx4 v6, s[16:19], s46 offen offset:0 nt lds
    buffer_load_dwordx4 v7, s[16:19], s46 offen offset:1056 nt lds
    v_mfma_f32_16x16x32_bf16 v[56:59], a[80:83], a[88:91], v[56:59]
    v_mfma_f32_16x16x32_bf16 v[88:91], a[80:83], a[92:95], v[88:91]
    v_mfma_f32_16x16x32_bf16 v[120:123], a[80:83], a[96:99], v[120:123]
    v_mfma_f32_16x16x32_bf16 v[152:155], a[80:83], a[100:103], v[152:155]
    v_mfma_f32_16x16x32_bf16 v[184:187], a[80:83], a[104:107], v[184:187]
    v_mfma_f32_16x16x32_bf16 v[216:219], a[80:83], a[108:111], v[216:219]
    v_mfma_f32_16x16x32_bf16 v[60:63], a[84:87], a[88:91], v[60:63]
    v_mfma_f32_16x16x32_bf16 v[92:95], a[84:87], a[92:95], v[92:95]
    v_mfma_f32_16x16x32_bf16 v[124:127], a[84:87], a[96:99], v[124:127]
    v_mfma_f32_16x16x32_bf16 v[156:159], a[84:87], a[100:103], v[156:159]
    v_mfma_f32_16x16x32_bf16 v[188:191], a[84:87], a[104:107], v[188:191]
    v_mfma_f32_16x16x32_bf16 v[220:223], a[84:87], a[108:111], v[220:223]
    s_waitcnt lgkmcnt(0)
    s_waitcnt vmcnt(11)
    s_barrier
    v_mfma_f32_16x16x32_bf16 v[32:35], a[0:3], a[32:35], v[32:35]
    ds_read_b128 a[88:91], v22 offset:12288
    ds_read_b128 a[92:95], v22 offset:13312
    v_mfma_f32_16x16x32_bf16 v[64:67], a[0:3], a[36:39], v[64:67]
    s_add_u32 m0, s50, 0
    ds_read_b128 a[96:99], v22 offset:14336
    ds_read_b128 a[100:103], v22 offset:15360
    v_mfma_f32_16x16x32_bf16 v[96:99], a[0:3], a[40:43], v[96:99]
    s_add_u32 s47, s55, s52
    ds_read_b128 a[104:107], v22 offset:16384
    ds_read_b128 a[108:111], v22 offset:17408
    v_mfma_f32_16x16x32_bf16 v[128:131], a[0:3], a[44:47], v[128:131]
    buffer_load_dwordx4 v224, s[24:27], s47 offen offset:0  lds
    buffer_load_dwordx4 v225, s[24:27], s47 offen offset:1024  lds
    v_mfma_f32_16x16x32_bf16 v[160:163], a[0:3], a[48:51], v[160:163]
    ds_read_b64_tr_b16 a[56:57], v23 offset:16384
    ds_read_b64_tr_b16 a[58:59], v23 offset:18432
    v_mfma_f32_16x16x32_bf16 v[192:195], a[0:3], a[52:55], v[192:195]
    ds_read_b64_tr_b16 a[60:61], v23 offset:16392
    ds_read_b64_tr_b16 a[62:63], v23 offset:18440
    v_mfma_f32_16x16x32_bf16 v[36:39], a[4:7], a[32:35], v[36:39]
    v_mfma_f32_16x16x32_bf16 v[68:71], a[4:7], a[36:39], v[68:71]
    ds_read_b64_tr_b16 a[64:65], v24 offset:16384
    ds_read_b64_tr_b16 a[66:67], v24 offset:18432
    v_mfma_f32_16x16x32_bf16 v[100:103], a[4:7], a[40:43], v[100:103]
    v_mfma_f32_16x16x32_bf16 v[132:135], a[4:7], a[44:47], v[132:135]
    v_mfma_f32_16x16x32_bf16 v[164:167], a[4:7], a[48:51], v[164:167]
    ds_read_b64_tr_b16 a[68:69], v24 offset:16392
    ds_read_b64_tr_b16 a[70:71], v24 offset:18440
    v_mfma_f32_16x16x32_bf16 v[196:199], a[4:7], a[52:55], v[196:199]
    v_mfma_f32_16x16x32_bf16 v[40:43], a[8:11], a[32:35], v[40:43]
    s_add_u32 s55, s55, 0x40000
    ds_read_b64_tr_b16 a[72:73], v25 offset:16384
    ds_read_b64_tr_b16 a[74:75], v25 offset:18432
    v_mfma_f32_16x16x32_bf16 v[72:75], a[8:11], a[36:39], v[72:75]
    buffer_load_dwordx4 v226, s[24:27], s47 offen offset:2048  lds
    v_mfma_f32_16x16x32_bf16 v[104:107], a[8:11], a[40:43], v[104:107]
    ds_read_b64_tr_b16 a[76:77], v25 offset:16392
    ds_read_b64_tr_b16 a[78:79], v25 offset:18440
    v_mfma_f32_16x16x32_bf16 v[136:139], a[8:11], a[44:47], v[136:139]
    v_mfma_f32_16x16x32_bf16 v[168:171], a[8:11], a[48:51], v[168:171]
    ds_read_b64_tr_b16 a[80:81], v26 offset:16384
    ds_read_b64_tr_b16 a[82:83], v26 offset:18432
    v_mfma_f32_16x16x32_bf16 v[200:203], a[8:11], a[52:55], v[200:203]
    v_mfma_f32_16x16x32_bf16 v[44:47], a[12:15], a[32:35], v[44:47]
    s_and_b32 s55, s55, 0x3fffff
    ds_read_b64_tr_b16 a[84:85], v26 offset:16392
    ds_read_b64_tr_b16 a[86:87], v26 offset:18440
    v_mfma_f32_16x16x32_bf16 v[76:79], a[12:15], a[36:39], v[76:79]
    buffer_load_dwordx4 v227, s[24:27], s47 offen offset:3072  lds
    v_mfma_f32_16x16x32_bf16 v[108:111], a[12:15], a[40:43], v[108:111]
    v_mfma_f32_16x16x32_bf16 v[140:143], a[12:15], a[44:47], v[140:143]
    v_mfma_f32_16x16x32_bf16 v[172:175], a[12:15], a[48:51], v[172:175]
    v_mfma_f32_16x16x32_bf16 v[204:207], a[12:15], a[52:55], v[204:207]
    s_add_u32 m0, s51, 0
    v_mfma_f32_16x16x32_bf16 v[48:51], a[16:19], a[32:35], v[48:51]
    s_add_u32 s47, s49, s53
    v_mfma_f32_16x16x32_bf16 v[80:83], a[16:19], a[36:39], v[80:83]
    buffer_load_dwordx4 v228, s[20:23], s47 offen offset:0  lds
    v_mfma_f32_16x16x32_bf16 v[112:115], a[16:19], a[40:43], v[112:115]
    v_mfma_f32_16x16x32_bf16 v[144:147], a[16:19], a[44:47], v[144:147]
    v_mfma_f32_16x16x32_bf16 v[176:179], a[16:19], a[48:51], v[176:179]
    v_mfma_f32_16x16x32_bf16 v[208:211], a[16:19], a[52:55], v[208:211]
    v_mfma_f32_16x16x32_bf16 v[52:55], a[20:23], a[32:35], v[52:55]
    s_add_u32 s49, s49, 64
    v_mfma_f32_16x16x32_bf16 v[84:87], a[20:23], a[36:39], v[84:87]
    buffer_load_dwordx4 v229, s[20:23], s47 offen offset:1024  lds
    v_mfma_f32_16x16x32_bf16 v[116:119], a[20:23], a[40:43], v[116:119]
    v_mfma_f32_16x16x32_bf16 v[148:151], a[20:23], a[44:47], v[148:151]
    v_mfma_f32_16x16x32_bf16 v[180:183], a[20:23], a[48:51], v[180:183]
    v_mfma_f32_16x16x32_bf16 v[212:215], a[20:23], a[52:55], v[212:215]
    v_mfma_f32_16x16x32_bf16 v[56:59], a[24:27], a[32:35], v[56:59]
    v_mfma_f32_16x16x32_bf16 v[88:91], a[24:27], a[36:39], v[88:91]
    s_and_b32 s49, s49, 0x3ff
    v_mfma_f32_16x16x32_bf16 v[120:123], a[24:27], a[40:43], v[120:123]
    buffer_load_dwordx4 v230, s[20:23], s47 offen offset:2048  lds
    v_mfma_f32_16x16x32_bf16 v[152:155], a[24:27], a[44:47], v[152:155]
    v_mfma_f32_16x16x32_bf16 v[184:187], a[24:27], a[48:51], v[184:187]
    v_mfma_f32_16x16x32_bf16 v[216:219], a[24:27], a[52:55], v[216:219]
    v_mfma_f32_16x16x32_bf16 v[60:63], a[28:31], a[32:35], v[60:63]
    v_mfma_f32_16x16x32_bf16 v[92:95], a[28:31], a[36:39], v[92:95]
    v_mfma_f32_16x16x32_bf16 v[124:127], a[28:31], a[40:43], v[124:127]
    v_mfma_f32_16x16x32_bf16 v[156:159], a[28:31], a[44:47], v[156:159]
    v_mfma_f32_16x16x32_bf16 v[188:191], a[28:31], a[48:51], v[188:191]
    v_mfma_f32_16x16x32_bf16 v[220:223], a[28:31], a[52:55], v[220:223]
    s_waitcnt lgkmcnt(0)
    s_waitcnt vmcnt(9)
    s_barrier
    v_mfma_f32_16x16x32_bf16 v[32:35], a[56:59], a[88:91], v[32:35]
    ds_read_b128 a[32:35], v22 offset:24576
    ds_read_b128 a[36:39], v22 offset:25600
    v_mfma_f32_16x16x32_bf16 v[64:67], a[56:59], a[92:95], v[64:67]
    s_add_u32 m0, s50, 16384
    ds_read_b128 a[40:43], v22 offset:26624
    ds_read_b128 a[44:47], v22 offset:27648
    v_mfma_f32_16x16x32_bf16 v[96:99], a[56:59], a[96:99], v[96:99]
    s_add_u32 s47, s55, s52
    ds_read_b128 a[48:51], v22 offset:28672
    ds_read_b128 a[52:55], v22 offset:29696
    v_mfma_f32_16x16x32_bf16 v[128:131], a[56:59], a[100:103], v[128:131]
    buffer_load_dwordx4 v224, s[24:27], s47 offen offset:0  lds
    buffer_load_dwordx4 v225, s[24:27], s47 offen offset:1024  lds
    v_mfma_f32_16x16x32_bf16 v[160:163], a[56:59], a[104:107], v[160:163]
    ds_read_b64_tr_b16 a[0:1], v23 offset:32768
    ds_read_b64_tr_b16 a[2:3], v23 offset:34816
    v_mfma_f32_16x16x32_bf16 v[192:195], a[56:59], a[108:111], v[192:195]
    ds_read_b64_tr_b16 a[4:5], v23 offset:32776
    ds_read_b64_tr_b16 a[6:7], v23 offset:34824
    v_mfma_f32_16x16x32_bf16 v[36:39], a[60:63], a[88:91], v[36:39]
    v_mfma_f32_16x16x32_bf16 v[68:71], a[60:63], a[92:95], v[68:71]
    ds_read_b64_tr_b16 a[8:9], v24 offset:32768
    ds_read_b64_tr_b16 a[10:11], v24 offset:34816
    v_mfma_f32_16x16x32_bf16 v[100:103], a[60:63], a[96:99], v[100:103]
    v_mfma_f32_16x16x32_bf16 v[132:135], a[60:63], a[100:103], v[132:135]
    v_mfma_f32_16x16x32_bf16 v[164:167], a[60:63], a[104:107], v[164:167]
    s_add_u32 s55, s55, 0x40000
    ds_read_b64_tr_b16 a[12:13], v24 offset:32776
    ds_read_b64_tr_b16 a[14:15], v24 offset:34824
    v_mfma_f32_16x16x32_bf16 v[196:199], a[60:63], a[108:111], v[196:199]
    buffer_load_dwordx4 v226, s[24:27], s47 offen offset:2048  lds
    v_mfma_f32_16x16x32_bf16 v[40:43], a[64:67], a[88:91], v[40:43]
    ds_read_b64_tr_b16 a[16:17], v25 offset:32768
    ds_read_b64_tr_b16 a[18:19], v25 offset:34816
    v_mfma_f32_16x16x32_bf16 v[72:75], a[64:67], a[92:95], v[72:75]
    v_mfma_f32_16x16x32_bf16 v[104:107], a[64:67], a[96:99], v[104:107]
    s_and_b32 s55, s55, 0x3fffff
    ds_read_b64_tr_b16 a[20:21], v25 offset:32776
    ds_read_b64_tr_b16 a[22:23], v25 offset:34824
    v_mfma_f32_16x16x32_bf16 v[136:139], a[64:67], a[100:103], v[136:139]
    buffer_load_dwordx4 v227, s[24:27], s47 offen offset:3072  lds
    v_mfma_f32_16x16x32_bf16 v[168:171], a[64:67], a[104:107], v[168:171]
    ds_read_b64_tr_b16 a[24:25], v26 offset:32768
    ds_read_b64_tr_b16 a[26:27], v26 offset:34816
    v_mfma_f32_16x16x32_bf16 v[200:203], a[64:67], a[108:111], v[200:203]
    v_mfma_f32_16x16x32_bf16 v[44:47], a[68:71], a[88:91], v[44:47]
    s_add_u32 m0, s51, 12288
    ds_read_b64_tr_b16 a[28:29], v26 offset:32776
    ds_read_b64_tr_b16 a[30:31], v26 offset:34824
    v_mfma_f32_16x16x32_bf16 v[76:79], a[68:71], a[92:95], v[76:79]
    s_add_u32 s47, s49, s53
    v_mfma_f32_16x16x32_bf16 v[108:111], a[68:71], a[96:99], v[108:111]
    buffer_load_dwordx4 v228, s[20:23], s47 offen offset:0  lds
    v_mfma_f32_16x16x32_bf16 v[140:143], a[68:71], a[100:103], v[140:143]
    v_mfma_f32_16x16x32_bf16 v[172:175], a[68:71], a[104:107], v[172:175]
    v_mfma_f32_16x16x32_bf16 v[204:207], a[68:71], a[108:111], v[204:207]
    v_mfma_f32_16x16x32_bf16 v[48:51], a[72:75], a[88:91], v[48:51]
    s_add_u32 s49, s49, 64
    v_mfma_f32_16x16x32_bf16 v[80:83], a[72:75], a[92:95], v[80:83]
    buffer_load_dwordx4 v229, s[20:23], s47 offen offset:1024  lds
    v_mfma_f32_16x16x32_bf16 v[112:115], a[72:75], a[96:99], v[112:115]
    v_mfma_f32_16x16x32_bf16 v[144:147], a[72:75], a[100:103], v[144:147]
    v_mfma_f32_16x16x32_bf16 v[176:179], a[72:75], a[104:107], v[176:179]
    v_mfma_f32_16x16x32_bf16 v[208:211], a[72:75], a[108:111], v[208:211]
    s_and_b32 s49, s49, 0x3ff
    v_mfma_f32_16x16x32_bf16 v[52:55], a[76:79], a[88:91], v[52:55]
    buffer_load_dwordx4 v230, s[20:23], s47 offen offset:2048  lds
    v_mfma_f32_16x16x32_bf16 v[84:87], a[76:79], a[92:95], v[84:87]
    v_mfma_f32_16x16x32_bf16 v[116:119], a[76:79], a[96:99], v[116:119]
    v_mfma_f32_16x16x32_bf16 v[148:151], a[76:79], a[100:103], v[148:151]
    s_add_u32 m0, s38, 16896
    v_mfma_f32_16x16x32_bf16 v[180:183], a[76:79], a[104:107], v[180:183]
    s_add_u32 s46, s39, 262144
    v_mfma_f32_16x16x32_bf16 v[212:215], a[76:79], a[108:111], v[212:215]
    buffer_load_dwordx4 v6, s[16:19], s46 offen offset:0 nt lds
    buffer_load_dwordx4 v7, s[16:19], s46 offen offset:1056 nt lds
    v_mfma_f32_16x16x32_bf16 v[56:59], a[80:83], a[88:91], v[56:59]
    v_mfma_f32_16x16x32_bf16 v[88:91], a[80:83], a[92:95], v[88:91]
    v_mfma_f32_16x16x32_bf16 v[120:123], a[80:83], a[96:99], v[120:123]
    v_mfma_f32_16x16x32_bf16 v[152:155], a[80:83], a[100:103], v[152:155]
    v_mfma_f32_16x16x32_bf16 v[184:187], a[80:83], a[104:107], v[184:187]
    v_mfma_f32_16x16x32_bf16 v[216:219], a[80:83], a[108:111], v[216:219]
    v_mfma_f32_16x16x32_bf16 v[60:63], a[84:87], a[88:91], v[60:63]
    v_mfma_f32_16x16x32_bf16 v[92:95], a[84:87], a[92:95], v[92:95]
    v_mfma_f32_16x16x32_bf16 v[124:127], a[84:87], a[96:99], v[124:127]
    v_mfma_f32_16x16x32_bf16 v[156:159], a[84:87], a[100:103], v[156:159]
    v_mfma_f32_16x16x32_bf16 v[188:191], a[84:87], a[104:107], v[188:191]
    v_mfma_f32_16x16x32_bf16 v[220:223], a[84:87], a[108:111], v[220:223]
    s_waitcnt lgkmcnt(0)
    s_waitcnt vmcnt(9)
    s_barrier
    v_mfma_f32_16x16x32_bf16 v[32:35], a[0:3], a[32:35], v[32:35]
    ds_read_b128 a[88:91], v22 offset:0
    ds_read_b128 a[92:95], v22 offset:1024
    v_mfma_f32_16x16x32_bf16 v[64:67], a[0:3], a[36:39], v[64:67]
    s_add_u32 m0, s50, 32768
    ds_read_b128 a[96:99], v22 offset:2048
    ds_read_b128 a[100:103], v22 offset:3072
    v_mfma_f32_16x16x32_bf16 v[96:99], a[0:3], a[40:43], v[96:99]
    s_add_u32 s47, s55, s52
    ds_read_b128 a[104:107], v22 offset:4096
    ds_read_b128 a[108:111], v22 offset:5120
    v_mfma_f32_16x16x32_bf16 v[128:131], a[0:3], a[44:47], v[128:131]
    buffer_load_dwordx4 v224, s[24:27], s47 offen offset:0  lds
    buffer_load_dwordx4 v225, s[24:27], s47 offen offset:1024  lds
    v_mfma_f32_16x16x32_bf16 v[160:163], a[0:3], a[48:51], v[160:163]
    ds_read_b64_tr_b16 a[56:57], v23 offset:0
    ds_read_b64_tr_b16 a[58:59], v23 offset:2048
    v_mfma_f32_16x16x32_bf16 v[192:195], a[0:3], a[52:55], v[192:195]
    ds_read_b64_tr_b16 a[60:61], v23 offset:8
    ds_read_b64_tr_b16 a[62:63], v23 offset:2056
    v_mfma_f32_16x16x32_bf16 v[36:39], a[4:7], a[32:35], v[36:39]
    v_mfma_f32_16x16x32_bf16 v[68:71], a[4:7], a[36:39], v[68:71]
    ds_read_b64_tr_b16 a[64:65], v24 offset:0
    ds_read_b64_tr_b16 a[66:67], v24 offset:2048
    v_mfma_f32_16x16x32_bf16 v[100:103], a[4:7], a[40:43], v[100:103]
    v_mfma_f32_16x16x32_bf16 v[132:135], a[4:7], a[44:47], v[132:135]
    v_mfma_f32_16x16x32_bf16 v[164:167], a[4:7], a[48:51], v[164:167]
    s_add_u32 s55, s55, 0x40000
    ds_read_b64_tr_b16 a[68:69], v24 offset:8
    ds_read_b64_tr_b16 a[70:71], v24 offset:2056
    v_mfma_f32_16x16x32_bf16 v[196:199], a[4:7], a[52:55], v[196:199]
    buffer_load_dwordx4 v226, s[24:27], s47 offen offset:2048  lds
    v_mfma_f32_16x16x32_bf16 v[40:43], a[8:11], a[32:35], v[40:43]
    ds_read_b64_tr_b16 a[72:73], v25 offset:0
    ds_read_b64_tr_b16 a[74:75], v25 offset:2048
    v_mfma_f32_16x16x32_bf16 v[72:75], a[8:11], a[36:39], v[72:75]
    v_mfma_f32_16x16x32_bf16 v[104:107], a[8:11], a[40:43], v[104:107]
    s_and_b32 s55, s55, 0x3fffff
    ds_read_b64_tr_b16 a[76:77], v25 offset:8
    ds_read_b64_tr_b16 a[78:79], v25 offset:2056
    v_mfma_f32_16x16x32_bf16 v[136:139], a[8:11], a[44:47], v[136:139]
    buffer_load_dwordx4 v227, s[24:27], s47 offen offset:3072  lds
    v_mfma_f32_16x16x32_bf16 v[168:171], a[8:11], a[48:51], v[168:171]
    ds_read_b64_tr_b16 a[80:81], v26 offset:0
    ds_read_b64_tr_b16 a[82:83], v26 offset:2048
    v_mfma_f32_16x16x32_bf16 v[200:203], a[8:11], a[52:55], v[200:203]
    v_mfma_f32_16x16x32_bf16 v[44:47], a[12:15], a[32:35], v[44:47]
    s_add_u32 m0, s51, 24576
    ds_read_b64_tr_b16 a[84:85], v26 offset:8
    ds_read_b64_tr_b16 a[86:87], v26 offset:2056
    v_mfma_f32_16x16x32_bf16 v[76:79], a[12:15], a[36:39], v[76:79]
    s_add_u32 s47, s49, s53
    v_mfma_f32_16x16x32_bf16 v[108:111], a[12:15], a[40:43], v[108:111]
    buffer_load_dwordx4 v228, s[20:23], s47 offen offset:0  lds
    v_mfma_f32_16x16x32_bf16 v[140:143], a[12:15], a[44:47], v[140:143]
    v_mfma_f32_16x16x32_bf16 v[172:175], a[12:15], a[48:51], v[172:175]
    v_mfma_f32_16x16x32_bf16 v[204:207], a[12:15], a[52:55], v[204:207]
    s_add_u32 s49, s49, 64
    v_mfma_f32_16x16x32_bf16 v[48:51], a[16:19], a[32:35], v[48:51]
    buffer_load_dwordx4 v229, s[20:23], s47 offen offset:1024  lds
    v_mfma_f32_16x16x32_bf16 v[80:83], a[16:19], a[36:39], v[80:83]
    v_mfma_f32_16x16x32_bf16 v[112:115], a[16:19], a[40:43], v[112:115]
    v_mfma_f32_16x16x32_bf16 v[144:147], a[16:19], a[44:47], v[144:147]
    v_mfma_f32_16x16x32_bf16 v[176:179], a[16:19], a[48:51], v[176:179]
    s_and_b32 s49, s49, 0x3ff
    v_mfma_f32_16x16x32_bf16 v[208:211], a[16:19], a[52:55], v[208:211]
    buffer_load_dwordx4 v230, s[20:23], s47 offen offset:2048  lds
    v_mfma_f32_16x16x32_bf16 v[52:55], a[20:23], a[32:35], v[52:55]
    v_mfma_f32_16x16x32_bf16 v[84:87], a[20:23], a[36:39], v[84:87]
    v_mfma_f32_16x16x32_bf16 v[116:119], a[20:23], a[40:43], v[116:119]
    s_add_u32 m0, s38, 50688
    v_mfma_f32_16x16x32_bf16 v[148:151], a[20:23], a[44:47], v[148:151]
    s_add_u32 s46, s39, 270336
    v_mfma_f32_16x16x32_bf16 v[180:183], a[20:23], a[48:51], v[180:183]
    buffer_load_dwordx4 v6, s[16:19], s46 offen offset:0 nt lds
    buffer_load_dwordx4 v7, s[16:19], s46 offen offset:1056 nt lds
    s_add_u32 s39, s39, 16384
    v_mfma_f32_16x16x32_bf16 v[212:215], a[20:23], a[52:55], v[212:215]
    v_mfma_f32_16x16x32_bf16 v[56:59], a[24:27], a[32:35], v[56:59]
    v_mfma_f32_16x16x32_bf16 v[88:91], a[24:27], a[36:39], v[88:91]
    v_mfma_f32_16x16x32_bf16 v[120:123], a[24:27], a[40:43], v[120:123]
    v_mfma_f32_16x16x32_bf16 v[152:155], a[24:27], a[44:47], v[152:155]
    v_mfma_f32_16x16x32_bf16 v[184:187], a[24:27], a[48:51], v[184:187]
    v_mfma_f32_16x16x32_bf16 v[216:219], a[24:27], a[52:55], v[216:219]
    v_mfma_f32_16x16x32_bf16 v[60:63], a[28:31], a[32:35], v[60:63]
    v_mfma_f32_16x16x32_bf16 v[92:95], a[28:31], a[36:39], v[92:95]
    v_mfma_f32_16x16x32_bf16 v[124:127], a[28:31], a[40:43], v[124:127]
    v_mfma_f32_16x16x32_bf16 v[156:159], a[28:31], a[44:47], v[156:159]
    v_mfma_f32_16x16x32_bf16 v[188:191], a[28:31], a[48:51], v[188:191]
    v_mfma_f32_16x16x32_bf16 v[220:223], a[28:31], a[52:55], v[220:223]
    s_waitcnt lgkmcnt(0)
    s_waitcnt vmcnt(11)
    s_barrier
    v_mfma_f32_16x16x32_bf16 v[32:35], a[56:59], a[88:91], v[32:35]
    ds_read_b128 a[32:35], v22 offset:12288
    ds_read_b128 a[36:39], v22 offset:13312
    v_mfma_f32_16x16x32_bf16 v[64:67], a[56:59], a[92:95], v[64:67]
    s_add_u32 m0, s50, 0
    ds_read_b128 a[40:43], v22 offset:14336
    ds_read_b128 a[44:47], v22 offset:15360
    v_mfma_f32_16x16x32_bf16 v[96:99], a[56:59], a[96:99], v[96:99]
    s_add_u32 s47, s55, s52
    ds_read_b128 a[48:51], v22 offset:16384
    ds_read_b128 a[52:55], v22 offset:17408
    v_mfma_f32_16x16x32_bf16 v[128:131], a[56:59], a[100:103], v[128:131]
    buffer_load_dwordx4 v224, s[24:27], s47 offen offset:0  lds
    buffer_load_dwordx4 v225, s[24:27], s47 offen offset:1024  lds
    v_mfma_f32_16x16x32_bf16 v[160:163], a[56:59], a[104:107], v[160:163]
    ds_read_b64_tr_b16 a[0:1], v23 offset:16384
    ds_read_b64_tr_b16 a[2:3], v23 offset:18432
    v_mfma_f32_16x16x32_bf16 v[192:195], a[56:59], a[108:111], v[192:195]
    ds_read_b64_tr_b16 a[4:5], v23 offset:16392
    ds_read_b64_tr_b16 a[6:7], v23 offset:18440
    v_mfma_f32_16x16x32_bf16 v[36:39], a[60:63], a[88:91], v[36:39]
    v_mfma_f32_16x16x32_bf16 v[68:71], a[60:63], a[92:95], v[68:71]
    ds_read_b64_tr_b16 a[8:9], v24 offset:16384
    ds_read_b64_tr_b16 a[10:11], v24 offset:18432
    v_mfma_f32_16x16x32_bf16 v[100:103], a[60:63], a[96:99], v[100:103]
    v_mfma_f32_16x16x32_bf16 v[132:135], a[60:63], a[100:103], v[132:135]
    v_mfma_f32_16x16x32_bf16 v[164:167], a[60:63], a[104:107], v[164:167]
    ds_read_b64_tr_b16 a[12:13], v24 offset:16392
    ds_read_b64_tr_b16 a[14:15], v24 offset:18440
    v_mfma_f32_16x16x32_bf16 v[196:199], a[60:63], a[108:111], v[196:199]
    v_mfma_f32_16x16x32_bf16 v[40:43], a[64:67], a[88:91], v[40:43]
    s_add_u32 s55, s55, 0x40000
    ds_read_b64_tr_b16 a[16:17], v25 offset:16384
    ds_read_b64_tr_b16 a[18:19], v25 offset:18432
    v_mfma_f32_16x16x32_bf16 v[72:75], a[64:67], a[92:95], v[72:75]
    buffer_load_dwordx4 v226, s[24:27], s47 offen offset:2048  lds
    v_mfma_f32_16x16x32_bf16 v[104:107], a[64:67], a[96:99], v[104:107]
    ds_read_b64_tr_b16 a[20:21], v25 offset:16392
    ds_read_b64_tr_b16 a[22:23], v25 offset:18440
    v_mfma_f32_16x16x32_bf16 v[136:139], a[64:67], a[100:103], v[136:139]
    v_mfma_f32_16x16x32_bf16 v[168:171], a[64:67], a[104:107], v[168:171]
    ds_read_b64_tr_b16 a[24:25], v26 offset:16384
    ds_read_b64_tr_b16 a[26:27], v26 offset:18432
    v_mfma_f32_16x16x32_bf16 v[200:203], a[64:67], a[108:111], v[200:203]
    v_mfma_f32_16x16x32_bf16 v[44:47], a[68:71], a[88:91], v[44:47]
    s_and_b32 s55, s55, 0x3fffff
    ds_read_b64_tr_b16 a[28:29], v26 offset:16392
    ds_read_b64_tr_b16 a[30:31], v26 offset:18440
    v_mfma_f32_16x16x32_bf16 v[76:79], a[68:71], a[92:95], v[76:79]
    buffer_load_dwordx4 v227, s[24:27], s47 offen offset:3072  lds
    v_mfma_f32_16x16x32_bf16 v[108:111], a[68:71], a[96:99], v[108:111]
    v_mfma_f32_16x16x32_bf16 v[140:143], a[68:71], a[100:103], v[140:143]
    v_mfma_f32_16x16x32_bf16 v[172:175], a[68:71], a[104:107], v[172:175]
    v_mfma_f32_16x16x32_bf16 v[204:207], a[68:71], a[108:111], v[204:207]
    s_add_u32 m0, s51, 0
    v_mfma_f32_16x16x32_bf16 v[48:51], a[72:75], a[88:91], v[48:51]
    s_add_u32 s47, s49, s53
    v_mfma_f32_16x16x32_bf16 v[80:83], a[72:75], a[92:95], v[80:83]
    buffer_load_dwordx4 v228, s[20:23], s47 offen offset:0  lds
    v_mfma_f32_16x16x32_bf16 v[112:115], a[72:75], a[96:99], v[112:115]
    v_mfma_f32_16x16x32_bf16 v[144:147], a[72:75], a[100:103], v[144:147]
    v_mfma_f32_16x16x32_bf16 v[176:179], a[72:75], a[104:107], v[176:179]
    v_mfma_f32_16x16x32_bf16 v[208:211], a[72:75], a[108:111], v[208:211]
    v_mfma_f32_16x16x32_bf16 v[52:55], a[76:79], a[88:91], v[52:55]
    s_add_u32 s49, s49, 64
    v_mfma_f32_16x16x32_bf16 v[84:87], a[76:79], a[92:95], v[84:87]
    buffer_load_dwordx4 v229, s[20:23], s47 offen offset:1024  lds
    v_mfma_f32_16x16x32_bf16 v[116:119], a[76:79], a[96:99], v[116:119]
    v_mfma_f32_16x16x32_bf16 v[148:151], a[76:79], a[100:103], v[148:151]
    v_mfma_f32_16x16x32_bf16 v[180:183], a[76:79], a[104:107], v[180:183]
    v_mfma_f32_16x16x32_bf16 v[212:215], a[76:79], a[108:111], v[212:215]
    v_mfma_f32_16x16x32_bf16 v[56:59], a[80:83], a[88:91], v[56:59]
    v_mfma_f32_16x16x32_bf16 v[88:91], a[80:83], a[92:95], v[88:91]
    s_and_b32 s49, s49, 0x3ff
    v_mfma_f32_16x16x32_bf16 v[120:123], a[80:83], a[96:99], v[120:123]
    buffer_load_dwordx4 v230, s[20:23], s47 offen offset:2048  lds
    v_mfma_f32_16x16x32_bf16 v[152:155], a[80:83], a[100:103], v[152:155]
    v_mfma_f32_16x16x32_bf16 v[184:187], a[80:83], a[104:107], v[184:187]
    v_mfma_f32_16x16x32_bf16 v[216:219], a[80:83], a[108:111], v[216:219]
    v_mfma_f32_16x16x32_bf16 v[60:63], a[84:87], a[88:91], v[60:63]
    v_mfma_f32_16x16x32_bf16 v[92:95], a[84:87], a[92:95], v[92:95]
    v_mfma_f32_16x16x32_bf16 v[124:127], a[84:87], a[96:99], v[124:127]
    v_mfma_f32_16x16x32_bf16 v[156:159], a[84:87], a[100:103], v[156:159]
    v_mfma_f32_16x16x32_bf16 v[188:191], a[84:87], a[104:107], v[188:191]
    v_mfma_f32_16x16x32_bf16 v[220:223], a[84:87], a[108:111], v[220:223]
    s_waitcnt lgkmcnt(0)
    s_waitcnt vmcnt(9)
    s_barrier
    v_mfma_f32_16x16x32_bf16 v[32:35], a[0:3], a[32:35], v[32:35]
    ds_read_b128 a[88:91], v22 offset:24576
    ds_read_b128 a[92:95], v22 offset:25600
    v_mfma_f32_16x16x32_bf16 v[64:67], a[0:3], a[36:39], v[64:67]
    s_add_u32 m0, s50, 16384
    ds_read_b128 a[96:99], v22 offset:26624
    ds_read_b128 a[100:103], v22 offset:27648
    v_mfma_f32_16x16x32_bf16 v[96:99], a[0:3], a[40:43], v[96:99]
    s_add_u32 s47, s55, s52
    ds_read_b128 a[104:107], v22 offset:28672
    ds_read_b128 a[108:111], v22 offset:29696
    v_mfma_f32_16x16x32_bf16 v[128:131], a[0:3], a[44:47], v[128:131]
    buffer_load_dwordx4 v224, s[24:27], s47 offen offset:0  lds
    buffer_load_dwordx4 v225, s[24:27], s47 offen offset:1024  lds
    v_mfma_f32_16x16x32_bf16 v[160:163], a[0:3], a[48:51], v[160:163]
    ds_read_b64_tr_b16 a[56:57], v23 offset:32768
    ds_read_b64_tr_b16 a[58:59], v23 offset:34816
    v_mfma_f32_16x16x32_bf16 v[192:195], a[0:3], a[52:55], v[192:195]
    ds_read_b64_tr_b16 a[60:61], v23 offset:32776
    ds_read_b64_tr_b16 a[62:63], v23 offset:34824
    v_mfma_f32_16x16x32_bf16 v[36:39], a[4:7], a[32:35], v[36:39]
    v_mfma_f32_16x16x32_bf16 v[68:71], a[4:7], a[36:39], v[68:71]
    ds_read_b64_tr_b16 a[64:65], v24 offset:32768
    ds_read_b64_tr_b16 a[66:67], v24 offset:34816
    v_mfma_f32_16x16x32_bf16 v[100:103], a[4:7], a[40:43], v[100:103]
    v_mfma_f32_16x16x32_bf16 v[132:135], a[4:7], a[44:47], v[132:135]
    v_mfma_f32_16x16x32_bf16 v[164:167], a[4:7], a[48:51], v[164:167]
    s_add_u32 s55, s55, 0x40000
    ds_read_b64_tr_b16 a[68:69], v24 offset:32776
    ds_read_b64_tr_b16 a[70:71], v24 offset:34824
    v_mfma_f32_16x16x32_bf16 v[196:199], a[4:7], a[52:55], v[196:199]
    buffer_load_dwordx4 v226, s[24:27], s47 offen offset:2048  lds
    v_mfma_f32_16x16x32_bf16 v[40:43], a[8:11], a[32:35], v[40:43]
    ds_read_b64_tr_b16 a[72:73], v25 offset:32768
    ds_read_b64_tr_b16 a[74:75], v25 offset:34816
    v_mfma_f32_16x16x32_bf16 v[72:75], a[8:11], a[36:39], v[72:75]
    v_mfma_f32_16x16x32_bf16 v[104:107], a[8:11], a[40:43], v[104:107]
    s_and_b32 s55, s55, 0x3fffff
    ds_read_b64_tr_b16 a[76:77], v25 offset:32776
    ds_read_b64_tr_b16 a[78:79], v25 offset:34824
    v_mfma_f32_16x16x32_bf16 v[136:139], a[8:11], a[44:47], v[136:139]
    buffer_load_dwordx4 v227, s[24:27], s47 offen offset:3072  lds
    v_mfma_f32_16x16x32_bf16 v[168:171], a[8:11], a[48:51], v[168:171]
    ds_read_b64_tr_b16 a[80:81], v26 offset:32768
    ds_read_b64_tr_b16 a[82:83], v26 offset:34816
    v_mfma_f32_16x16x32_bf16 v[200:203], a[8:11], a[52:55], v[200:203]
    v_mfma_f32_16x16x32_bf16 v[44:47], a[12:15], a[32:35], v[44:47]
    s_add_u32 m0, s51, 12288
    ds_read_b64_tr_b16 a[84:85], v26 offset:32776
    ds_read_b64_tr_b16 a[86:87], v26 offset:34824
    v_mfma_f32_16x16x32_bf16 v[76:79], a[12:15], a[36:39], v[76:79]
    s_add_u32 s47, s49, s53
    v_mfma_f32_16x16x32_bf16 v[108:111], a[12:15], a[40:43], v[108:111]
    buffer_load_dwordx4 v228, s[20:23], s47 offen offset:0  lds
    v_mfma_f32_16x16x32_bf16 v[140:143], a[12:15], a[44:47], v[140:143]
    v_mfma_f32_16x16x32_bf16 v[172:175], a[12:15], a[48:51], v[172:175]
    v_mfma_f32_16x16x32_bf16 v[204:207], a[12:15], a[52:55], v[204:207]
    v_mfma_f32_16x16x32_bf16 v[48:51], a[16:19], a[32:35], v[48:51]
    s_add_u32 s49, s49, 64
    v_mfma_f32_16x16x32_bf16 v[80:83], a[16:19], a[36:39], v[80:83]
    buffer_load_dwordx4 v229, s[20:23], s47 offen offset:1024  lds
    v_mfma_f32_16x16x32_bf16 v[112:115], a[16:19], a[40:43], v[112:115]
    v_mfma_f32_16x16x32_bf16 v[144:147], a[16:19], a[44:47], v[144:147]
    v_mfma_f32_16x16x32_bf16 v[176:179], a[16:19], a[48:51], v[176:179]
    v_mfma_f32_16x16x32_bf16 v[208:211], a[16:19], a[52:55], v[208:211]
    s_and_b32 s49, s49, 0x3ff
    v_mfma_f32_16x16x32_bf16 v[52:55], a[20:23], a[32:35], v[52:55]
    buffer_load_dwordx4 v230, s[20:23], s47 offen offset:2048  lds
    v_mfma_f32_16x16x32_bf16 v[84:87], a[20:23], a[36:39], v[84:87]
    v_mfma_f32_16x16x32_bf16 v[116:119], a[20:23], a[40:43], v[116:119]
    v_mfma_f32_16x16x32_bf16 v[148:151], a[20:23], a[44:47], v[148:151]
    s_add_u32 m0, s38, 8448
    v_mfma_f32_16x16x32_bf16 v[180:183], a[20:23], a[48:51], v[180:183]
    s_add_u32 s46, s40, 0
    v_mfma_f32_16x16x32_bf16 v[212:215], a[20:23], a[52:55], v[212:215]
    buffer_load_dwordx4 v6, s[96:99], s46 offen offset:0 nt lds
    buffer_load_dwordx4 v7, s[96:99], s46 offen offset:1056 nt lds
    v_mfma_f32_16x16x32_bf16 v[56:59], a[24:27], a[32:35], v[56:59]
    v_mfma_f32_16x16x32_bf16 v[88:91], a[24:27], a[36:39], v[88:91]
    v_mfma_f32_16x16x32_bf16 v[120:123], a[24:27], a[40:43], v[120:123]
    v_mfma_f32_16x16x32_bf16 v[152:155], a[24:27], a[44:47], v[152:155]
    v_mfma_f32_16x16x32_bf16 v[184:187], a[24:27], a[48:51], v[184:187]
    v_mfma_f32_16x16x32_bf16 v[216:219], a[24:27], a[52:55], v[216:219]
    v_mfma_f32_16x16x32_bf16 v[60:63], a[28:31], a[32:35], v[60:63]
    v_mfma_f32_16x16x32_bf16 v[92:95], a[28:31], a[36:39], v[92:95]
    v_mfma_f32_16x16x32_bf16 v[124:127], a[28:31], a[40:43], v[124:127]
    v_mfma_f32_16x16x32_bf16 v[156:159], a[28:31], a[44:47], v[156:159]
    v_mfma_f32_16x16x32_bf16 v[188:191], a[28:31], a[48:51], v[188:191]
    v_mfma_f32_16x16x32_bf16 v[220:223], a[28:31], a[52:55], v[220:223]
    s_waitcnt lgkmcnt(0)
    s_waitcnt vmcnt(9)
    s_barrier
    v_mfma_f32_16x16x32_bf16 v[32:35], a[56:59], a[88:91], v[32:35]
    ds_read_b128 a[32:35], v22 offset:0
    ds_read_b128 a[36:39], v22 offset:1024
    v_mfma_f32_16x16x32_bf16 v[64:67], a[56:59], a[92:95], v[64:67]
    s_add_u32 m0, s50, 32768
    ds_read_b128 a[40:43], v22 offset:2048
    ds_read_b128 a[44:47], v22 offset:3072
    v_mfma_f32_16x16x32_bf16 v[96:99], a[56:59], a[96:99], v[96:99]
    s_add_u32 s47, s55, s52
    ds_read_b128 a[48:51], v22 offset:4096
    ds_read_b128 a[52:55], v22 offset:5120
    v_mfma_f32_16x16x32_bf16 v[128:131], a[56:59], a[100:103], v[128:131]
    buffer_load_dwordx4 v224, s[24:27], s47 offen offset:0  lds
    buffer_load_dwordx4 v225, s[24:27], s47 offen offset:1024  lds
    v_mfma_f32_16x16x32_bf16 v[160:163], a[56:59], a[104:107], v[160:163]
    ds_read_b64_tr_b16 a[0:1], v23 offset:0
    ds_read_b64_tr_b16 a[2:3], v23 offset:2048
    v_mfma_f32_16x16x32_bf16 v[192:195], a[56:59], a[108:111], v[192:195]
    ds_read_b64_tr_b16 a[4:5], v23 offset:8
    ds_read_b64_tr_b16 a[6:7], v23 offset:2056
    v_mfma_f32_16x16x32_bf16 v[36:39], a[60:63], a[88:91], v[36:39]
    v_mfma_f32_16x16x32_bf16 v[68:71], a[60:63], a[92:95], v[68:71]
    ds_read_b64_tr_b16 a[8:9], v24 offset:0
    ds_read_b64_tr_b16 a[10:11], v24 offset:2048
    v_mfma_f32_16x16x32_bf16 v[100:103], a[60:63], a[96:99], v[100:103]
    v_mfma_f32_16x16x32_bf16 v[132:135], a[60:63], a[100:103], v[132:135]
    v_mfma_f32_16x16x32_bf16 v[164:167], a[60:63], a[104:107], v[164:167]
    ds_read_b64_tr_b16 a[12:13], v24 offset:8
    ds_read_b64_tr_b16 a[14:15], v24 offset:2056
    v_mfma_f32_16x16x32_bf16 v[196:199], a[60:63], a[108:111], v[196:199]
    v_mfma_f32_16x16x32_bf16 v[40:43], a[64:67], a[88:91], v[40:43]
    s_add_u32 s55, s55, 0x40000
    ds_read_b64_tr_b16 a[16:17], v25 offset:0
    ds_read_b64_tr_b16 a[18:19], v25 offset:2048
    v_mfma_f32_16x16x32_bf16 v[72:75], a[64:67], a[92:95], v[72:75]
    buffer_load_dwordx4 v226, s[24:27], s47 offen offset:2048  lds
    v_mfma_f32_16x16x32_bf16 v[104:107], a[64:67], a[96:99], v[104:107]
    ds_read_b64_tr_b16 a[20:21], v25 offset:8
    ds_read_b64_tr_b16 a[22:23], v25 offset:2056
    v_mfma_f32_16x16x32_bf16 v[136:139], a[64:67], a[100:103], v[136:139]
    v_mfma_f32_16x16x32_bf16 v[168:171], a[64:67], a[104:107], v[168:171]
    ds_read_b64_tr_b16 a[24:25], v26 offset:0
    ds_read_b64_tr_b16 a[26:27], v26 offset:2048
    v_mfma_f32_16x16x32_bf16 v[200:203], a[64:67], a[108:111], v[200:203]
    v_mfma_f32_16x16x32_bf16 v[44:47], a[68:71], a[88:91], v[44:47]
    s_and_b32 s55, s55, 0x3fffff
    ds_read_b64_tr_b16 a[28:29], v26 offset:8
    ds_read_b64_tr_b16 a[30:31], v26 offset:2056
    v_mfma_f32_16x16x32_bf16 v[76:79], a[68:71], a[92:95], v[76:79]
    buffer_load_dwordx4 v227, s[24:27], s47 offen offset:3072  lds
    v_mfma_f32_16x16x32_bf16 v[108:111], a[68:71], a[96:99], v[108:111]
    v_mfma_f32_16x16x32_bf16 v[140:143], a[68:71], a[100:103], v[140:143]
    v_mfma_f32_16x16x32_bf16 v[172:175], a[68:71], a[104:107], v[172:175]
    v_mfma_f32_16x16x32_bf16 v[204:207], a[68:71], a[108:111], v[204:207]
    s_add_u32 m0, s51, 24576
    v_mfma_f32_16x16x32_bf16 v[48:51], a[72:75], a[88:91], v[48:51]
    s_add_u32 s47, s49, s53
    v_mfma_f32_16x16x32_bf16 v[80:83], a[72:75], a[92:95], v[80:83]
    buffer_load_dwordx4 v228, s[20:23], s47 offen offset:0  lds
    v_mfma_f32_16x16x32_bf16 v[112:115], a[72:75], a[96:99], v[112:115]
    v_mfma_f32_16x16x32_bf16 v[144:147], a[72:75], a[100:103], v[144:147]
    v_mfma_f32_16x16x32_bf16 v[176:179], a[72:75], a[104:107], v[176:179]
    v_mfma_f32_16x16x32_bf16 v[208:211], a[72:75], a[108:111], v[208:211]
    v_mfma_f32_16x16x32_bf16 v[52:55], a[76:79], a[88:91], v[52:55]
    s_add_u32 s49, s49, 64
    v_mfma_f32_16x16x32_bf16 v[84:87], a[76:79], a[92:95], v[84:87]
    buffer_load_dwordx4 v229, s[20:23], s47 offen offset:1024  lds
    v_mfma_f32_16x16x32_bf16 v[116:119], a[76:79], a[96:99], v[116:119]
    v_mfma_f32_16x16x32_bf16 v[148:151], a[76:79], a[100:103], v[148:151]
    v_mfma_f32_16x16x32_bf16 v[180:183], a[76:79], a[104:107], v[180:183]
    v_mfma_f32_16x16x32_bf16 v[212:215], a[76:79], a[108:111], v[212:215]
    v_mfma_f32_16x16x32_bf16 v[56:59], a[80:83], a[88:91], v[56:59]
    v_mfma_f32_16x16x32_bf16 v[88:91], a[80:83], a[92:95], v[88:91]
    s_and_b32 s49, s49, 0x3ff
    v_mfma_f32_16x16x32_bf16 v[120:123], a[80:83], a[96:99], v[120:123]
    buffer_load_dwordx4 v230, s[20:23], s47 offen offset:2048  lds
    v_mfma_f32_16x16x32_bf16 v[152:155], a[80:83], a[100:103], v[152:155]
    v_mfma_f32_16x16x32_bf16 v[184:187], a[80:83], a[104:107], v[184:187]
    v_mfma_f32_16x16x32_bf16 v[216:219], a[80:83], a[108:111], v[216:219]
    v_mfma_f32_16x16x32_bf16 v[60:63], a[84:87], a[88:91], v[60:63]
    v_mfma_f32_16x16x32_bf16 v[92:95], a[84:87], a[92:95], v[92:95]
    v_mfma_f32_16x16x32_bf16 v[124:127], a[84:87], a[96:99], v[124:127]
    v_mfma_f32_16x16x32_bf16 v[156:159], a[84:87], a[100:103], v[156:159]
    v_mfma_f32_16x16x32_bf16 v[188:191], a[84:87], a[104:107], v[188:191]
    v_mfma_f32_16x16x32_bf16 v[220:223], a[84:87], a[108:111], v[220:223]
    s_waitcnt lgkmcnt(0)
    s_waitcnt vmcnt(9)
    s_barrier
    v_mfma_f32_16x16x32_bf16 v[32:35], a[0:3], a[32:35], v[32:35]
    ds_read_b128 a[88:91], v22 offset:12288
    ds_read_b128 a[92:95], v22 offset:13312
    v_mfma_f32_16x16x32_bf16 v[64:67], a[0:3], a[36:39], v[64:67]
    s_add_u32 m0, s50, 0
    ds_read_b128 a[96:99], v22 offset:14336
    ds_read_b128 a[100:103], v22 offset:15360
    v_mfma_f32_16x16x32_bf16 v[96:99], a[0:3], a[40:43], v[96:99]
    s_add_u32 s47, s55, s52
    ds_read_b128 a[104:107], v22 offset:16384
    ds_read_b128 a[108:111], v22 offset:17408
    v_mfma_f32_16x16x32_bf16 v[128:131], a[0:3], a[44:47], v[128:131]
    buffer_load_dwordx4 v224, s[24:27], s47 offen offset:0  lds
    buffer_load_dwordx4 v225, s[24:27], s47 offen offset:1024  lds
    v_mfma_f32_16x16x32_bf16 v[160:163], a[0:3], a[48:51], v[160:163]
    ds_read_b64_tr_b16 a[56:57], v23 offset:16384
    ds_read_b64_tr_b16 a[58:59], v23 offset:18432
    v_mfma_f32_16x16x32_bf16 v[192:195], a[0:3], a[52:55], v[192:195]
    ds_read_b64_tr_b16 a[60:61], v23 offset:16392
    ds_read_b64_tr_b16 a[62:63], v23 offset:18440
    v_mfma_f32_16x16x32_bf16 v[36:39], a[4:7], a[32:35], v[36:39]
    v_mfma_f32_16x16x32_bf16 v[68:71], a[4:7], a[36:39], v[68:71]
    ds_read_b64_tr_b16 a[64:65], v24 offset:16384
    ds_read_b64_tr_b16 a[66:67], v24 offset:18432
    v_mfma_f32_16x16x32_bf16 v[100:103], a[4:7], a[40:43], v[100:103]
    v_mfma_f32_16x16x32_bf16 v[132:135], a[4:7], a[44:47], v[132:135]
    v_mfma_f32_16x16x32_bf16 v[164:167], a[4:7], a[48:51], v[164:167]
    s_add_u32 s55, s55, 0x40000
    ds_read_b64_tr_b16 a[68:69], v24 offset:16392
    ds_read_b64_tr_b16 a[70:71], v24 offset:18440
    v_mfma_f32_16x16x32_bf16 v[196:199], a[4:7], a[52:55], v[196:199]
    buffer_load_dwordx4 v226, s[24:27], s47 offen offset:2048  lds
    v_mfma_f32_16x16x32_bf16 v[40:43], a[8:11], a[32:35], v[40:43]
    ds_read_b64_tr_b16 a[72:73], v25 offset:16384
    ds_read_b64_tr_b16 a[74:75], v25 offset:18432
    v_mfma_f32_16x16x32_bf16 v[72:75], a[8:11], a[36:39], v[72:75]
    v_mfma_f32_16x16x32_bf16 v[104:107], a[8:11], a[40:43], v[104:107]
    s_and_b32 s55, s55, 0x3fffff
    ds_read_b64_tr_b16 a[76:77], v25 offset:16392
    ds_read_b64_tr_b16 a[78:79], v25 offset:18440
    v_mfma_f32_16x16x32_bf16 v[136:139], a[8:11], a[44:47], v[136:139]
    buffer_load_dwordx4 v227, s[24:27], s47 offen offset:3072  lds
    v_mfma_f32_16x16x32_bf16 v[168:171], a[8:11], a[48:51], v[168:171]
    ds_read_b64_tr_b16 a[80:81], v26 offset:16384
    ds_read_b64_tr_b16 a[82:83], v26 offset:18432
    v_mfma_f32_16x16x32_bf16 v[200:203], a[8:11], a[52:55], v[200:203]
    v_mfma_f32_16x16x32_bf16 v[44:47], a[12:15], a[32:35], v[44:47]
    s_add_u32 m0, s51, 0
    ds_read_b64_tr_b16 a[84:85], v26 offset:16392
    ds_read_b64_tr_b16 a[86:87], v26 offset:18440
    v_mfma_f32_16x16x32_bf16 v[76:79], a[12:15], a[36:39], v[76:79]
    s_add_u32 s47, s49, s53
    v_mfma_f32_16x16x32_bf16 v[108:111], a[12:15], a[40:43], v[108:111]
    buffer_load_dwordx4 v228, s[20:23], s47 offen offset:0  lds
    v_mfma_f32_16x16x32_bf16 v[140:143], a[12:15], a[44:47], v[140:143]
    v_mfma_f32_16x16x32_bf16 v[172:175], a[12:15], a[48:51], v[172:175]
    v_mfma_f32_16x16x32_bf16 v[204:207], a[12:15], a[52:55], v[204:207]
    v_mfma_f32_16x16x32_bf16 v[48:51], a[16:19], a[32:35], v[48:51]
    s_add_u32 s49, s49, 64
    v_mfma_f32_16x16x32_bf16 v[80:83], a[16:19], a[36:39], v[80:83]
    buffer_load_dwordx4 v229, s[20:23], s47 offen offset:1024  lds
    v_mfma_f32_16x16x32_bf16 v[112:115], a[16:19], a[40:43], v[112:115]
    v_mfma_f32_16x16x32_bf16 v[144:147], a[16:19], a[44:47], v[144:147]
    v_mfma_f32_16x16x32_bf16 v[176:179], a[16:19], a[48:51], v[176:179]
    v_mfma_f32_16x16x32_bf16 v[208:211], a[16:19], a[52:55], v[208:211]
    s_and_b32 s49, s49, 0x3ff
    v_mfma_f32_16x16x32_bf16 v[52:55], a[20:23], a[32:35], v[52:55]
    buffer_load_dwordx4 v230, s[20:23], s47 offen offset:2048  lds
    v_mfma_f32_16x16x32_bf16 v[84:87], a[20:23], a[36:39], v[84:87]
    v_mfma_f32_16x16x32_bf16 v[116:119], a[20:23], a[40:43], v[116:119]
    v_mfma_f32_16x16x32_bf16 v[148:151], a[20:23], a[44:47], v[148:151]
    s_add_u32 m0, s38, 42240
    v_mfma_f32_16x16x32_bf16 v[180:183], a[20:23], a[48:51], v[180:183]
    s_add_u32 s46, s40, 8192
    v_mfma_f32_16x16x32_bf16 v[212:215], a[20:23], a[52:55], v[212:215]
    buffer_load_dwordx4 v6, s[96:99], s46 offen offset:0 nt lds
    buffer_load_dwordx4 v7, s[96:99], s46 offen offset:1056 nt lds
    v_mfma_f32_16x16x32_bf16 v[56:59], a[24:27], a[32:35], v[56:59]
    v_mfma_f32_16x16x32_bf16 v[88:91], a[24:27], a[36:39], v[88:91]
    v_mfma_f32_16x16x32_bf16 v[120:123], a[24:27], a[40:43], v[120:123]
    v_mfma_f32_16x16x32_bf16 v[152:155], a[24:27], a[44:47], v[152:155]
    v_mfma_f32_16x16x32_bf16 v[184:187], a[24:27], a[48:51], v[184:187]
    v_mfma_f32_16x16x32_bf16 v[216:219], a[24:27], a[52:55], v[216:219]
    v_mfma_f32_16x16x32_bf16 v[60:63], a[28:31], a[32:35], v[60:63]
    v_mfma_f32_16x16x32_bf16 v[92:95], a[28:31], a[36:39], v[92:95]
    v_mfma_f32_16x16x32_bf16 v[124:127], a[28:31], a[40:43], v[124:127]
    v_mfma_f32_16x16x32_bf16 v[156:159], a[28:31], a[44:47], v[156:159]
    v_mfma_f32_16x16x32_bf16 v[188:191], a[28:31], a[48:51], v[188:191]
    v_mfma_f32_16x16x32_bf16 v[220:223], a[28:31], a[52:55], v[220:223]
    s_waitcnt lgkmcnt(0)
    s_waitcnt vmcnt(9)
    s_barrier
    v_mfma_f32_16x16x32_bf16 v[32:35], a[56:59], a[88:91], v[32:35]
    ds_read_b128 a[32:35], v22 offset:24576
    ds_read_b128 a[36:39], v22 offset:25600
    v_mfma_f32_16x16x32_bf16 v[64:67], a[56:59], a[92:95], v[64:67]
    s_add_u32 m0, s50, 16384
    ds_read_b128 a[40:43], v22 offset:26624
    ds_read_b128 a[44:47], v22 offset:27648
    v_mfma_f32_16x16x32_bf16 v[96:99], a[56:59], a[96:99], v[96:99]
    s_add_u32 s47, s55, s52
    ds_read_b128 a[48:51], v22 offset:28672
    ds_read_b128 a[52:55], v22 offset:29696
    v_mfma_f32_16x16x32_bf16 v[128:131], a[56:59], a[100:103], v[128:131]
    buffer_load_dwordx4 v224, s[24:27], s47 offen offset:0  lds
    buffer_load_dwordx4 v225, s[24:27], s47 offen offset:1024  lds
    v_mfma_f32_16x16x32_bf16 v[160:163], a[56:59], a[104:107], v[160:163]
    ds_read_b64_tr_b16 a[0:1], v23 offset:32768
    ds_read_b64_tr_b16 a[2:3], v23 offset:34816
    v_mfma_f32_16x16x32_bf16 v[192:195], a[56:59], a[108:111], v[192:195]
    ds_read_b64_tr_b16 a[4:5], v23 offset:32776
    ds_read_b64_tr_b16 a[6:7], v23 offset:34824
    v_mfma_f32_16x16x32_bf16 v[36:39], a[60:63], a[88:91], v[36:39]
    v_mfma_f32_16x16x32_bf16 v[68:71], a[60:63], a[92:95], v[68:71]
    ds_read_b64_tr_b16 a[8:9], v24 offset:32768
    ds_read_b64_tr_b16 a[10:11], v24 offset:34816
    v_mfma_f32_16x16x32_bf16 v[100:103], a[60:63], a[96:99], v[100:103]
    v_mfma_f32_16x16x32_bf16 v[132:135], a[60:63], a[100:103], v[132:135]
    v_mfma_f32_16x16x32_bf16 v[164:167], a[60:63], a[104:107], v[164:167]
    s_add_u32 s55, s55, 0x40000
    ds_read_b64_tr_b16 a[12:13], v24 offset:32776
    ds_read_b64_tr_b16 a[14:15], v24 offset:34824
    v_mfma_f32_16x16x32_bf16 v[196:199], a[60:63], a[108:111], v[196:199]
    buffer_load_dwordx4 v226, s[24:27], s47 offen offset:2048  lds
    v_mfma_f32_16x16x32_bf16 v[40:43], a[64:67], a[88:91], v[40:43]
    ds_read_b64_tr_b16 a[16:17], v25 offset:32768
    ds_read_b64_tr_b16 a[18:19], v25 offset:34816
    v_mfma_f32_16x16x32_bf16 v[72:75], a[64:67], a[92:95], v[72:75]
    v_mfma_f32_16x16x32_bf16 v[104:107], a[64:67], a[96:99], v[104:107]
    s_and_b32 s55, s55, 0x3fffff
    ds_read_b64_tr_b16 a[20:21], v25 offset:32776
    ds_read_b64_tr_b16 a[22:23], v25 offset:34824
    v_mfma_f32_16x16x32_bf16 v[136:139], a[64:67], a[100:103], v[136:139]
    buffer_load_dwordx4 v227, s[24:27], s47 offen offset:3072  lds
    v_mfma_f32_16x16x32_bf16 v[168:171], a[64:67], a[104:107], v[168:171]
    ds_read_b64_tr_b16 a[24:25], v26 offset:32768
    ds_read_b64_tr_b16 a[26:27], v26 offset:34816
    v_mfma_f32_16x16x32_bf16 v[200:203], a[64:67], a[108:111], v[200:203]
    v_mfma_f32_16x16x32_bf16 v[44:47], a[68:71], a[88:91], v[44:47]
    s_add_u32 m0, s51, 12288
    ds_read_b64_tr_b16 a[28:29], v26 offset:32776
    ds_read_b64_tr_b16 a[30:31], v26 offset:34824
    v_mfma_f32_16x16x32_bf16 v[76:79], a[68:71], a[92:95], v[76:79]
    s_add_u32 s47, s49, s53
    v_mfma_f32_16x16x32_bf16 v[108:111], a[68:71], a[96:99], v[108:111]
    buffer_load_dwordx4 v228, s[20:23], s47 offen offset:0  lds
    v_mfma_f32_16x16x32_bf16 v[140:143], a[68:71], a[100:103], v[140:143]
    v_mfma_f32_16x16x32_bf16 v[172:175], a[68:71], a[104:107], v[172:175]
    v_mfma_f32_16x16x32_bf16 v[204:207], a[68:71], a[108:111], v[204:207]
    v_mfma_f32_16x16x32_bf16 v[48:51], a[72:75], a[88:91], v[48:51]
    s_add_u32 s49, s49, 64
    v_mfma_f32_16x16x32_bf16 v[80:83], a[72:75], a[92:95], v[80:83]
    buffer_load_dwordx4 v229, s[20:23], s47 offen offset:1024  lds
    v_mfma_f32_16x16x32_bf16 v[112:115], a[72:75], a[96:99], v[112:115]
    v_mfma_f32_16x16x32_bf16 v[144:147], a[72:75], a[100:103], v[144:147]
    v_mfma_f32_16x16x32_bf16 v[176:179], a[72:75], a[104:107], v[176:179]
    v_mfma_f32_16x16x32_bf16 v[208:211], a[72:75], a[108:111], v[208:211]
    s_and_b32 s49, s49, 0x3ff
    v_mfma_f32_16x16x32_bf16 v[52:55], a[76:79], a[88:91], v[52:55]
    buffer_load_dwordx4 v230, s[20:23], s47 offen offset:2048  lds
    v_mfma_f32_16x16x32_bf16 v[84:87], a[76:79], a[92:95], v[84:87]
    v_mfma_f32_16x16x32_bf16 v[116:119], a[76:79], a[96:99], v[116:119]
    v_mfma_f32_16x16x32_bf16 v[148:151], a[76:79], a[100:103], v[148:151]
    s_add_u32 m0, s38, 25344
    v_mfma_f32_16x16x32_bf16 v[180:183], a[76:79], a[104:107], v[180:183]
    s_add_u32 s46, s40, 262144
    v_mfma_f32_16x16x32_bf16 v[212:215], a[76:79], a[108:111], v[212:215]
    buffer_load_dwordx4 v6, s[96:99], s46 offen offset:0 nt lds
    buffer_load_dwordx4 v7, s[96:99], s46 offen offset:1056 nt lds
    v_mfma_f32_16x16x32_bf16 v[56:59], a[80:83], a[88:91], v[56:59]
    v_mfma_f32_16x16x32_bf16 v[88:91], a[80:83], a[92:95], v[88:91]
    v_mfma_f32_16x16x32_bf16 v[120:123], a[80:83], a[96:99], v[120:123]
    v_mfma_f32_16x16x32_bf16 v[152:155], a[80:83], a[100:103], v[152:155]
    v_mfma_f32_16x16x32_bf16 v[184:187], a[80:83], a[104:107], v[184:187]
    v_mfma_f32_16x16x32_bf16 v[216:219], a[80:83], a[108:111], v[216:219]
    v_mfma_f32_16x16x32_bf16 v[60:63], a[84:87], a[88:91], v[60:63]
    v_mfma_f32_16x16x32_bf16 v[92:95], a[84:87], a[92:95], v[92:95]
    v_mfma_f32_16x16x32_bf16 v[124:127], a[84:87], a[96:99], v[124:127]
    v_mfma_f32_16x16x32_bf16 v[156:159], a[84:87], a[100:103], v[156:159]
    v_mfma_f32_16x16x32_bf16 v[188:191], a[84:87], a[104:107], v[188:191]
    v_mfma_f32_16x16x32_bf16 v[220:223], a[84:87], a[108:111], v[220:223]
    s_waitcnt lgkmcnt(0)
    s_waitcnt vmcnt(11)
    s_barrier
    v_mfma_f32_16x16x32_bf16 v[32:35], a[0:3], a[32:35], v[32:35]
    ds_read_b128 a[88:91], v22 offset:0
    ds_read_b128 a[92:95], v22 offset:1024
    v_mfma_f32_16x16x32_bf16 v[64:67], a[0:3], a[36:39], v[64:67]
    s_add_u32 m0, s50, 32768
    ds_read_b128 a[96:99], v22 offset:2048
    ds_read_b128 a[100:103], v22 offset:3072
    v_mfma_f32_16x16x32_bf16 v[96:99], a[0:3], a[40:43], v[96:99]
    s_add_u32 s47, s55, s52
    ds_read_b128 a[104:107], v22 offset:4096
    ds_read_b128 a[108:111], v22 offset:5120
    v_mfma_f32_16x16x32_bf16 v[128:131], a[0:3], a[44:47], v[128:131]
    buffer_load_dwordx4 v224, s[24:27], s47 offen offset:0  lds
    buffer_load_dwordx4 v225, s[24:27], s47 offen offset:1024  lds
    v_mfma_f32_16x16x32_bf16 v[160:163], a[0:3], a[48:51], v[160:163]
    ds_read_b64_tr_b16 a[56:57], v23 offset:0
    ds_read_b64_tr_b16 a[58:59], v23 offset:2048
    v_mfma_f32_16x16x32_bf16 v[192:195], a[0:3], a[52:55], v[192:195]
    ds_read_b64_tr_b16 a[60:61], v23 offset:8
    ds_read_b64_tr_b16 a[62:63], v23 offset:2056
    v_mfma_f32_16x16x32_bf16 v[36:39], a[4:7], a[32:35], v[36:39]
    v_mfma_f32_16x16x32_bf16 v[68:71], a[4:7], a[36:39], v[68:71]
    ds_read_b64_tr_b16 a[64:65], v24 offset:0
    ds_read_b64_tr_b16 a[66:67], v24 offset:2048
    v_mfma_f32_16x16x32_bf16 v[100:103], a[4:7], a[40:43], v[100:103]
    v_mfma_f32_16x16x32_bf16 v[132:135], a[4:7], a[44:47], v[132:135]
    v_mfma_f32_16x16x32_bf16 v[164:167], a[4:7], a[48:51], v[164:167]
    ds_read_b64_tr_b16 a[68:69], v24 offset:8
    ds_read_b64_tr_b16 a[70:71], v24 offset:2056
    v_mfma_f32_16x16x32_bf16 v[196:199], a[4:7], a[52:55], v[196:199]
    v_mfma_f32_16x16x32_bf16 v[40:43], a[8:11], a[32:35], v[40:43]
    s_add_u32 s55, s55, 0x40000
    ds_read_b64_tr_b16 a[72:73], v25 offset:0
    ds_read_b64_tr_b16 a[74:75], v25 offset:2048
    v_mfma_f32_16x16x32_bf16 v[72:75], a[8:11], a[36:39], v[72:75]
    buffer_load_dwordx4 v226, s[24:27], s47 offen offset:2048  lds
    v_mfma_f32_16x16x32_bf16 v[104:107], a[8:11], a[40:43], v[104:107]
    ds_read_b64_tr_b16 a[76:77], v25 offset:8
    ds_read_b64_tr_b16 a[78:79], v25 offset:2056
    v_mfma_f32_16x16x32_bf16 v[136:139], a[8:11], a[44:47], v[136:139]
    v_mfma_f32_16x16x32_bf16 v[168:171], a[8:11], a[48:51], v[168:171]
    ds_read_b64_tr_b16 a[80:81], v26 offset:0
    ds_read_b64_tr_b16 a[82:83], v26 offset:2048
    v_mfma_f32_16x16x32_bf16 v[200:203], a[8:11], a[52:55], v[200:203]
    v_mfma_f32_16x16x32_bf16 v[44:47], a[12:15], a[32:35], v[44:47]
    s_and_b32 s55, s55, 0x3fffff
    ds_read_b64_tr_b16 a[84:85], v26 offset:8
    ds_read_b64_tr_b16 a[86:87], v26 offset:2056
    v_mfma_f32_16x16x32_bf16 v[76:79], a[12:15], a[36:39], v[76:79]
    buffer_load_dwordx4 v227, s[24:27], s47 offen offset:3072  lds
    v_mfma_f32_16x16x32_bf16 v[108:111], a[12:15], a[40:43], v[108:111]
    v_mfma_f32_16x16x32_bf16 v[140:143], a[12:15], a[44:47], v[140:143]
    v_mfma_f32_16x16x32_bf16 v[172:175], a[12:15], a[48:51], v[172:175]
    v_mfma_f32_16x16x32_bf16 v[204:207], a[12:15], a[52:55], v[204:207]
    s_add_u32 m0, s51, 24576
    v_mfma_f32_16x16x32_bf16 v[48:51], a[16:19], a[32:35], v[48:51]
    s_add_u32 s47, s49, s53
    v_mfma_f32_16x16x32_bf16 v[80:83], a[16:19], a[36:39], v[80:83]
    buffer_load_dwordx4 v228, s[20:23], s47 offen offset:0  lds
    v_mfma_f32_16x16x32_bf16 v[112:115], a[16:19], a[40:43], v[112:115]
    v_mfma_f32_16x16x32_bf16 v[144:147], a[16:19], a[44:47], v[144:147]
    v_mfma_f32_16x16x32_bf16 v[176:179], a[16:19], a[48:51], v[176:179]
    v_mfma_f32_16x16x32_bf16 v[208:211], a[16:19], a[52:55], v[208:211]
    v_mfma_f32_16x16x32_bf16 v[52:55], a[20:23], a[32:35], v[52:55]
    s_add_u32 s49, s49, 64
    v_mfma_f32_16x16x32_bf16 v[84:87], a[20:23], a[36:39], v[84:87]
    buffer_load_dwordx4 v229, s[20:23], s47 offen offset:1024  lds
    v_mfma_f32_16x16x32_bf16 v[116:119], a[20:23], a[40:43], v[116:119]
    v_mfma_f32_16x16x32_bf16 v[148:151], a[20:23], a[44:47], v[148:151]
    v_mfma_f32_16x16x32_bf16 v[180:183], a[20:23], a[48:51], v[180:183]
    v_mfma_f32_16x16x32_bf16 v[212:215], a[20:23], a[52:55], v[212:215]
    v_mfma_f32_16x16x32_bf16 v[56:59], a[24:27], a[32:35], v[56:59]
    v_mfma_f32_16x16x32_bf16 v[88:91], a[24:27], a[36:39], v[88:91]
    s_and_b32 s49, s49, 0x3ff
    v_mfma_f32_16x16x32_bf16 v[120:123], a[24:27], a[40:43], v[120:123]
    buffer_load_dwordx4 v230, s[20:23], s47 offen offset:2048  lds
    v_mfma_f32_16x16x32_bf16 v[152:155], a[24:27], a[44:47], v[152:155]
    v_mfma_f32_16x16x32_bf16 v[184:187], a[24:27], a[48:51], v[184:187]
    v_mfma_f32_16x16x32_bf16 v[216:219], a[24:27], a[52:55], v[216:219]
    v_mfma_f32_16x16x32_bf16 v[60:63], a[28:31], a[32:35], v[60:63]
    v_mfma_f32_16x16x32_bf16 v[92:95], a[28:31], a[36:39], v[92:95]
    v_mfma_f32_16x16x32_bf16 v[124:127], a[28:31], a[40:43], v[124:127]
    v_mfma_f32_16x16x32_bf16 v[156:159], a[28:31], a[44:47], v[156:159]
    v_mfma_f32_16x16x32_bf16 v[188:191], a[28:31], a[48:51], v[188:191]
    v_mfma_f32_16x16x32_bf16 v[220:223], a[28:31], a[52:55], v[220:223]
    s_waitcnt lgkmcnt(0)
    s_waitcnt vmcnt(9)
    s_barrier
    v_mfma_f32_16x16x32_bf16 v[32:35], a[56:59], a[88:91], v[32:35]
    ds_read_b128 a[32:35], v22 offset:12288
    ds_read_b128 a[36:39], v22 offset:13312
    v_mfma_f32_16x16x32_bf16 v[64:67], a[56:59], a[92:95], v[64:67]
    ds_read_b128 a[40:43], v22 offset:14336
    ds_read_b128 a[44:47], v22 offset:15360
    v_mfma_f32_16x16x32_bf16 v[96:99], a[56:59], a[96:99], v[96:99]
    ds_read_b128 a[48:51], v22 offset:16384
    ds_read_b128 a[52:55], v22 offset:17408
    v_mfma_f32_16x16x32_bf16 v[128:131], a[56:59], a[100:103], v[128:131]
    s_add_u32 m0, s38, 59136
    ds_read_b64_tr_b16 a[0:1], v23 offset:16384
    ds_read_b64_tr_b16 a[2:3], v23 offset:18432
    v_mfma_f32_16x16x32_bf16 v[160:163], a[56:59], a[104:107], v[160:163]
    s_add_u32 s46, s40, 270336
    v_mfma_f32_16x16x32_bf16 v[192:195], a[56:59], a[108:111], v[192:195]
    buffer_load_dwordx4 v6, s[96:99], s46 offen offset:0 nt lds
    buffer_load_dwordx4 v7, s[96:99], s46 offen offset:1056 nt lds
    s_add_u32 s40, s40, 16384
    v_mfma_f32_16x16x32_bf16 v[36:39], a[60:63], a[88:91], v[36:39]
    ds_read_b64_tr_b16 a[4:5], v23 offset:16392
    ds_read_b64_tr_b16 a[6:7], v23 offset:18440
    v_mfma_f32_16x16x32_bf16 v[68:71], a[60:63], a[92:95], v[68:71]
    ds_read_b64_tr_b16 a[8:9], v24 offset:16384
    ds_read_b64_tr_b16 a[10:11], v24 offset:18432
    v_mfma_f32_16x16x32_bf16 v[100:103], a[60:63], a[96:99], v[100:103]
    v_mfma_f32_16x16x32_bf16 v[132:135], a[60:63], a[100:103], v[132:135]
    v_mfma_f32_16x16x32_bf16 v[164:167], a[60:63], a[104:107], v[164:167]
    ds_read_b64_tr_b16 a[12:13], v24 offset:16392
    ds_read_b64_tr_b16 a[14:15], v24 offset:18440
    v_mfma_f32_16x16x32_bf16 v[196:199], a[60:63], a[108:111], v[196:199]
    v_mfma_f32_16x16x32_bf16 v[40:43], a[64:67], a[88:91], v[40:43]
    ds_read_b64_tr_b16 a[16:17], v25 offset:16384
    ds_read_b64_tr_b16 a[18:19], v25 offset:18432
    v_mfma_f32_16x16x32_bf16 v[72:75], a[64:67], a[92:95], v[72:75]
    v_mfma_f32_16x16x32_bf16 v[104:107], a[64:67], a[96:99], v[104:107]
    ds_read_b64_tr_b16 a[20:21], v25 offset:16392
    ds_read_b64_tr_b16 a[22:23], v25 offset:18440
    v_mfma_f32_16x16x32_bf16 v[136:139], a[64:67], a[100:103], v[136:139]
    v_mfma_f32_16x16x32_bf16 v[168:171], a[64:67], a[104:107], v[168:171]
    ds_read_b64_tr_b16 a[24:25], v26 offset:16384
    ds_read_b64_tr_b16 a[26:27], v26 offset:18432
    v_mfma_f32_16x16x32_bf16 v[200:203], a[64:67], a[108:111], v[200:203]
    v_mfma_f32_16x16x32_bf16 v[44:47], a[68:71], a[88:91], v[44:47]
    ds_read_b64_tr_b16 a[28:29], v26 offset:16392
    ds_read_b64_tr_b16 a[30:31], v26 offset:18440
    v_mfma_f32_16x16x32_bf16 v[76:79], a[68:71], a[92:95], v[76:79]
    v_mfma_f32_16x16x32_bf16 v[108:111], a[68:71], a[96:99], v[108:111]
    v_mfma_f32_16x16x32_bf16 v[140:143], a[68:71], a[100:103], v[140:143]
    v_mfma_f32_16x16x32_bf16 v[172:175], a[68:71], a[104:107], v[172:175]
    v_mfma_f32_16x16x32_bf16 v[204:207], a[68:71], a[108:111], v[204:207]
    v_mfma_f32_16x16x32_bf16 v[48:51], a[72:75], a[88:91], v[48:51]
    v_mfma_f32_16x16x32_bf16 v[80:83], a[72:75], a[92:95], v[80:83]
    v_mfma_f32_16x16x32_bf16 v[112:115], a[72:75], a[96:99], v[112:115]
    v_mfma_f32_16x16x32_bf16 v[144:147], a[72:75], a[100:103], v[144:147]
    v_mfma_f32_16x16x32_bf16 v[176:179], a[72:75], a[104:107], v[176:179]
    v_mfma_f32_16x16x32_bf16 v[208:211], a[72:75], a[108:111], v[208:211]
    v_mfma_f32_16x16x32_bf16 v[52:55], a[76:79], a[88:91], v[52:55]
    v_mfma_f32_16x16x32_bf16 v[84:87], a[76:79], a[92:95], v[84:87]
    v_mfma_f32_16x16x32_bf16 v[116:119], a[76:79], a[96:99], v[116:119]
    v_mfma_f32_16x16x32_bf16 v[148:151], a[76:79], a[100:103], v[148:151]
    v_mfma_f32_16x16x32_bf16 v[180:183], a[76:79], a[104:107], v[180:183]
    v_mfma_f32_16x16x32_bf16 v[212:215], a[76:79], a[108:111], v[212:215]
    v_mfma_f32_16x16x32_bf16 v[56:59], a[80:83], a[88:91], v[56:59]
    v_mfma_f32_16x16x32_bf16 v[88:91], a[80:83], a[92:95], v[88:91]
    v_mfma_f32_16x16x32_bf16 v[120:123], a[80:83], a[96:99], v[120:123]
    v_mfma_f32_16x16x32_bf16 v[152:155], a[80:83], a[100:103], v[152:155]
    v_mfma_f32_16x16x32_bf16 v[184:187], a[80:83], a[104:107], v[184:187]
    v_mfma_f32_16x16x32_bf16 v[216:219], a[80:83], a[108:111], v[216:219]
    v_mfma_f32_16x16x32_bf16 v[60:63], a[84:87], a[88:91], v[60:63]
    v_mfma_f32_16x16x32_bf16 v[92:95], a[84:87], a[92:95], v[92:95]
    v_mfma_f32_16x16x32_bf16 v[124:127], a[84:87], a[96:99], v[124:127]
    v_mfma_f32_16x16x32_bf16 v[156:159], a[84:87], a[100:103], v[156:159]
    v_mfma_f32_16x16x32_bf16 v[188:191], a[84:87], a[104:107], v[188:191]
    v_mfma_f32_16x16x32_bf16 v[220:223], a[84:87], a[108:111], v[220:223]
    s_waitcnt lgkmcnt(0)
    s_waitcnt vmcnt(2)
    s_barrier
    v_mfma_f32_16x16x32_bf16 v[32:35], a[0:3], a[32:35], v[32:35]
    ds_read_b128 a[88:91], v22 offset:24576
    ds_read_b128 a[92:95], v22 offset:25600
    v_mfma_f32_16x16x32_bf16 v[64:67], a[0:3], a[36:39], v[64:67]
    ds_read_b128 a[96:99], v22 offset:26624
    ds_read_b128 a[100:103], v22 offset:27648
    v_mfma_f32_16x16x32_bf16 v[96:99], a[0:3], a[40:43], v[96:99]
    ds_read_b128 a[104:107], v22 offset:28672
    ds_read_b128 a[108:111], v22 offset:29696
    v_mfma_f32_16x16x32_bf16 v[128:131], a[0:3], a[44:47], v[128:131]
    ds_read_b64_tr_b16 a[56:57], v23 offset:32768
    ds_read_b64_tr_b16 a[58:59], v23 offset:34816
    v_mfma_f32_16x16x32_bf16 v[160:163], a[0:3], a[48:51], v[160:163]
    v_mfma_f32_16x16x32_bf16 v[192:195], a[0:3], a[52:55], v[192:195]
    ds_read_b64_tr_b16 a[60:61], v23 offset:32776
    ds_read_b64_tr_b16 a[62:63], v23 offset:34824
    v_mfma_f32_16x16x32_bf16 v[36:39], a[4:7], a[32:35], v[36:39]
    v_mfma_f32_16x16x32_bf16 v[68:71], a[4:7], a[36:39], v[68:71]
    ds_read_b64_tr_b16 a[64:65], v24 offset:32768
    ds_read_b64_tr_b16 a[66:67], v24 offset:34816
    v_mfma_f32_16x16x32_bf16 v[100:103], a[4:7], a[40:43], v[100:103]
    v_mfma_f32_16x16x32_bf16 v[132:135], a[4:7], a[44:47], v[132:135]
    v_mfma_f32_16x16x32_bf16 v[164:167], a[4:7], a[48:51], v[164:167]
    ds_read_b64_tr_b16 a[68:69], v24 offset:32776
    ds_read_b64_tr_b16 a[70:71], v24 offset:34824
    v_mfma_f32_16x16x32_bf16 v[196:199], a[4:7], a[52:55], v[196:199]
    v_mfma_f32_16x16x32_bf16 v[40:43], a[8:11], a[32:35], v[40:43]
    ds_read_b64_tr_b16 a[72:73], v25 offset:32768
    ds_read_b64_tr_b16 a[74:75], v25 offset:34816
    v_mfma_f32_16x16x32_bf16 v[72:75], a[8:11], a[36:39], v[72:75]
    v_mfma_f32_16x16x32_bf16 v[104:107], a[8:11], a[40:43], v[104:107]
    ds_read_b64_tr_b16 a[76:77], v25 offset:32776
    ds_read_b64_tr_b16 a[78:79], v25 offset:34824
    v_mfma_f32_16x16x32_bf16 v[136:139], a[8:11], a[44:47], v[136:139]
    v_mfma_f32_16x16x32_bf16 v[168:171], a[8:11], a[48:51], v[168:171]
    ds_read_b64_tr_b16 a[80:81], v26 offset:32768
    ds_read_b64_tr_b16 a[82:83], v26 offset:34816
    v_mfma_f32_16x16x32_bf16 v[200:203], a[8:11], a[52:55], v[200:203]
    v_mfma_f32_16x16x32_bf16 v[44:47], a[12:15], a[32:35], v[44:47]
    ds_read_b64_tr_b16 a[84:85], v26 offset:32776
    ds_read_b64_tr_b16 a[86:87], v26 offset:34824
    v_mfma_f32_16x16x32_bf16 v[76:79], a[12:15], a[36:39], v[76:79]
    v_mfma_f32_16x16x32_bf16 v[108:111], a[12:15], a[40:43], v[108:111]
    v_mfma_f32_16x16x32_bf16 v[140:143], a[12:15], a[44:47], v[140:143]
    v_mfma_f32_16x16x32_bf16 v[172:175], a[12:15], a[48:51], v[172:175]
    v_mfma_f32_16x16x32_bf16 v[204:207], a[12:15], a[52:55], v[204:207]
    v_mfma_f32_16x16x32_bf16 v[48:51], a[16:19], a[32:35], v[48:51]
    v_mfma_f32_16x16x32_bf16 v[80:83], a[16:19], a[36:39], v[80:83]
    v_mfma_f32_16x16x32_bf16 v[112:115], a[16:19], a[40:43], v[112:115]
    v_mfma_f32_16x16x32_bf16 v[144:147], a[16:19], a[44:47], v[144:147]
    v_mfma_f32_16x16x32_bf16 v[176:179], a[16:19], a[48:51], v[176:179]
    v_mfma_f32_16x16x32_bf16 v[208:211], a[16:19], a[52:55], v[208:211]
    v_mfma_f32_16x16x32_bf16 v[52:55], a[20:23], a[32:35], v[52:55]
    v_mfma_f32_16x16x32_bf16 v[84:87], a[20:23], a[36:39], v[84:87]
    v_mfma_f32_16x16x32_bf16 v[116:119], a[20:23], a[40:43], v[116:119]
    v_mfma_f32_16x16x32_bf16 v[148:151], a[20:23], a[44:47], v[148:151]
    v_mfma_f32_16x16x32_bf16 v[180:183], a[20:23], a[48:51], v[180:183]
    v_mfma_f32_16x16x32_bf16 v[212:215], a[20:23], a[52:55], v[212:215]
    v_mfma_f32_16x16x32_bf16 v[56:59], a[24:27], a[32:35], v[56:59]
    v_mfma_f32_16x16x32_bf16 v[88:91], a[24:27], a[36:39], v[88:91]
    v_mfma_f32_16x16x32_bf16 v[120:123], a[24:27], a[40:43], v[120:123]
    v_mfma_f32_16x16x32_bf16 v[152:155], a[24:27], a[44:47], v[152:155]
    v_mfma_f32_16x16x32_bf16 v[184:187], a[24:27], a[48:51], v[184:187]
    v_mfma_f32_16x16x32_bf16 v[216:219], a[24:27], a[52:55], v[216:219]
    v_mfma_f32_16x16x32_bf16 v[60:63], a[28:31], a[32:35], v[60:63]
    v_mfma_f32_16x16x32_bf16 v[92:95], a[28:31], a[36:39], v[92:95]
    v_mfma_f32_16x16x32_bf16 v[124:127], a[28:31], a[40:43], v[124:127]
    v_mfma_f32_16x16x32_bf16 v[156:159], a[28:31], a[44:47], v[156:159]
    v_mfma_f32_16x16x32_bf16 v[188:191], a[28:31], a[48:51], v[188:191]
    v_mfma_f32_16x16x32_bf16 v[220:223], a[28:31], a[52:55], v[220:223]
    s_waitcnt lgkmcnt(0)
    s_barrier
    v_mfma_f32_16x16x32_bf16 v[32:35], a[56:59], a[88:91], v[32:35]
    s_add_u32 m0, s38, 67584
    s_add_u32 s46, s39, 0
    buffer_load_dwordx4 v6, s[16:19], s46 offen offset:0 nt lds
    buffer_load_dwordx4 v7, s[16:19], s46 offen offset:1056 nt lds
    v_mfma_f32_16x16x32_bf16 v[64:67], a[56:59], a[92:95], v[64:67]
    s_add_u32 m0, s38, 101376
    v_mfma_f32_16x16x32_bf16 v[96:99], a[56:59], a[96:99], v[96:99]
    s_add_u32 s46, s39, 8192
    buffer_load_dwordx4 v6, s[16:19], s46 offen offset:0 nt lds
    buffer_load_dwordx4 v7, s[16:19], s46 offen offset:1056 nt lds
    v_mfma_f32_16x16x32_bf16 v[128:131], a[56:59], a[100:103], v[128:131]
    v_mfma_f32_16x16x32_bf16 v[160:163], a[56:59], a[104:107], v[160:163]
    v_mfma_f32_16x16x32_bf16 v[192:195], a[56:59], a[108:111], v[192:195]
    s_add_u32 m0, s38, 84480
    v_mfma_f32_16x16x32_bf16 v[36:39], a[60:63], a[88:91], v[36:39]
    s_add_u32 s46, s39, 262144
    v_mfma_f32_16x16x32_bf16 v[68:71], a[60:63], a[92:95], v[68:71]
    buffer_load_dwordx4 v6, s[16:19], s46 offen offset:0 nt lds
    buffer_load_dwordx4 v7, s[16:19], s46 offen offset:1056 nt lds
    v_mfma_f32_16x16x32_bf16 v[100:103], a[60:63], a[96:99], v[100:103]
    v_mfma_f32_16x16x32_bf16 v[132:135], a[60:63], a[100:103], v[132:135]
    v_mfma_f32_16x16x32_bf16 v[164:167], a[60:63], a[104:107], v[164:167]
    s_add_u32 m0, s38, 118272
    v_mfma_f32_16x16x32_bf16 v[196:199], a[60:63], a[108:111], v[196:199]
    s_add_u32 s46, s39, 270336
    v_mfma_f32_16x16x32_bf16 v[40:43], a[64:67], a[88:91], v[40:43]
    buffer_load_dwordx4 v6, s[16:19], s46 offen offset:0 nt lds
    buffer_load_dwordx4 v7, s[16:19], s46 offen offset:1056 nt lds
    v_mfma_f32_16x16x32_bf16 v[72:75], a[64:67], a[92:95], v[72:75]
    v_mfma_f32_16x16x32_bf16 v[104:107], a[64:67], a[96:99], v[104:107]
    s_add_u32 s39, s39, 16384
    v_mfma_f32_16x16x32_bf16 v[136:139], a[64:67], a[100:103], v[136:139]
    s_add_u32 m0, s38, 76032
    v_mfma_f32_16x16x32_bf16 v[168:171], a[64:67], a[104:107], v[168:171]
    s_add_u32 s46, s40, 0
    v_mfma_f32_16x16x32_bf16 v[200:203], a[64:67], a[108:111], v[200:203]
    buffer_load_dwordx4 v6, s[96:99], s46 offen offset:0 nt lds
    buffer_load_dwordx4 v7, s[96:99], s46 offen offset:1056 nt lds
    v_mfma_f32_16x16x32_bf16 v[44:47], a[68:71], a[88:91], v[44:47]
    v_mfma_f32_16x16x32_bf16 v[76:79], a[68:71], a[92:95], v[76:79]
    v_mfma_f32_16x16x32_bf16 v[108:111], a[68:71], a[96:99], v[108:111]
    s_add_u32 m0, s38, 109824
    v_mfma_f32_16x16x32_bf16 v[140:143], a[68:71], a[100:103], v[140:143]
    s_add_u32 s46, s40, 8192
    v_mfma_f32_16x16x32_bf16 v[172:175], a[68:71], a[104:107], v[172:175]
    buffer_load_dwordx4 v6, s[96:99], s46 offen offset:0 nt lds
    buffer_load_dwordx4 v7, s[96:99], s46 offen offset:1056 nt lds
    v_mfma_f32_16x16x32_bf16 v[204:207], a[68:71], a[108:111], v[204:207]
    v_mfma_f32_16x16x32_bf16 v[48:51], a[72:75], a[88:91], v[48:51]
    v_mfma_f32_16x16x32_bf16 v[80:83], a[72:75], a[92:95], v[80:83]
    s_add_u32 m0, s38, 92928
    v_mfma_f32_16x16x32_bf16 v[112:115], a[72:75], a[96:99], v[112:115]
    s_add_u32 s46, s40, 262144
    v_mfma_f32_16x16x32_bf16 v[144:147], a[72:75], a[100:103], v[144:147]
    buffer_load_dwordx4 v6, s[96:99], s46 offen offset:0 nt lds
    buffer_load_dwordx4 v7, s[96:99], s46 offen offset:1056 nt lds
    v_mfma_f32_16x16x32_bf16 v[176:179], a[72:75], a[104:107], v[176:179]
    v_mfma_f32_16x16x32_bf16 v[208:211], a[72:75], a[108:111], v[208:211]
    v_mfma_f32_16x16x32_bf16 v[52:55], a[76:79], a[88:91], v[52:55]
    s_add_u32 m0, s38, 126720
    v_mfma_f32_16x16x32_bf16 v[84:87], a[76:79], a[92:95], v[84:87]
    s_add_u32 s46, s40, 270336
    v_mfma_f32_16x16x32_bf16 v[116:119], a[76:79], a[96:99], v[116:119]
    buffer_load_dwordx4 v6, s[96:99], s46 offen offset:0 nt lds
    buffer_load_dwordx4 v7, s[96:99], s46 offen offset:1056 nt lds
    s_add_u32 s40, s40, 16384
    v_mfma_f32_16x16x32_bf16 v[148:151], a[76:79], a[100:103], v[148:151]
    v_mfma_f32_16x16x32_bf16 v[180:183], a[76:79], a[104:107], v[180:183]
    v_mfma_f32_16x16x32_bf16 v[212:215], a[76:79], a[108:111], v[212:215]
    v_mfma_f32_16x16x32_bf16 v[56:59], a[80:83], a[88:91], v[56:59]
    v_mfma_f32_16x16x32_bf16 v[88:91], a[80:83], a[92:95], v[88:91]
    v_mfma_f32_16x16x32_bf16 v[120:123], a[80:83], a[96:99], v[120:123]
    v_mfma_f32_16x16x32_bf16 v[152:155], a[80:83], a[100:103], v[152:155]
    v_mfma_f32_16x16x32_bf16 v[184:187], a[80:83], a[104:107], v[184:187]
    v_mfma_f32_16x16x32_bf16 v[216:219], a[80:83], a[108:111], v[216:219]
    v_mfma_f32_16x16x32_bf16 v[60:63], a[84:87], a[88:91], v[60:63]
    v_mfma_f32_16x16x32_bf16 v[92:95], a[84:87], a[92:95], v[92:95]
    v_mfma_f32_16x16x32_bf16 v[124:127], a[84:87], a[96:99], v[124:127]
    v_mfma_f32_16x16x32_bf16 v[156:159], a[84:87], a[100:103], v[156:159]
    v_mfma_f32_16x16x32_bf16 v[188:191], a[84:87], a[104:107], v[188:191]
    v_mfma_f32_16x16x32_bf16 v[220:223], a[84:87], a[108:111], v[220:223]
    s_and_b32 s46, s2, 127
    s_lshl_b32 s46, s46, 15
    s_lshl_b32 s47, s32, 13
    s_add_u32 s46, s46, s47
    v_lshlrev_b32 v248, 6, v1
    s_and_b32 s57, s57, 0xffff
    s_mov_b32 s58, 4194304
    s_mov_b32 s59, 0x20000
    s_waitcnt vmcnt(16)
    s_waitcnt lgkmcnt(0)
    s_barrier
    ds_read_b128 a[192:195], v2 offset:0
    ds_read_b128 a[196:199], v2 offset:64
    ds_read_b128 a[200:203], v2 offset:128
    ds_read_b128 a[204:207], v2 offset:192
    ds_read_b128 a[208:211], v2 offset:512
    ds_read_b128 a[212:215], v2 offset:576
    ds_read_b128 a[216:219], v2 offset:640
    ds_read_b128 a[220:223], v2 offset:704
    ds_read_b64_tr_b16 a[224:225], v4 offset:0
    ds_read_b64_tr_b16 a[226:227], v4 offset:512
    ds_read_b64_tr_b16 a[228:229], v4 offset:32
    ds_read_b64_tr_b16 a[230:231], v4 offset:544
    ds_read_b64_tr_b16 a[232:233], v4 offset:64
    ds_read_b64_tr_b16 a[234:235], v4 offset:576
    ds_read_b64_tr_b16 a[236:237], v4 offset:96
    ds_read_b64_tr_b16 a[238:239], v4 offset:608
    ds_read_b64_tr_b16 a[240:241], v4 offset:128
    ds_read_b64_tr_b16 a[242:243], v4 offset:640
    ds_read_b64_tr_b16 a[244:245], v4 offset:160
    ds_read_b64_tr_b16 a[246:247], v4 offset:672
    ds_read_b64_tr_b16 a[248:249], v4 offset:192
    ds_read_b64_tr_b16 a[250:251], v4 offset:704
    ds_read_b64_tr_b16 a[252:253], v4 offset:224
    ds_read_b64_tr_b16 a[254:255], v4 offset:736
    v_lshrrev_b32 v18, 3, v1
    v_bfe_u32 v21, v1, 4, 2
    v_lshlrev_b32 v21, 1, v21
    v_and_b32 v19, 7, v1
    v_xor_b32 v21, v21, v19
    v_lshlrev_b32 v21, 4, v21
    v_lshl_add_u32 v27, v18, 10, v21
    s_lshl_b32 s46, s34, 15
    s_lshl_b32 s47, s33, 9
    s_add_u32 s46, s46, s47
    s_lshl_b32 s47, s33, 17
    s_add_u32 s50, s46, s47
    s_xor_b32 s47, s47, 0x20000
    s_add_u32 s51, s46, s47
    s_lshl_b32 s52, s33, 13
    s_lshl_b32 s47, s34, 12
    s_add_u32 s52, s52, s47
    s_lshl_b32 s47, s37, 18
    s_add_u32 s20, s14, s47
    s_addc_u32 s21, s15, 0
    s_and_b32 s21, s21, 0xffff
    s_mov_b32 s22, 262144
    s_mov_b32 s23, 0x20000
    s_mov_b32 s46, 0x3e0293ee
    s_mov_b32 s47, 0x3e0293ee
    v_pk_mul_f32 v[32:33], v[32:33], s[46:47]
    v_pk_mul_f32 v[34:35], v[34:35], s[46:47]
    v_pk_mul_f32 v[36:37], v[36:37], s[46:47]
    v_pk_mul_f32 v[38:39], v[38:39], s[46:47]
    v_cvt_pk_bf16_f32 v32, v32, v33
    v_cvt_pk_bf16_f32 v33, v34, v35
    v_cvt_pk_bf16_f32 v34, v36, v37
    v_cvt_pk_bf16_f32 v35, v38, v39
    v_pk_mul_f32 v[40:41], v[40:41], s[46:47]
    v_pk_mul_f32 v[42:43], v[42:43], s[46:47]
    v_pk_mul_f32 v[44:45], v[44:45], s[46:47]
    v_pk_mul_f32 v[46:47], v[46:47], s[46:47]
    v_cvt_pk_bf16_f32 v36, v40, v41
    v_cvt_pk_bf16_f32 v37, v42, v43
    v_cvt_pk_bf16_f32 v38, v44, v45
    v_cvt_pk_bf16_f32 v39, v46, v47
    v_pk_mul_f32 v[48:49], v[48:49], s[46:47]
    v_pk_mul_f32 v[50:51], v[50:51], s[46:47]
    v_pk_mul_f32 v[52:53], v[52:53], s[46:47]
    v_pk_mul_f32 v[54:55], v[54:55], s[46:47]
    v_cvt_pk_bf16_f32 v40, v48, v49
    v_cvt_pk_bf16_f32 v41, v50, v51
    v_cvt_pk_bf16_f32 v42, v52, v53
    v_cvt_pk_bf16_f32 v43, v54, v55
    v_pk_mul_f32 v[56:57], v[56:57], s[46:47]
    v_pk_mul_f32 v[58:59], v[58:59], s[46:47]
    v_pk_mul_f32 v[60:61], v[60:61], s[46:47]
    v_pk_mul_f32 v[62:63], v[62:63], s[46:47]
    v_cvt_pk_bf16_f32 v44, v56, v57
    v_cvt_pk_bf16_f32 v45, v58, v59
    v_cvt_pk_bf16_f32 v46, v60, v61
    v_cvt_pk_bf16_f32 v47, v62, v63
    v_pk_mul_f32 v[64:65], v[64:65], s[46:47]
    v_pk_mul_f32 v[66:67], v[66:67], s[46:47]
    v_pk_mul_f32 v[68:69], v[68:69], s[46:47]
    v_pk_mul_f32 v[70:71], v[70:71], s[46:47]
    v_cvt_pk_bf16_f32 v48, v64, v65
    v_cvt_pk_bf16_f32 v49, v66, v67
    v_cvt_pk_bf16_f32 v50, v68, v69
    v_cvt_pk_bf16_f32 v51, v70, v71
    v_pk_mul_f32 v[72:73], v[72:73], s[46:47]
    v_pk_mul_f32 v[74:75], v[74:75], s[46:47]
    v_pk_mul_f32 v[76:77], v[76:77], s[46:47]
    v_pk_mul_f32 v[78:79], v[78:79], s[46:47]
    v_cvt_pk_bf16_f32 v52, v72, v73
    v_cvt_pk_bf16_f32 v53, v74, v75
    v_cvt_pk_bf16_f32 v54, v76, v77
    v_cvt_pk_bf16_f32 v55, v78, v79
    v_pk_mul_f32 v[80:81], v[80:81], s[46:47]
    v_pk_mul_f32 v[82:83], v[82:83], s[46:47]
    v_pk_mul_f32 v[84:85], v[84:85], s[46:47]
    v_pk_mul_f32 v[86:87], v[86:87], s[46:47]
    v_cvt_pk_bf16_f32 v56, v80, v81
    v_cvt_pk_bf16_f32 v57, v82, v83
    v_cvt_pk_bf16_f32 v58, v84, v85
    v_cvt_pk_bf16_f32 v59, v86, v87
    v_pk_mul_f32 v[88:89], v[88:89], s[46:47]
    v_pk_mul_f32 v[90:91], v[90:91], s[46:47]
    v_pk_mul_f32 v[92:93], v[92:93], s[46:47]
    v_pk_mul_f32 v[94:95], v[94:95], s[46:47]
    v_cvt_pk_bf16_f32 v60, v88, v89
    v_cvt_pk_bf16_f32 v61, v90, v91
    v_cvt_pk_bf16_f32 v62, v92, v93
    v_cvt_pk_bf16_f32 v63, v94, v95
    v_pk_mul_f32 v[96:97], v[96:97], s[46:47]
    v_pk_mul_f32 v[98:99], v[98:99], s[46:47]
    v_pk_mul_f32 v[100:101], v[100:101], s[46:47]
    v_pk_mul_f32 v[102:103], v[102:103], s[46:47]
    v_cvt_pk_bf16_f32 v64, v96, v97
    v_cvt_pk_bf16_f32 v65, v98, v99
    v_cvt_pk_bf16_f32 v66, v100, v101
    v_cvt_pk_bf16_f32 v67, v102, v103
    v_pk_mul_f32 v[104:105], v[104:105], s[46:47]
    v_pk_mul_f32 v[106:107], v[106:107], s[46:47]
    v_pk_mul_f32 v[108:109], v[108:109], s[46:47]
    v_pk_mul_f32 v[110:111], v[110:111], s[46:47]
    v_cvt_pk_bf16_f32 v68, v104, v105
    v_cvt_pk_bf16_f32 v69, v106, v107
    v_cvt_pk_bf16_f32 v70, v108, v109
    v_cvt_pk_bf16_f32 v71, v110, v111
    v_pk_mul_f32 v[112:113], v[112:113], s[46:47]
    v_pk_mul_f32 v[114:115], v[114:115], s[46:47]
    v_pk_mul_f32 v[116:117], v[116:117], s[46:47]
    v_pk_mul_f32 v[118:119], v[118:119], s[46:47]
    v_cvt_pk_bf16_f32 v72, v112, v113
    v_cvt_pk_bf16_f32 v73, v114, v115
    v_cvt_pk_bf16_f32 v74, v116, v117
    v_cvt_pk_bf16_f32 v75, v118, v119
    v_pk_mul_f32 v[120:121], v[120:121], s[46:47]
    v_pk_mul_f32 v[122:123], v[122:123], s[46:47]
    v_pk_mul_f32 v[124:125], v[124:125], s[46:47]
    v_pk_mul_f32 v[126:127], v[126:127], s[46:47]
    v_cvt_pk_bf16_f32 v76, v120, v121
    v_cvt_pk_bf16_f32 v77, v122, v123
    v_cvt_pk_bf16_f32 v78, v124, v125
    v_cvt_pk_bf16_f32 v79, v126, v127
    v_pk_mul_f32 v[128:129], v[128:129], s[46:47]
    v_pk_mul_f32 v[130:131], v[130:131], s[46:47]
    v_pk_mul_f32 v[132:133], v[132:133], s[46:47]
    v_pk_mul_f32 v[134:135], v[134:135], s[46:47]
    v_cvt_pk_bf16_f32 v80, v128, v129
    v_cvt_pk_bf16_f32 v81, v130, v131
    v_cvt_pk_bf16_f32 v82, v132, v133
    v_cvt_pk_bf16_f32 v83, v134, v135
    v_pk_mul_f32 v[136:137], v[136:137], s[46:47]
    v_pk_mul_f32 v[138:139], v[138:139], s[46:47]
    v_pk_mul_f32 v[140:141], v[140:141], s[46:47]
    v_pk_mul_f32 v[142:143], v[142:143], s[46:47]
    v_cvt_pk_bf16_f32 v84, v136, v137
    v_cvt_pk_bf16_f32 v85, v138, v139
    v_cvt_pk_bf16_f32 v86, v140, v141
    v_cvt_pk_bf16_f32 v87, v142, v143
    v_pk_mul_f32 v[144:145], v[144:145], s[46:47]
    v_pk_mul_f32 v[146:147], v[146:147], s[46:47]
    v_pk_mul_f32 v[148:149], v[148:149], s[46:47]
    v_pk_mul_f32 v[150:151], v[150:151], s[46:47]
    v_cvt_pk_bf16_f32 v88, v144, v145
    v_cvt_pk_bf16_f32 v89, v146, v147
    v_cvt_pk_bf16_f32 v90, v148, v149
    v_cvt_pk_bf16_f32 v91, v150, v151
    v_pk_mul_f32 v[152:153], v[152:153], s[46:47]
    v_pk_mul_f32 v[154:155], v[154:155], s[46:47]
    v_pk_mul_f32 v[156:157], v[156:157], s[46:47]
    v_pk_mul_f32 v[158:159], v[158:159], s[46:47]
    v_cvt_pk_bf16_f32 v92, v152, v153
    v_cvt_pk_bf16_f32 v93, v154, v155
    v_cvt_pk_bf16_f32 v94, v156, v157
    v_cvt_pk_bf16_f32 v95, v158, v159
    v_pk_mul_f32 v[160:161], v[160:161], s[46:47]
    v_pk_mul_f32 v[162:163], v[162:163], s[46:47]
    v_pk_mul_f32 v[164:165], v[164:165], s[46:47]
    v_pk_mul_f32 v[166:167], v[166:167], s[46:47]
    v_cvt_pk_bf16_f32 v96, v160, v161
    v_cvt_pk_bf16_f32 v97, v162, v163
    v_cvt_pk_bf16_f32 v98, v164, v165
    v_cvt_pk_bf16_f32 v99, v166, v167
    v_pk_mul_f32 v[168:169], v[168:169], s[46:47]
    v_pk_mul_f32 v[170:171], v[170:171], s[46:47]
    v_pk_mul_f32 v[172:173], v[172:173], s[46:47]
    v_pk_mul_f32 v[174:175], v[174:175], s[46:47]
    v_cvt_pk_bf16_f32 v100, v168, v169
    v_cvt_pk_bf16_f32 v101, v170, v171
    v_cvt_pk_bf16_f32 v102, v172, v173
    v_cvt_pk_bf16_f32 v103, v174, v175
    v_pk_mul_f32 v[176:177], v[176:177], s[46:47]
    v_pk_mul_f32 v[178:179], v[178:179], s[46:47]
    v_pk_mul_f32 v[180:181], v[180:181], s[46:47]
    v_pk_mul_f32 v[182:183], v[182:183], s[46:47]
    v_cvt_pk_bf16_f32 v104, v176, v177
    v_cvt_pk_bf16_f32 v105, v178, v179
    v_cvt_pk_bf16_f32 v106, v180, v181
    v_cvt_pk_bf16_f32 v107, v182, v183
    v_pk_mul_f32 v[184:185], v[184:185], s[46:47]
    v_pk_mul_f32 v[186:187], v[186:187], s[46:47]
    v_pk_mul_f32 v[188:189], v[188:189], s[46:47]
    v_pk_mul_f32 v[190:191], v[190:191], s[46:47]
    v_cvt_pk_bf16_f32 v108, v184, v185
    v_cvt_pk_bf16_f32 v109, v186, v187
    v_cvt_pk_bf16_f32 v110, v188, v189
    v_cvt_pk_bf16_f32 v111, v190, v191
    v_pk_mul_f32 v[192:193], v[192:193], s[46:47]
    v_pk_mul_f32 v[194:195], v[194:195], s[46:47]
    v_pk_mul_f32 v[196:197], v[196:197], s[46:47]
    v_pk_mul_f32 v[198:199], v[198:199], s[46:47]
    v_cvt_pk_bf16_f32 v112, v192, v193
    v_cvt_pk_bf16_f32 v113, v194, v195
    v_cvt_pk_bf16_f32 v114, v196, v197
    v_cvt_pk_bf16_f32 v115, v198, v199
    v_pk_mul_f32 v[200:201], v[200:201], s[46:47]
    v_pk_mul_f32 v[202:203], v[202:203], s[46:47]
    v_pk_mul_f32 v[204:205], v[204:205], s[46:47]
    v_pk_mul_f32 v[206:207], v[206:207], s[46:47]
    v_cvt_pk_bf16_f32 v116, v200, v201
    v_cvt_pk_bf16_f32 v117, v202, v203
    v_cvt_pk_bf16_f32 v118, v204, v205
    v_cvt_pk_bf16_f32 v119, v206, v207
    v_pk_mul_f32 v[208:209], v[208:209], s[46:47]
    v_pk_mul_f32 v[210:211], v[210:211], s[46:47]
    v_pk_mul_f32 v[212:213], v[212:213], s[46:47]
    v_pk_mul_f32 v[214:215], v[214:215], s[46:47]
    v_cvt_pk_bf16_f32 v120, v208, v209
    v_cvt_pk_bf16_f32 v121, v210, v211
    v_cvt_pk_bf16_f32 v122, v212, v213
    v_cvt_pk_bf16_f32 v123, v214, v215
    v_pk_mul_f32 v[216:217], v[216:217], s[46:47]
    v_pk_mul_f32 v[218:219], v[218:219], s[46:47]
    v_pk_mul_f32 v[220:221], v[220:221], s[46:47]
    v_pk_mul_f32 v[222:223], v[222:223], s[46:47]
    v_cvt_pk_bf16_f32 v124, v216, v217
    v_cvt_pk_bf16_f32 v125, v218, v219
    v_cvt_pk_bf16_f32 v126, v220, v221
    v_cvt_pk_bf16_f32 v127, v222, v223
    s_waitcnt lgkmcnt(0)
    v_mfma_f32_16x16x32_bf16 v[128:131], a[192:195], v[32:35], 0
    v_mfma_f32_16x16x32_bf16 v[136:139], a[192:195], v[48:51], 0
    v_mfma_f32_16x16x32_bf16 v[128:131], a[196:199], v[36:39], v[128:131]
    v_mfma_f32_16x16x32_bf16 v[136:139], a[196:199], v[52:55], v[136:139]
    v_mfma_f32_16x16x32_bf16 v[128:131], a[200:203], v[40:43], v[128:131]
    v_mfma_f32_16x16x32_bf16 v[136:139], a[200:203], v[56:59], v[136:139]
    v_mfma_f32_16x16x32_bf16 v[128:131], a[204:207], v[44:47], v[128:131]
    v_mfma_f32_16x16x32_bf16 v[136:139], a[204:207], v[60:63], v[136:139]
    v_mfma_f32_16x16x32_bf16 v[132:135], a[208:211], v[32:35], 0
    v_mfma_f32_16x16x32_bf16 v[140:143], a[208:211], v[48:51], 0
    v_mfma_f32_16x16x32_bf16 v[132:135], a[212:215], v[36:39], v[132:135]
    v_mfma_f32_16x16x32_bf16 v[140:143], a[212:215], v[52:55], v[140:143]
    v_mfma_f32_16x16x32_bf16 v[132:135], a[216:219], v[40:43], v[132:135]
    v_mfma_f32_16x16x32_bf16 v[140:143], a[216:219], v[56:59], v[140:143]
    v_mfma_f32_16x16x32_bf16 v[132:135], a[220:223], v[44:47], v[132:135]
    v_mfma_f32_16x16x32_bf16 v[140:143], a[220:223], v[60:63], v[140:143]
    s_nop 7
    v_max3_f32 v14, v128, v129, v130
    v_max3_f32 v15, v136, v137, v138
    v_max3_f32 v14, v14, v131, v132
    v_max3_f32 v15, v15, v139, v140
    v_max3_f32 v14, v14, v133, v134
    v_max3_f32 v15, v15, v141, v142
    v_max_f32 v14, v14, v135
    v_max_f32 v15, v15, v143
    v_mov_b32 v16, v14
    s_nop 1
    v_permlane16_swap_b32 v14, v16
    s_nop 1
    v_max_f32 v14, v14, v16
    v_mov_b32 v16, v14
    s_nop 1
    v_permlane32_swap_b32 v14, v16
    s_nop 1
    v_max_f32 v14, v14, v16
    v_sub_f32 v128, v128, v14
    v_sub_f32 v129, v129, v14
    v_sub_f32 v130, v130, v14
    v_sub_f32 v131, v131, v14
    v_sub_f32 v132, v132, v14
    v_sub_f32 v133, v133, v14
    v_sub_f32 v134, v134, v14
    v_sub_f32 v135, v135, v14
    v_sub_f32 v176, 0, v14
    v_sub_f32 v177, 0, v14
    v_sub_f32 v178, 0, v14
    v_sub_f32 v179, 0, v14
    v_mov_b32 v8, 0
    v_mov_b32 v16, v15
    s_nop 1
    v_permlane16_swap_b32 v15, v16
    s_nop 1
    v_max_f32 v15, v15, v16
    v_mov_b32 v16, v15
    s_nop 1
    v_permlane32_swap_b32 v15, v16
    s_nop 1
    v_max_f32 v15, v15, v16
    v_sub_f32 v136, v136, v15
    v_sub_f32 v137, v137, v15
    v_sub_f32 v138, v138, v15
    v_sub_f32 v139, v139, v15
    v_sub_f32 v140, v140, v15
    v_sub_f32 v141, v141, v15
    v_sub_f32 v142, v142, v15
    v_sub_f32 v143, v143, v15
    v_sub_f32 v180, 0, v15
    v_sub_f32 v181, 0, v15
    v_sub_f32 v182, 0, v15
    v_sub_f32 v183, 0, v15
    v_mov_b32 v9, 0
    v_exp_f32 v128, v128
    v_exp_f32 v129, v129
    v_exp_f32 v130, v130
    v_add_f32 v8, v8, v128
    v_add_f32 v8, v8, v129
    v_exp_f32 v131, v131
    v_exp_f32 v136, v136
    v_add_f32 v8, v8, v130
    v_cvt_pk_bf16_f32 v200, v128, v129
    v_add_f32 v8, v8, v131
    v_cvt_pk_bf16_f32 v201, v130, v131
    v_exp_f32 v137, v137
    v_exp_f32 v138, v138
    v_add_f32 v9, v9, v136
    v_add_f32 v9, v9, v137
    v_mfma_f32_16x16x32_bf16 v[144:147], a[192:195], v[64:67], 0
    v_exp_f32 v139, v139
    v_mfma_f32_16x16x32_bf16 v[152:155], a[192:195], v[80:83], 0
    v_exp_f32 v132, v132
    v_mfma_f32_16x16x32_bf16 v[144:147], a[196:199], v[68:71], v[144:147]
    v_add_f32 v9, v9, v138
    v_cvt_pk_bf16_f32 v204, v136, v137
    v_mfma_f32_16x16x32_bf16 v[152:155], a[196:199], v[84:87], v[152:155]
    v_add_f32 v9, v9, v139
    v_cvt_pk_bf16_f32 v205, v138, v139
    v_mfma_f32_16x16x32_bf16 v[144:147], a[200:203], v[72:75], v[144:147]
    v_exp_f32 v133, v133
    v_mfma_f32_16x16x32_bf16 v[152:155], a[200:203], v[88:91], v[152:155]
    v_exp_f32 v134, v134
    v_mfma_f32_16x16x32_bf16 v[144:147], a[204:207], v[76:79], v[144:147]
    v_add_f32 v8, v8, v132
    v_add_f32 v8, v8, v133
    v_mfma_f32_16x16x32_bf16 v[152:155], a[204:207], v[92:95], v[152:155]
    v_exp_f32 v135, v135
    v_mfma_f32_16x16x32_bf16 v[148:151], a[208:211], v[64:67], 0
    v_exp_f32 v140, v140
    v_mfma_f32_16x16x32_bf16 v[156:159], a[208:211], v[80:83], 0
    v_add_f32 v8, v8, v134
    v_cvt_pk_bf16_f32 v202, v132, v133
    v_mfma_f32_16x16x32_bf16 v[148:151], a[212:215], v[68:71], v[148:151]
    v_add_f32 v8, v8, v135
    v_cvt_pk_bf16_f32 v203, v134, v135
    v_mfma_f32_16x16x32_bf16 v[156:159], a[212:215], v[84:87], v[156:159]
    v_exp_f32 v141, v141
    v_mfma_f32_16x16x32_bf16 v[148:151], a[216:219], v[72:75], v[148:151]
    v_exp_f32 v142, v142
    v_add_f32 v9, v9, v140
    v_add_f32 v9, v9, v141
    v_mfma_f32_16x16x32_bf16 v[156:159], a[216:219], v[88:91], v[156:159]
    v_exp_f32 v143, v143
    s_nop 0
    v_add_f32 v9, v9, v142
    v_cvt_pk_bf16_f32 v206, v140, v141
    v_add_f32 v9, v9, v143
    v_cvt_pk_bf16_f32 v207, v142, v143
    v_mfma_f32_16x16x32_bf16 v[148:151], a[220:223], v[76:79], v[148:151]
    v_mfma_f32_16x16x32_bf16 v[156:159], a[220:223], v[92:95], v[156:159]
    s_waitcnt lgkmcnt(0)
    v_mfma_f32_16x16x32_bf16 a[0:3], a[224:227], v[200:203], 0
    v_mfma_f32_16x16x32_bf16 a[32:35], a[224:227], v[204:207], 0
    v_mfma_f32_16x16x32_bf16 a[4:7], a[228:231], v[200:203], 0
    v_max3_f32 v14, v144, v145, v146
    v_max3_f32 v15, v152, v153, v154
    v_mfma_f32_16x16x32_bf16 a[36:39], a[228:231], v[204:207], 0
    v_max3_f32 v14, v14, v147, v148
    v_max3_f32 v15, v15, v155, v156
    v_mfma_f32_16x16x32_bf16 a[8:11], a[232:235], v[200:203], 0
    v_max3_f32 v14, v14, v149, v150
    v_max3_f32 v15, v15, v157, v158
    v_mfma_f32_16x16x32_bf16 a[40:43], a[232:235], v[204:207], 0
    v_max_f32 v14, v14, v151
    v_max_f32 v15, v15, v159
    v_mfma_f32_16x16x32_bf16 a[12:15], a[236:239], v[200:203], 0
    v_mov_b32 v16, v14
    s_nop 1
    v_permlane16_swap_b32 v14, v16
    s_nop 1
    v_max_f32 v14, v14, v16
    v_mov_b32 v16, v14
    s_nop 1
    v_permlane32_swap_b32 v14, v16
    s_nop 1
    v_max_f32 v14, v14, v16
    v_mfma_f32_16x16x32_bf16 a[44:47], a[236:239], v[204:207], 0
    v_sub_f32 v144, v144, v14
    v_sub_f32 v145, v145, v14
    v_sub_f32 v146, v146, v14
    v_sub_f32 v147, v147, v14
    v_sub_f32 v148, v148, v14
    v_sub_f32 v149, v149, v14
    v_sub_f32 v150, v150, v14
    v_sub_f32 v151, v151, v14
    v_sub_f32 v184, 0, v14
    v_sub_f32 v185, 0, v14
    v_sub_f32 v186, 0, v14
    v_sub_f32 v187, 0, v14
    v_mov_b32 v10, 0
    v_mov_b32 v16, v15
    s_nop 1
    v_permlane16_swap_b32 v15, v16
    s_nop 1
    v_max_f32 v15, v15, v16
    v_mov_b32 v16, v15
    s_nop 1
    v_permlane32_swap_b32 v15, v16
    s_nop 1
    v_max_f32 v15, v15, v16
    v_mfma_f32_16x16x32_bf16 a[16:19], a[240:243], v[200:203], 0
    v_sub_f32 v152, v152, v15
    v_sub_f32 v153, v153, v15
    v_mfma_f32_16x16x32_bf16 a[48:51], a[240:243], v[204:207], 0
    v_sub_f32 v154, v154, v15
    v_sub_f32 v155, v155, v15
    v_mfma_f32_16x16x32_bf16 a[20:23], a[244:247], v[200:203], 0
    v_sub_f32 v156, v156, v15
    v_sub_f32 v157, v157, v15
    v_mfma_f32_16x16x32_bf16 a[52:55], a[244:247], v[204:207], 0
    v_sub_f32 v158, v158, v15
    v_sub_f32 v159, v159, v15
    v_mfma_f32_16x16x32_bf16 a[24:27], a[248:251], v[200:203], 0
    v_sub_f32 v188, 0, v15
    v_sub_f32 v189, 0, v15
    v_mfma_f32_16x16x32_bf16 a[56:59], a[248:251], v[204:207], 0
    v_sub_f32 v190, 0, v15
    v_sub_f32 v191, 0, v15
    v_mfma_f32_16x16x32_bf16 a[28:31], a[252:255], v[200:203], 0
    v_mov_b32 v11, 0
    v_exp_f32 v144, v144
    v_mfma_f32_16x16x32_bf16 a[60:63], a[252:255], v[204:207], 0
    v_exp_f32 v145, v145
    v_exp_f32 v146, v146
    s_waitcnt vmcnt(16)
    s_barrier
    v_mfma_f32_16x16x32_bf16 v[160:163], a[192:195], v[96:99], 0
    v_add_f32 v10, v10, v144
    v_add_f32 v10, v10, v145
    v_exp_f32 v147, v147
    v_mfma_f32_16x16x32_bf16 v[168:171], a[192:195], v[112:115], 0
    v_exp_f32 v152, v152
    v_mfma_f32_16x16x32_bf16 v[160:163], a[196:199], v[100:103], v[160:163]
    v_add_f32 v10, v10, v146
    v_cvt_pk_bf16_f32 v208, v144, v145
    v_add_f32 v10, v10, v147
    v_cvt_pk_bf16_f32 v209, v146, v147
    v_mfma_f32_16x16x32_bf16 v[168:171], a[196:199], v[116:119], v[168:171]
    v_exp_f32 v153, v153
    v_exp_f32 v154, v154
    v_mfma_f32_16x16x32_bf16 v[160:163], a[200:203], v[104:107], v[160:163]
    v_add_f32 v11, v11, v152
    v_add_f32 v11, v11, v153
    v_mfma_f32_16x16x32_bf16 v[168:171], a[200:203], v[120:123], v[168:171]
    v_exp_f32 v155, v155
    v_exp_f32 v148, v148
    v_mfma_f32_16x16x32_bf16 v[160:163], a[204:207], v[108:111], v[160:163]
    ds_read_b128 a[192:195], v2 offset:33792
    ds_read_b128 a[196:199], v2 offset:33856
    v_add_f32 v11, v11, v154
    v_cvt_pk_bf16_f32 v212, v152, v153
    v_add_f32 v11, v11, v155
    v_cvt_pk_bf16_f32 v213, v154, v155
    v_mfma_f32_16x16x32_bf16 v[168:171], a[204:207], v[124:127], v[168:171]
    v_exp_f32 v149, v149
    v_exp_f32 v150, v150
    v_mfma_f32_16x16x32_bf16 v[164:167], a[208:211], v[96:99], 0
    v_add_f32 v10, v10, v148
    v_add_f32 v10, v10, v149
    ds_read_b128 a[200:203], v2 offset:33920
    ds_read_b128 a[204:207], v2 offset:33984
    v_mfma_f32_16x16x32_bf16 v[172:175], a[208:211], v[112:115], 0
    v_exp_f32 v151, v151
    v_exp_f32 v156, v156
    v_mfma_f32_16x16x32_bf16 v[164:167], a[212:215], v[100:103], v[164:167]
    v_add_f32 v10, v10, v150
    v_cvt_pk_bf16_f32 v210, v148, v149
    v_add_f32 v10, v10, v151
    v_cvt_pk_bf16_f32 v211, v150, v151
    v_mfma_f32_16x16x32_bf16 v[172:175], a[212:215], v[116:119], v[172:175]
    v_exp_f32 v157, v157
    v_mfma_f32_16x16x32_bf16 v[164:167], a[216:219], v[104:107], v[164:167]
    v_exp_f32 v158, v158
    v_add_f32 v11, v11, v156
    v_add_f32 v11, v11, v157
    v_mfma_f32_16x16x32_bf16 v[172:175], a[216:219], v[120:123], v[172:175]
    s_sub_u32 s40, s40, 8192
    v_exp_f32 v159, v159
    s_nop 0
    v_add_f32 v11, v11, v158
    v_cvt_pk_bf16_f32 v214, v156, v157
    v_add_f32 v11, v11, v159
    v_cvt_pk_bf16_f32 v215, v158, v159
    v_mfma_f32_16x16x32_bf16 v[164:167], a[220:223], v[108:111], v[164:167]
    s_add_u32 m0, s38, 8448
    ds_read_b128 a[208:211], v2 offset:34304
    ds_read_b128 a[212:215], v2 offset:34368
    v_mfma_f32_16x16x32_bf16 v[172:175], a[220:223], v[124:127], v[172:175]
    s_add_u32 s46, s40, 8192
    ds_read_b128 a[216:219], v2 offset:34432
    ds_read_b128 a[220:223], v2 offset:34496
    v_mfma_f32_16x16x32_bf16 a[64:67], a[224:227], v[208:211], 0
    s_waitcnt vmcnt(4)
    buffer_load_dwordx4 v6, s[96:99], s46 offen offset:0 nt lds
    buffer_load_dwordx4 v7, s[96:99], s46 offen offset:1056 nt lds
    v_mfma_f32_16x16x32_bf16 a[96:99], a[224:227], v[212:215], 0
    v_mfma_f32_16x16x32_bf16 a[68:71], a[228:231], v[208:211], 0
    v_max3_f32 v14, v160, v161, v162
    v_max3_f32 v15, v168, v169, v170
    v_mfma_f32_16x16x32_bf16 a[100:103], a[228:231], v[212:215], 0
    v_max3_f32 v14, v14, v163, v164
    v_max3_f32 v15, v15, v171, v172
    v_mfma_f32_16x16x32_bf16 a[72:75], a[232:235], v[208:211], 0
    v_max3_f32 v14, v14, v165, v166
    v_max3_f32 v15, v15, v173, v174
    v_mfma_f32_16x16x32_bf16 a[104:107], a[232:235], v[212:215], 0
    v_max_f32 v14, v14, v167
    v_max_f32 v15, v15, v175
    v_mfma_f32_16x16x32_bf16 a[76:79], a[236:239], v[208:211], 0
    v_mov_b32 v16, v14
    s_nop 1
    v_permlane16_swap_b32 v14, v16
    s_nop 1
    v_max_f32 v14, v14, v16
    v_mov_b32 v16, v14
    s_nop 1
    v_permlane32_swap_b32 v14, v16
    s_nop 1
    v_max_f32 v14, v14, v16
    v_mfma_f32_16x16x32_bf16 a[108:111], a[236:239], v[212:215], 0
    v_sub_f32 v160, v160, v14
    v_sub_f32 v161, v161, v14
    v_sub_f32 v162, v162, v14
    v_sub_f32 v163, v163, v14
    v_sub_f32 v164, v164, v14
    v_sub_f32 v165, v165, v14
    v_sub_f32 v166, v166, v14
    v_sub_f32 v167, v167, v14
    v_sub_f32 v192, 0, v14
    v_sub_f32 v193, 0, v14
    v_sub_f32 v194, 0, v14
    v_sub_f32 v195, 0, v14
    v_mov_b32 v12, 0
    v_mov_b32 v16, v15
    s_nop 1
    v_permlane16_swap_b32 v15, v16
    s_nop 1
    v_max_f32 v15, v15, v16
    v_mov_b32 v16, v15
    s_nop 1
    v_permlane32_swap_b32 v15, v16
    s_nop 1
    v_max_f32 v15, v15, v16
    v_mfma_f32_16x16x32_bf16 a[80:83], a[240:243], v[208:211], 0
    v_sub_f32 v168, v168, v15
    v_sub_f32 v169, v169, v15
    v_mfma_f32_16x16x32_bf16 a[112:115], a[240:243], v[212:215], 0
    v_sub_f32 v170, v170, v15
    v_sub_f32 v171, v171, v15
    v_mfma_f32_16x16x32_bf16 a[84:87], a[244:247], v[208:211], 0
    v_sub_f32 v172, v172, v15
    v_sub_f32 v173, v173, v15
    v_mfma_f32_16x16x32_bf16 a[116:119], a[244:247], v[212:215], 0
    v_sub_f32 v174, v174, v15
    v_sub_f32 v175, v175, v15
    v_mfma_f32_16x16x32_bf16 a[88:91], a[248:251], v[208:211], 0
    v_sub_f32 v196, 0, v15
    v_sub_f32 v197, 0, v15
    v_mfma_f32_16x16x32_bf16 a[120:123], a[248:251], v[212:215], 0
    v_sub_f32 v198, 0, v15
    v_sub_f32 v199, 0, v15
    v_mfma_f32_16x16x32_bf16 a[92:95], a[252:255], v[208:211], 0
    v_mov_b32 v13, 0
    v_exp_f32 v160, v160
    v_mfma_f32_16x16x32_bf16 a[124:127], a[252:255], v[212:215], 0
    v_exp_f32 v161, v161
    v_exp_f32 v162, v162
    s_waitcnt lgkmcnt(0)
    v_mfma_f32_16x16x32_bf16 v[128:131], a[192:195], v[32:35], v[176:179]
    v_add_f32 v12, v12, v160
    v_add_f32 v12, v12, v161
    v_exp_f32 v163, v163
    v_mfma_f32_16x16x32_bf16 v[136:139], a[192:195], v[48:51], v[180:183]
    v_exp_f32 v168, v168
    v_mfma_f32_16x16x32_bf16 v[128:131], a[196:199], v[36:39], v[128:131]
    v_add_f32 v12, v12, v162
    v_cvt_pk_bf16_f32 v216, v160, v161
    v_add_f32 v12, v12, v163
    v_cvt_pk_bf16_f32 v217, v162, v163
    v_mfma_f32_16x16x32_bf16 v[136:139], a[196:199], v[52:55], v[136:139]
    v_exp_f32 v169, v169
    v_exp_f32 v170, v170
    v_mfma_f32_16x16x32_bf16 v[128:131], a[200:203], v[40:43], v[128:131]
    v_add_f32 v13, v13, v168
    v_add_f32 v13, v13, v169
    v_mfma_f32_16x16x32_bf16 v[136:139], a[200:203], v[56:59], v[136:139]
    v_exp_f32 v171, v171
    v_exp_f32 v164, v164
    v_mfma_f32_16x16x32_bf16 v[128:131], a[204:207], v[44:47], v[128:131]
    v_add_f32 v13, v13, v170
    v_cvt_pk_bf16_f32 v220, v168, v169
    v_add_f32 v13, v13, v171
    v_cvt_pk_bf16_f32 v221, v170, v171
    v_mfma_f32_16x16x32_bf16 v[136:139], a[204:207], v[60:63], v[136:139]
    v_exp_f32 v165, v165
    v_exp_f32 v166, v166
    v_mfma_f32_16x16x32_bf16 v[132:135], a[208:211], v[32:35], v[176:179]
    v_add_f32 v12, v12, v164
    v_add_f32 v12, v12, v165
    v_mfma_f32_16x16x32_bf16 v[140:143], a[208:211], v[48:51], v[180:183]
    v_exp_f32 v167, v167
    v_exp_f32 v172, v172
    v_mfma_f32_16x16x32_bf16 v[132:135], a[212:215], v[36:39], v[132:135]
    v_add_f32 v12, v12, v166
    v_cvt_pk_bf16_f32 v218, v164, v165
    v_add_f32 v12, v12, v167
    v_cvt_pk_bf16_f32 v219, v166, v167
    v_mfma_f32_16x16x32_bf16 v[140:143], a[212:215], v[52:55], v[140:143]
    v_exp_f32 v173, v173
    v_mfma_f32_16x16x32_bf16 v[132:135], a[216:219], v[40:43], v[132:135]
    v_exp_f32 v174, v174
    v_add_f32 v13, v13, v172
    v_add_f32 v13, v13, v173
    v_mfma_f32_16x16x32_bf16 v[140:143], a[216:219], v[56:59], v[140:143]
    v_exp_f32 v175, v175
    s_nop 0
    v_add_f32 v13, v13, v174
    v_cvt_pk_bf16_f32 v222, v172, v173
    v_add_f32 v13, v13, v175
    v_cvt_pk_bf16_f32 v223, v174, v175
    v_mfma_f32_16x16x32_bf16 v[132:135], a[220:223], v[44:47], v[132:135]
    v_exp_f32 v128, v128
    v_mfma_f32_16x16x32_bf16 v[140:143], a[220:223], v[60:63], v[140:143]
    v_exp_f32 v129, v129
    v_mfma_f32_16x16x32_bf16 a[128:131], a[224:227], v[216:219], 0
    v_exp_f32 v130, v130
    v_mfma_f32_16x16x32_bf16 a[160:163], a[224:227], v[220:223], 0
    v_add_f32 v8, v8, v128
    v_add_f32 v8, v8, v129
    v_mfma_f32_16x16x32_bf16 a[132:135], a[228:231], v[216:219], 0
    v_exp_f32 v131, v131
    v_mfma_f32_16x16x32_bf16 a[164:167], a[228:231], v[220:223], 0
    v_exp_f32 v136, v136
    v_mfma_f32_16x16x32_bf16 a[136:139], a[232:235], v[216:219], 0
    v_add_f32 v8, v8, v130
    v_cvt_pk_bf16_f32 v200, v128, v129
    v_mfma_f32_16x16x32_bf16 a[168:171], a[232:235], v[220:223], 0
    v_add_f32 v8, v8, v131
    v_cvt_pk_bf16_f32 v201, v130, v131
    v_mfma_f32_16x16x32_bf16 a[140:143], a[236:239], v[216:219], 0
    ds_read_b64_tr_b16 a[224:225], v4 offset:33792
    ds_read_b64_tr_b16 a[226:227], v4 offset:34304
    v_mfma_f32_16x16x32_bf16 a[172:175], a[236:239], v[220:223], 0
    v_exp_f32 v137, v137
    v_mfma_f32_16x16x32_bf16 a[144:147], a[240:243], v[216:219], 0
    v_exp_f32 v138, v138
    v_mfma_f32_16x16x32_bf16 a[176:179], a[240:243], v[220:223], 0
    v_add_f32 v9, v9, v136
    v_add_f32 v9, v9, v137
    v_mfma_f32_16x16x32_bf16 a[148:151], a[244:247], v[216:219], 0
    ds_read_b64_tr_b16 a[228:229], v4 offset:33824
    ds_read_b64_tr_b16 a[230:231], v4 offset:34336
    v_mfma_f32_16x16x32_bf16 a[180:183], a[244:247], v[220:223], 0
    v_exp_f32 v139, v139
    v_mfma_f32_16x16x32_bf16 a[152:155], a[248:251], v[216:219], 0
    v_exp_f32 v132, v132
    v_mfma_f32_16x16x32_bf16 a[184:187], a[248:251], v[220:223], 0
    v_add_f32 v9, v9, v138
    v_cvt_pk_bf16_f32 v204, v136, v137
    v_add_f32 v9, v9, v139
    v_cvt_pk_bf16_f32 v205, v138, v139
    v_mfma_f32_16x16x32_bf16 a[156:159], a[252:255], v[216:219], 0
    ds_read_b64_tr_b16 a[232:233], v4 offset:33856
    ds_read_b64_tr_b16 a[234:235], v4 offset:34368
    ds_read_b64_tr_b16 a[236:237], v4 offset:33888
    ds_read_b64_tr_b16 a[238:239], v4 offset:34400
    v_mfma_f32_16x16x32_bf16 a[188:191], a[252:255], v[220:223], 0
    v_exp_f32 v133, v133
    v_exp_f32 v134, v134
    v_add_f32 v8, v8, v132
    v_add_f32 v8, v8, v133
    v_exp_f32 v135, v135
    v_exp_f32 v140, v140
    s_mov_b32 s41, 0
    .p2align 6
L_loop_f:
    v_mfma_f32_16x16x32_bf16 v[144:147], a[192:195], v[64:67], v[184:187]
    ds_read_b64_tr_b16 a[240:241], v4 offset:33920
    ds_read_b64_tr_b16 a[242:243], v4 offset:34432
    v_mfma_f32_16x16x32_bf16 v[152:155], a[192:195], v[80:83], v[188:191]
    v_add_f32 v8, v8, v134
    v_cvt_pk_bf16_f32 v202, v132, v133
    v_mfma_f32_16x16x32_bf16 v[144:147], a[196:199], v[68:71], v[144:147]
    v_add_f32 v8, v8, v135
    v_cvt_pk_bf16_f32 v203, v134, v135
    v_mfma_f32_16x16x32_bf16 v[152:155], a[196:199], v[84:87], v[152:155]
    ds_read_b64_tr_b16 a[244:245], v4 offset:33952
    ds_read_b64_tr_b16 a[246:247], v4 offset:34464
    v_mfma_f32_16x16x32_bf16 v[144:147], a[200:203], v[72:75], v[144:147]
    v_exp_f32 v141, v141
    v_mfma_f32_16x16x32_bf16 v[152:155], a[200:203], v[88:91], v[152:155]
    v_exp_f32 v142, v142
    v_mfma_f32_16x16x32_bf16 v[144:147], a[204:207], v[76:79], v[144:147]
    ds_read_b64_tr_b16 a[248:249], v4 offset:33984
    ds_read_b64_tr_b16 a[250:251], v4 offset:34496
    v_mfma_f32_16x16x32_bf16 v[152:155], a[204:207], v[92:95], v[152:155]
    v_add_f32 v9, v9, v140
    v_add_f32 v9, v9, v141
    v_mfma_f32_16x16x32_bf16 v[148:151], a[208:211], v[64:67], v[184:187]
    v_exp_f32 v143, v143
    v_mfma_f32_16x16x32_bf16 v[156:159], a[208:211], v[80:83], v[188:191]
    s_nop 0
    ds_read_b64_tr_b16 a[252:253], v4 offset:34016
    ds_read_b64_tr_b16 a[254:255], v4 offset:34528
    v_mfma_f32_16x16x32_bf16 v[148:151], a[212:215], v[68:71], v[148:151]
    v_add_f32 v9, v9, v142
    v_cvt_pk_bf16_f32 v206, v140, v141
    v_mfma_f32_16x16x32_bf16 v[156:159], a[212:215], v[84:87], v[156:159]
    s_add_u32 m0, s38, 25344
    v_add_f32 v9, v9, v143
    v_cvt_pk_bf16_f32 v207, v142, v143
    v_mfma_f32_16x16x32_bf16 v[148:151], a[216:219], v[72:75], v[148:151]
    s_add_u32 s46, s40, 270336
    v_exp_f32 v144, v144
    v_mfma_f32_16x16x32_bf16 v[156:159], a[216:219], v[88:91], v[156:159]
    s_waitcnt vmcnt(4)
    buffer_load_dwordx4 v6, s[96:99], s46 offen offset:0 nt lds
    buffer_load_dwordx4 v7, s[96:99], s46 offen offset:1056 nt lds
    v_mfma_f32_16x16x32_bf16 v[148:151], a[220:223], v[76:79], v[148:151]
    v_exp_f32 v145, v145
    v_mfma_f32_16x16x32_bf16 v[156:159], a[220:223], v[92:95], v[156:159]
    v_exp_f32 v146, v146
    s_waitcnt lgkmcnt(0)
    v_mfma_f32_16x16x32_bf16 a[0:3], a[224:227], v[200:203], a[0:3]
    v_add_f32 v10, v10, v144
    v_add_f32 v10, v10, v145
    v_mfma_f32_16x16x32_bf16 a[32:35], a[224:227], v[204:207], a[32:35]
    v_exp_f32 v147, v147
    v_mfma_f32_16x16x32_bf16 a[4:7], a[228:231], v[200:203], a[4:7]
    v_exp_f32 v152, v152
    v_mfma_f32_16x16x32_bf16 a[36:39], a[228:231], v[204:207], a[36:39]
    v_add_f32 v10, v10, v146
    v_cvt_pk_bf16_f32 v208, v144, v145
    v_mfma_f32_16x16x32_bf16 a[8:11], a[232:235], v[200:203], a[8:11]
    v_add_f32 v10, v10, v147
    v_cvt_pk_bf16_f32 v209, v146, v147
    v_mfma_f32_16x16x32_bf16 a[40:43], a[232:235], v[204:207], a[40:43]
    v_exp_f32 v153, v153
    v_mfma_f32_16x16x32_bf16 a[12:15], a[236:239], v[200:203], a[12:15]
    v_exp_f32 v154, v154
    v_mfma_f32_16x16x32_bf16 a[44:47], a[236:239], v[204:207], a[44:47]
    v_add_f32 v11, v11, v152
    v_add_f32 v11, v11, v153
    v_mfma_f32_16x16x32_bf16 a[16:19], a[240:243], v[200:203], a[16:19]
    v_exp_f32 v155, v155
    v_mfma_f32_16x16x32_bf16 a[48:51], a[240:243], v[204:207], a[48:51]
    v_exp_f32 v148, v148
    v_mfma_f32_16x16x32_bf16 a[20:23], a[244:247], v[200:203], a[20:23]
    v_add_f32 v11, v11, v154
    v_cvt_pk_bf16_f32 v212, v152, v153
    v_mfma_f32_16x16x32_bf16 a[52:55], a[244:247], v[204:207], a[52:55]
    v_add_f32 v11, v11, v155
    v_cvt_pk_bf16_f32 v213, v154, v155
    v_mfma_f32_16x16x32_bf16 a[24:27], a[248:251], v[200:203], a[24:27]
    v_exp_f32 v149, v149
    v_mfma_f32_16x16x32_bf16 a[56:59], a[248:251], v[204:207], a[56:59]
    v_exp_f32 v150, v150
    v_mfma_f32_16x16x32_bf16 a[28:31], a[252:255], v[200:203], a[28:31]
    v_add_f32 v10, v10, v148
    v_add_f32 v10, v10, v149
    v_mfma_f32_16x16x32_bf16 a[60:63], a[252:255], v[204:207], a[60:63]
    v_exp_f32 v151, v151
    s_waitcnt vmcnt(6)
    s_barrier
    v_mfma_f32_16x16x32_bf16 v[160:163], a[192:195], v[96:99], v[192:195]
    v_exp_f32 v156, v156
    v_mfma_f32_16x16x32_bf16 v[168:171], a[192:195], v[112:115], v[196:199]
    v_add_f32 v10, v10, v150
    v_cvt_pk_bf16_f32 v210, v148, v149
    v_mfma_f32_16x16x32_bf16 v[160:163], a[196:199], v[100:103], v[160:163]
    v_add_f32 v10, v10, v151
    v_cvt_pk_bf16_f32 v211, v150, v151
    v_mfma_f32_16x16x32_bf16 v[168:171], a[196:199], v[116:119], v[168:171]
    s_add_u32 s40, s40, 16384
    ds_read_b128 a[192:195], v3 offset:0
    ds_read_b128 a[196:199], v3 offset:64
    v_mfma_f32_16x16x32_bf16 v[160:163], a[200:203], v[104:107], v[160:163]
    s_add_u32 m0, s38, 0
    v_exp_f32 v157, v157
    v_mfma_f32_16x16x32_bf16 v[168:171], a[200:203], v[120:123], v[168:171]
    s_add_u32 s46, s39, 0
    v_exp_f32 v158, v158
    v_mfma_f32_16x16x32_bf16 v[160:163], a[204:207], v[108:111], v[160:163]
    s_waitcnt vmcnt(2)
    buffer_load_dwordx4 v6, s[16:19], s46 offen offset:0 nt lds
    buffer_load_dwordx4 v7, s[16:19], s46 offen offset:1056 nt lds
    v_mfma_f32_16x16x32_bf16 v[168:171], a[204:207], v[124:127], v[168:171]
    v_add_f32 v11, v11, v156
    v_add_f32 v11, v11, v157
    v_mfma_f32_16x16x32_bf16 v[164:167], a[208:211], v[96:99], v[192:195]
    ds_read_b128 a[200:203], v3 offset:128
    ds_read_b128 a[204:207], v3 offset:192
    v_mfma_f32_16x16x32_bf16 v[172:175], a[208:211], v[112:115], v[196:199]
    v_exp_f32 v159, v159
    v_mfma_f32_16x16x32_bf16 v[164:167], a[212:215], v[100:103], v[164:167]
    s_nop 0
    v_add_f32 v11, v11, v158
    v_cvt_pk_bf16_f32 v214, v156, v157
    v_mfma_f32_16x16x32_bf16 v[172:175], a[212:215], v[116:119], v[172:175]
    v_add_f32 v11, v11, v159
    v_cvt_pk_bf16_f32 v215, v158, v159
    v_mfma_f32_16x16x32_bf16 v[164:167], a[216:219], v[104:107], v[164:167]
    v_exp_f32 v160, v160
    v_mfma_f32_16x16x32_bf16 v[172:175], a[216:219], v[120:123], v[172:175]
    ds_read_b128 a[208:211], v3 offset:512
    ds_read_b128 a[212:215], v3 offset:576
    v_mfma_f32_16x16x32_bf16 v[164:167], a[220:223], v[108:111], v[164:167]
    v_exp_f32 v161, v161
    v_mfma_f32_16x16x32_bf16 v[172:175], a[220:223], v[124:127], v[172:175]
    v_exp_f32 v162, v162
    v_mfma_f32_16x16x32_bf16 a[64:67], a[224:227], v[208:211], a[64:67]
    v_add_f32 v12, v12, v160
    v_add_f32 v12, v12, v161
    v_mfma_f32_16x16x32_bf16 a[96:99], a[224:227], v[212:215], a[96:99]
    v_exp_f32 v163, v163
    v_mfma_f32_16x16x32_bf16 a[68:71], a[228:231], v[208:211], a[68:71]
    ds_read_b128 a[216:219], v3 offset:640
    ds_read_b128 a[220:223], v3 offset:704
    v_mfma_f32_16x16x32_bf16 a[100:103], a[228:231], v[212:215], a[100:103]
    v_exp_f32 v168, v168
    v_mfma_f32_16x16x32_bf16 a[72:75], a[232:235], v[208:211], a[72:75]
    v_add_f32 v12, v12, v162
    v_cvt_pk_bf16_f32 v216, v160, v161
    v_mfma_f32_16x16x32_bf16 a[104:107], a[232:235], v[212:215], a[104:107]
    v_add_f32 v12, v12, v163
    v_cvt_pk_bf16_f32 v217, v162, v163
    v_mfma_f32_16x16x32_bf16 a[76:79], a[236:239], v[208:211], a[76:79]
    v_exp_f32 v169, v169
    v_mfma_f32_16x16x32_bf16 a[108:111], a[236:239], v[212:215], a[108:111]
    v_exp_f32 v170, v170
    v_mfma_f32_16x16x32_bf16 a[80:83], a[240:243], v[208:211], a[80:83]
    v_add_f32 v13, v13, v168
    v_add_f32 v13, v13, v169
    v_mfma_f32_16x16x32_bf16 a[112:115], a[240:243], v[212:215], a[112:115]
    v_exp_f32 v171, v171
    v_mfma_f32_16x16x32_bf16 a[84:87], a[244:247], v[208:211], a[84:87]
    v_exp_f32 v164, v164
    v_mfma_f32_16x16x32_bf16 a[116:119], a[244:247], v[212:215], a[116:119]
    v_add_f32 v13, v13, v170
    v_cvt_pk_bf16_f32 v220, v168, v169
    v_mfma_f32_16x16x32_bf16 a[88:91], a[248:251], v[208:211], a[88:91]
    v_add_f32 v13, v13, v171
    v_cvt_pk_bf16_f32 v221, v170, v171
    v_mfma_f32_16x16x32_bf16 a[120:123], a[248:251], v[212:215], a[120:123]
    s_add_u32 m0, s38, 33792
    v_exp_f32 v165, v165
    v_mfma_f32_16x16x32_bf16 a[92:95], a[252:255], v[208:211], a[92:95]
    s_add_u32 s46, s39, 8192
    v_exp_f32 v166, v166
    v_mfma_f32_16x16x32_bf16 a[124:127], a[252:255], v[212:215], a[124:127]
    s_waitcnt vmcnt(4)
    buffer_load_dwordx4 v6, s[16:19], s46 offen offset:0 nt lds
    buffer_load_dwordx4 v7, s[16:19], s46 offen offset:1056 nt lds
    s_waitcnt lgkmcnt(0)
    v_mfma_f32_16x16x32_bf16 v[128:131], a[192:195], v[32:35], v[176:179]
    v_add_f32 v12, v12, v164
    v_add_f32 v12, v12, v165
    v_mfma_f32_16x16x32_bf16 v[136:139], a[192:195], v[48:51], v[180:183]
    v_exp_f32 v167, v167
    v_mfma_f32_16x16x32_bf16 v[128:131], a[196:199], v[36:39], v[128:131]
    v_exp_f32 v172, v172
    v_mfma_f32_16x16x32_bf16 v[136:139], a[196:199], v[52:55], v[136:139]
    v_add_f32 v12, v12, v166
    v_cvt_pk_bf16_f32 v218, v164, v165
    v_mfma_f32_16x16x32_bf16 v[128:131], a[200:203], v[40:43], v[128:131]
    v_add_f32 v12, v12, v167
    v_cvt_pk_bf16_f32 v219, v166, v167
    v_mfma_f32_16x16x32_bf16 v[136:139], a[200:203], v[56:59], v[136:139]
    v_exp_f32 v173, v173
    v_mfma_f32_16x16x32_bf16 v[128:131], a[204:207], v[44:47], v[128:131]
    v_exp_f32 v174, v174
    v_mfma_f32_16x16x32_bf16 v[136:139], a[204:207], v[60:63], v[136:139]
    v_add_f32 v13, v13, v172
    v_add_f32 v13, v13, v173
    v_mfma_f32_16x16x32_bf16 v[132:135], a[208:211], v[32:35], v[176:179]
    v_exp_f32 v175, v175
    v_mfma_f32_16x16x32_bf16 v[140:143], a[208:211], v[48:51], v[180:183]
    s_nop 0
    v_add_f32 v13, v13, v174
    v_cvt_pk_bf16_f32 v222, v172, v173
    v_mfma_f32_16x16x32_bf16 v[132:135], a[212:215], v[36:39], v[132:135]
    v_add_f32 v13, v13, v175
    v_cvt_pk_bf16_f32 v223, v174, v175
    v_mfma_f32_16x16x32_bf16 v[140:143], a[212:215], v[52:55], v[140:143]
    v_exp_f32 v128, v128
    v_mfma_f32_16x16x32_bf16 v[132:135], a[216:219], v[40:43], v[132:135]
    v_exp_f32 v129, v129
    v_mfma_f32_16x16x32_bf16 v[140:143], a[216:219], v[56:59], v[140:143]
    v_exp_f32 v130, v130
    v_mfma_f32_16x16x32_bf16 v[132:135], a[220:223], v[44:47], v[132:135]
    v_add_f32 v8, v8, v128
    v_add_f32 v8, v8, v129
    v_mfma_f32_16x16x32_bf16 v[140:143], a[220:223], v[60:63], v[140:143]
    v_exp_f32 v131, v131
    v_mfma_f32_16x16x32_bf16 a[128:131], a[224:227], v[216:219], a[128:131]
    v_exp_f32 v136, v136
    v_mfma_f32_16x16x32_bf16 a[160:163], a[224:227], v[220:223], a[160:163]
    v_add_f32 v8, v8, v130
    v_cvt_pk_bf16_f32 v200, v128, v129
    v_mfma_f32_16x16x32_bf16 a[132:135], a[228:231], v[216:219], a[132:135]
    v_add_f32 v8, v8, v131
    v_cvt_pk_bf16_f32 v201, v130, v131
    v_mfma_f32_16x16x32_bf16 a[164:167], a[228:231], v[220:223], a[164:167]
    ds_read_b64_tr_b16 a[224:225], v5 offset:0
    ds_read_b64_tr_b16 a[226:227], v5 offset:512
    v_mfma_f32_16x16x32_bf16 a[136:139], a[232:235], v[216:219], a[136:139]
    s_add_u32 m0, s38, 16896
    v_exp_f32 v137, v137
    v_mfma_f32_16x16x32_bf16 a[168:171], a[232:235], v[220:223], a[168:171]
    s_add_u32 s46, s39, 262144
    v_exp_f32 v138, v138
    v_mfma_f32_16x16x32_bf16 a[140:143], a[236:239], v[216:219], a[140:143]
    s_waitcnt vmcnt(2)
    buffer_load_dwordx4 v6, s[16:19], s46 offen offset:0 nt lds
    buffer_load_dwordx4 v7, s[16:19], s46 offen offset:1056 nt lds
    v_mfma_f32_16x16x32_bf16 a[172:175], a[236:239], v[220:223], a[172:175]
    v_add_f32 v9, v9, v136
    v_add_f32 v9, v9, v137
    v_mfma_f32_16x16x32_bf16 a[144:147], a[240:243], v[216:219], a[144:147]
    ds_read_b64_tr_b16 a[228:229], v5 offset:32
    ds_read_b64_tr_b16 a[230:231], v5 offset:544
    v_mfma_f32_16x16x32_bf16 a[176:179], a[240:243], v[220:223], a[176:179]
    v_exp_f32 v139, v139
    v_mfma_f32_16x16x32_bf16 a[148:151], a[244:247], v[216:219], a[148:151]
    v_exp_f32 v132, v132
    v_mfma_f32_16x16x32_bf16 a[180:183], a[244:247], v[220:223], a[180:183]
    v_add_f32 v9, v9, v138
    v_cvt_pk_bf16_f32 v204, v136, v137
    v_mfma_f32_16x16x32_bf16 a[152:155], a[248:251], v[216:219], a[152:155]
    ds_read_b64_tr_b16 a[232:233], v5 offset:64
    ds_read_b64_tr_b16 a[234:235], v5 offset:576
    ds_read_b64_tr_b16 a[236:237], v5 offset:96
    ds_read_b64_tr_b16 a[238:239], v5 offset:608
    v_mfma_f32_16x16x32_bf16 a[184:187], a[248:251], v[220:223], a[184:187]
    v_add_f32 v9, v9, v139
    v_cvt_pk_bf16_f32 v205, v138, v139
    v_mfma_f32_16x16x32_bf16 a[156:159], a[252:255], v[216:219], a[156:159]
    v_exp_f32 v133, v133
    v_mfma_f32_16x16x32_bf16 a[188:191], a[252:255], v[220:223], a[188:191]
    v_exp_f32 v134, v134
    v_add_f32 v8, v8, v132
    v_add_f32 v8, v8, v133
    v_exp_f32 v135, v135
    v_exp_f32 v140, v140
    v_mfma_f32_16x16x32_bf16 v[144:147], a[192:195], v[64:67], v[184:187]
    ds_read_b64_tr_b16 a[240:241], v5 offset:128
    ds_read_b64_tr_b16 a[242:243], v5 offset:640
    v_mfma_f32_16x16x32_bf16 v[152:155], a[192:195], v[80:83], v[188:191]
    v_add_f32 v8, v8, v134
    v_cvt_pk_bf16_f32 v202, v132, v133
    v_mfma_f32_16x16x32_bf16 v[144:147], a[196:199], v[68:71], v[144:147]
    v_add_f32 v8, v8, v135
    v_cvt_pk_bf16_f32 v203, v134, v135
    v_mfma_f32_16x16x32_bf16 v[152:155], a[196:199], v[84:87], v[152:155]
    ds_read_b64_tr_b16 a[244:245], v5 offset:160
    ds_read_b64_tr_b16 a[246:247], v5 offset:672
    v_mfma_f32_16x16x32_bf16 v[144:147], a[200:203], v[72:75], v[144:147]
    v_exp_f32 v141, v141
    v_mfma_f32_16x16x32_bf16 v[152:155], a[200:203], v[88:91], v[152:155]
    v_exp_f32 v142, v142
    v_mfma_f32_16x16x32_bf16 v[144:147], a[204:207], v[76:79], v[144:147]
    ds_read_b64_tr_b16 a[248:249], v5 offset:192
    ds_read_b64_tr_b16 a[250:251], v5 offset:704
    v_mfma_f32_16x16x32_bf16 v[152:155], a[204:207], v[92:95], v[152:155]
    v_add_f32 v9, v9, v140
    v_add_f32 v9, v9, v141
    v_mfma_f32_16x16x32_bf16 v[148:151], a[208:211], v[64:67], v[184:187]
    v_exp_f32 v143, v143
    v_mfma_f32_16x16x32_bf16 v[156:159], a[208:211], v[80:83], v[188:191]
    s_nop 0
    ds_read_b64_tr_b16 a[252:253], v5 offset:224
    ds_read_b64_tr_b16 a[254:255], v5 offset:736
    v_mfma_f32_16x16x32_bf16 v[148:151], a[212:215], v[68:71], v[148:151]
    v_add_f32 v9, v9, v142
    v_cvt_pk_bf16_f32 v206, v140, v141
    v_mfma_f32_16x16x32_bf16 v[156:159], a[212:215], v[84:87], v[156:159]
    s_add_u32 m0, s38, 50688
    v_add_f32 v9, v9, v143
    v_cvt_pk_bf16_f32 v207, v142, v143
    v_mfma_f32_16x16x32_bf16 v[148:151], a[216:219], v[72:75], v[148:151]
    s_add_u32 s46, s39, 270336
    v_exp_f32 v144, v144
    v_mfma_f32_16x16x32_bf16 v[156:159], a[216:219], v[88:91], v[156:159]
    s_waitcnt vmcnt(4)
    buffer_load_dwordx4 v6, s[16:19], s46 offen offset:0 nt lds
    buffer_load_dwordx4 v7, s[16:19], s46 offen offset:1056 nt lds
    v_mfma_f32_16x16x32_bf16 v[148:151], a[220:223], v[76:79], v[148:151]
    v_exp_f32 v145, v145
    v_mfma_f32_16x16x32_bf16 v[156:159], a[220:223], v[92:95], v[156:159]
    v_exp_f32 v146, v146
    s_waitcnt lgkmcnt(0)
    v_mfma_f32_16x16x32_bf16 a[0:3], a[224:227], v[200:203], a[0:3]
    v_add_f32 v10, v10, v144
    v_add_f32 v10, v10, v145
    v_mfma_f32_16x16x32_bf16 a[32:35], a[224:227], v[204:207], a[32:35]
    v_exp_f32 v147, v147
    v_mfma_f32_16x16x32_bf16 a[4:7], a[228:231], v[200:203], a[4:7]
    v_exp_f32 v152, v152
    v_mfma_f32_16x16x32_bf16 a[36:39], a[228:231], v[204:207], a[36:39]
    v_add_f32 v10, v10, v146
    v_cvt_pk_bf16_f32 v208, v144, v145
    v_mfma_f32_16x16x32_bf16 a[8:11], a[232:235], v[200:203], a[8:11]
    v_add_f32 v10, v10, v147
    v_cvt_pk_bf16_f32 v209, v146, v147
    v_mfma_f32_16x16x32_bf16 a[40:43], a[232:235], v[204:207], a[40:43]
    v_exp_f32 v153, v153
    v_mfma_f32_16x16x32_bf16 a[12:15], a[236:239], v[200:203], a[12:15]
    v_exp_f32 v154, v154
    v_mfma_f32_16x16x32_bf16 a[44:47], a[236:239], v[204:207], a[44:47]
    v_add_f32 v11, v11, v152
    v_add_f32 v11, v11, v153
    v_mfma_f32_16x16x32_bf16 a[16:19], a[240:243], v[200:203], a[16:19]
    v_exp_f32 v155, v155
    v_mfma_f32_16x16x32_bf16 a[48:51], a[240:243], v[204:207], a[48:51]
    v_exp_f32 v148, v148
    v_mfma_f32_16x16x32_bf16 a[20:23], a[244:247], v[200:203], a[20:23]
    v_add_f32 v11, v11, v154
    v_cvt_pk_bf16_f32 v212, v152, v153
    v_mfma_f32_16x16x32_bf16 a[52:55], a[244:247], v[204:207], a[52:55]
    v_add_f32 v11, v11, v155
    v_cvt_pk_bf16_f32 v213, v154, v155
    v_mfma_f32_16x16x32_bf16 a[24:27], a[248:251], v[200:203], a[24:27]
    v_exp_f32 v149, v149
    v_mfma_f32_16x16x32_bf16 a[56:59], a[248:251], v[204:207], a[56:59]
    v_exp_f32 v150, v150
    v_mfma_f32_16x16x32_bf16 a[28:31], a[252:255], v[200:203], a[28:31]
    v_add_f32 v10, v10, v148
    v_add_f32 v10, v10, v149
    v_mfma_f32_16x16x32_bf16 a[60:63], a[252:255], v[204:207], a[60:63]
    v_exp_f32 v151, v151
    s_waitcnt vmcnt(10)
    s_barrier
    v_mfma_f32_16x16x32_bf16 v[160:163], a[192:195], v[96:99], v[192:195]
    v_exp_f32 v156, v156
    v_mfma_f32_16x16x32_bf16 v[168:171], a[192:195], v[112:115], v[196:199]
    v_add_f32 v10, v10, v150
    v_cvt_pk_bf16_f32 v210, v148, v149
    v_mfma_f32_16x16x32_bf16 v[160:163], a[196:199], v[100:103], v[160:163]
    v_add_f32 v10, v10, v151
    v_cvt_pk_bf16_f32 v211, v150, v151
    v_mfma_f32_16x16x32_bf16 v[168:171], a[196:199], v[116:119], v[168:171]
    s_add_u32 s39, s39, 16384
    ds_read_b128 a[192:195], v3 offset:33792
    ds_read_b128 a[196:199], v3 offset:33856
    v_mfma_f32_16x16x32_bf16 v[160:163], a[200:203], v[104:107], v[160:163]
    s_add_u32 m0, s38, 42240
    v_exp_f32 v157, v157
    v_mfma_f32_16x16x32_bf16 v[168:171], a[200:203], v[120:123], v[168:171]
    s_add_u32 s46, s40, 0
    v_exp_f32 v158, v158
    v_mfma_f32_16x16x32_bf16 v[160:163], a[204:207], v[108:111], v[160:163]
    s_waitcnt vmcnt(2)
    buffer_load_dwordx4 v6, s[96:99], s46 offen offset:0 nt lds
    buffer_load_dwordx4 v7, s[96:99], s46 offen offset:1056 nt lds
    v_mfma_f32_16x16x32_bf16 v[168:171], a[204:207], v[124:127], v[168:171]
    v_add_f32 v11, v11, v156
    v_add_f32 v11, v11, v157
    v_mfma_f32_16x16x32_bf16 v[164:167], a[208:211], v[96:99], v[192:195]
    ds_read_b128 a[200:203], v3 offset:33920
    ds_read_b128 a[204:207], v3 offset:33984
    v_mfma_f32_16x16x32_bf16 v[172:175], a[208:211], v[112:115], v[196:199]
    v_exp_f32 v159, v159
    v_mfma_f32_16x16x32_bf16 v[164:167], a[212:215], v[100:103], v[164:167]
    s_nop 0
    v_add_f32 v11, v11, v158
    v_cvt_pk_bf16_f32 v214, v156, v157
    v_mfma_f32_16x16x32_bf16 v[172:175], a[212:215], v[116:119], v[172:175]
    v_add_f32 v11, v11, v159
    v_cvt_pk_bf16_f32 v215, v158, v159
    v_mfma_f32_16x16x32_bf16 v[164:167], a[216:219], v[104:107], v[164:167]
    v_exp_f32 v160, v160
    v_mfma_f32_16x16x32_bf16 v[172:175], a[216:219], v[120:123], v[172:175]
    ds_read_b128 a[208:211], v3 offset:34304
    ds_read_b128 a[212:215], v3 offset:34368
    v_mfma_f32_16x16x32_bf16 v[164:167], a[220:223], v[108:111], v[164:167]
    v_exp_f32 v161, v161
    v_mfma_f32_16x16x32_bf16 v[172:175], a[220:223], v[124:127], v[172:175]
    v_exp_f32 v162, v162
    v_mfma_f32_16x16x32_bf16 a[64:67], a[224:227], v[208:211], a[64:67]
    v_add_f32 v12, v12, v160
    v_add_f32 v12, v12, v161
    v_mfma_f32_16x16x32_bf16 a[96:99], a[224:227], v[212:215], a[96:99]
    v_exp_f32 v163, v163
    v_mfma_f32_16x16x32_bf16 a[68:71], a[228:231], v[208:211], a[68:71]
    ds_read_b128 a[216:219], v3 offset:34432
    ds_read_b128 a[220:223], v3 offset:34496
    v_mfma_f32_16x16x32_bf16 a[100:103], a[228:231], v[212:215], a[100:103]
    v_exp_f32 v168, v168
    v_mfma_f32_16x16x32_bf16 a[72:75], a[232:235], v[208:211], a[72:75]
    v_add_f32 v12, v12, v162
    v_cvt_pk_bf16_f32 v216, v160, v161
    v_mfma_f32_16x16x32_bf16 a[104:107], a[232:235], v[212:215], a[104:107]
    v_add_f32 v12, v12, v163
    v_cvt_pk_bf16_f32 v217, v162, v163
    v_mfma_f32_16x16x32_bf16 a[76:79], a[236:239], v[208:211], a[76:79]
    v_exp_f32 v169, v169
    v_mfma_f32_16x16x32_bf16 a[108:111], a[236:239], v[212:215], a[108:111]
    v_exp_f32 v170, v170
    v_mfma_f32_16x16x32_bf16 a[80:83], a[240:243], v[208:211], a[80:83]
    v_add_f32 v13, v13, v168
    v_add_f32 v13, v13, v169
    v_mfma_f32_16x16x32_bf16 a[112:115], a[240:243], v[212:215], a[112:115]
    v_exp_f32 v171, v171
    v_mfma_f32_16x16x32_bf16 a[84:87], a[244:247], v[208:211], a[84:87]
    v_exp_f32 v164, v164
    v_mfma_f32_16x16x32_bf16 a[116:119], a[244:247], v[212:215], a[116:119]
    v_add_f32 v13, v13, v170
    v_cvt_pk_bf16_f32 v220, v168, v169
    v_mfma_f32_16x16x32_bf16 a[88:91], a[248:251], v[208:211], a[88:91]
    v_add_f32 v13, v13, v171
    v_cvt_pk_bf16_f32 v221, v170, v171
    v_mfma_f32_16x16x32_bf16 a[120:123], a[248:251], v[212:215], a[120:123]
    s_add_u32 m0, s38, 76032
    v_exp_f32 v165, v165
    v_mfma_f32_16x16x32_bf16 a[92:95], a[252:255], v[208:211], a[92:95]
    s_add_u32 s46, s40, 8192
    v_exp_f32 v166, v166
    v_mfma_f32_16x16x32_bf16 a[124:127], a[252:255], v[212:215], a[124:127]
    s_waitcnt vmcnt(4)
    buffer_load_dwordx4 v6, s[96:99], s46 offen offset:0 nt lds
    buffer_load_dwordx4 v7, s[96:99], s46 offen offset:1056 nt lds
    s_waitcnt lgkmcnt(0)
    v_mfma_f32_16x16x32_bf16 v[128:131], a[192:195], v[32:35], v[176:179]
    v_add_f32 v12, v12, v164
    v_add_f32 v12, v12, v165
    v_mfma_f32_16x16x32_bf16 v[136:139], a[192:195], v[48:51], v[180:183]
    v_exp_f32 v167, v167
    v_mfma_f32_16x16x32_bf16 v[128:131], a[196:199], v[36:39], v[128:131]
    v_exp_f32 v172, v172
    v_mfma_f32_16x16x32_bf16 v[136:139], a[196:199], v[52:55], v[136:139]
    v_add_f32 v12, v12, v166
    v_cvt_pk_bf16_f32 v218, v164, v165
    v_mfma_f32_16x16x32_bf16 v[128:131], a[200:203], v[40:43], v[128:131]
    v_add_f32 v12, v12, v167
    v_cvt_pk_bf16_f32 v219, v166, v167
    v_mfma_f32_16x16x32_bf16 v[136:139], a[200:203], v[56:59], v[136:139]
    v_exp_f32 v173, v173
    v_mfma_f32_16x16x32_bf16 v[128:131], a[204:207], v[44:47], v[128:131]
    v_exp_f32 v174, v174
    v_mfma_f32_16x16x32_bf16 v[136:139], a[204:207], v[60:63], v[136:139]
    v_add_f32 v13, v13, v172
    v_add_f32 v13, v13, v173
    v_mfma_f32_16x16x32_bf16 v[132:135], a[208:211], v[32:35], v[176:179]
    v_exp_f32 v175, v175
    v_mfma_f32_16x16x32_bf16 v[140:143], a[208:211], v[48:51], v[180:183]
    s_nop 0
    v_add_f32 v13, v13, v174
    v_cvt_pk_bf16_f32 v222, v172, v173
    v_mfma_f32_16x16x32_bf16 v[132:135], a[212:215], v[36:39], v[132:135]
    v_add_f32 v13, v13, v175
    v_cvt_pk_bf16_f32 v223, v174, v175
    v_mfma_f32_16x16x32_bf16 v[140:143], a[212:215], v[52:55], v[140:143]
    v_exp_f32 v128, v128
    v_mfma_f32_16x16x32_bf16 v[132:135], a[216:219], v[40:43], v[132:135]
    v_exp_f32 v129, v129
    v_mfma_f32_16x16x32_bf16 v[140:143], a[216:219], v[56:59], v[140:143]
    v_exp_f32 v130, v130
    v_mfma_f32_16x16x32_bf16 v[132:135], a[220:223], v[44:47], v[132:135]
    v_add_f32 v8, v8, v128
    v_add_f32 v8, v8, v129
    v_mfma_f32_16x16x32_bf16 v[140:143], a[220:223], v[60:63], v[140:143]
    v_exp_f32 v131, v131
    v_mfma_f32_16x16x32_bf16 a[128:131], a[224:227], v[216:219], a[128:131]
    v_exp_f32 v136, v136
    v_mfma_f32_16x16x32_bf16 a[160:163], a[224:227], v[220:223], a[160:163]
    v_add_f32 v8, v8, v130
    v_cvt_pk_bf16_f32 v200, v128, v129
    v_mfma_f32_16x16x32_bf16 a[132:135], a[228:231], v[216:219], a[132:135]
    v_add_f32 v8, v8, v131
    v_cvt_pk_bf16_f32 v201, v130, v131
    v_mfma_f32_16x16x32_bf16 a[164:167], a[228:231], v[220:223], a[164:167]
    ds_read_b64_tr_b16 a[224:225], v5 offset:33792
    ds_read_b64_tr_b16 a[226:227], v5 offset:34304
    v_mfma_f32_16x16x32_bf16 a[136:139], a[232:235], v[216:219], a[136:139]
    s_add_u32 m0, s38, 59136
    v_exp_f32 v137, v137
    v_mfma_f32_16x16x32_bf16 a[168:171], a[232:235], v[220:223], a[168:171]
    s_add_u32 s46, s40, 262144
    v_exp_f32 v138, v138
    v_mfma_f32_16x16x32_bf16 a[140:143], a[236:239], v[216:219], a[140:143]
    s_waitcnt vmcnt(2)
    buffer_load_dwordx4 v6, s[96:99], s46 offen offset:0 nt lds
    buffer_load_dwordx4 v7, s[96:99], s46 offen offset:1056 nt lds
    v_mfma_f32_16x16x32_bf16 a[172:175], a[236:239], v[220:223], a[172:175]
    v_add_f32 v9, v9, v136
    v_add_f32 v9, v9, v137
    v_mfma_f32_16x16x32_bf16 a[144:147], a[240:243], v[216:219], a[144:147]
    ds_read_b64_tr_b16 a[228:229], v5 offset:33824
    ds_read_b64_tr_b16 a[230:231], v5 offset:34336
    v_mfma_f32_16x16x32_bf16 a[176:179], a[240:243], v[220:223], a[176:179]
    v_exp_f32 v139, v139
    v_mfma_f32_16x16x32_bf16 a[148:151], a[244:247], v[216:219], a[148:151]
    v_exp_f32 v132, v132
    v_mfma_f32_16x16x32_bf16 a[180:183], a[244:247], v[220:223], a[180:183]
    v_add_f32 v9, v9, v138
    v_cvt_pk_bf16_f32 v204, v136, v137
    v_mfma_f32_16x16x32_bf16 a[152:155], a[248:251], v[216:219], a[152:155]
    ds_read_b64_tr_b16 a[232:233], v5 offset:33856
    ds_read_b64_tr_b16 a[234:235], v5 offset:34368
    ds_read_b64_tr_b16 a[236:237], v5 offset:33888
    ds_read_b64_tr_b16 a[238:239], v5 offset:34400
    v_mfma_f32_16x16x32_bf16 a[184:187], a[248:251], v[220:223], a[184:187]
    v_add_f32 v9, v9, v139
    v_cvt_pk_bf16_f32 v205, v138, v139
    v_mfma_f32_16x16x32_bf16 a[156:159], a[252:255], v[216:219], a[156:159]
    v_exp_f32 v133, v133
    v_mfma_f32_16x16x32_bf16 a[188:191], a[252:255], v[220:223], a[188:191]
    v_exp_f32 v134, v134
    v_add_f32 v8, v8, v132
    v_add_f32 v8, v8, v133
    v_exp_f32 v135, v135
    v_exp_f32 v140, v140
    v_mfma_f32_16x16x32_bf16 v[144:147], a[192:195], v[64:67], v[184:187]
    ds_read_b64_tr_b16 a[240:241], v5 offset:33920
    ds_read_b64_tr_b16 a[242:243], v5 offset:34432
    v_mfma_f32_16x16x32_bf16 v[152:155], a[192:195], v[80:83], v[188:191]
    v_add_f32 v8, v8, v134
    v_cvt_pk_bf16_f32 v202, v132, v133
    v_mfma_f32_16x16x32_bf16 v[144:147], a[196:199], v[68:71], v[144:147]
    v_add_f32 v8, v8, v135
    v_cvt_pk_bf16_f32 v203, v134, v135
    v_mfma_f32_16x16x32_bf16 v[152:155], a[196:199], v[84:87], v[152:155]
    ds_read_b64_tr_b16 a[244:245], v5 offset:33952
    ds_read_b64_tr_b16 a[246:247], v5 offset:34464
    v_mfma_f32_16x16x32_bf16 v[144:147], a[200:203], v[72:75], v[144:147]
    v_exp_f32 v141, v141
    v_mfma_f32_16x16x32_bf16 v[152:155], a[200:203], v[88:91], v[152:155]
    v_exp_f32 v142, v142
    v_mfma_f32_16x16x32_bf16 v[144:147], a[204:207], v[76:79], v[144:147]
    ds_read_b64_tr_b16 a[248:249], v5 offset:33984
    ds_read_b64_tr_b16 a[250:251], v5 offset:34496
    v_mfma_f32_16x16x32_bf16 v[152:155], a[204:207], v[92:95], v[152:155]
    v_add_f32 v9, v9, v140
    v_add_f32 v9, v9, v141
    v_mfma_f32_16x16x32_bf16 v[148:151], a[208:211], v[64:67], v[184:187]
    v_exp_f32 v143, v143
    v_mfma_f32_16x16x32_bf16 v[156:159], a[208:211], v[80:83], v[188:191]
    s_nop 0
    ds_read_b64_tr_b16 a[252:253], v5 offset:34016
    ds_read_b64_tr_b16 a[254:255], v5 offset:34528
    v_mfma_f32_16x16x32_bf16 v[148:151], a[212:215], v[68:71], v[148:151]
    v_add_f32 v9, v9, v142
    v_cvt_pk_bf16_f32 v206, v140, v141
    v_mfma_f32_16x16x32_bf16 v[156:159], a[212:215], v[84:87], v[156:159]
    s_add_u32 m0, s38, 92928
    v_add_f32 v9, v9, v143
    v_cvt_pk_bf16_f32 v207, v142, v143
    v_mfma_f32_16x16x32_bf16 v[148:151], a[216:219], v[72:75], v[148:151]
    s_add_u32 s46, s40, 270336
    v_exp_f32 v144, v144
    v_mfma_f32_16x16x32_bf16 v[156:159], a[216:219], v[88:91], v[156:159]
    s_waitcnt vmcnt(4)
    buffer_load_dwordx4 v6, s[96:99], s46 offen offset:0 nt lds
    buffer_load_dwordx4 v7, s[96:99], s46 offen offset:1056 nt lds
    v_mfma_f32_16x16x32_bf16 v[148:151], a[220:223], v[76:79], v[148:151]
    v_exp_f32 v145, v145
    v_mfma_f32_16x16x32_bf16 v[156:159], a[220:223], v[92:95], v[156:159]
    v_exp_f32 v146, v146
    s_waitcnt lgkmcnt(0)
    v_mfma_f32_16x16x32_bf16 a[0:3], a[224:227], v[200:203], a[0:3]
    v_add_f32 v10, v10, v144
    v_add_f32 v10, v10, v145
    v_mfma_f32_16x16x32_bf16 a[32:35], a[224:227], v[204:207], a[32:35]
    v_exp_f32 v147, v147
    v_mfma_f32_16x16x32_bf16 a[4:7], a[228:231], v[200:203], a[4:7]
    v_exp_f32 v152, v152
    v_mfma_f32_16x16x32_bf16 a[36:39], a[228:231], v[204:207], a[36:39]
    v_add_f32 v10, v10, v146
    v_cvt_pk_bf16_f32 v208, v144, v145
    v_mfma_f32_16x16x32_bf16 a[8:11], a[232:235], v[200:203], a[8:11]
    v_add_f32 v10, v10, v147
    v_cvt_pk_bf16_f32 v209, v146, v147
    v_mfma_f32_16x16x32_bf16 a[40:43], a[232:235], v[204:207], a[40:43]
    v_exp_f32 v153, v153
    v_mfma_f32_16x16x32_bf16 a[12:15], a[236:239], v[200:203], a[12:15]
    v_exp_f32 v154, v154
    v_mfma_f32_16x16x32_bf16 a[44:47], a[236:239], v[204:207], a[44:47]
    v_add_f32 v11, v11, v152
    v_add_f32 v11, v11, v153
    v_mfma_f32_16x16x32_bf16 a[16:19], a[240:243], v[200:203], a[16:19]
    v_exp_f32 v155, v155
    v_mfma_f32_16x16x32_bf16 a[48:51], a[240:243], v[204:207], a[48:51]
    v_exp_f32 v148, v148
    v_mfma_f32_16x16x32_bf16 a[20:23], a[244:247], v[200:203], a[20:23]
    v_add_f32 v11, v11, v154
    v_cvt_pk_bf16_f32 v212, v152, v153
    v_mfma_f32_16x16x32_bf16 a[52:55], a[244:247], v[204:207], a[52:55]
    v_add_f32 v11, v11, v155
    v_cvt_pk_bf16_f32 v213, v154, v155
    v_mfma_f32_16x16x32_bf16 a[24:27], a[248:251], v[200:203], a[24:27]
    v_exp_f32 v149, v149
    v_mfma_f32_16x16x32_bf16 a[56:59], a[248:251], v[204:207], a[56:59]
    v_exp_f32 v150, v150
    v_mfma_f32_16x16x32_bf16 a[28:31], a[252:255], v[200:203], a[28:31]
    v_add_f32 v10, v10, v148
    v_add_f32 v10, v10, v149
    v_mfma_f32_16x16x32_bf16 a[60:63], a[252:255], v[204:207], a[60:63]
    v_exp_f32 v151, v151
    s_waitcnt vmcnt(10)
    s_barrier
    v_mfma_f32_16x16x32_bf16 v[160:163], a[192:195], v[96:99], v[192:195]
    v_exp_f32 v156, v156
    v_mfma_f32_16x16x32_bf16 v[168:171], a[192:195], v[112:115], v[196:199]
    v_add_f32 v10, v10, v150
    v_cvt_pk_bf16_f32 v210, v148, v149
    v_mfma_f32_16x16x32_bf16 v[160:163], a[196:199], v[100:103], v[160:163]
    v_add_f32 v10, v10, v151
    v_cvt_pk_bf16_f32 v211, v150, v151
    v_mfma_f32_16x16x32_bf16 v[168:171], a[196:199], v[116:119], v[168:171]
    s_add_u32 s40, s40, 16384
    ds_read_b128 a[192:195], v2 offset:0
    ds_read_b128 a[196:199], v2 offset:64
    v_mfma_f32_16x16x32_bf16 v[160:163], a[200:203], v[104:107], v[160:163]
    s_add_u32 m0, s38, 67584
    v_exp_f32 v157, v157
    v_mfma_f32_16x16x32_bf16 v[168:171], a[200:203], v[120:123], v[168:171]
    s_add_u32 s46, s39, 0
    v_exp_f32 v158, v158
    v_mfma_f32_16x16x32_bf16 v[160:163], a[204:207], v[108:111], v[160:163]
    s_waitcnt vmcnt(2)
    buffer_load_dwordx4 v6, s[16:19], s46 offen offset:0 nt lds
    buffer_load_dwordx4 v7, s[16:19], s46 offen offset:1056 nt lds
    v_mfma_f32_16x16x32_bf16 v[168:171], a[204:207], v[124:127], v[168:171]
    v_add_f32 v11, v11, v156
    v_add_f32 v11, v11, v157
    v_mfma_f32_16x16x32_bf16 v[164:167], a[208:211], v[96:99], v[192:195]
    ds_read_b128 a[200:203], v2 offset:128
    ds_read_b128 a[204:207], v2 offset:192
    v_mfma_f32_16x16x32_bf16 v[172:175], a[208:211], v[112:115], v[196:199]
    v_exp_f32 v159, v159
    v_mfma_f32_16x16x32_bf16 v[164:167], a[212:215], v[100:103], v[164:167]
    s_nop 0
    v_add_f32 v11, v11, v158
    v_cvt_pk_bf16_f32 v214, v156, v157
    v_mfma_f32_16x16x32_bf16 v[172:175], a[212:215], v[116:119], v[172:175]
    v_add_f32 v11, v11, v159
    v_cvt_pk_bf16_f32 v215, v158, v159
    v_mfma_f32_16x16x32_bf16 v[164:167], a[216:219], v[104:107], v[164:167]
    v_exp_f32 v160, v160
    v_mfma_f32_16x16x32_bf16 v[172:175], a[216:219], v[120:123], v[172:175]
    ds_read_b128 a[208:211], v2 offset:512
    ds_read_b128 a[212:215], v2 offset:576
    v_mfma_f32_16x16x32_bf16 v[164:167], a[220:223], v[108:111], v[164:167]
    v_exp_f32 v161, v161
    v_mfma_f32_16x16x32_bf16 v[172:175], a[220:223], v[124:127], v[172:175]
    v_exp_f32 v162, v162
    v_mfma_f32_16x16x32_bf16 a[64:67], a[224:227], v[208:211], a[64:67]
    v_add_f32 v12, v12, v160
    v_add_f32 v12, v12, v161
    v_mfma_f32_16x16x32_bf16 a[96:99], a[224:227], v[212:215], a[96:99]
    v_exp_f32 v163, v163
    v_mfma_f32_16x16x32_bf16 a[68:71], a[228:231], v[208:211], a[68:71]
    ds_read_b128 a[216:219], v2 offset:640
    ds_read_b128 a[220:223], v2 offset:704
    v_mfma_f32_16x16x32_bf16 a[100:103], a[228:231], v[212:215], a[100:103]
    v_exp_f32 v168, v168
    v_mfma_f32_16x16x32_bf16 a[72:75], a[232:235], v[208:211], a[72:75]
    v_add_f32 v12, v12, v162
    v_cvt_pk_bf16_f32 v216, v160, v161
    v_mfma_f32_16x16x32_bf16 a[104:107], a[232:235], v[212:215], a[104:107]
    v_add_f32 v12, v12, v163
    v_cvt_pk_bf16_f32 v217, v162, v163
    v_mfma_f32_16x16x32_bf16 a[76:79], a[236:239], v[208:211], a[76:79]
    v_exp_f32 v169, v169
    v_mfma_f32_16x16x32_bf16 a[108:111], a[236:239], v[212:215], a[108:111]
    v_exp_f32 v170, v170
    v_mfma_f32_16x16x32_bf16 a[80:83], a[240:243], v[208:211], a[80:83]
    v_add_f32 v13, v13, v168
    v_add_f32 v13, v13, v169
    v_mfma_f32_16x16x32_bf16 a[112:115], a[240:243], v[212:215], a[112:115]
    v_exp_f32 v171, v171
    v_mfma_f32_16x16x32_bf16 a[84:87], a[244:247], v[208:211], a[84:87]
    v_exp_f32 v164, v164
    v_mfma_f32_16x16x32_bf16 a[116:119], a[244:247], v[212:215], a[116:119]
    v_add_f32 v13, v13, v170
    v_cvt_pk_bf16_f32 v220, v168, v169
    v_mfma_f32_16x16x32_bf16 a[88:91], a[248:251], v[208:211], a[88:91]
    v_add_f32 v13, v13, v171
    v_cvt_pk_bf16_f32 v221, v170, v171
    v_mfma_f32_16x16x32_bf16 a[120:123], a[248:251], v[212:215], a[120:123]
    s_add_u32 m0, s38, 101376
    v_exp_f32 v165, v165
    v_mfma_f32_16x16x32_bf16 a[92:95], a[252:255], v[208:211], a[92:95]
    s_add_u32 s46, s39, 8192
    v_exp_f32 v166, v166
    v_mfma_f32_16x16x32_bf16 a[124:127], a[252:255], v[212:215], a[124:127]
    s_waitcnt vmcnt(4)
    buffer_load_dwordx4 v6, s[16:19], s46 offen offset:0 nt lds
    buffer_load_dwordx4 v7, s[16:19], s46 offen offset:1056 nt lds
    s_waitcnt lgkmcnt(0)
    v_mfma_f32_16x16x32_bf16 v[128:131], a[192:195], v[32:35], v[176:179]
    v_add_f32 v12, v12, v164
    v_add_f32 v12, v12, v165
    v_mfma_f32_16x16x32_bf16 v[136:139], a[192:195], v[48:51], v[180:183]
    v_exp_f32 v167, v167
    v_mfma_f32_16x16x32_bf16 v[128:131], a[196:199], v[36:39], v[128:131]
    v_exp_f32 v172, v172
    v_mfma_f32_16x16x32_bf16 v[136:139], a[196:199], v[52:55], v[136:139]
    v_add_f32 v12, v12, v166
    v_cvt_pk_bf16_f32 v218, v164, v165
    v_mfma_f32_16x16x32_bf16 v[128:131], a[200:203], v[40:43], v[128:131]
    v_add_f32 v12, v12, v167
    v_cvt_pk_bf16_f32 v219, v166, v167
    v_mfma_f32_16x16x32_bf16 v[136:139], a[200:203], v[56:59], v[136:139]
    v_exp_f32 v173, v173
    v_mfma_f32_16x16x32_bf16 v[128:131], a[204:207], v[44:47], v[128:131]
    v_exp_f32 v174, v174
    v_mfma_f32_16x16x32_bf16 v[136:139], a[204:207], v[60:63], v[136:139]
    v_add_f32 v13, v13, v172
    v_add_f32 v13, v13, v173
    v_mfma_f32_16x16x32_bf16 v[132:135], a[208:211], v[32:35], v[176:179]
    v_exp_f32 v175, v175
    v_mfma_f32_16x16x32_bf16 v[140:143], a[208:211], v[48:51], v[180:183]
    s_nop 0
    v_add_f32 v13, v13, v174
    v_cvt_pk_bf16_f32 v222, v172, v173
    v_mfma_f32_16x16x32_bf16 v[132:135], a[212:215], v[36:39], v[132:135]
    v_add_f32 v13, v13, v175
    v_cvt_pk_bf16_f32 v223, v174, v175
    v_mfma_f32_16x16x32_bf16 v[140:143], a[212:215], v[52:55], v[140:143]
    v_exp_f32 v128, v128
    v_mfma_f32_16x16x32_bf16 v[132:135], a[216:219], v[40:43], v[132:135]
    v_exp_f32 v129, v129
    v_mfma_f32_16x16x32_bf16 v[140:143], a[216:219], v[56:59], v[140:143]
    v_exp_f32 v130, v130
    v_mfma_f32_16x16x32_bf16 v[132:135], a[220:223], v[44:47], v[132:135]
    v_add_f32 v8, v8, v128
    v_add_f32 v8, v8, v129
    v_mfma_f32_16x16x32_bf16 v[140:143], a[220:223], v[60:63], v[140:143]
    v_exp_f32 v131, v131
    v_mfma_f32_16x16x32_bf16 a[128:131], a[224:227], v[216:219], a[128:131]
    v_exp_f32 v136, v136
    v_mfma_f32_16x16x32_bf16 a[160:163], a[224:227], v[220:223], a[160:163]
    v_add_f32 v8, v8, v130
    v_cvt_pk_bf16_f32 v200, v128, v129
    v_mfma_f32_16x16x32_bf16 a[132:135], a[228:231], v[216:219], a[132:135]
    v_add_f32 v8, v8, v131
    v_cvt_pk_bf16_f32 v201, v130, v131
    v_mfma_f32_16x16x32_bf16 a[164:167], a[228:231], v[220:223], a[164:167]
    ds_read_b64_tr_b16 a[224:225], v4 offset:0
    ds_read_b64_tr_b16 a[226:227], v4 offset:512
    v_mfma_f32_16x16x32_bf16 a[136:139], a[232:235], v[216:219], a[136:139]
    s_add_u32 m0, s38, 84480
    v_exp_f32 v137, v137
    v_mfma_f32_16x16x32_bf16 a[168:171], a[232:235], v[220:223], a[168:171]
    s_add_u32 s46, s39, 262144
    v_exp_f32 v138, v138
    v_mfma_f32_16x16x32_bf16 a[140:143], a[236:239], v[216:219], a[140:143]
    s_waitcnt vmcnt(2)
    buffer_load_dwordx4 v6, s[16:19], s46 offen offset:0 nt lds
    buffer_load_dwordx4 v7, s[16:19], s46 offen offset:1056 nt lds
    v_mfma_f32_16x16x32_bf16 a[172:175], a[236:239], v[220:223], a[172:175]
    v_add_f32 v9, v9, v136
    v_add_f32 v9, v9, v137
    v_mfma_f32_16x16x32_bf16 a[144:147], a[240:243], v[216:219], a[144:147]
    ds_read_b64_tr_b16 a[228:229], v4 offset:32
    ds_read_b64_tr_b16 a[230:231], v4 offset:544
    v_mfma_f32_16x16x32_bf16 a[176:179], a[240:243], v[220:223], a[176:179]
    v_exp_f32 v139, v139
    v_mfma_f32_16x16x32_bf16 a[148:151], a[244:247], v[216:219], a[148:151]
    v_exp_f32 v132, v132
    v_mfma_f32_16x16x32_bf16 a[180:183], a[244:247], v[220:223], a[180:183]
    v_add_f32 v9, v9, v138
    v_cvt_pk_bf16_f32 v204, v136, v137
    v_mfma_f32_16x16x32_bf16 a[152:155], a[248:251], v[216:219], a[152:155]
    ds_read_b64_tr_b16 a[232:233], v4 offset:64
    ds_read_b64_tr_b16 a[234:235], v4 offset:576
    ds_read_b64_tr_b16 a[236:237], v4 offset:96
    ds_read_b64_tr_b16 a[238:239], v4 offset:608
    v_mfma_f32_16x16x32_bf16 a[184:187], a[248:251], v[220:223], a[184:187]
    v_add_f32 v9, v9, v139
    v_cvt_pk_bf16_f32 v205, v138, v139
    v_mfma_f32_16x16x32_bf16 a[156:159], a[252:255], v[216:219], a[156:159]
    v_exp_f32 v133, v133
    v_mfma_f32_16x16x32_bf16 a[188:191], a[252:255], v[220:223], a[188:191]
    v_exp_f32 v134, v134
    v_add_f32 v8, v8, v132
    v_add_f32 v8, v8, v133
    v_exp_f32 v135, v135
    v_exp_f32 v140, v140
    v_mfma_f32_16x16x32_bf16 v[144:147], a[192:195], v[64:67], v[184:187]
    ds_read_b64_tr_b16 a[240:241], v4 offset:128
    ds_read_b64_tr_b16 a[242:243], v4 offset:640
    v_mfma_f32_16x16x32_bf16 v[152:155], a[192:195], v[80:83], v[188:191]
    v_add_f32 v8, v8, v134
    v_cvt_pk_bf16_f32 v202, v132, v133
    v_mfma_f32_16x16x32_bf16 v[144:147], a[196:199], v[68:71], v[144:147]
    v_add_f32 v8, v8, v135
    v_cvt_pk_bf16_f32 v203, v134, v135
    v_mfma_f32_16x16x32_bf16 v[152:155], a[196:199], v[84:87], v[152:155]
    ds_read_b64_tr_b16 a[244:245], v4 offset:160
    ds_read_b64_tr_b16 a[246:247], v4 offset:672
    v_mfma_f32_16x16x32_bf16 v[144:147], a[200:203], v[72:75], v[144:147]
    v_exp_f32 v141, v141
    v_mfma_f32_16x16x32_bf16 v[152:155], a[200:203], v[88:91], v[152:155]
    v_exp_f32 v142, v142
    v_mfma_f32_16x16x32_bf16 v[144:147], a[204:207], v[76:79], v[144:147]
    ds_read_b64_tr_b16 a[248:249], v4 offset:192
    ds_read_b64_tr_b16 a[250:251], v4 offset:704
    v_mfma_f32_16x16x32_bf16 v[152:155], a[204:207], v[92:95], v[152:155]
    v_add_f32 v9, v9, v140
    v_add_f32 v9, v9, v141
    v_mfma_f32_16x16x32_bf16 v[148:151], a[208:211], v[64:67], v[184:187]
    v_exp_f32 v143, v143
    v_mfma_f32_16x16x32_bf16 v[156:159], a[208:211], v[80:83], v[188:191]
    s_nop 0
    ds_read_b64_tr_b16 a[252:253], v4 offset:224
    ds_read_b64_tr_b16 a[254:255], v4 offset:736
    v_mfma_f32_16x16x32_bf16 v[148:151], a[212:215], v[68:71], v[148:151]
    v_add_f32 v9, v9, v142
    v_cvt_pk_bf16_f32 v206, v140, v141
    v_mfma_f32_16x16x32_bf16 v[156:159], a[212:215], v[84:87], v[156:159]
    s_add_u32 m0, s38, 118272
    v_add_f32 v9, v9, v143
    v_cvt_pk_bf16_f32 v207, v142, v143
    v_mfma_f32_16x16x32_bf16 v[148:151], a[216:219], v[72:75], v[148:151]
    s_add_u32 s46, s39, 270336
    v_exp_f32 v144, v144
    v_mfma_f32_16x16x32_bf16 v[156:159], a[216:219], v[88:91], v[156:159]
    s_waitcnt vmcnt(4)
    buffer_load_dwordx4 v6, s[16:19], s46 offen offset:0 nt lds
    buffer_load_dwordx4 v7, s[16:19], s46 offen offset:1056 nt lds
    v_mfma_f32_16x16x32_bf16 v[148:151], a[220:223], v[76:79], v[148:151]
    v_exp_f32 v145, v145
    v_mfma_f32_16x16x32_bf16 v[156:159], a[220:223], v[92:95], v[156:159]
    v_exp_f32 v146, v146
    s_waitcnt lgkmcnt(0)
    v_mfma_f32_16x16x32_bf16 a[0:3], a[224:227], v[200:203], a[0:3]
    v_add_f32 v10, v10, v144
    v_add_f32 v10, v10, v145
    v_mfma_f32_16x16x32_bf16 a[32:35], a[224:227], v[204:207], a[32:35]
    v_exp_f32 v147, v147
    v_mfma_f32_16x16x32_bf16 a[4:7], a[228:231], v[200:203], a[4:7]
    v_exp_f32 v152, v152
    v_mfma_f32_16x16x32_bf16 a[36:39], a[228:231], v[204:207], a[36:39]
    v_add_f32 v10, v10, v146
    v_cvt_pk_bf16_f32 v208, v144, v145
    v_mfma_f32_16x16x32_bf16 a[8:11], a[232:235], v[200:203], a[8:11]
    v_add_f32 v10, v10, v147
    v_cvt_pk_bf16_f32 v209, v146, v147
    v_mfma_f32_16x16x32_bf16 a[40:43], a[232:235], v[204:207], a[40:43]
    v_exp_f32 v153, v153
    v_mfma_f32_16x16x32_bf16 a[12:15], a[236:239], v[200:203], a[12:15]
    v_exp_f32 v154, v154
    v_mfma_f32_16x16x32_bf16 a[44:47], a[236:239], v[204:207], a[44:47]
    v_add_f32 v11, v11, v152
    v_add_f32 v11, v11, v153
    v_mfma_f32_16x16x32_bf16 a[16:19], a[240:243], v[200:203], a[16:19]
    v_exp_f32 v155, v155
    v_mfma_f32_16x16x32_bf16 a[48:51], a[240:243], v[204:207], a[48:51]
    v_exp_f32 v148, v148
    v_mfma_f32_16x16x32_bf16 a[20:23], a[244:247], v[200:203], a[20:23]
    v_add_f32 v11, v11, v154
    v_cvt_pk_bf16_f32 v212, v152, v153
    v_mfma_f32_16x16x32_bf16 a[52:55], a[244:247], v[204:207], a[52:55]
    v_add_f32 v11, v11, v155
    v_cvt_pk_bf16_f32 v213, v154, v155
    v_mfma_f32_16x16x32_bf16 a[24:27], a[248:251], v[200:203], a[24:27]
    v_exp_f32 v149, v149
    v_mfma_f32_16x16x32_bf16 a[56:59], a[248:251], v[204:207], a[56:59]
    v_exp_f32 v150, v150
    v_mfma_f32_16x16x32_bf16 a[28:31], a[252:255], v[200:203], a[28:31]
    v_add_f32 v10, v10, v148
    v_add_f32 v10, v10, v149
    v_mfma_f32_16x16x32_bf16 a[60:63], a[252:255], v[204:207], a[60:63]
    v_exp_f32 v151, v151
    s_waitcnt vmcnt(10)
    s_barrier
    v_mfma_f32_16x16x32_bf16 v[160:163], a[192:195], v[96:99], v[192:195]
    v_exp_f32 v156, v156
    v_mfma_f32_16x16x32_bf16 v[168:171], a[192:195], v[112:115], v[196:199]
    v_add_f32 v10, v10, v150
    v_cvt_pk_bf16_f32 v210, v148, v149
    v_mfma_f32_16x16x32_bf16 v[160:163], a[196:199], v[100:103], v[160:163]
    v_add_f32 v10, v10, v151
    v_cvt_pk_bf16_f32 v211, v150, v151
    v_mfma_f32_16x16x32_bf16 v[168:171], a[196:199], v[116:119], v[168:171]
    s_add_u32 s39, s39, 16384
    ds_read_b128 a[192:195], v2 offset:33792
    ds_read_b128 a[196:199], v2 offset:33856
    v_mfma_f32_16x16x32_bf16 v[160:163], a[200:203], v[104:107], v[160:163]
    s_add_u32 m0, s38, 109824
    v_exp_f32 v157, v157
    v_mfma_f32_16x16x32_bf16 v[168:171], a[200:203], v[120:123], v[168:171]
    s_add_u32 s46, s40, 0
    v_exp_f32 v158, v158
    v_mfma_f32_16x16x32_bf16 v[160:163], a[204:207], v[108:111], v[160:163]
    s_waitcnt vmcnt(2)
    buffer_load_dwordx4 v6, s[96:99], s46 offen offset:0 nt lds
    buffer_load_dwordx4 v7, s[96:99], s46 offen offset:1056 nt lds
    v_mfma_f32_16x16x32_bf16 v[168:171], a[204:207], v[124:127], v[168:171]
    v_add_f32 v11, v11, v156
    v_add_f32 v11, v11, v157
    v_mfma_f32_16x16x32_bf16 v[164:167], a[208:211], v[96:99], v[192:195]
    ds_read_b128 a[200:203], v2 offset:33920
    ds_read_b128 a[204:207], v2 offset:33984
    v_mfma_f32_16x16x32_bf16 v[172:175], a[208:211], v[112:115], v[196:199]
    v_exp_f32 v159, v159
    v_mfma_f32_16x16x32_bf16 v[164:167], a[212:215], v[100:103], v[164:167]
    s_nop 0
    v_add_f32 v11, v11, v158
    v_cvt_pk_bf16_f32 v214, v156, v157
    v_mfma_f32_16x16x32_bf16 v[172:175], a[212:215], v[116:119], v[172:175]
    v_add_f32 v11, v11, v159
    v_cvt_pk_bf16_f32 v215, v158, v159
    v_mfma_f32_16x16x32_bf16 v[164:167], a[216:219], v[104:107], v[164:167]
    v_exp_f32 v160, v160
    v_mfma_f32_16x16x32_bf16 v[172:175], a[216:219], v[120:123], v[172:175]
    ds_read_b128 a[208:211], v2 offset:34304
    ds_read_b128 a[212:215], v2 offset:34368
    v_mfma_f32_16x16x32_bf16 v[164:167], a[220:223], v[108:111], v[164:167]
    v_exp_f32 v161, v161
    v_mfma_f32_16x16x32_bf16 v[172:175], a[220:223], v[124:127], v[172:175]
    v_exp_f32 v162, v162
    v_mfma_f32_16x16x32_bf16 a[64:67], a[224:227], v[208:211], a[64:67]
    v_add_f32 v12, v12, v160
    v_add_f32 v12, v12, v161
    v_mfma_f32_16x16x32_bf16 a[96:99], a[224:227], v[212:215], a[96:99]
    v_exp_f32 v163, v163
    v_mfma_f32_16x16x32_bf16 a[68:71], a[228:231], v[208:211], a[68:71]
    ds_read_b128 a[216:219], v2 offset:34432
    ds_read_b128 a[220:223], v2 offset:34496
    v_mfma_f32_16x16x32_bf16 a[100:103], a[228:231], v[212:215], a[100:103]
    v_exp_f32 v168, v168
    v_mfma_f32_16x16x32_bf16 a[72:75], a[232:235], v[208:211], a[72:75]
    v_add_f32 v12, v12, v162
    v_cvt_pk_bf16_f32 v216, v160, v161
    v_mfma_f32_16x16x32_bf16 a[104:107], a[232:235], v[212:215], a[104:107]
    v_add_f32 v12, v12, v163
    v_cvt_pk_bf16_f32 v217, v162, v163
    v_mfma_f32_16x16x32_bf16 a[76:79], a[236:239], v[208:211], a[76:79]
    v_exp_f32 v169, v169
    v_mfma_f32_16x16x32_bf16 a[108:111], a[236:239], v[212:215], a[108:111]
    v_exp_f32 v170, v170
    v_mfma_f32_16x16x32_bf16 a[80:83], a[240:243], v[208:211], a[80:83]
    v_add_f32 v13, v13, v168
    v_add_f32 v13, v13, v169
    v_mfma_f32_16x16x32_bf16 a[112:115], a[240:243], v[212:215], a[112:115]
    v_exp_f32 v171, v171
    v_mfma_f32_16x16x32_bf16 a[84:87], a[244:247], v[208:211], a[84:87]
    v_exp_f32 v164, v164
    v_mfma_f32_16x16x32_bf16 a[116:119], a[244:247], v[212:215], a[116:119]
    v_add_f32 v13, v13, v170
    v_cvt_pk_bf16_f32 v220, v168, v169
    v_mfma_f32_16x16x32_bf16 a[88:91], a[248:251], v[208:211], a[88:91]
    v_add_f32 v13, v13, v171
    v_cvt_pk_bf16_f32 v221, v170, v171
    v_mfma_f32_16x16x32_bf16 a[120:123], a[248:251], v[212:215], a[120:123]
    s_add_u32 m0, s38, 8448
    v_exp_f32 v165, v165
    v_mfma_f32_16x16x32_bf16 a[92:95], a[252:255], v[208:211], a[92:95]
    s_add_u32 s46, s40, 8192
    v_exp_f32 v166, v166
    v_mfma_f32_16x16x32_bf16 a[124:127], a[252:255], v[212:215], a[124:127]
    s_waitcnt vmcnt(4)
    buffer_load_dwordx4 v6, s[96:99], s46 offen offset:0 nt lds
    buffer_load_dwordx4 v7, s[96:99], s46 offen offset:1056 nt lds
    s_waitcnt lgkmcnt(0)
    v_mfma_f32_16x16x32_bf16 v[128:131], a[192:195], v[32:35], v[176:179]
    v_add_f32 v12, v12, v164
    v_add_f32 v12, v12, v165
    v_mfma_f32_16x16x32_bf16 v[136:139], a[192:195], v[48:51], v[180:183]
    v_exp_f32 v167, v167
    v_mfma_f32_16x16x32_bf16 v[128:131], a[196:199], v[36:39], v[128:131]
    v_exp_f32 v172, v172
    v_mfma_f32_16x16x32_bf16 v[136:139], a[196:199], v[52:55], v[136:139]
    v_add_f32 v12, v12, v166
    v_cvt_pk_bf16_f32 v218, v164, v165
    v_mfma_f32_16x16x32_bf16 v[128:131], a[200:203], v[40:43], v[128:131]
    v_add_f32 v12, v12, v167
    v_cvt_pk_bf16_f32 v219, v166, v167
    v_mfma_f32_16x16x32_bf16 v[136:139], a[200:203], v[56:59], v[136:139]
    v_exp_f32 v173, v173
    v_mfma_f32_16x16x32_bf16 v[128:131], a[204:207], v[44:47], v[128:131]
    v_exp_f32 v174, v174
    v_mfma_f32_16x16x32_bf16 v[136:139], a[204:207], v[60:63], v[136:139]
    v_add_f32 v13, v13, v172
    v_add_f32 v13, v13, v173
    v_mfma_f32_16x16x32_bf16 v[132:135], a[208:211], v[32:35], v[176:179]
    v_exp_f32 v175, v175
    v_mfma_f32_16x16x32_bf16 v[140:143], a[208:211], v[48:51], v[180:183]
    s_nop 0
    v_add_f32 v13, v13, v174
    v_cvt_pk_bf16_f32 v222, v172, v173
    v_mfma_f32_16x16x32_bf16 v[132:135], a[212:215], v[36:39], v[132:135]
    v_add_f32 v13, v13, v175
    v_cvt_pk_bf16_f32 v223, v174, v175
    v_mfma_f32_16x16x32_bf16 v[140:143], a[212:215], v[52:55], v[140:143]
    v_exp_f32 v128, v128
    v_mfma_f32_16x16x32_bf16 v[132:135], a[216:219], v[40:43], v[132:135]
    v_exp_f32 v129, v129
    v_mfma_f32_16x16x32_bf16 v[140:143], a[216:219], v[56:59], v[140:143]
    v_exp_f32 v130, v130
    v_mfma_f32_16x16x32_bf16 v[132:135], a[220:223], v[44:47], v[132:135]
    v_add_f32 v8, v8, v128
    v_add_f32 v8, v8, v129
    v_mfma_f32_16x16x32_bf16 v[140:143], a[220:223], v[60:63], v[140:143]
    v_exp_f32 v131, v131
    v_mfma_f32_16x16x32_bf16 a[128:131], a[224:227], v[216:219], a[128:131]
    v_exp_f32 v136, v136
    v_mfma_f32_16x16x32_bf16 a[160:163], a[224:227], v[220:223], a[160:163]
    v_add_f32 v8, v8, v130
    v_cvt_pk_bf16_f32 v200, v128, v129
    v_mfma_f32_16x16x32_bf16 a[132:135], a[228:231], v[216:219], a[132:135]
    v_add_f32 v8, v8, v131
    v_cvt_pk_bf16_f32 v201, v130, v131
    v_mfma_f32_16x16x32_bf16 a[164:167], a[228:231], v[220:223], a[164:167]
    ds_read_b64_tr_b16 a[224:225], v4 offset:33792
    ds_read_b64_tr_b16 a[226:227], v4 offset:34304
    v_mfma_f32_16x16x32_bf16 a[136:139], a[232:235], v[216:219], a[136:139]
    s_add_u32 m0, s38, 126720
    v_exp_f32 v137, v137
    v_mfma_f32_16x16x32_bf16 a[168:171], a[232:235], v[220:223], a[168:171]
    s_add_u32 s46, s40, 262144
    v_exp_f32 v138, v138
    v_mfma_f32_16x16x32_bf16 a[140:143], a[236:239], v[216:219], a[140:143]
    s_waitcnt vmcnt(2)
    buffer_load_dwordx4 v6, s[96:99], s46 offen offset:0 nt lds
    buffer_load_dwordx4 v7, s[96:99], s46 offen offset:1056 nt lds
    v_mfma_f32_16x16x32_bf16 a[172:175], a[236:239], v[220:223], a[172:175]
    v_add_f32 v9, v9, v136
    v_add_f32 v9, v9, v137
    v_mfma_f32_16x16x32_bf16 a[144:147], a[240:243], v[216:219], a[144:147]
    ds_read_b64_tr_b16 a[228:229], v4 offset:33824
    ds_read_b64_tr_b16 a[230:231], v4 offset:34336
    v_mfma_f32_16x16x32_bf16 a[176:179], a[240:243], v[220:223], a[176:179]
    v_exp_f32 v139, v139
    v_mfma_f32_16x16x32_bf16 a[148:151], a[244:247], v[216:219], a[148:151]
    v_exp_f32 v132, v132
    v_mfma_f32_16x16x32_bf16 a[180:183], a[244:247], v[220:223], a[180:183]
    v_add_f32 v9, v9, v138
    v_cvt_pk_bf16_f32 v204, v136, v137
    v_mfma_f32_16x16x32_bf16 a[152:155], a[248:251], v[216:219], a[152:155]
    ds_read_b64_tr_b16 a[232:233], v4 offset:33856
    ds_read_b64_tr_b16 a[234:235], v4 offset:34368
    ds_read_b64_tr_b16 a[236:237], v4 offset:33888
    ds_read_b64_tr_b16 a[238:239], v4 offset:34400
    v_mfma_f32_16x16x32_bf16 a[184:187], a[248:251], v[220:223], a[184:187]
    v_add_f32 v9, v9, v139
    v_cvt_pk_bf16_f32 v205, v138, v139
    v_mfma_f32_16x16x32_bf16 a[156:159], a[252:255], v[216:219], a[156:159]
    v_exp_f32 v133, v133
    v_mfma_f32_16x16x32_bf16 a[188:191], a[252:255], v[220:223], a[188:191]
    v_exp_f32 v134, v134
    v_add_f32 v8, v8, v132
    v_add_f32 v8, v8, v133
    v_exp_f32 v135, v135
    v_exp_f32 v140, v140
    s_add_u32 s41, s41, 1
    s_cmp_lt_u32 s41, 7
    s_cbranch_scc1 L_loop_f
    v_mfma_f32_16x16x32_bf16 v[144:147], a[192:195], v[64:67], v[184:187]
    ds_read_b64_tr_b16 a[240:241], v4 offset:33920
    ds_read_b64_tr_b16 a[242:243], v4 offset:34432
    v_mfma_f32_16x16x32_bf16 v[152:155], a[192:195], v[80:83], v[188:191]
    v_add_f32 v8, v8, v134
    v_cvt_pk_bf16_f32 v202, v132, v133
    v_mfma_f32_16x16x32_bf16 v[144:147], a[196:199], v[68:71], v[144:147]
    v_add_f32 v8, v8, v135
    v_cvt_pk_bf16_f32 v203, v134, v135
    v_mfma_f32_16x16x32_bf16 v[152:155], a[196:199], v[84:87], v[152:155]
    ds_read_b64_tr_b16 a[244:245], v4 offset:33952
    ds_read_b64_tr_b16 a[246:247], v4 offset:34464
    v_mfma_f32_16x16x32_bf16 v[144:147], a[200:203], v[72:75], v[144:147]
    v_exp_f32 v141, v141
    v_mfma_f32_16x16x32_bf16 v[152:155], a[200:203], v[88:91], v[152:155]
    v_exp_f32 v142, v142
    v_mfma_f32_16x16x32_bf16 v[144:147], a[204:207], v[76:79], v[144:147]
    ds_read_b64_tr_b16 a[248:249], v4 offset:33984
    ds_read_b64_tr_b16 a[250:251], v4 offset:34496
    v_mfma_f32_16x16x32_bf16 v[152:155], a[204:207], v[92:95], v[152:155]
    v_add_f32 v9, v9, v140
    v_add_f32 v9, v9, v141
    v_mfma_f32_16x16x32_bf16 v[148:151], a[208:211], v[64:67], v[184:187]
    v_exp_f32 v143, v143
    v_mfma_f32_16x16x32_bf16 v[156:159], a[208:211], v[80:83], v[188:191]
    s_nop 0
    ds_read_b64_tr_b16 a[252:253], v4 offset:34016
    ds_read_b64_tr_b16 a[254:255], v4 offset:34528
    v_mfma_f32_16x16x32_bf16 v[148:151], a[212:215], v[68:71], v[148:151]
    v_add_f32 v9, v9, v142
    v_cvt_pk_bf16_f32 v206, v140, v141
    v_mfma_f32_16x16x32_bf16 v[156:159], a[212:215], v[84:87], v[156:159]
    s_add_u32 m0, s38, 25344
    v_add_f32 v9, v9, v143
    v_cvt_pk_bf16_f32 v207, v142, v143
    v_mfma_f32_16x16x32_bf16 v[148:151], a[216:219], v[72:75], v[148:151]
    s_add_u32 s46, s40, 270336
    v_exp_f32 v144, v144
    v_mfma_f32_16x16x32_bf16 v[156:159], a[216:219], v[88:91], v[156:159]
    s_waitcnt vmcnt(4)
    buffer_load_dwordx4 v6, s[96:99], s46 offen offset:0 nt lds
    buffer_load_dwordx4 v7, s[96:99], s46 offen offset:1056 nt lds
    v_mfma_f32_16x16x32_bf16 v[148:151], a[220:223], v[76:79], v[148:151]
    v_exp_f32 v145, v145
    v_mfma_f32_16x16x32_bf16 v[156:159], a[220:223], v[92:95], v[156:159]
    v_exp_f32 v146, v146
    s_waitcnt lgkmcnt(0)
    v_mfma_f32_16x16x32_bf16 a[0:3], a[224:227], v[200:203], a[0:3]
    v_add_f32 v10, v10, v144
    v_add_f32 v10, v10, v145
    v_mfma_f32_16x16x32_bf16 a[32:35], a[224:227], v[204:207], a[32:35]
    v_exp_f32 v147, v147
    v_mfma_f32_16x16x32_bf16 a[4:7], a[228:231], v[200:203], a[4:7]
    v_exp_f32 v152, v152
    v_mfma_f32_16x16x32_bf16 a[36:39], a[228:231], v[204:207], a[36:39]
    v_add_f32 v10, v10, v146
    v_cvt_pk_bf16_f32 v208, v144, v145
    v_mfma_f32_16x16x32_bf16 a[8:11], a[232:235], v[200:203], a[8:11]
    v_add_f32 v10, v10, v147
    v_cvt_pk_bf16_f32 v209, v146, v147
    v_mfma_f32_16x16x32_bf16 a[40:43], a[232:235], v[204:207], a[40:43]
    v_exp_f32 v153, v153
    v_mfma_f32_16x16x32_bf16 a[12:15], a[236:239], v[200:203], a[12:15]
    v_exp_f32 v154, v154
    v_mfma_f32_16x16x32_bf16 a[44:47], a[236:239], v[204:207], a[44:47]
    v_add_f32 v11, v11, v152
    v_add_f32 v11, v11, v153
    v_mfma_f32_16x16x32_bf16 a[16:19], a[240:243], v[200:203], a[16:19]
    v_exp_f32 v155, v155
    v_mfma_f32_16x16x32_bf16 a[48:51], a[240:243], v[204:207], a[48:51]
    v_exp_f32 v148, v148
    v_mfma_f32_16x16x32_bf16 a[20:23], a[244:247], v[200:203], a[20:23]
    v_add_f32 v11, v11, v154
    v_cvt_pk_bf16_f32 v212, v152, v153
    v_mfma_f32_16x16x32_bf16 a[52:55], a[244:247], v[204:207], a[52:55]
    v_add_f32 v11, v11, v155
    v_cvt_pk_bf16_f32 v213, v154, v155
    v_mfma_f32_16x16x32_bf16 a[24:27], a[248:251], v[200:203], a[24:27]
    v_exp_f32 v149, v149
    v_mfma_f32_16x16x32_bf16 a[56:59], a[248:251], v[204:207], a[56:59]
    v_exp_f32 v150, v150
    v_mfma_f32_16x16x32_bf16 a[28:31], a[252:255], v[200:203], a[28:31]
    v_add_f32 v10, v10, v148
    v_add_f32 v10, v10, v149
    v_mfma_f32_16x16x32_bf16 a[60:63], a[252:255], v[204:207], a[60:63]
    v_exp_f32 v151, v151
    s_waitcnt vmcnt(10)
    s_barrier
    v_mfma_f32_16x16x32_bf16 v[160:163], a[192:195], v[96:99], v[192:195]
    v_exp_f32 v156, v156
    v_mfma_f32_16x16x32_bf16 v[168:171], a[192:195], v[112:115], v[196:199]
    v_add_f32 v10, v10, v150
    v_cvt_pk_bf16_f32 v210, v148, v149
    v_mfma_f32_16x16x32_bf16 v[160:163], a[196:199], v[100:103], v[160:163]
    v_add_f32 v10, v10, v151
    v_cvt_pk_bf16_f32 v211, v150, v151
    v_mfma_f32_16x16x32_bf16 v[168:171], a[196:199], v[116:119], v[168:171]
    s_add_u32 s40, s40, 16384
    ds_read_b128 a[192:195], v3 offset:0
    ds_read_b128 a[196:199], v3 offset:64
    v_mfma_f32_16x16x32_bf16 v[160:163], a[200:203], v[104:107], v[160:163]
    s_and_b32 s44, s2, 127
    s_lshl_b32 s44, s44, 15
    s_lshl_b32 s45, s32, 13
    s_add_u32 s44, s44, s45
    v_lshlrev_b32 v246, 7, v1
    s_and_b32 s57, s57, 0xffff
    s_mov_b32 s58, 4194304
    s_mov_b32 s59, 0x20000
    buffer_load_dword v245, v246, s[56:59], s44 offen
    s_getpc_b64 s[44:45]
L_k1_pc2:
    s_add_u32 s44, s44, reduce_kernel - L_k1_pc2
    s_addc_u32 s45, s45, 0
    v_lshrrev_b32 v244, 2, v246
    s_mov_b32 s47, L_k2_end - reduce_kernel
    v_min_u32 v244, s47, v244
    global_load_dword v243, v244, s[44:45]
    v_mfma_f32_16x16x32_bf16 v[168:171], a[200:203], v[120:123], v[168:171]
    v_exp_f32 v157, v157
    v_mfma_f32_16x16x32_bf16 v[160:163], a[204:207], v[108:111], v[160:163]
    v_exp_f32 v158, v158
    v_mfma_f32_16x16x32_bf16 v[168:171], a[204:207], v[124:127], v[168:171]
    v_add_f32 v11, v11, v156
    v_add_f32 v11, v11, v157
    v_mfma_f32_16x16x32_bf16 v[164:167], a[208:211], v[96:99], v[192:195]
    ds_read_b128 a[200:203], v3 offset:128
    ds_read_b128 a[204:207], v3 offset:192
    v_mfma_f32_16x16x32_bf16 v[172:175], a[208:211], v[112:115], v[196:199]
    v_exp_f32 v159, v159
    v_mfma_f32_16x16x32_bf16 v[164:167], a[212:215], v[100:103], v[164:167]
    s_nop 0
    v_add_f32 v11, v11, v158
    v_cvt_pk_bf16_f32 v214, v156, v157
    v_mfma_f32_16x16x32_bf16 v[172:175], a[212:215], v[116:119], v[172:175]
    v_add_f32 v11, v11, v159
    v_cvt_pk_bf16_f32 v215, v158, v159
    v_mfma_f32_16x16x32_bf16 v[164:167], a[216:219], v[104:107], v[164:167]
    v_exp_f32 v160, v160
    v_mfma_f32_16x16x32_bf16 v[172:175], a[216:219], v[120:123], v[172:175]
    ds_read_b128 a[208:211], v3 offset:512
    ds_read_b128 a[212:215], v3 offset:576
    v_mfma_f32_16x16x32_bf16 v[164:167], a[220:223], v[108:111], v[164:167]
    v_exp_f32 v161, v161
    v_mfma_f32_16x16x32_bf16 v[172:175], a[220:223], v[124:127], v[172:175]
    v_exp_f32 v162, v162
    v_mfma_f32_16x16x32_bf16 a[64:67], a[224:227], v[208:211], a[64:67]
    v_add_f32 v12, v12, v160
    v_add_f32 v12, v12, v161
    v_mfma_f32_16x16x32_bf16 a[96:99], a[224:227], v[212:215], a[96:99]
    v_exp_f32 v163, v163
    v_mfma_f32_16x16x32_bf16 a[68:71], a[228:231], v[208:211], a[68:71]
    ds_read_b128 a[216:219], v3 offset:640
    ds_read_b128 a[220:223], v3 offset:704
    v_mfma_f32_16x16x32_bf16 a[100:103], a[228:231], v[212:215], a[100:103]
    v_exp_f32 v168, v168
    v_mfma_f32_16x16x32_bf16 a[72:75], a[232:235], v[208:211], a[72:75]
    v_add_f32 v12, v12, v162
    v_cvt_pk_bf16_f32 v216, v160, v161
    v_mfma_f32_16x16x32_bf16 a[104:107], a[232:235], v[212:215], a[104:107]
    v_add_f32 v12, v12, v163
    v_cvt_pk_bf16_f32 v217, v162, v163
    v_mfma_f32_16x16x32_bf16 a[76:79], a[236:239], v[208:211], a[76:79]
    v_exp_f32 v169, v169
    v_mfma_f32_16x16x32_bf16 a[108:111], a[236:239], v[212:215], a[108:111]
    v_exp_f32 v170, v170
    v_mfma_f32_16x16x32_bf16 a[80:83], a[240:243], v[208:211], a[80:83]
    v_add_f32 v13, v13, v168
    v_add_f32 v13, v13, v169
    v_mfma_f32_16x16x32_bf16 a[112:115], a[240:243], v[212:215], a[112:115]
    v_exp_f32 v171, v171
    v_mfma_f32_16x16x32_bf16 a[84:87], a[244:247], v[208:211], a[84:87]
    v_exp_f32 v164, v164
    v_mfma_f32_16x16x32_bf16 a[116:119], a[244:247], v[212:215], a[116:119]
    v_add_f32 v13, v13, v170
    v_cvt_pk_bf16_f32 v220, v168, v169
    v_mfma_f32_16x16x32_bf16 a[88:91], a[248:251], v[208:211], a[88:91]
    v_add_f32 v13, v13, v171
    v_cvt_pk_bf16_f32 v221, v170, v171
    v_mfma_f32_16x16x32_bf16 a[120:123], a[248:251], v[212:215], a[120:123]
    v_exp_f32 v165, v165
    v_mfma_f32_16x16x32_bf16 a[92:95], a[252:255], v[208:211], a[92:95]
    v_exp_f32 v166, v166
    v_mfma_f32_16x16x32_bf16 a[124:127], a[252:255], v[212:215], a[124:127]
    v_add_f32 v12, v12, v164
    v_add_f32 v12, v12, v165
    s_waitcnt lgkmcnt(0)
    v_mfma_f32_16x16x32_bf16 v[128:131], a[192:195], v[32:35], v[176:179]
    v_exp_f32 v167, v167
    v_mfma_f32_16x16x32_bf16 v[136:139], a[192:195], v[48:51], v[180:183]
    v_exp_f32 v172, v172
    v_mfma_f32_16x16x32_bf16 v[128:131], a[196:199], v[36:39], v[128:131]
    v_add_f32 v12, v12, v166
    v_cvt_pk_bf16_f32 v218, v164, v165
    v_mfma_f32_16x16x32_bf16 v[136:139], a[196:199], v[52:55], v[136:139]
    v_add_f32 v12, v12, v167
    v_cvt_pk_bf16_f32 v219, v166, v167
    v_mfma_f32_16x16x32_bf16 v[128:131], a[200:203], v[40:43], v[128:131]
    v_exp_f32 v173, v173
    v_mfma_f32_16x16x32_bf16 v[136:139], a[200:203], v[56:59], v[136:139]
    v_exp_f32 v174, v174
    v_mfma_f32_16x16x32_bf16 v[128:131], a[204:207], v[44:47], v[128:131]
    v_add_f32 v13, v13, v172
    v_add_f32 v13, v13, v173
    v_mfma_f32_16x16x32_bf16 v[136:139], a[204:207], v[60:63], v[136:139]
    v_exp_f32 v175, v175
    v_mfma_f32_16x16x32_bf16 v[132:135], a[208:211], v[32:35], v[176:179]
    s_nop 0
    v_add_f32 v13, v13, v174
    v_cvt_pk_bf16_f32 v222, v172, v173
    v_mfma_f32_16x16x32_bf16 v[140:143], a[208:211], v[48:51], v[180:183]
    v_add_f32 v13, v13, v175
    v_cvt_pk_bf16_f32 v223, v174, v175
    v_mfma_f32_16x16x32_bf16 v[132:135], a[212:215], v[36:39], v[132:135]
    v_exp_f32 v128, v128
    v_mfma_f32_16x16x32_bf16 v[140:143], a[212:215], v[52:55], v[140:143]
    v_exp_f32 v129, v129
    v_mfma_f32_16x16x32_bf16 v[132:135], a[216:219], v[40:43], v[132:135]
    v_exp_f32 v130, v130
    v_mfma_f32_16x16x32_bf16 v[140:143], a[216:219], v[56:59], v[140:143]
    v_add_f32 v8, v8, v128
    v_add_f32 v8, v8, v129
    v_mfma_f32_16x16x32_bf16 v[132:135], a[220:223], v[44:47], v[132:135]
    v_exp_f32 v131, v131
    v_mfma_f32_16x16x32_bf16 v[140:143], a[220:223], v[60:63], v[140:143]
    v_exp_f32 v136, v136
    v_mfma_f32_16x16x32_bf16 a[128:131], a[224:227], v[216:219], a[128:131]
    v_add_f32 v8, v8, v130
    v_cvt_pk_bf16_f32 v200, v128, v129
    v_mfma_f32_16x16x32_bf16 a[160:163], a[224:227], v[220:223], a[160:163]
    v_add_f32 v8, v8, v131
    v_cvt_pk_bf16_f32 v201, v130, v131
    v_mfma_f32_16x16x32_bf16 a[132:135], a[228:231], v[216:219], a[132:135]
    ds_read_b64_tr_b16 a[224:225], v5 offset:0
    ds_read_b64_tr_b16 a[226:227], v5 offset:512
    v_mfma_f32_16x16x32_bf16 a[164:167], a[228:231], v[220:223], a[164:167]
    v_exp_f32 v137, v137
    v_mfma_f32_16x16x32_bf16 a[136:139], a[232:235], v[216:219], a[136:139]
    v_exp_f32 v138, v138
    v_mfma_f32_16x16x32_bf16 a[168:171], a[232:235], v[220:223], a[168:171]
    v_add_f32 v9, v9, v136
    v_add_f32 v9, v9, v137
    v_mfma_f32_16x16x32_bf16 a[140:143], a[236:239], v[216:219], a[140:143]
    ds_read_b64_tr_b16 a[228:229], v5 offset:32
    ds_read_b64_tr_b16 a[230:231], v5 offset:544
    v_mfma_f32_16x16x32_bf16 a[172:175], a[236:239], v[220:223], a[172:175]
    v_exp_f32 v139, v139
    v_mfma_f32_16x16x32_bf16 a[144:147], a[240:243], v[216:219], a[144:147]
    v_exp_f32 v132, v132
    v_mfma_f32_16x16x32_bf16 a[176:179], a[240:243], v[220:223], a[176:179]
    v_add_f32 v9, v9, v138
    v_cvt_pk_bf16_f32 v204, v136, v137
    v_mfma_f32_16x16x32_bf16 a[148:151], a[244:247], v[216:219], a[148:151]
    ds_read_b64_tr_b16 a[232:233], v5 offset:64
    ds_read_b64_tr_b16 a[234:235], v5 offset:576
    v_mfma_f32_16x16x32_bf16 a[180:183], a[244:247], v[220:223], a[180:183]
    v_add_f32 v9, v9, v139
    v_cvt_pk_bf16_f32 v205, v138, v139
    v_mfma_f32_16x16x32_bf16 a[152:155], a[248:251], v[216:219], a[152:155]
    v_exp_f32 v133, v133
    v_mfma_f32_16x16x32_bf16 a[184:187], a[248:251], v[220:223], a[184:187]
    v_exp_f32 v134, v134
    v_mfma_f32_16x16x32_bf16 a[156:159], a[252:255], v[216:219], a[156:159]
    ds_read_b64_tr_b16 a[236:237], v5 offset:96
    ds_read_b64_tr_b16 a[238:239], v5 offset:608
    v_mfma_f32_16x16x32_bf16 a[188:191], a[252:255], v[220:223], a[188:191]
    v_add_f32 v8, v8, v132
    v_add_f32 v8, v8, v133
    v_exp_f32 v135, v135
    v_exp_f32 v140, v140
    v_mfma_f32_16x16x32_bf16 v[144:147], a[192:195], v[64:67], v[184:187]
    ds_read_b64_tr_b16 a[240:241], v5 offset:128
    ds_read_b64_tr_b16 a[242:243], v5 offset:640
    v_mfma_f32_16x16x32_bf16 v[152:155], a[192:195], v[80:83], v[188:191]
    v_add_f32 v8, v8, v134
    v_cvt_pk_bf16_f32 v202, v132, v133
    v_mfma_f32_16x16x32_bf16 v[144:147], a[196:199], v[68:71], v[144:147]
    v_add_f32 v8, v8, v135
    v_cvt_pk_bf16_f32 v203, v134, v135
    v_mfma_f32_16x16x32_bf16 v[152:155], a[196:199], v[84:87], v[152:155]
    ds_read_b64_tr_b16 a[244:245], v5 offset:160
    ds_read_b64_tr_b16 a[246:247], v5 offset:672
    v_mfma_f32_16x16x32_bf16 v[144:147], a[200:203], v[72:75], v[144:147]
    v_exp_f32 v141, v141
    v_mfma_f32_16x16x32_bf16 v[152:155], a[200:203], v[88:91], v[152:155]
    v_exp_f32 v142, v142
    v_mfma_f32_16x16x32_bf16 v[144:147], a[204:207], v[76:79], v[144:147]
    ds_read_b64_tr_b16 a[248:249], v5 offset:192
    ds_read_b64_tr_b16 a[250:251], v5 offset:704
    v_mfma_f32_16x16x32_bf16 v[152:155], a[204:207], v[92:95], v[152:155]
    v_add_f32 v9, v9, v140
    v_add_f32 v9, v9, v141
    v_mfma_f32_16x16x32_bf16 v[148:151], a[208:211], v[64:67], v[184:187]
    v_exp_f32 v143, v143
    v_mfma_f32_16x16x32_bf16 v[156:159], a[208:211], v[80:83], v[188:191]
    s_nop 0
    ds_read_b64_tr_b16 a[252:253], v5 offset:224
    ds_read_b64_tr_b16 a[254:255], v5 offset:736
    v_mfma_f32_16x16x32_bf16 v[148:151], a[212:215], v[68:71], v[148:151]
    v_add_f32 v9, v9, v142
    v_cvt_pk_bf16_f32 v206, v140, v141
    v_mfma_f32_16x16x32_bf16 v[156:159], a[212:215], v[84:87], v[156:159]
    v_add_f32 v9, v9, v143
    v_cvt_pk_bf16_f32 v207, v142, v143
    v_mfma_f32_16x16x32_bf16 v[148:151], a[216:219], v[72:75], v[148:151]
    v_exp_f32 v144, v144
    v_mfma_f32_16x16x32_bf16 v[156:159], a[216:219], v[88:91], v[156:159]
    v_exp_f32 v145, v145
    v_mfma_f32_16x16x32_bf16 v[148:151], a[220:223], v[76:79], v[148:151]
    v_exp_f32 v146, v146
    v_mfma_f32_16x16x32_bf16 v[156:159], a[220:223], v[92:95], v[156:159]
    v_add_f32 v10, v10, v144
    v_add_f32 v10, v10, v145
    s_waitcnt lgkmcnt(0)
    v_mfma_f32_16x16x32_bf16 a[0:3], a[224:227], v[200:203], a[0:3]
    v_exp_f32 v147, v147
    v_mfma_f32_16x16x32_bf16 a[32:35], a[224:227], v[204:207], a[32:35]
    v_exp_f32 v152, v152
    v_mfma_f32_16x16x32_bf16 a[4:7], a[228:231], v[200:203], a[4:7]
    v_add_f32 v10, v10, v146
    v_cvt_pk_bf16_f32 v208, v144, v145
    v_mfma_f32_16x16x32_bf16 a[36:39], a[228:231], v[204:207], a[36:39]
    v_add_f32 v10, v10, v147
    v_cvt_pk_bf16_f32 v209, v146, v147
    v_mfma_f32_16x16x32_bf16 a[8:11], a[232:235], v[200:203], a[8:11]
    v_exp_f32 v153, v153
    v_mfma_f32_16x16x32_bf16 a[40:43], a[232:235], v[204:207], a[40:43]
    v_exp_f32 v154, v154
    v_mfma_f32_16x16x32_bf16 a[12:15], a[236:239], v[200:203], a[12:15]
    v_add_f32 v11, v11, v152
    v_add_f32 v11, v11, v153
    v_mfma_f32_16x16x32_bf16 a[44:47], a[236:239], v[204:207], a[44:47]
    v_exp_f32 v155, v155
    v_mfma_f32_16x16x32_bf16 a[16:19], a[240:243], v[200:203], a[16:19]
    v_exp_f32 v148, v148
    v_mfma_f32_16x16x32_bf16 a[48:51], a[240:243], v[204:207], a[48:51]
    v_add_f32 v11, v11, v154
    v_cvt_pk_bf16_f32 v212, v152, v153
    v_mfma_f32_16x16x32_bf16 a[20:23], a[244:247], v[200:203], a[20:23]
    v_add_f32 v11, v11, v155
    v_cvt_pk_bf16_f32 v213, v154, v155
    v_mfma_f32_16x16x32_bf16 a[52:55], a[244:247], v[204:207], a[52:55]
    v_exp_f32 v149, v149
    v_mfma_f32_16x16x32_bf16 a[24:27], a[248:251], v[200:203], a[24:27]
    v_exp_f32 v150, v150
    v_mfma_f32_16x16x32_bf16 a[56:59], a[248:251], v[204:207], a[56:59]
    v_add_f32 v10, v10, v148
    v_add_f32 v10, v10, v149
    v_mfma_f32_16x16x32_bf16 a[28:31], a[252:255], v[200:203], a[28:31]
    v_exp_f32 v151, v151
    v_mfma_f32_16x16x32_bf16 a[60:63], a[252:255], v[204:207], a[60:63]
    v_exp_f32 v156, v156
    s_waitcnt vmcnt(2)
    s_barrier
    v_mfma_f32_16x16x32_bf16 v[160:163], a[192:195], v[96:99], v[192:195]
    s_add_u32 m0, s52, 0
    v_add_f32 v10, v10, v150
    v_cvt_pk_bf16_f32 v210, v148, v149
    v_mfma_f32_16x16x32_bf16 v[168:171], a[192:195], v[112:115], v[196:199]
    s_add_u32 s46, s50, 0
    v_add_f32 v10, v10, v151
    v_cvt_pk_bf16_f32 v211, v150, v151
    v_mfma_f32_16x16x32_bf16 v[160:163], a[196:199], v[100:103], v[160:163]
    buffer_load_dwordx4 v27, s[20:23], s46 offen  lds
    v_mfma_f32_16x16x32_bf16 v[168:171], a[196:199], v[116:119], v[168:171]
    ds_read_b128 a[192:195], v3 offset:33792
    ds_read_b128 a[196:199], v3 offset:33856
    v_mfma_f32_16x16x32_bf16 v[160:163], a[200:203], v[104:107], v[160:163]
    v_exp_f32 v157, v157
    v_mfma_f32_16x16x32_bf16 v[168:171], a[200:203], v[120:123], v[168:171]
    v_exp_f32 v158, v158
    v_mfma_f32_16x16x32_bf16 v[160:163], a[204:207], v[108:111], v[160:163]
    v_add_f32 v11, v11, v156
    v_add_f32 v11, v11, v157
    v_mfma_f32_16x16x32_bf16 v[168:171], a[204:207], v[124:127], v[168:171]
    s_add_u32 m0, s52, 1024
    ds_read_b128 a[200:203], v3 offset:33920
    ds_read_b128 a[204:207], v3 offset:33984
    v_mfma_f32_16x16x32_bf16 v[164:167], a[208:211], v[96:99], v[192:195]
    s_add_u32 s46, s50, 8192
    v_exp_f32 v159, v159
    v_mfma_f32_16x16x32_bf16 v[172:175], a[208:211], v[112:115], v[196:199]
    s_nop 0
    buffer_load_dwordx4 v27, s[20:23], s46 offen  lds
    v_mfma_f32_16x16x32_bf16 v[164:167], a[212:215], v[100:103], v[164:167]
    v_add_f32 v11, v11, v158
    v_cvt_pk_bf16_f32 v214, v156, v157
    v_mfma_f32_16x16x32_bf16 v[172:175], a[212:215], v[116:119], v[172:175]
    v_add_f32 v11, v11, v159
    v_cvt_pk_bf16_f32 v215, v158, v159
    v_mfma_f32_16x16x32_bf16 v[164:167], a[216:219], v[104:107], v[164:167]
    v_exp_f32 v160, v160
    v_mfma_f32_16x16x32_bf16 v[172:175], a[216:219], v[120:123], v[172:175]
    s_add_u32 m0, s52, 2048
    ds_read_b128 a[208:211], v3 offset:34304
    ds_read_b128 a[212:215], v3 offset:34368
    v_mfma_f32_16x16x32_bf16 v[164:167], a[220:223], v[108:111], v[164:167]
    s_add_u32 s46, s50, 16384
    v_exp_f32 v161, v161
    v_mfma_f32_16x16x32_bf16 v[172:175], a[220:223], v[124:127], v[172:175]
    buffer_load_dwordx4 v27, s[20:23], s46 offen  lds
    v_mfma_f32_16x16x32_bf16 a[64:67], a[224:227], v[208:211], a[64:67]
    v_exp_f32 v162, v162
    v_mfma_f32_16x16x32_bf16 a[96:99], a[224:227], v[212:215], a[96:99]
    v_add_f32 v12, v12, v160
    v_add_f32 v12, v12, v161
    v_mfma_f32_16x16x32_bf16 a[68:71], a[228:231], v[208:211], a[68:71]
    v_exp_f32 v163, v163
    v_mfma_f32_16x16x32_bf16 a[100:103], a[228:231], v[212:215], a[100:103]
    s_add_u32 m0, s52, 3072
    ds_read_b128 a[216:219], v3 offset:34432
    ds_read_b128 a[220:223], v3 offset:34496
    v_mfma_f32_16x16x32_bf16 a[72:75], a[232:235], v[208:211], a[72:75]
    s_add_u32 s46, s50, 24576
    v_exp_f32 v168, v168
    v_mfma_f32_16x16x32_bf16 a[104:107], a[232:235], v[212:215], a[104:107]
    buffer_load_dwordx4 v27, s[20:23], s46 offen  lds
    v_add_f32 v12, v12, v162
    v_cvt_pk_bf16_f32 v216, v160, v161
    v_mfma_f32_16x16x32_bf16 a[76:79], a[236:239], v[208:211], a[76:79]
    v_add_f32 v12, v12, v163
    v_cvt_pk_bf16_f32 v217, v162, v163
    v_mfma_f32_16x16x32_bf16 a[108:111], a[236:239], v[212:215], a[108:111]
    s_add_u32 m0, s52, 16384
    v_exp_f32 v169, v169
    v_mfma_f32_16x16x32_bf16 a[80:83], a[240:243], v[208:211], a[80:83]
    s_add_u32 s46, s50, 65536
    v_exp_f32 v170, v170
    v_mfma_f32_16x16x32_bf16 a[112:115], a[240:243], v[212:215], a[112:115]
    buffer_load_dwordx4 v27, s[20:23], s46 offen  lds
    v_mfma_f32_16x16x32_bf16 a[84:87], a[244:247], v[208:211], a[84:87]
    v_add_f32 v13, v13, v168
    v_add_f32 v13, v13, v169
    v_mfma_f32_16x16x32_bf16 a[116:119], a[244:247], v[212:215], a[116:119]
    v_exp_f32 v171, v171
    v_mfma_f32_16x16x32_bf16 a[88:91], a[248:251], v[208:211], a[88:91]
    s_add_u32 m0, s52, 17408
    v_exp_f32 v164, v164
    v_mfma_f32_16x16x32_bf16 a[120:123], a[248:251], v[212:215], a[120:123]
    s_add_u32 s46, s50, 73728
    v_add_f32 v13, v13, v170
    v_cvt_pk_bf16_f32 v220, v168, v169
    v_mfma_f32_16x16x32_bf16 a[92:95], a[252:255], v[208:211], a[92:95]
    buffer_load_dwordx4 v27, s[20:23], s46 offen  lds
    v_add_f32 v13, v13, v171
    v_cvt_pk_bf16_f32 v221, v170, v171
    v_mfma_f32_16x16x32_bf16 a[124:127], a[252:255], v[212:215], a[124:127]
    v_exp_f32 v165, v165
    s_waitcnt lgkmcnt(0)
    v_mfma_f32_16x16x32_bf16 v[128:131], a[192:195], v[32:35], v[176:179]
    s_add_u32 m0, s52, 18432
    v_exp_f32 v166, v166
    v_mfma_f32_16x16x32_bf16 v[136:139], a[192:195], v[48:51], v[180:183]
    s_add_u32 s46, s50, 81920
    v_add_f32 v12, v12, v164
    v_add_f32 v12, v12, v165
    v_mfma_f32_16x16x32_bf16 v[128:131], a[196:199], v[36:39], v[128:131]
    buffer_load_dwordx4 v27, s[20:23], s46 offen  lds
    v_mfma_f32_16x16x32_bf16 v[136:139], a[196:199], v[52:55], v[136:139]
    v_exp_f32 v167, v167
    v_mfma_f32_16x16x32_bf16 v[128:131], a[200:203], v[40:43], v[128:131]
    v_exp_f32 v172, v172
    v_mfma_f32_16x16x32_bf16 v[136:139], a[200:203], v[56:59], v[136:139]
    s_add_u32 m0, s52, 19456
    v_add_f32 v12, v12, v166
    v_cvt_pk_bf16_f32 v218, v164, v165
    v_mfma_f32_16x16x32_bf16 v[128:131], a[204:207], v[44:47], v[128:131]
    s_add_u32 s46, s50, 90112
    v_add_f32 v12, v12, v167
    v_cvt_pk_bf16_f32 v219, v166, v167
    v_mfma_f32_16x16x32_bf16 v[136:139], a[204:207], v[60:63], v[136:139]
    buffer_load_dwordx4 v27, s[20:23], s46 offen  lds
    s_add_u32 m0, s52, 32768
    s_add_u32 s46, s51, 0
    buffer_load_dwordx4 v27, s[20:23], s46 offen  lds
    v_mfma_f32_16x16x32_bf16 v[132:135], a[208:211], v[32:35], v[176:179]
    v_exp_f32 v173, v173
    v_mfma_f32_16x16x32_bf16 v[140:143], a[208:211], v[48:51], v[180:183]
    v_exp_f32 v174, v174
    v_mfma_f32_16x16x32_bf16 v[132:135], a[212:215], v[36:39], v[132:135]
    v_add_f32 v13, v13, v172
    v_add_f32 v13, v13, v173
    v_mfma_f32_16x16x32_bf16 v[140:143], a[212:215], v[52:55], v[140:143]
    v_exp_f32 v175, v175
    v_mfma_f32_16x16x32_bf16 v[132:135], a[216:219], v[40:43], v[132:135]
    s_nop 0
    v_add_f32 v13, v13, v174
    v_cvt_pk_bf16_f32 v222, v172, v173
    v_mfma_f32_16x16x32_bf16 v[140:143], a[216:219], v[56:59], v[140:143]
    v_add_f32 v13, v13, v175
    v_cvt_pk_bf16_f32 v223, v174, v175
    v_mfma_f32_16x16x32_bf16 v[132:135], a[220:223], v[44:47], v[132:135]
    s_add_u32 m0, s52, 33792
    v_exp_f32 v128, v128
    v_mfma_f32_16x16x32_bf16 v[140:143], a[220:223], v[60:63], v[140:143]
    s_add_u32 s46, s51, 8192
    v_exp_f32 v129, v129
    v_mfma_f32_16x16x32_bf16 a[128:131], a[224:227], v[216:219], a[128:131]
    buffer_load_dwordx4 v27, s[20:23], s46 offen  lds
    v_mfma_f32_16x16x32_bf16 a[160:163], a[224:227], v[220:223], a[160:163]
    v_exp_f32 v130, v130
    v_mfma_f32_16x16x32_bf16 a[132:135], a[228:231], v[216:219], a[132:135]
    s_add_u32 m0, s52, 34816
    v_add_f32 v8, v8, v128
    v_add_f32 v8, v8, v129
    v_mfma_f32_16x16x32_bf16 a[164:167], a[228:231], v[220:223], a[164:167]
    s_add_u32 s46, s51, 16384
    v_exp_f32 v131, v131
    v_mfma_f32_16x16x32_bf16 a[136:139], a[232:235], v[216:219], a[136:139]
    buffer_load_dwordx4 v27, s[20:23], s46 offen  lds
    v_exp_f32 v136, v136
    v_mfma_f32_16x16x32_bf16 a[168:171], a[232:235], v[220:223], a[168:171]
    v_add_f32 v8, v8, v130
    v_cvt_pk_bf16_f32 v200, v128, v129
    v_mfma_f32_16x16x32_bf16 a[140:143], a[236:239], v[216:219], a[140:143]
    v_add_f32 v8, v8, v131
    v_cvt_pk_bf16_f32 v201, v130, v131
    v_mfma_f32_16x16x32_bf16 a[172:175], a[236:239], v[220:223], a[172:175]
    s_add_u32 m0, s52, 35840
    ds_read_b64_tr_b16 a[224:225], v5 offset:33792
    ds_read_b64_tr_b16 a[226:227], v5 offset:34304
    ds_read_b64_tr_b16 a[228:229], v5 offset:33824
    ds_read_b64_tr_b16 a[230:231], v5 offset:34336
    v_mfma_f32_16x16x32_bf16 a[144:147], a[240:243], v[216:219], a[144:147]
    s_add_u32 s46, s51, 24576
    v_exp_f32 v137, v137
    v_mfma_f32_16x16x32_bf16 a[176:179], a[240:243], v[220:223], a[176:179]
    buffer_load_dwordx4 v27, s[20:23], s46 offen  lds
    v_exp_f32 v138, v138
    v_mfma_f32_16x16x32_bf16 a[148:151], a[244:247], v[216:219], a[148:151]
    v_add_f32 v9, v9, v136
    v_add_f32 v9, v9, v137
    v_mfma_f32_16x16x32_bf16 a[180:183], a[244:247], v[220:223], a[180:183]
    s_add_u32 m0, s52, 49152
    v_exp_f32 v139, v139
    v_mfma_f32_16x16x32_bf16 a[152:155], a[248:251], v[216:219], a[152:155]
    s_add_u32 s46, s51, 65536
    v_exp_f32 v132, v132
    v_mfma_f32_16x16x32_bf16 a[184:187], a[248:251], v[220:223], a[184:187]
    buffer_load_dwordx4 v27, s[20:23], s46 offen  lds
    v_add_f32 v9, v9, v138
    v_cvt_pk_bf16_f32 v204, v136, v137
    s_add_u32 m0, s52, 50176
    s_add_u32 s46, s51, 73728
    buffer_load_dwordx4 v27, s[20:23], s46 offen  lds
    v_mfma_f32_16x16x32_bf16 a[156:159], a[252:255], v[216:219], a[156:159]
    ds_read_b64_tr_b16 a[232:233], v5 offset:33856
    ds_read_b64_tr_b16 a[234:235], v5 offset:34368
    v_add_f32 v9, v9, v139
    v_cvt_pk_bf16_f32 v205, v138, v139
    ds_read_b64_tr_b16 a[236:237], v5 offset:33888
    ds_read_b64_tr_b16 a[238:239], v5 offset:34400
    s_add_u32 m0, s52, 51200
    s_add_u32 s46, s51, 81920
    buffer_load_dwordx4 v27, s[20:23], s46 offen  lds
    s_add_u32 m0, s52, 52224
    s_add_u32 s46, s51, 90112
    buffer_load_dwordx4 v27, s[20:23], s46 offen  lds
    v_mfma_f32_16x16x32_bf16 a[188:191], a[252:255], v[220:223], a[188:191]
    v_exp_f32 v133, v133
    v_exp_f32 v134, v134
    v_add_f32 v8, v8, v132
    v_add_f32 v8, v8, v133
    v_exp_f32 v135, v135
    v_exp_f32 v140, v140
    v_mfma_f32_16x16x32_bf16 v[144:147], a[192:195], v[64:67], v[184:187]
    ds_read_b64_tr_b16 a[240:241], v5 offset:33920
    ds_read_b64_tr_b16 a[242:243], v5 offset:34432
    v_mfma_f32_16x16x32_bf16 v[152:155], a[192:195], v[80:83], v[188:191]
    v_add_f32 v8, v8, v134
    v_cvt_pk_bf16_f32 v202, v132, v133
    v_mfma_f32_16x16x32_bf16 v[144:147], a[196:199], v[68:71], v[144:147]
    v_add_f32 v8, v8, v135
    v_cvt_pk_bf16_f32 v203, v134, v135
    v_mfma_f32_16x16x32_bf16 v[152:155], a[196:199], v[84:87], v[152:155]
    ds_read_b64_tr_b16 a[244:245], v5 offset:33952
    ds_read_b64_tr_b16 a[246:247], v5 offset:34464
    v_mfma_f32_16x16x32_bf16 v[144:147], a[200:203], v[72:75], v[144:147]
    v_exp_f32 v141, v141
    v_mfma_f32_16x16x32_bf16 v[152:155], a[200:203], v[88:91], v[152:155]
    v_exp_f32 v142, v142
    v_mfma_f32_16x16x32_bf16 v[144:147], a[204:207], v[76:79], v[144:147]
    ds_read_b64_tr_b16 a[248:249], v5 offset:33984
    ds_read_b64_tr_b16 a[250:251], v5 offset:34496
    v_mfma_f32_16x16x32_bf16 v[152:155], a[204:207], v[92:95], v[152:155]
    v_add_f32 v9, v9, v140
    v_add_f32 v9, v9, v141
    v_mfma_f32_16x16x32_bf16 v[148:151], a[208:211], v[64:67], v[184:187]
    v_exp_f32 v143, v143
    v_mfma_f32_16x16x32_bf16 v[156:159], a[208:211], v[80:83], v[188:191]
    s_nop 0
    ds_read_b64_tr_b16 a[252:253], v5 offset:34016
    ds_read_b64_tr_b16 a[254:255], v5 offset:34528
    v_mfma_f32_16x16x32_bf16 v[148:151], a[212:215], v[68:71], v[148:151]
    v_add_f32 v9, v9, v142
    v_cvt_pk_bf16_f32 v206, v140, v141
    v_mfma_f32_16x16x32_bf16 v[156:159], a[212:215], v[84:87], v[156:159]
    v_add_f32 v9, v9, v143
    v_cvt_pk_bf16_f32 v207, v142, v143
    v_mfma_f32_16x16x32_bf16 v[148:151], a[216:219], v[72:75], v[148:151]
    v_exp_f32 v144, v144
    v_mfma_f32_16x16x32_bf16 v[156:159], a[216:219], v[88:91], v[156:159]
    v_exp_f32 v145, v145
    v_mfma_f32_16x16x32_bf16 v[148:151], a[220:223], v[76:79], v[148:151]
    v_exp_f32 v146, v146
    v_mfma_f32_16x16x32_bf16 v[156:159], a[220:223], v[92:95], v[156:159]
    v_add_f32 v10, v10, v144
    v_add_f32 v10, v10, v145
    s_waitcnt lgkmcnt(0)
    v_mfma_f32_16x16x32_bf16 a[0:3], a[224:227], v[200:203], a[0:3]
    v_exp_f32 v147, v147
    v_mfma_f32_16x16x32_bf16 a[32:35], a[224:227], v[204:207], a[32:35]
    v_exp_f32 v152, v152
    v_mfma_f32_16x16x32_bf16 a[4:7], a[228:231], v[200:203], a[4:7]
    v_add_f32 v10, v10, v146
    v_cvt_pk_bf16_f32 v208, v144, v145
    v_mfma_f32_16x16x32_bf16 a[36:39], a[228:231], v[204:207], a[36:39]
    v_add_f32 v10, v10, v147
    v_cvt_pk_bf16_f32 v209, v146, v147
    v_mfma_f32_16x16x32_bf16 a[8:11], a[232:235], v[200:203], a[8:11]
    v_exp_f32 v153, v153
    v_mfma_f32_16x16x32_bf16 a[40:43], a[232:235], v[204:207], a[40:43]
    v_exp_f32 v154, v154
    v_mfma_f32_16x16x32_bf16 a[12:15], a[236:239], v[200:203], a[12:15]
    v_add_f32 v11, v11, v152
    v_add_f32 v11, v11, v153
    v_mfma_f32_16x16x32_bf16 a[44:47], a[236:239], v[204:207], a[44:47]
    v_exp_f32 v155, v155
    v_mfma_f32_16x16x32_bf16 a[16:19], a[240:243], v[200:203], a[16:19]
    v_exp_f32 v148, v148
    v_mfma_f32_16x16x32_bf16 a[48:51], a[240:243], v[204:207], a[48:51]
    v_add_f32 v11, v11, v154
    v_cvt_pk_bf16_f32 v212, v152, v153
    v_mfma_f32_16x16x32_bf16 a[20:23], a[244:247], v[200:203], a[20:23]
    v_add_f32 v11, v11, v155
    v_cvt_pk_bf16_f32 v213, v154, v155
    v_mfma_f32_16x16x32_bf16 a[52:55], a[244:247], v[204:207], a[52:55]
    v_exp_f32 v149, v149
    v_mfma_f32_16x16x32_bf16 a[24:27], a[248:251], v[200:203], a[24:27]
    v_exp_f32 v150, v150
    v_mfma_f32_16x16x32_bf16 a[56:59], a[248:251], v[204:207], a[56:59]
    v_add_f32 v10, v10, v148
    v_add_f32 v10, v10, v149
    v_mfma_f32_16x16x32_bf16 a[28:31], a[252:255], v[200:203], a[28:31]
    v_exp_f32 v151, v151
    v_mfma_f32_16x16x32_bf16 a[60:63], a[252:255], v[204:207], a[60:63]
    v_exp_f32 v156, v156
    s_barrier
    v_mfma_f32_16x16x32_bf16 v[160:163], a[192:195], v[96:99], v[192:195]
    v_add_f32 v10, v10, v150
    v_cvt_pk_bf16_f32 v210, v148, v149
    v_mfma_f32_16x16x32_bf16 v[168:171], a[192:195], v[112:115], v[196:199]
    v_add_f32 v10, v10, v151
    v_cvt_pk_bf16_f32 v211, v150, v151
    v_mfma_f32_16x16x32_bf16 v[160:163], a[196:199], v[100:103], v[160:163]
    v_exp_f32 v157, v157
    v_mfma_f32_16x16x32_bf16 v[168:171], a[196:199], v[116:119], v[168:171]
    v_exp_f32 v158, v158
    v_mfma_f32_16x16x32_bf16 v[160:163], a[200:203], v[104:107], v[160:163]
    v_add_f32 v11, v11, v156
    v_add_f32 v11, v11, v157
    v_mfma_f32_16x16x32_bf16 v[168:171], a[200:203], v[120:123], v[168:171]
    v_exp_f32 v159, v159
    v_mfma_f32_16x16x32_bf16 v[160:163], a[204:207], v[108:111], v[160:163]
    s_nop 0
    v_add_f32 v11, v11, v158
    v_cvt_pk_bf16_f32 v214, v156, v157
    v_mfma_f32_16x16x32_bf16 v[168:171], a[204:207], v[124:127], v[168:171]
    v_add_f32 v11, v11, v159
    v_cvt_pk_bf16_f32 v215, v158, v159
    v_mfma_f32_16x16x32_bf16 v[164:167], a[208:211], v[96:99], v[192:195]
    v_mfma_f32_16x16x32_bf16 v[172:175], a[208:211], v[112:115], v[196:199]
    v_mfma_f32_16x16x32_bf16 v[164:167], a[212:215], v[100:103], v[164:167]
    v_exp_f32 v160, v160
    v_mfma_f32_16x16x32_bf16 v[172:175], a[212:215], v[116:119], v[172:175]
    v_exp_f32 v161, v161
    v_mfma_f32_16x16x32_bf16 v[164:167], a[216:219], v[104:107], v[164:167]
    v_exp_f32 v162, v162
    v_mfma_f32_16x16x32_bf16 v[172:175], a[216:219], v[120:123], v[172:175]
    v_add_f32 v12, v12, v160
    v_add_f32 v12, v12, v161
    v_mfma_f32_16x16x32_bf16 v[164:167], a[220:223], v[108:111], v[164:167]
    v_exp_f32 v163, v163
    v_mfma_f32_16x16x32_bf16 v[172:175], a[220:223], v[124:127], v[172:175]
    v_exp_f32 v168, v168
    v_mfma_f32_16x16x32_bf16 a[64:67], a[224:227], v[208:211], a[64:67]
    v_add_f32 v12, v12, v162
    v_cvt_pk_bf16_f32 v216, v160, v161
    v_mfma_f32_16x16x32_bf16 a[96:99], a[224:227], v[212:215], a[96:99]
    v_add_f32 v12, v12, v163
    v_cvt_pk_bf16_f32 v217, v162, v163
    v_mfma_f32_16x16x32_bf16 a[68:71], a[228:231], v[208:211], a[68:71]
    v_exp_f32 v169, v169
    v_mfma_f32_16x16x32_bf16 a[100:103], a[228:231], v[212:215], a[100:103]
    v_exp_f32 v170, v170
    v_mfma_f32_16x16x32_bf16 a[72:75], a[232:235], v[208:211], a[72:75]
    v_add_f32 v13, v13, v168
    v_add_f32 v13, v13, v169
    v_mfma_f32_16x16x32_bf16 a[104:107], a[232:235], v[212:215], a[104:107]
    v_exp_f32 v171, v171
    v_mfma_f32_16x16x32_bf16 a[76:79], a[236:239], v[208:211], a[76:79]
    v_exp_f32 v164, v164
    v_mfma_f32_16x16x32_bf16 a[108:111], a[236:239], v[212:215], a[108:111]
    v_add_f32 v13, v13, v170
    v_cvt_pk_bf16_f32 v220, v168, v169
    v_mfma_f32_16x16x32_bf16 a[80:83], a[240:243], v[208:211], a[80:83]
    v_add_f32 v13, v13, v171
    v_cvt_pk_bf16_f32 v221, v170, v171
    v_mfma_f32_16x16x32_bf16 a[112:115], a[240:243], v[212:215], a[112:115]
    v_exp_f32 v165, v165
    v_mfma_f32_16x16x32_bf16 a[84:87], a[244:247], v[208:211], a[84:87]
    v_exp_f32 v166, v166
    v_mfma_f32_16x16x32_bf16 a[116:119], a[244:247], v[212:215], a[116:119]
    v_add_f32 v12, v12, v164
    v_add_f32 v12, v12, v165
    v_mfma_f32_16x16x32_bf16 a[88:91], a[248:251], v[208:211], a[88:91]
    v_exp_f32 v167, v167
    v_mfma_f32_16x16x32_bf16 a[120:123], a[248:251], v[212:215], a[120:123]
    v_exp_f32 v172, v172
    v_mfma_f32_16x16x32_bf16 a[92:95], a[252:255], v[208:211], a[92:95]
    v_add_f32 v12, v12, v166
    v_cvt_pk_bf16_f32 v218, v164, v165
    v_mfma_f32_16x16x32_bf16 a[124:127], a[252:255], v[212:215], a[124:127]
    v_add_f32 v12, v12, v167
    v_cvt_pk_bf16_f32 v219, v166, v167
    v_exp_f32 v173, v173
    v_exp_f32 v174, v174
    v_add_f32 v13, v13, v172
    v_add_f32 v13, v13, v173
    v_exp_f32 v175, v175
    s_nop 0
    v_add_f32 v13, v13, v174
    v_cvt_pk_bf16_f32 v222, v172, v173
    v_add_f32 v13, v13, v175
    v_cvt_pk_bf16_f32 v223, v174, v175
    s_nop 1
    v_mfma_f32_16x16x32_bf16 a[128:131], a[224:227], v[216:219], a[128:131]
    v_mfma_f32_16x16x32_bf16 a[160:163], a[224:227], v[220:223], a[160:163]
    v_mfma_f32_16x16x32_bf16 a[132:135], a[228:231], v[216:219], a[132:135]
    v_mfma_f32_16x16x32_bf16 a[164:167], a[228:231], v[220:223], a[164:167]
    v_mfma_f32_16x16x32_bf16 a[136:139], a[232:235], v[216:219], a[136:139]
    v_mfma_f32_16x16x32_bf16 a[168:171], a[232:235], v[220:223], a[168:171]
    v_mfma_f32_16x16x32_bf16 a[140:143], a[236:239], v[216:219], a[140:143]
    v_mfma_f32_16x16x32_bf16 a[172:175], a[236:239], v[220:223], a[172:175]
    v_mfma_f32_16x16x32_bf16 a[144:147], a[240:243], v[216:219], a[144:147]
    v_mfma_f32_16x16x32_bf16 a[176:179], a[240:243], v[220:223], a[176:179]
    v_mfma_f32_16x16x32_bf16 a[148:151], a[244:247], v[216:219], a[148:151]
    v_mfma_f32_16x16x32_bf16 a[180:183], a[244:247], v[220:223], a[180:183]
    v_mfma_f32_16x16x32_bf16 a[152:155], a[248:251], v[216:219], a[152:155]
    v_mfma_f32_16x16x32_bf16 a[184:187], a[248:251], v[220:223], a[184:187]
    v_mfma_f32_16x16x32_bf16 a[156:159], a[252:255], v[216:219], a[156:159]
    v_mfma_f32_16x16x32_bf16 a[188:191], a[252:255], v[220:223], a[188:191]
    v_mov_b32 v16, v8
    s_nop 1
    v_permlane16_swap_b32 v8, v16
    s_nop 1
    v_add_f32 v8, v8, v16
    v_mov_b32 v16, v8
    s_nop 1
    v_permlane32_swap_b32 v8, v16
    s_nop 1
    v_add_f32 v8, v8, v16
    v_mov_b32 v16, v9
    s_nop 1
    v_permlane16_swap_b32 v9, v16
    s_nop 1
    v_add_f32 v9, v9, v16
    v_mov_b32 v16, v9
    s_nop 1
    v_permlane32_swap_b32 v9, v16
    s_nop 1
    v_add_f32 v9, v9, v16
    v_mov_b32 v16, v10
    s_nop 1
    v_permlane16_swap_b32 v10, v16
    s_nop 1
    v_add_f32 v10, v10, v16
    v_mov_b32 v16, v10
    s_nop 1
    v_permlane32_swap_b32 v10, v16
    s_nop 1
    v_add_f32 v10, v10, v16
    v_mov_b32 v16, v11
    s_nop 1
    v_permlane16_swap_b32 v11, v16
    s_nop 1
    v_add_f32 v11, v11, v16
    v_mov_b32 v16, v11
    s_nop 1
    v_permlane32_swap_b32 v11, v16
    s_nop 1
    v_add_f32 v11, v11, v16
    v_mov_b32 v16, v12
    s_nop 1
    v_permlane16_swap_b32 v12, v16
    s_nop 1
    v_add_f32 v12, v12, v16
    v_mov_b32 v16, v12
    s_nop 1
    v_permlane32_swap_b32 v12, v16
    s_nop 1
    v_add_f32 v12, v12, v16
    v_mov_b32 v16, v13
    s_nop 1
    v_permlane16_swap_b32 v13, v16
    s_nop 1
    v_add_f32 v13, v13, v16
    v_mov_b32 v16, v13
    s_nop 1
    v_permlane32_swap_b32 v13, v16
    s_nop 1
    v_add_f32 v13, v13, v16
    v_max3_f32 v17, v8, v9, v10
    v_max3_f32 v18, v11, v12, v13
    v_add_f32 v19, v8, v9
    v_add_f32 v19, v19, v10
    v_add_f32 v19, v19, v11
    v_add_f32 v19, v19, v12
    v_add_f32 v19, v19, v13
    s_mov_b32 s46, 0x4b800000
    v_cmp_ngt_f32 vcc, s46, v19
    s_nop 1
    s_cmp_lg_u64 vcc, 0
    s_cselect_b32 s46, 1, 0
    v_mov_b32 v17, s46
    s_lshl_b32 s47, s32, 2
    s_add_u32 s47, s47, 163824
    v_mov_b32 v18, s47
    v_mov_b32 v19, 163824
    ds_write_b32 v18, v17
    s_waitcnt lgkmcnt(0)
    s_barrier
    ds_read_b128 v[128:131], v19
    s_waitcnt lgkmcnt(0)
    v_or_b32 v128, v128, v129
    v_or3_b32 v128, v128, v130, v131
    s_nop 0
    v_readfirstlane_b32 s46, v128
    s_nop 3
    s_cmp_lg_u32 s46, 0
    s_cbranch_scc1 L_fallback
L_join:
    v_rcp_f32 v8, v8
    v_rcp_f32 v9, v9
    v_rcp_f32 v10, v10
    v_rcp_f32 v11, v11
    v_rcp_f32 v12, v12
    v_rcp_f32 v13, v13
    s_mul_i32 s46, s32, 24576
    s_add_u32 s46, s46, 65536
    v_add_u32 v2, s46, v7
    s_xor_b32 s47, s32, 2
    s_mul_i32 s46, s47, 24576
    s_add_u32 s46, s46, 65536
    v_add_u32 v3, s46, v7
    v_lshrrev_b32 v20, 4, v1
    v_bfe_u32 v17, v1, 2, 2
    v_and_b32 v16, 3, v1
    v_lshl_add_u32 v18, v20, 2, v17
    v_bfe_u32 v19, v18, 1, 2
    v_lshlrev_b32 v18, 7, v18
    v_lshl_add_u32 v18, v16, 3, v18
    s_lshl_b32 s46, s33, 13
    v_add_u32 v18, s46, v18
    v_xor_b32 v21, 0, v19
    v_lshl_add_u32 v224, v21, 5, v18
    v_add_u32 v228, 65536, v224
    v_add_u32 v232, 131072, v224
    v_xor_b32 v21, 1, v19
    v_lshl_add_u32 v225, v21, 5, v18
    v_add_u32 v229, 65536, v225
    v_add_u32 v233, 131072, v225
    v_xor_b32 v21, 2, v19
    v_lshl_add_u32 v226, v21, 5, v18
    v_add_u32 v230, 65536, v226
    v_add_u32 v234, 131072, v226
    v_xor_b32 v21, 3, v19
    v_lshl_add_u32 v227, v21, 5, v18
    v_add_u32 v231, 65536, v227
    v_add_u32 v235, 131072, v227
    s_barrier
    v_mov_b32 v16, v8
    v_mov_b32 v17, v8
    v_accvgpr_read_b32 v128, a0
    v_accvgpr_read_b32 v129, a1
    v_accvgpr_read_b32 v130, a2
    v_accvgpr_read_b32 v131, a3
    v_accvgpr_read_b32 v132, a4
    v_accvgpr_read_b32 v133, a5
    v_accvgpr_read_b32 v134, a6
    v_accvgpr_read_b32 v135, a7
    v_pk_mul_f32 v[128:129], v[128:129], v[16:17]
    v_pk_mul_f32 v[130:131], v[130:131], v[16:17]
    v_pk_mul_f32 v[132:133], v[132:133], v[16:17]
    v_pk_mul_f32 v[134:135], v[134:135], v[16:17]
    v_cvt_pk_bf16_f32 v32, v128, v129
    v_cvt_pk_bf16_f32 v33, v130, v131
    v_cvt_pk_bf16_f32 v34, v132, v133
    v_cvt_pk_bf16_f32 v35, v134, v135
    ds_write_b128 v2, v[32:35] offset:0
    v_accvgpr_read_b32 v136, a8
    v_accvgpr_read_b32 v137, a9
    v_accvgpr_read_b32 v138, a10
    v_accvgpr_read_b32 v139, a11
    v_accvgpr_read_b32 v140, a12
    v_accvgpr_read_b32 v141, a13
    v_accvgpr_read_b32 v142, a14
    v_accvgpr_read_b32 v143, a15
    v_pk_mul_f32 v[136:137], v[136:137], v[16:17]
    v_pk_mul_f32 v[138:139], v[138:139], v[16:17]
    v_pk_mul_f32 v[140:141], v[140:141], v[16:17]
    v_pk_mul_f32 v[142:143], v[142:143], v[16:17]
    v_cvt_pk_bf16_f32 v36, v136, v137
    v_cvt_pk_bf16_f32 v37, v138, v139
    v_cvt_pk_bf16_f32 v38, v140, v141
    v_cvt_pk_bf16_f32 v39, v142, v143
    ds_write_b128 v2, v[36:39] offset:1024
    v_accvgpr_read_b32 v144, a16
    v_accvgpr_read_b32 v145, a17
    v_accvgpr_read_b32 v146, a18
    v_accvgpr_read_b32 v147, a19
    v_accvgpr_read_b32 v148, a20
    v_accvgpr_read_b32 v149, a21
    v_accvgpr_read_b32 v150, a22
    v_accvgpr_read_b32 v151, a23
    v_pk_mul_f32 v[144:145], v[144:145], v[16:17]
    v_pk_mul_f32 v[146:147], v[146:147], v[16:17]
    v_pk_mul_f32 v[148:149], v[148:149], v[16:17]
    v_pk_mul_f32 v[150:151], v[150:151], v[16:17]
    v_cvt_pk_bf16_f32 v40, v144, v145
    v_cvt_pk_bf16_f32 v41, v146, v147
    v_cvt_pk_bf16_f32 v42, v148, v149
    v_cvt_pk_bf16_f32 v43, v150, v151
    ds_write_b128 v2, v[40:43] offset:2048
    v_accvgpr_read_b32 v152, a24
    v_accvgpr_read_b32 v153, a25
    v_accvgpr_read_b32 v154, a26
    v_accvgpr_read_b32 v155, a27
    v_accvgpr_read_b32 v156, a28
    v_accvgpr_read_b32 v157, a29
    v_accvgpr_read_b32 v158, a30
    v_accvgpr_read_b32 v159, a31
    v_pk_mul_f32 v[152:153], v[152:153], v[16:17]
    v_pk_mul_f32 v[154:155], v[154:155], v[16:17]
    v_pk_mul_f32 v[156:157], v[156:157], v[16:17]
    v_pk_mul_f32 v[158:159], v[158:159], v[16:17]
    v_cvt_pk_bf16_f32 v44, v152, v153
    v_cvt_pk_bf16_f32 v45, v154, v155
    v_cvt_pk_bf16_f32 v46, v156, v157
    v_cvt_pk_bf16_f32 v47, v158, v159
    ds_write_b128 v2, v[44:47] offset:3072
    v_mov_b32 v16, v9
    v_mov_b32 v17, v9
    v_accvgpr_read_b32 v160, a32
    v_accvgpr_read_b32 v161, a33
    v_accvgpr_read_b32 v162, a34
    v_accvgpr_read_b32 v163, a35
    v_accvgpr_read_b32 v164, a36
    v_accvgpr_read_b32 v165, a37
    v_accvgpr_read_b32 v166, a38
    v_accvgpr_read_b32 v167, a39
    v_pk_mul_f32 v[160:161], v[160:161], v[16:17]
    v_pk_mul_f32 v[162:163], v[162:163], v[16:17]
    v_pk_mul_f32 v[164:165], v[164:165], v[16:17]
    v_pk_mul_f32 v[166:167], v[166:167], v[16:17]
    v_cvt_pk_bf16_f32 v48, v160, v161
    v_cvt_pk_bf16_f32 v49, v162, v163
    v_cvt_pk_bf16_f32 v50, v164, v165
    v_cvt_pk_bf16_f32 v51, v166, v167
    ds_write_b128 v2, v[48:51] offset:4096
    v_accvgpr_read_b32 v168, a40
    v_accvgpr_read_b32 v169, a41
    v_accvgpr_read_b32 v170, a42
    v_accvgpr_read_b32 v171, a43
    v_accvgpr_read_b32 v172, a44
    v_accvgpr_read_b32 v173, a45
    v_accvgpr_read_b32 v174, a46
    v_accvgpr_read_b32 v175, a47
    v_pk_mul_f32 v[168:169], v[168:169], v[16:17]
    v_pk_mul_f32 v[170:171], v[170:171], v[16:17]
    v_pk_mul_f32 v[172:173], v[172:173], v[16:17]
    v_pk_mul_f32 v[174:175], v[174:175], v[16:17]
    v_cvt_pk_bf16_f32 v52, v168, v169
    v_cvt_pk_bf16_f32 v53, v170, v171
    v_cvt_pk_bf16_f32 v54, v172, v173
    v_cvt_pk_bf16_f32 v55, v174, v175
    ds_write_b128 v2, v[52:55] offset:5120
    v_accvgpr_read_b32 v128, a48
    v_accvgpr_read_b32 v129, a49
    v_accvgpr_read_b32 v130, a50
    v_accvgpr_read_b32 v131, a51
    v_accvgpr_read_b32 v132, a52
    v_accvgpr_read_b32 v133, a53
    v_accvgpr_read_b32 v134, a54
    v_accvgpr_read_b32 v135, a55
    v_pk_mul_f32 v[128:129], v[128:129], v[16:17]
    v_pk_mul_f32 v[130:131], v[130:131], v[16:17]
    v_pk_mul_f32 v[132:133], v[132:133], v[16:17]
    v_pk_mul_f32 v[134:135], v[134:135], v[16:17]
    v_cvt_pk_bf16_f32 v56, v128, v129
    v_cvt_pk_bf16_f32 v57, v130, v131
    v_cvt_pk_bf16_f32 v58, v132, v133
    v_cvt_pk_bf16_f32 v59, v134, v135
    ds_write_b128 v2, v[56:59] offset:6144
    v_accvgpr_read_b32 v136, a56
    v_accvgpr_read_b32 v137, a57
    v_accvgpr_read_b32 v138, a58
    v_accvgpr_read_b32 v139, a59
    v_accvgpr_read_b32 v140, a60
    v_accvgpr_read_b32 v141, a61
    v_accvgpr_read_b32 v142, a62
    v_accvgpr_read_b32 v143, a63
    v_pk_mul_f32 v[136:137], v[136:137], v[16:17]
    v_pk_mul_f32 v[138:139], v[138:139], v[16:17]
    v_pk_mul_f32 v[140:141], v[140:141], v[16:17]
    v_pk_mul_f32 v[142:143], v[142:143], v[16:17]
    v_cvt_pk_bf16_f32 v60, v136, v137
    v_cvt_pk_bf16_f32 v61, v138, v139
    v_cvt_pk_bf16_f32 v62, v140, v141
    v_cvt_pk_bf16_f32 v63, v142, v143
    ds_write_b128 v2, v[60:63] offset:7168
    v_mov_b32 v16, v10
    v_mov_b32 v17, v10
    v_accvgpr_read_b32 v144, a64
    v_accvgpr_read_b32 v145, a65
    v_accvgpr_read_b32 v146, a66
    v_accvgpr_read_b32 v147, a67
    v_accvgpr_read_b32 v148, a68
    v_accvgpr_read_b32 v149, a69
    v_accvgpr_read_b32 v150, a70
    v_accvgpr_read_b32 v151, a71
    v_pk_mul_f32 v[144:145], v[144:145], v[16:17]
    v_pk_mul_f32 v[146:147], v[146:147], v[16:17]
    v_pk_mul_f32 v[148:149], v[148:149], v[16:17]
    v_pk_mul_f32 v[150:151], v[150:151], v[16:17]
    v_cvt_pk_bf16_f32 v64, v144, v145
    v_cvt_pk_bf16_f32 v65, v146, v147
    v_cvt_pk_bf16_f32 v66, v148, v149
    v_cvt_pk_bf16_f32 v67, v150, v151
    ds_write_b128 v2, v[64:67] offset:8192
    v_accvgpr_read_b32 v152, a72
    v_accvgpr_read_b32 v153, a73
    v_accvgpr_read_b32 v154, a74
    v_accvgpr_read_b32 v155, a75
    v_accvgpr_read_b32 v156, a76
    v_accvgpr_read_b32 v157, a77
    v_accvgpr_read_b32 v158, a78
    v_accvgpr_read_b32 v159, a79
    v_pk_mul_f32 v[152:153], v[152:153], v[16:17]
    v_pk_mul_f32 v[154:155], v[154:155], v[16:17]
    v_pk_mul_f32 v[156:157], v[156:157], v[16:17]
    v_pk_mul_f32 v[158:159], v[158:159], v[16:17]
    v_cvt_pk_bf16_f32 v68, v152, v153
    v_cvt_pk_bf16_f32 v69, v154, v155
    v_cvt_pk_bf16_f32 v70, v156, v157
    v_cvt_pk_bf16_f32 v71, v158, v159
    ds_write_b128 v2, v[68:71] offset:9216
    v_accvgpr_read_b32 v160, a80
    v_accvgpr_read_b32 v161, a81
    v_accvgpr_read_b32 v162, a82
    v_accvgpr_read_b32 v163, a83
    v_accvgpr_read_b32 v164, a84
    v_accvgpr_read_b32 v165, a85
    v_accvgpr_read_b32 v166, a86
    v_accvgpr_read_b32 v167, a87
    v_pk_mul_f32 v[160:161], v[160:161], v[16:17]
    v_pk_mul_f32 v[162:163], v[162:163], v[16:17]
    v_pk_mul_f32 v[164:165], v[164:165], v[16:17]
    v_pk_mul_f32 v[166:167], v[166:167], v[16:17]
    v_cvt_pk_bf16_f32 v72, v160, v161
    v_cvt_pk_bf16_f32 v73, v162, v163
    v_cvt_pk_bf16_f32 v74, v164, v165
    v_cvt_pk_bf16_f32 v75, v166, v167
    ds_write_b128 v2, v[72:75] offset:10240
    v_accvgpr_read_b32 v168, a88
    v_accvgpr_read_b32 v169, a89
    v_accvgpr_read_b32 v170, a90
    v_accvgpr_read_b32 v171, a91
    v_accvgpr_read_b32 v172, a92
    v_accvgpr_read_b32 v173, a93
    v_accvgpr_read_b32 v174, a94
    v_accvgpr_read_b32 v175, a95
    v_pk_mul_f32 v[168:169], v[168:169], v[16:17]
    v_pk_mul_f32 v[170:171], v[170:171], v[16:17]
    v_pk_mul_f32 v[172:173], v[172:173], v[16:17]
    v_pk_mul_f32 v[174:175], v[174:175], v[16:17]
    v_cvt_pk_bf16_f32 v76, v168, v169
    v_cvt_pk_bf16_f32 v77, v170, v171
    v_cvt_pk_bf16_f32 v78, v172, v173
    v_cvt_pk_bf16_f32 v79, v174, v175
    ds_write_b128 v2, v[76:79] offset:11264
    v_mov_b32 v16, v11
    v_mov_b32 v17, v11
    v_accvgpr_read_b32 v128, a96
    v_accvgpr_read_b32 v129, a97
    v_accvgpr_read_b32 v130, a98
    v_accvgpr_read_b32 v131, a99
    v_accvgpr_read_b32 v132, a100
    v_accvgpr_read_b32 v133, a101
    v_accvgpr_read_b32 v134, a102
    v_accvgpr_read_b32 v135, a103
    v_pk_mul_f32 v[128:129], v[128:129], v[16:17]
    v_pk_mul_f32 v[130:131], v[130:131], v[16:17]
    v_pk_mul_f32 v[132:133], v[132:133], v[16:17]
    v_pk_mul_f32 v[134:135], v[134:135], v[16:17]
    v_cvt_pk_bf16_f32 v80, v128, v129
    v_cvt_pk_bf16_f32 v81, v130, v131
    v_cvt_pk_bf16_f32 v82, v132, v133
    v_cvt_pk_bf16_f32 v83, v134, v135
    ds_write_b128 v2, v[80:83] offset:12288
    v_accvgpr_read_b32 v136, a104
    v_accvgpr_read_b32 v137, a105
    v_accvgpr_read_b32 v138, a106
    v_accvgpr_read_b32 v139, a107
    v_accvgpr_read_b32 v140, a108
    v_accvgpr_read_b32 v141, a109
    v_accvgpr_read_b32 v142, a110
    v_accvgpr_read_b32 v143, a111
    v_pk_mul_f32 v[136:137], v[136:137], v[16:17]
    v_pk_mul_f32 v[138:139], v[138:139], v[16:17]
    v_pk_mul_f32 v[140:141], v[140:141], v[16:17]
    v_pk_mul_f32 v[142:143], v[142:143], v[16:17]
    v_cvt_pk_bf16_f32 v84, v136, v137
    v_cvt_pk_bf16_f32 v85, v138, v139
    v_cvt_pk_bf16_f32 v86, v140, v141
    v_cvt_pk_bf16_f32 v87, v142, v143
    ds_write_b128 v2, v[84:87] offset:13312
    v_accvgpr_read_b32 v144, a112
    v_accvgpr_read_b32 v145, a113
    v_accvgpr_read_b32 v146, a114
    v_accvgpr_read_b32 v147, a115
    v_accvgpr_read_b32 v148, a116
    v_accvgpr_read_b32 v149, a117
    v_accvgpr_read_b32 v150, a118
    v_accvgpr_read_b32 v151, a119
    v_pk_mul_f32 v[144:145], v[144:145], v[16:17]
    v_pk_mul_f32 v[146:147], v[146:147], v[16:17]
    v_pk_mul_f32 v[148:149], v[148:149], v[16:17]
    v_pk_mul_f32 v[150:151], v[150:151], v[16:17]
    v_cvt_pk_bf16_f32 v88, v144, v145
    v_cvt_pk_bf16_f32 v89, v146, v147
    v_cvt_pk_bf16_f32 v90, v148, v149
    v_cvt_pk_bf16_f32 v91, v150, v151
    ds_write_b128 v2, v[88:91] offset:14336
    v_accvgpr_read_b32 v152, a120
    v_accvgpr_read_b32 v153, a121
    v_accvgpr_read_b32 v154, a122
    v_accvgpr_read_b32 v155, a123
    v_accvgpr_read_b32 v156, a124
    v_accvgpr_read_b32 v157, a125
    v_accvgpr_read_b32 v158, a126
    v_accvgpr_read_b32 v159, a127
    v_pk_mul_f32 v[152:153], v[152:153], v[16:17]
    v_pk_mul_f32 v[154:155], v[154:155], v[16:17]
    v_pk_mul_f32 v[156:157], v[156:157], v[16:17]
    v_pk_mul_f32 v[158:159], v[158:159], v[16:17]
    v_cvt_pk_bf16_f32 v92, v152, v153
    v_cvt_pk_bf16_f32 v93, v154, v155
    v_cvt_pk_bf16_f32 v94, v156, v157
    v_cvt_pk_bf16_f32 v95, v158, v159
    ds_write_b128 v2, v[92:95] offset:15360
    v_mov_b32 v16, v12
    v_mov_b32 v17, v12
    v_accvgpr_read_b32 v160, a128
    v_accvgpr_read_b32 v161, a129
    v_accvgpr_read_b32 v162, a130
    v_accvgpr_read_b32 v163, a131
    v_accvgpr_read_b32 v164, a132
    v_accvgpr_read_b32 v165, a133
    v_accvgpr_read_b32 v166, a134
    v_accvgpr_read_b32 v167, a135
    v_pk_mul_f32 v[160:161], v[160:161], v[16:17]
    v_pk_mul_f32 v[162:163], v[162:163], v[16:17]
    v_pk_mul_f32 v[164:165], v[164:165], v[16:17]
    v_pk_mul_f32 v[166:167], v[166:167], v[16:17]
    v_cvt_pk_bf16_f32 v96, v160, v161
    v_cvt_pk_bf16_f32 v97, v162, v163
    v_cvt_pk_bf16_f32 v98, v164, v165
    v_cvt_pk_bf16_f32 v99, v166, v167
    ds_write_b128 v2, v[96:99] offset:16384
    v_accvgpr_read_b32 v168, a136
    v_accvgpr_read_b32 v169, a137
    v_accvgpr_read_b32 v170, a138
    v_accvgpr_read_b32 v171, a139
    v_accvgpr_read_b32 v172, a140
    v_accvgpr_read_b32 v173, a141
    v_accvgpr_read_b32 v174, a142
    v_accvgpr_read_b32 v175, a143
    v_pk_mul_f32 v[168:169], v[168:169], v[16:17]
    v_pk_mul_f32 v[170:171], v[170:171], v[16:17]
    v_pk_mul_f32 v[172:173], v[172:173], v[16:17]
    v_pk_mul_f32 v[174:175], v[174:175], v[16:17]
    v_cvt_pk_bf16_f32 v100, v168, v169
    v_cvt_pk_bf16_f32 v101, v170, v171
    v_cvt_pk_bf16_f32 v102, v172, v173
    v_cvt_pk_bf16_f32 v103, v174, v175
    ds_write_b128 v2, v[100:103] offset:17408
    v_accvgpr_read_b32 v128, a144
    v_accvgpr_read_b32 v129, a145
    v_accvgpr_read_b32 v130, a146
    v_accvgpr_read_b32 v131, a147
    v_accvgpr_read_b32 v132, a148
    v_accvgpr_read_b32 v133, a149
    v_accvgpr_read_b32 v134, a150
    v_accvgpr_read_b32 v135, a151
    v_pk_mul_f32 v[128:129], v[128:129], v[16:17]
    v_pk_mul_f32 v[130:131], v[130:131], v[16:17]
    v_pk_mul_f32 v[132:133], v[132:133], v[16:17]
    v_pk_mul_f32 v[134:135], v[134:135], v[16:17]
    v_cvt_pk_bf16_f32 v104, v128, v129
    v_cvt_pk_bf16_f32 v105, v130, v131
    v_cvt_pk_bf16_f32 v106, v132, v133
    v_cvt_pk_bf16_f32 v107, v134, v135
    ds_write_b128 v2, v[104:107] offset:18432
    v_accvgpr_read_b32 v136, a152
    v_accvgpr_read_b32 v137, a153
    v_accvgpr_read_b32 v138, a154
    v_accvgpr_read_b32 v139, a155
    v_accvgpr_read_b32 v140, a156
    v_accvgpr_read_b32 v141, a157
    v_accvgpr_read_b32 v142, a158
    v_accvgpr_read_b32 v143, a159
    v_pk_mul_f32 v[136:137], v[136:137], v[16:17]
    v_pk_mul_f32 v[138:139], v[138:139], v[16:17]
    v_pk_mul_f32 v[140:141], v[140:141], v[16:17]
    v_pk_mul_f32 v[142:143], v[142:143], v[16:17]
    v_cvt_pk_bf16_f32 v108, v136, v137
    v_cvt_pk_bf16_f32 v109, v138, v139
    v_cvt_pk_bf16_f32 v110, v140, v141
    v_cvt_pk_bf16_f32 v111, v142, v143
    ds_write_b128 v2, v[108:111] offset:19456
    v_mov_b32 v16, v13
    v_mov_b32 v17, v13
    v_accvgpr_read_b32 v144, a160
    v_accvgpr_read_b32 v145, a161
    v_accvgpr_read_b32 v146, a162
    v_accvgpr_read_b32 v147, a163
    v_accvgpr_read_b32 v148, a164
    v_accvgpr_read_b32 v149, a165
    v_accvgpr_read_b32 v150, a166
    v_accvgpr_read_b32 v151, a167
    v_pk_mul_f32 v[144:145], v[144:145], v[16:17]
    v_pk_mul_f32 v[146:147], v[146:147], v[16:17]
    v_pk_mul_f32 v[148:149], v[148:149], v[16:17]
    v_pk_mul_f32 v[150:151], v[150:151], v[16:17]
    v_cvt_pk_bf16_f32 v112, v144, v145
    v_cvt_pk_bf16_f32 v113, v146, v147
    v_cvt_pk_bf16_f32 v114, v148, v149
    v_cvt_pk_bf16_f32 v115, v150, v151
    ds_write_b128 v2, v[112:115] offset:20480
    v_accvgpr_read_b32 v152, a168
    v_accvgpr_read_b32 v153, a169
    v_accvgpr_read_b32 v154, a170
    v_accvgpr_read_b32 v155, a171
    v_accvgpr_read_b32 v156, a172
    v_accvgpr_read_b32 v157, a173
    v_accvgpr_read_b32 v158, a174
    v_accvgpr_read_b32 v159, a175
    v_pk_mul_f32 v[152:153], v[152:153], v[16:17]
    v_pk_mul_f32 v[154:155], v[154:155], v[16:17]
    v_pk_mul_f32 v[156:157], v[156:157], v[16:17]
    v_pk_mul_f32 v[158:159], v[158:159], v[16:17]
    v_cvt_pk_bf16_f32 v116, v152, v153
    v_cvt_pk_bf16_f32 v117, v154, v155
    v_cvt_pk_bf16_f32 v118, v156, v157
    v_cvt_pk_bf16_f32 v119, v158, v159
    ds_write_b128 v2, v[116:119] offset:21504
    v_accvgpr_read_b32 v160, a176
    v_accvgpr_read_b32 v161, a177
    v_accvgpr_read_b32 v162, a178
    v_accvgpr_read_b32 v163, a179
    v_accvgpr_read_b32 v164, a180
    v_accvgpr_read_b32 v165, a181
    v_accvgpr_read_b32 v166, a182
    v_accvgpr_read_b32 v167, a183
    v_pk_mul_f32 v[160:161], v[160:161], v[16:17]
    v_pk_mul_f32 v[162:163], v[162:163], v[16:17]
    v_pk_mul_f32 v[164:165], v[164:165], v[16:17]
    v_pk_mul_f32 v[166:167], v[166:167], v[16:17]
    v_cvt_pk_bf16_f32 v120, v160, v161
    v_cvt_pk_bf16_f32 v121, v162, v163
    v_cvt_pk_bf16_f32 v122, v164, v165
    v_cvt_pk_bf16_f32 v123, v166, v167
    ds_write_b128 v2, v[120:123] offset:22528
    v_accvgpr_read_b32 v168, a184
    v_accvgpr_read_b32 v169, a185
    v_accvgpr_read_b32 v170, a186
    v_accvgpr_read_b32 v171, a187
    v_accvgpr_read_b32 v172, a188
    v_accvgpr_read_b32 v173, a189
    v_accvgpr_read_b32 v174, a190
    v_accvgpr_read_b32 v175, a191
    v_pk_mul_f32 v[168:169], v[168:169], v[16:17]
    v_pk_mul_f32 v[170:171], v[170:171], v[16:17]
    v_pk_mul_f32 v[172:173], v[172:173], v[16:17]
    v_pk_mul_f32 v[174:175], v[174:175], v[16:17]
    v_cvt_pk_bf16_f32 v124, v168, v169
    v_cvt_pk_bf16_f32 v125, v170, v171
    v_cvt_pk_bf16_f32 v126, v172, v173
    v_cvt_pk_bf16_f32 v127, v174, v175
    ds_write_b128 v2, v[124:127] offset:23552
    s_lshl_b32 s46, s35, 3
    s_add_u32 s46, s46, s36
    s_lshl_b32 s46, s46, 4
    s_add_u32 s46, s46, s37
    s_mul_i32 s46, s46, 196608
    s_mul_i32 s47, s34, 98304
    s_add_u32 s46, s46, s47
    s_lshl_b32 s47, s33, 13
    s_add_u32 s46, s46, s47
    s_add_u32 s28, s12, s46
    s_addc_u32 s29, s13, 0
    s_and_b32 s29, s29, 0xffff
    s_mov_b32 s30, 90112
    s_mov_b32 s31, 0x20000
    s_waitcnt lgkmcnt(0)
    s_waitcnt vmcnt(12)
    s_barrier
    ds_read_b64_tr_b16 a[192:193], v224 offset:0
    ds_read_b64_tr_b16 a[194:195], v224 offset:2048
    ds_read_b64_tr_b16 a[196:197], v225 offset:0
    ds_read_b64_tr_b16 a[198:199], v225 offset:2048
    ds_read_b64_tr_b16 a[200:201], v226 offset:0
    ds_read_b64_tr_b16 a[202:203], v226 offset:2048
    ds_read_b64_tr_b16 a[204:205], v227 offset:0
    ds_read_b64_tr_b16 a[206:207], v227 offset:2048
    s_waitcnt lgkmcnt(0)
    v_mfma_f32_16x16x32_bf16 a[0:3], a[192:195], v[32:35], 0
    ds_read_b64_tr_b16 a[208:209], v224 offset:4096
    ds_read_b64_tr_b16 a[210:211], v224 offset:6144
    v_mfma_f32_16x16x32_bf16 a[16:19], a[192:195], v[48:51], 0
    ds_read_b64_tr_b16 a[212:213], v225 offset:4096
    ds_read_b64_tr_b16 a[214:215], v225 offset:6144
    v_mfma_f32_16x16x32_bf16 a[32:35], a[192:195], v[64:67], 0
    ds_read_b64_tr_b16 a[216:217], v226 offset:4096
    ds_read_b64_tr_b16 a[218:219], v226 offset:6144
    v_mfma_f32_16x16x32_bf16 a[48:51], a[192:195], v[80:83], 0
    v_mfma_f32_16x16x32_bf16 a[64:67], a[192:195], v[96:99], 0
    ds_read_b64_tr_b16 a[220:221], v227 offset:4096
    ds_read_b64_tr_b16 a[222:223], v227 offset:6144
    v_mfma_f32_16x16x32_bf16 a[80:83], a[192:195], v[112:115], 0
    ds_read_b128 v[128:131], v3 offset:0
    ds_read_b128 v[132:135], v3 offset:1024
    v_mfma_f32_16x16x32_bf16 a[4:7], a[196:199], v[32:35], 0
    v_mfma_f32_16x16x32_bf16 a[20:23], a[196:199], v[48:51], 0
    v_mfma_f32_16x16x32_bf16 a[36:39], a[196:199], v[64:67], 0
    ds_read_b128 v[136:139], v3 offset:2048
    ds_read_b128 v[140:143], v3 offset:3072
    v_mfma_f32_16x16x32_bf16 a[52:55], a[196:199], v[80:83], 0
    v_mfma_f32_16x16x32_bf16 a[68:71], a[196:199], v[96:99], 0
    v_mfma_f32_16x16x32_bf16 a[84:87], a[196:199], v[112:115], 0
    v_mfma_f32_16x16x32_bf16 a[8:11], a[200:203], v[32:35], 0
    ds_read_b128 v[144:147], v3 offset:4096
    ds_read_b128 v[148:151], v3 offset:5120
    v_mfma_f32_16x16x32_bf16 a[24:27], a[200:203], v[48:51], 0
    v_mfma_f32_16x16x32_bf16 a[40:43], a[200:203], v[64:67], 0
    v_mfma_f32_16x16x32_bf16 a[56:59], a[200:203], v[80:83], 0
    ds_read_b128 v[152:155], v3 offset:6144
    ds_read_b128 v[156:159], v3 offset:7168
    v_mfma_f32_16x16x32_bf16 a[72:75], a[200:203], v[96:99], 0
    v_mfma_f32_16x16x32_bf16 a[88:91], a[200:203], v[112:115], 0
    v_mfma_f32_16x16x32_bf16 a[12:15], a[204:207], v[32:35], 0
    v_mfma_f32_16x16x32_bf16 a[28:31], a[204:207], v[48:51], 0
    v_mfma_f32_16x16x32_bf16 a[44:47], a[204:207], v[64:67], 0
    v_mfma_f32_16x16x32_bf16 a[60:63], a[204:207], v[80:83], 0
    v_mfma_f32_16x16x32_bf16 a[76:79], a[204:207], v[96:99], 0
    v_mfma_f32_16x16x32_bf16 a[92:95], a[204:207], v[112:115], 0
    s_waitcnt lgkmcnt(8)
    s_waitcnt vmcnt(8)
    s_barrier
    v_mfma_f32_16x16x32_bf16 a[0:3], a[208:211], v[36:39], a[0:3]
    ds_read_b64_tr_b16 a[224:225], v224 offset:16384
    ds_read_b64_tr_b16 a[226:227], v224 offset:18432
    v_mfma_f32_16x16x32_bf16 a[16:19], a[208:211], v[52:55], a[16:19]
    ds_read_b64_tr_b16 a[228:229], v225 offset:16384
    ds_read_b64_tr_b16 a[230:231], v225 offset:18432
    v_mfma_f32_16x16x32_bf16 a[32:35], a[208:211], v[68:71], a[32:35]
    ds_read_b64_tr_b16 a[232:233], v226 offset:16384
    ds_read_b64_tr_b16 a[234:235], v226 offset:18432
    v_mfma_f32_16x16x32_bf16 a[48:51], a[208:211], v[84:87], a[48:51]
    v_mfma_f32_16x16x32_bf16 a[64:67], a[208:211], v[100:103], a[64:67]
    ds_read_b64_tr_b16 a[236:237], v227 offset:16384
    ds_read_b64_tr_b16 a[238:239], v227 offset:18432
    v_mfma_f32_16x16x32_bf16 a[80:83], a[208:211], v[116:119], a[80:83]
    ds_read_b128 v[160:163], v3 offset:8192
    ds_read_b128 v[164:167], v3 offset:9216
    v_mfma_f32_16x16x32_bf16 a[4:7], a[212:215], v[36:39], a[4:7]
    v_mfma_f32_16x16x32_bf16 a[20:23], a[212:215], v[52:55], a[20:23]
    v_mfma_f32_16x16x32_bf16 a[36:39], a[212:215], v[68:71], a[36:39]
    ds_read_b128 v[168:171], v3 offset:10240
    ds_read_b128 v[172:175], v3 offset:11264
    v_mfma_f32_16x16x32_bf16 a[52:55], a[212:215], v[84:87], a[52:55]
    v_mfma_f32_16x16x32_bf16 a[68:71], a[212:215], v[100:103], a[68:71]
    v_mfma_f32_16x16x32_bf16 a[84:87], a[212:215], v[116:119], a[84:87]
    v_mfma_f32_16x16x32_bf16 a[8:11], a[216:219], v[36:39], a[8:11]
    ds_read_b128 v[176:179], v3 offset:12288
    ds_read_b128 v[180:183], v3 offset:13312
    v_mfma_f32_16x16x32_bf16 a[24:27], a[216:219], v[52:55], a[24:27]
    v_mfma_f32_16x16x32_bf16 a[40:43], a[216:219], v[68:71], a[40:43]
    v_mfma_f32_16x16x32_bf16 a[56:59], a[216:219], v[84:87], a[56:59]
    ds_read_b128 v[184:187], v3 offset:14336
    ds_read_b128 v[188:191], v3 offset:15360
    v_mfma_f32_16x16x32_bf16 a[72:75], a[216:219], v[100:103], a[72:75]
    v_mfma_f32_16x16x32_bf16 a[88:91], a[216:219], v[116:119], a[88:91]
    v_mfma_f32_16x16x32_bf16 a[12:15], a[220:223], v[36:39], a[12:15]
    v_mfma_f32_16x16x32_bf16 a[28:31], a[220:223], v[52:55], a[28:31]
    v_mfma_f32_16x16x32_bf16 a[44:47], a[220:223], v[68:71], a[44:47]
    v_mfma_f32_16x16x32_bf16 a[60:63], a[220:223], v[84:87], a[60:63]
    v_mfma_f32_16x16x32_bf16 a[76:79], a[220:223], v[100:103], a[76:79]
    v_mfma_f32_16x16x32_bf16 a[92:95], a[220:223], v[116:119], a[92:95]
    s_waitcnt lgkmcnt(8)
    v_mfma_f32_16x16x32_bf16 a[0:3], a[224:227], v[40:43], a[0:3]
    ds_read_b64_tr_b16 a[240:241], v224 offset:20480
    ds_read_b64_tr_b16 a[242:243], v224 offset:22528
    v_mfma_f32_16x16x32_bf16 a[16:19], a[224:227], v[56:59], a[16:19]
    ds_read_b64_tr_b16 a[244:245], v225 offset:20480
    ds_read_b64_tr_b16 a[246:247], v225 offset:22528
    v_mfma_f32_16x16x32_bf16 a[32:35], a[224:227], v[72:75], a[32:35]
    ds_read_b64_tr_b16 a[248:249], v226 offset:20480
    ds_read_b64_tr_b16 a[250:251], v226 offset:22528
    v_mfma_f32_16x16x32_bf16 a[48:51], a[224:227], v[88:91], a[48:51]
    v_mfma_f32_16x16x32_bf16 a[64:67], a[224:227], v[104:107], a[64:67]
    ds_read_b64_tr_b16 a[252:253], v227 offset:20480
    ds_read_b64_tr_b16 a[254:255], v227 offset:22528
    v_mfma_f32_16x16x32_bf16 a[80:83], a[224:227], v[120:123], a[80:83]
    ds_read_b128 v[192:195], v3 offset:16384
    ds_read_b128 v[196:199], v3 offset:17408
    v_mfma_f32_16x16x32_bf16 a[4:7], a[228:231], v[40:43], a[4:7]
    v_mfma_f32_16x16x32_bf16 a[20:23], a[228:231], v[56:59], a[20:23]
    v_mfma_f32_16x16x32_bf16 a[36:39], a[228:231], v[72:75], a[36:39]
    ds_read_b128 v[200:203], v3 offset:18432
    ds_read_b128 v[204:207], v3 offset:19456
    v_mfma_f32_16x16x32_bf16 a[52:55], a[228:231], v[88:91], a[52:55]
    v_mfma_f32_16x16x32_bf16 a[68:71], a[228:231], v[104:107], a[68:71]
    v_mfma_f32_16x16x32_bf16 a[84:87], a[228:231], v[120:123], a[84:87]
    v_mfma_f32_16x16x32_bf16 a[8:11], a[232:235], v[40:43], a[8:11]
    ds_read_b128 v[208:211], v3 offset:20480
    ds_read_b128 v[212:215], v3 offset:21504
    v_mfma_f32_16x16x32_bf16 a[24:27], a[232:235], v[56:59], a[24:27]
    v_mfma_f32_16x16x32_bf16 a[40:43], a[232:235], v[72:75], a[40:43]
    v_mfma_f32_16x16x32_bf16 a[56:59], a[232:235], v[88:91], a[56:59]
    ds_read_b128 v[216:219], v3 offset:22528
    ds_read_b128 v[220:223], v3 offset:23552
    v_mfma_f32_16x16x32_bf16 a[72:75], a[232:235], v[104:107], a[72:75]
    v_mfma_f32_16x16x32_bf16 a[88:91], a[232:235], v[120:123], a[88:91]
    v_mfma_f32_16x16x32_bf16 a[12:15], a[236:239], v[40:43], a[12:15]
    v_mfma_f32_16x16x32_bf16 a[28:31], a[236:239], v[56:59], a[28:31]
    v_mfma_f32_16x16x32_bf16 a[44:47], a[236:239], v[72:75], a[44:47]
    v_mfma_f32_16x16x32_bf16 a[60:63], a[236:239], v[88:91], a[60:63]
    v_mfma_f32_16x16x32_bf16 a[76:79], a[236:239], v[104:107], a[76:79]
    v_mfma_f32_16x16x32_bf16 a[92:95], a[236:239], v[120:123], a[92:95]
    s_waitcnt lgkmcnt(8)
    s_waitcnt lgkmcnt(0)
    s_waitcnt vmcnt(4)
    s_barrier
    v_mfma_f32_16x16x32_bf16 a[0:3], a[240:243], v[44:47], a[0:3]
    ds_read_b64_tr_b16 a[192:193], v224 offset:32768
    ds_read_b64_tr_b16 a[194:195], v224 offset:34816
    v_mfma_f32_16x16x32_bf16 a[16:19], a[240:243], v[60:63], a[16:19]
    s_add_u32 m0, s52, 65536
    ds_read_b64_tr_b16 a[196:197], v225 offset:32768
    ds_read_b64_tr_b16 a[198:199], v225 offset:34816
    v_mfma_f32_16x16x32_bf16 a[32:35], a[240:243], v[76:79], a[32:35]
    s_add_u32 s46, s50, 128
    ds_read_b64_tr_b16 a[200:201], v226 offset:32768
    ds_read_b64_tr_b16 a[202:203], v226 offset:34816
    v_mfma_f32_16x16x32_bf16 a[48:51], a[240:243], v[92:95], a[48:51]
    buffer_load_dwordx4 v27, s[20:23], s46 offen  lds
    v_mfma_f32_16x16x32_bf16 a[64:67], a[240:243], v[108:111], a[64:67]
    s_add_u32 m0, s52, 66560
    ds_read_b64_tr_b16 a[204:205], v227 offset:32768
    ds_read_b64_tr_b16 a[206:207], v227 offset:34816
    v_mfma_f32_16x16x32_bf16 a[80:83], a[240:243], v[124:127], a[80:83]
    s_add_u32 s46, s50, 8320
    buffer_load_dwordx4 v27, s[20:23], s46 offen  lds
    v_mfma_f32_16x16x32_bf16 a[4:7], a[244:247], v[44:47], a[4:7]
    s_add_u32 m0, s52, 67584
    v_mfma_f32_16x16x32_bf16 a[20:23], a[244:247], v[60:63], a[20:23]
    s_add_u32 s46, s50, 16512
    buffer_load_dwordx4 v27, s[20:23], s46 offen  lds
    v_mfma_f32_16x16x32_bf16 a[36:39], a[244:247], v[76:79], a[36:39]
    s_add_u32 m0, s52, 68608
    v_mfma_f32_16x16x32_bf16 a[52:55], a[244:247], v[92:95], a[52:55]
    s_add_u32 s46, s50, 24704
    v_mfma_f32_16x16x32_bf16 a[68:71], a[244:247], v[108:111], a[68:71]
    buffer_load_dwordx4 v27, s[20:23], s46 offen  lds
    v_mfma_f32_16x16x32_bf16 a[84:87], a[244:247], v[124:127], a[84:87]
    s_add_u32 m0, s52, 81920
    v_mfma_f32_16x16x32_bf16 a[8:11], a[248:251], v[44:47], a[8:11]
    s_add_u32 s46, s50, 65664
    buffer_load_dwordx4 v27, s[20:23], s46 offen  lds
    v_mfma_f32_16x16x32_bf16 a[24:27], a[248:251], v[60:63], a[24:27]
    s_add_u32 m0, s52, 82944
    v_mfma_f32_16x16x32_bf16 a[40:43], a[248:251], v[76:79], a[40:43]
    s_add_u32 s46, s50, 73856
    buffer_load_dwordx4 v27, s[20:23], s46 offen  lds
    v_mfma_f32_16x16x32_bf16 a[56:59], a[248:251], v[92:95], a[56:59]
    s_add_u32 m0, s52, 83968
    v_mfma_f32_16x16x32_bf16 a[72:75], a[248:251], v[108:111], a[72:75]
    s_add_u32 s46, s50, 82048
    buffer_load_dwordx4 v27, s[20:23], s46 offen  lds
    v_mfma_f32_16x16x32_bf16 a[88:91], a[248:251], v[124:127], a[88:91]
    s_add_u32 m0, s52, 84992
    v_mfma_f32_16x16x32_bf16 a[12:15], a[252:255], v[44:47], a[12:15]
    s_add_u32 s46, s50, 90240
    v_mfma_f32_16x16x32_bf16 a[28:31], a[252:255], v[60:63], a[28:31]
    buffer_load_dwordx4 v27, s[20:23], s46 offen  lds
    v_mfma_f32_16x16x32_bf16 a[44:47], a[252:255], v[76:79], a[44:47]
    v_mfma_f32_16x16x32_bf16 a[60:63], a[252:255], v[92:95], a[60:63]
    v_mfma_f32_16x16x32_bf16 a[76:79], a[252:255], v[108:111], a[76:79]
    v_mfma_f32_16x16x32_bf16 a[92:95], a[252:255], v[124:127], a[92:95]
    s_waitcnt lgkmcnt(8)
    s_waitcnt lgkmcnt(0)
    v_mfma_f32_16x16x32_bf16 a[0:3], a[192:195], v[128:131], a[0:3]
    ds_read_b64_tr_b16 a[208:209], v224 offset:36864
    ds_read_b64_tr_b16 a[210:211], v224 offset:38912
    v_mfma_f32_16x16x32_bf16 a[16:19], a[192:195], v[144:147], a[16:19]
    s_add_u32 m0, s52, 98304
    ds_read_b64_tr_b16 a[212:213], v225 offset:36864
    ds_read_b64_tr_b16 a[214:215], v225 offset:38912
    v_mfma_f32_16x16x32_bf16 a[32:35], a[192:195], v[160:163], a[32:35]
    s_add_u32 s46, s51, 128
    ds_read_b64_tr_b16 a[216:217], v226 offset:36864
    ds_read_b64_tr_b16 a[218:219], v226 offset:38912
    v_mfma_f32_16x16x32_bf16 a[48:51], a[192:195], v[176:179], a[48:51]
    buffer_load_dwordx4 v27, s[20:23], s46 offen  lds
    v_mfma_f32_16x16x32_bf16 a[64:67], a[192:195], v[192:195], a[64:67]
    s_add_u32 m0, s52, 99328
    ds_read_b64_tr_b16 a[220:221], v227 offset:36864
    ds_read_b64_tr_b16 a[222:223], v227 offset:38912
    v_mfma_f32_16x16x32_bf16 a[80:83], a[192:195], v[208:211], a[80:83]
    s_add_u32 s46, s51, 8320
    buffer_load_dwordx4 v27, s[20:23], s46 offen  lds
    v_mfma_f32_16x16x32_bf16 a[4:7], a[196:199], v[128:131], a[4:7]
    s_add_u32 m0, s52, 100352
    v_mfma_f32_16x16x32_bf16 a[20:23], a[196:199], v[144:147], a[20:23]
    s_add_u32 s46, s51, 16512
    buffer_load_dwordx4 v27, s[20:23], s46 offen  lds
    v_mfma_f32_16x16x32_bf16 a[36:39], a[196:199], v[160:163], a[36:39]
    s_add_u32 m0, s52, 101376
    v_mfma_f32_16x16x32_bf16 a[52:55], a[196:199], v[176:179], a[52:55]
    s_add_u32 s46, s51, 24704
    v_mfma_f32_16x16x32_bf16 a[68:71], a[196:199], v[192:195], a[68:71]
    buffer_load_dwordx4 v27, s[20:23], s46 offen  lds
    v_mfma_f32_16x16x32_bf16 a[84:87], a[196:199], v[208:211], a[84:87]
    s_add_u32 m0, s52, 114688
    v_mfma_f32_16x16x32_bf16 a[8:11], a[200:203], v[128:131], a[8:11]
    s_add_u32 s46, s51, 65664
    buffer_load_dwordx4 v27, s[20:23], s46 offen  lds
    v_mfma_f32_16x16x32_bf16 a[24:27], a[200:203], v[144:147], a[24:27]
    s_add_u32 m0, s52, 115712
    v_mfma_f32_16x16x32_bf16 a[40:43], a[200:203], v[160:163], a[40:43]
    s_add_u32 s46, s51, 73856
    buffer_load_dwordx4 v27, s[20:23], s46 offen  lds
    v_mfma_f32_16x16x32_bf16 a[56:59], a[200:203], v[176:179], a[56:59]
    s_add_u32 m0, s52, 116736
    v_mfma_f32_16x16x32_bf16 a[72:75], a[200:203], v[192:195], a[72:75]
    s_add_u32 s46, s51, 82048
    buffer_load_dwordx4 v27, s[20:23], s46 offen  lds
    v_mfma_f32_16x16x32_bf16 a[88:91], a[200:203], v[208:211], a[88:91]
    s_add_u32 m0, s52, 117760
    v_mfma_f32_16x16x32_bf16 a[12:15], a[204:207], v[128:131], a[12:15]
    s_add_u32 s46, s51, 90240
    v_mfma_f32_16x16x32_bf16 a[28:31], a[204:207], v[144:147], a[28:31]
    buffer_load_dwordx4 v27, s[20:23], s46 offen  lds
    v_mfma_f32_16x16x32_bf16 a[44:47], a[204:207], v[160:163], a[44:47]
    v_mfma_f32_16x16x32_bf16 a[60:63], a[204:207], v[176:179], a[60:63]
    v_mfma_f32_16x16x32_bf16 a[76:79], a[204:207], v[192:195], a[76:79]
    v_mfma_f32_16x16x32_bf16 a[92:95], a[204:207], v[208:211], a[92:95]
    s_waitcnt lgkmcnt(0)
    s_waitcnt vmcnt(16)
    s_barrier
    v_mfma_f32_16x16x32_bf16 a[0:3], a[208:211], v[132:135], a[0:3]
    ds_read_b64_tr_b16 a[224:225], v224 offset:49152
    ds_read_b64_tr_b16 a[226:227], v224 offset:51200
    v_mfma_f32_16x16x32_bf16 a[16:19], a[208:211], v[148:151], a[16:19]
    s_add_u32 m0, s52, 131072
    ds_read_b64_tr_b16 a[228:229], v225 offset:49152
    ds_read_b64_tr_b16 a[230:231], v225 offset:51200
    v_mfma_f32_16x16x32_bf16 a[32:35], a[208:211], v[164:167], a[32:35]
    s_add_u32 s46, s50, 256
    ds_read_b64_tr_b16 a[232:233], v226 offset:49152
    ds_read_b64_tr_b16 a[234:235], v226 offset:51200
    v_mfma_f32_16x16x32_bf16 a[48:51], a[208:211], v[180:183], a[48:51]
    buffer_load_dwordx4 v27, s[20:23], s46 offen  lds
    v_mfma_f32_16x16x32_bf16 a[64:67], a[208:211], v[196:199], a[64:67]
    s_add_u32 m0, s52, 132096
    ds_read_b64_tr_b16 a[236:237], v227 offset:49152
    ds_read_b64_tr_b16 a[238:239], v227 offset:51200
    v_mfma_f32_16x16x32_bf16 a[80:83], a[208:211], v[212:215], a[80:83]
    s_add_u32 s46, s50, 8448
    buffer_load_dwordx4 v27, s[20:23], s46 offen  lds
    v_mfma_f32_16x16x32_bf16 a[4:7], a[212:215], v[132:135], a[4:7]
    s_add_u32 m0, s52, 133120
    v_mfma_f32_16x16x32_bf16 a[20:23], a[212:215], v[148:151], a[20:23]
    s_add_u32 s46, s50, 16640
    buffer_load_dwordx4 v27, s[20:23], s46 offen  lds
    v_mfma_f32_16x16x32_bf16 a[36:39], a[212:215], v[164:167], a[36:39]
    s_add_u32 m0, s52, 134144
    v_mfma_f32_16x16x32_bf16 a[52:55], a[212:215], v[180:183], a[52:55]
    s_add_u32 s46, s50, 24832
    v_mfma_f32_16x16x32_bf16 a[68:71], a[212:215], v[196:199], a[68:71]
    buffer_load_dwordx4 v27, s[20:23], s46 offen  lds
    v_mfma_f32_16x16x32_bf16 a[84:87], a[212:215], v[212:215], a[84:87]
    s_add_u32 m0, s52, 147456
    v_mfma_f32_16x16x32_bf16 a[8:11], a[216:219], v[132:135], a[8:11]
    s_add_u32 s46, s50, 65792
    buffer_load_dwordx4 v27, s[20:23], s46 offen  lds
    v_mfma_f32_16x16x32_bf16 a[24:27], a[216:219], v[148:151], a[24:27]
    s_add_u32 m0, s52, 148480
    v_mfma_f32_16x16x32_bf16 a[40:43], a[216:219], v[164:167], a[40:43]
    s_add_u32 s46, s50, 73984
    buffer_load_dwordx4 v27, s[20:23], s46 offen  lds
    v_mfma_f32_16x16x32_bf16 a[56:59], a[216:219], v[180:183], a[56:59]
    s_add_u32 m0, s52, 149504
    v_mfma_f32_16x16x32_bf16 a[72:75], a[216:219], v[196:199], a[72:75]
    s_add_u32 s46, s50, 82176
    buffer_load_dwordx4 v27, s[20:23], s46 offen  lds
    v_mfma_f32_16x16x32_bf16 a[88:91], a[216:219], v[212:215], a[88:91]
    s_add_u32 m0, s52, 150528
    v_mfma_f32_16x16x32_bf16 a[12:15], a[220:223], v[132:135], a[12:15]
    s_add_u32 s46, s50, 90368
    v_mfma_f32_16x16x32_bf16 a[28:31], a[220:223], v[148:151], a[28:31]
    buffer_load_dwordx4 v27, s[20:23], s46 offen  lds
    v_mfma_f32_16x16x32_bf16 a[44:47], a[220:223], v[164:167], a[44:47]
    v_mfma_f32_16x16x32_bf16 a[60:63], a[220:223], v[180:183], a[60:63]
    v_mfma_f32_16x16x32_bf16 a[76:79], a[220:223], v[196:199], a[76:79]
    v_mfma_f32_16x16x32_bf16 a[92:95], a[220:223], v[212:215], a[92:95]
    s_waitcnt lgkmcnt(0)
    v_mfma_f32_16x16x32_bf16 a[0:3], a[224:227], v[136:139], a[0:3]
    ds_read_b64_tr_b16 a[240:241], v224 offset:53248
    ds_read_b64_tr_b16 a[242:243], v224 offset:55296
    v_mfma_f32_16x16x32_bf16 a[16:19], a[224:227], v[152:155], a[16:19]
    s_add_u32 m0, s52, 0
    ds_read_b64_tr_b16 a[244:245], v225 offset:53248
    ds_read_b64_tr_b16 a[246:247], v225 offset:55296
    v_mfma_f32_16x16x32_bf16 a[32:35], a[224:227], v[168:171], a[32:35]
    s_add_u32 s46, s51, 256
    ds_read_b64_tr_b16 a[248:249], v226 offset:53248
    ds_read_b64_tr_b16 a[250:251], v226 offset:55296
    v_mfma_f32_16x16x32_bf16 a[48:51], a[224:227], v[184:187], a[48:51]
    buffer_load_dwordx4 v27, s[20:23], s46 offen  lds
    v_mfma_f32_16x16x32_bf16 a[64:67], a[224:227], v[200:203], a[64:67]
    ds_read_b64_tr_b16 a[252:253], v227 offset:53248
    ds_read_b64_tr_b16 a[254:255], v227 offset:55296
    v_mfma_f32_16x16x32_bf16 a[80:83], a[224:227], v[216:219], a[80:83]
    v_mfma_f32_16x16x32_bf16 a[4:7], a[228:231], v[136:139], a[4:7]
    s_add_u32 m0, s52, 1024
    v_mfma_f32_16x16x32_bf16 a[20:23], a[228:231], v[152:155], a[20:23]
    s_add_u32 s46, s51, 8448
    v_mfma_f32_16x16x32_bf16 a[36:39], a[228:231], v[168:171], a[36:39]
    buffer_load_dwordx4 v27, s[20:23], s46 offen  lds
    v_mfma_f32_16x16x32_bf16 a[52:55], a[228:231], v[184:187], a[52:55]
    v_mfma_f32_16x16x32_bf16 a[68:71], a[228:231], v[200:203], a[68:71]
    s_add_u32 m0, s52, 2048
    v_mfma_f32_16x16x32_bf16 a[84:87], a[228:231], v[216:219], a[84:87]
    s_add_u32 s46, s51, 16640
    v_mfma_f32_16x16x32_bf16 a[8:11], a[232:235], v[136:139], a[8:11]
    buffer_load_dwordx4 v27, s[20:23], s46 offen  lds
    v_mfma_f32_16x16x32_bf16 a[24:27], a[232:235], v[152:155], a[24:27]
    v_mfma_f32_16x16x32_bf16 a[40:43], a[232:235], v[168:171], a[40:43]
    v_mfma_f32_16x16x32_bf16 a[56:59], a[232:235], v[184:187], a[56:59]
    s_add_u32 m0, s52, 3072
    v_mfma_f32_16x16x32_bf16 a[72:75], a[232:235], v[200:203], a[72:75]
    s_add_u32 s46, s51, 24832
    v_mfma_f32_16x16x32_bf16 a[88:91], a[232:235], v[216:219], a[88:91]
    buffer_load_dwordx4 v27, s[20:23], s46 offen  lds
    v_mfma_f32_16x16x32_bf16 a[12:15], a[236:239], v[136:139], a[12:15]
    v_mfma_f32_16x16x32_bf16 a[28:31], a[236:239], v[152:155], a[28:31]
    v_mfma_f32_16x16x32_bf16 a[44:47], a[236:239], v[168:171], a[44:47]
    v_mfma_f32_16x16x32_bf16 a[60:63], a[236:239], v[184:187], a[60:63]
    v_mfma_f32_16x16x32_bf16 a[76:79], a[236:239], v[200:203], a[76:79]
    v_mfma_f32_16x16x32_bf16 a[92:95], a[236:239], v[216:219], a[92:95]
    s_waitcnt lgkmcnt(0)
    s_waitcnt vmcnt(24)
    s_barrier
    v_mfma_f32_16x16x32_bf16 a[0:3], a[240:243], v[140:143], a[0:3]
    ds_read_b64_tr_b16 a[192:193], v228 offset:0
    ds_read_b64_tr_b16 a[194:195], v228 offset:2048
    v_mfma_f32_16x16x32_bf16 a[16:19], a[240:243], v[156:159], a[16:19]
    s_add_u32 m0, s52, 16384
    ds_read_b64_tr_b16 a[196:197], v229 offset:0
    ds_read_b64_tr_b16 a[198:199], v229 offset:2048
    v_mfma_f32_16x16x32_bf16 a[32:35], a[240:243], v[172:175], a[32:35]
    s_add_u32 s46, s51, 65792
    ds_read_b64_tr_b16 a[200:201], v230 offset:0
    ds_read_b64_tr_b16 a[202:203], v230 offset:2048
    v_mfma_f32_16x16x32_bf16 a[48:51], a[240:243], v[188:191], a[48:51]
    buffer_load_dwordx4 v27, s[20:23], s46 offen  lds
    v_mfma_f32_16x16x32_bf16 a[64:67], a[240:243], v[204:207], a[64:67]
    ds_read_b64_tr_b16 a[204:205], v231 offset:0
    ds_read_b64_tr_b16 a[206:207], v231 offset:2048
    v_mfma_f32_16x16x32_bf16 a[80:83], a[240:243], v[220:223], a[80:83]
    v_mfma_f32_16x16x32_bf16 a[4:7], a[244:247], v[140:143], a[4:7]
    s_add_u32 m0, s52, 17408
    v_mfma_f32_16x16x32_bf16 a[20:23], a[244:247], v[156:159], a[20:23]
    s_add_u32 s46, s51, 73984
    v_mfma_f32_16x16x32_bf16 a[36:39], a[244:247], v[172:175], a[36:39]
    buffer_load_dwordx4 v27, s[20:23], s46 offen  lds
    v_mfma_f32_16x16x32_bf16 a[52:55], a[244:247], v[188:191], a[52:55]
    v_mfma_f32_16x16x32_bf16 a[68:71], a[244:247], v[204:207], a[68:71]
    s_add_u32 m0, s52, 18432
    v_mfma_f32_16x16x32_bf16 a[84:87], a[244:247], v[220:223], a[84:87]
    s_add_u32 s46, s51, 82176
    v_mfma_f32_16x16x32_bf16 a[8:11], a[248:251], v[140:143], a[8:11]
    buffer_load_dwordx4 v27, s[20:23], s46 offen  lds
    v_mfma_f32_16x16x32_bf16 a[24:27], a[248:251], v[156:159], a[24:27]
    v_mfma_f32_16x16x32_bf16 a[40:43], a[248:251], v[172:175], a[40:43]
    v_mfma_f32_16x16x32_bf16 a[56:59], a[248:251], v[188:191], a[56:59]
    s_add_u32 m0, s52, 19456
    v_mfma_f32_16x16x32_bf16 a[72:75], a[248:251], v[204:207], a[72:75]
    s_add_u32 s46, s51, 90368
    v_mfma_f32_16x16x32_bf16 a[88:91], a[248:251], v[220:223], a[88:91]
    buffer_load_dwordx4 v27, s[20:23], s46 offen  lds
    v_mfma_f32_16x16x32_bf16 a[12:15], a[252:255], v[140:143], a[12:15]
    v_mfma_f32_16x16x32_bf16 a[28:31], a[252:255], v[156:159], a[28:31]
    v_mfma_f32_16x16x32_bf16 a[44:47], a[252:255], v[172:175], a[44:47]
    v_mfma_f32_16x16x32_bf16 a[60:63], a[252:255], v[188:191], a[60:63]
    v_mfma_f32_16x16x32_bf16 a[76:79], a[252:255], v[204:207], a[76:79]
    v_mfma_f32_16x16x32_bf16 a[92:95], a[252:255], v[220:223], a[92:95]
    s_waitcnt lgkmcnt(0)
    v_mfma_f32_16x16x32_bf16 a[96:99], a[192:195], v[32:35], 0
    ds_read_b64_tr_b16 a[208:209], v228 offset:4096
    ds_read_b64_tr_b16 a[210:211], v228 offset:6144
    v_mfma_f32_16x16x32_bf16 a[112:115], a[192:195], v[48:51], 0
    ds_read_b64_tr_b16 a[212:213], v229 offset:4096
    ds_read_b64_tr_b16 a[214:215], v229 offset:6144
    v_mfma_f32_16x16x32_bf16 a[128:131], a[192:195], v[64:67], 0
    ds_read_b64_tr_b16 a[216:217], v230 offset:4096
    ds_read_b64_tr_b16 a[218:219], v230 offset:6144
    v_mfma_f32_16x16x32_bf16 a[144:147], a[192:195], v[80:83], 0
    v_mfma_f32_16x16x32_bf16 a[160:163], a[192:195], v[96:99], 0
    ds_read_b64_tr_b16 a[220:221], v231 offset:4096
    ds_read_b64_tr_b16 a[222:223], v231 offset:6144
    v_mfma_f32_16x16x32_bf16 a[176:179], a[192:195], v[112:115], 0
    v_mfma_f32_16x16x32_bf16 a[100:103], a[196:199], v[32:35], 0
    v_mfma_f32_16x16x32_bf16 a[116:119], a[196:199], v[48:51], 0
    v_mfma_f32_16x16x32_bf16 a[132:135], a[196:199], v[64:67], 0
    v_mfma_f32_16x16x32_bf16 a[148:151], a[196:199], v[80:83], 0
    v_mfma_f32_16x16x32_bf16 a[164:167], a[196:199], v[96:99], 0
    v_mfma_f32_16x16x32_bf16 a[180:183], a[196:199], v[112:115], 0
    v_mfma_f32_16x16x32_bf16 a[104:107], a[200:203], v[32:35], 0
    v_mfma_f32_16x16x32_bf16 a[120:123], a[200:203], v[48:51], 0
    v_mfma_f32_16x16x32_bf16 a[136:139], a[200:203], v[64:67], 0
    v_mfma_f32_16x16x32_bf16 a[152:155], a[200:203], v[80:83], 0
    v_mfma_f32_16x16x32_bf16 a[168:171], a[200:203], v[96:99], 0
    v_mfma_f32_16x16x32_bf16 a[184:187], a[200:203], v[112:115], 0
    v_mfma_f32_16x16x32_bf16 a[108:111], a[204:207], v[32:35], 0
    v_mfma_f32_16x16x32_bf16 a[124:127], a[204:207], v[48:51], 0
    v_mfma_f32_16x16x32_bf16 a[140:143], a[204:207], v[64:67], 0
    v_mfma_f32_16x16x32_bf16 a[156:159], a[204:207], v[80:83], 0
    v_mfma_f32_16x16x32_bf16 a[172:175], a[204:207], v[96:99], 0
    v_mfma_f32_16x16x32_bf16 a[188:191], a[204:207], v[112:115], 0
    s_waitcnt lgkmcnt(0)
    s_waitcnt vmcnt(24)
    s_barrier
    v_mfma_f32_16x16x32_bf16 a[96:99], a[208:211], v[36:39], a[96:99]
    ds_read_b64_tr_b16 a[224:225], v228 offset:16384
    ds_read_b64_tr_b16 a[226:227], v228 offset:18432
    v_mfma_f32_16x16x32_bf16 a[112:115], a[208:211], v[52:55], a[112:115]
    v_accvgpr_read_b32 v236, a0
    v_accvgpr_read_b32 v237, a1
    v_mfma_f32_16x16x32_bf16 a[128:131], a[208:211], v[68:71], a[128:131]
    v_accvgpr_read_b32 v238, a2
    v_accvgpr_read_b32 v239, a3
    v_mfma_f32_16x16x32_bf16 a[144:147], a[208:211], v[84:87], a[144:147]
    ds_read_b64_tr_b16 a[228:229], v229 offset:16384
    ds_read_b64_tr_b16 a[230:231], v229 offset:18432
    v_mfma_f32_16x16x32_bf16 a[160:163], a[208:211], v[100:103], a[160:163]
    v_accvgpr_read_b32 v240, a4
    v_accvgpr_read_b32 v241, a5
    v_mfma_f32_16x16x32_bf16 a[176:179], a[208:211], v[116:119], a[176:179]
    s_add_u32 m0, s52, 32768
    ds_read_b64_tr_b16 a[232:233], v230 offset:16384
    ds_read_b64_tr_b16 a[234:235], v230 offset:18432
    v_mfma_f32_16x16x32_bf16 a[100:103], a[212:215], v[36:39], a[100:103]
    s_add_u32 s46, s50, 384
    v_accvgpr_read_b32 v242, a6
    v_accvgpr_read_b32 v243, a7
    v_mfma_f32_16x16x32_bf16 a[116:119], a[212:215], v[52:55], a[116:119]
    buffer_load_dwordx4 v27, s[20:23], s46 offen  lds
    v_mfma_f32_16x16x32_bf16 a[132:135], a[212:215], v[68:71], a[132:135]
    v_cvt_pk_bf16_f32 v244, v236, v237
    v_cvt_pk_bf16_f32 v245, v238, v239
    v_mfma_f32_16x16x32_bf16 a[148:151], a[212:215], v[84:87], a[148:151]
    ds_read_b64_tr_b16 a[236:237], v231 offset:16384
    ds_read_b64_tr_b16 a[238:239], v231 offset:18432
    v_mfma_f32_16x16x32_bf16 a[164:167], a[212:215], v[100:103], a[164:167]
    s_add_u32 m0, s52, 33792
    v_cvt_pk_bf16_f32 v246, v240, v241
    v_cvt_pk_bf16_f32 v247, v242, v243
    v_mfma_f32_16x16x32_bf16 a[180:183], a[212:215], v[116:119], a[180:183]
    s_add_u32 s46, s50, 8576
    s_mov_b32 s48, 0
    buffer_store_dwordx4 v[244:247], v7, s[28:31], s48 offen offset:0 sc1
    v_mfma_f32_16x16x32_bf16 a[104:107], a[216:219], v[36:39], a[104:107]
    buffer_load_dwordx4 v27, s[20:23], s46 offen  lds
    v_mfma_f32_16x16x32_bf16 a[120:123], a[216:219], v[52:55], a[120:123]
    v_accvgpr_read_b32 v236, a8
    v_accvgpr_read_b32 v237, a9
    v_mfma_f32_16x16x32_bf16 a[136:139], a[216:219], v[68:71], a[136:139]
    s_add_u32 m0, s52, 34816
    v_accvgpr_read_b32 v238, a10
    v_accvgpr_read_b32 v239, a11
    v_mfma_f32_16x16x32_bf16 a[152:155], a[216:219], v[84:87], a[152:155]
    s_add_u32 s46, s50, 16768
    v_accvgpr_read_b32 v240, a12
    v_accvgpr_read_b32 v241, a13
    v_mfma_f32_16x16x32_bf16 a[168:171], a[216:219], v[100:103], a[168:171]
    buffer_load_dwordx4 v27, s[20:23], s46 offen  lds
    v_mfma_f32_16x16x32_bf16 a[184:187], a[216:219], v[116:119], a[184:187]
    s_add_u32 m0, s52, 35840
    v_accvgpr_read_b32 v242, a14
    v_accvgpr_read_b32 v243, a15
    v_mfma_f32_16x16x32_bf16 a[108:111], a[220:223], v[36:39], a[108:111]
    s_add_u32 s46, s50, 24960
    v_cvt_pk_bf16_f32 v248, v236, v237
    v_cvt_pk_bf16_f32 v249, v238, v239
    v_mfma_f32_16x16x32_bf16 a[124:127], a[220:223], v[52:55], a[124:127]
    buffer_load_dwordx4 v27, s[20:23], s46 offen  lds
    v_mfma_f32_16x16x32_bf16 a[140:143], a[220:223], v[68:71], a[140:143]
    v_cvt_pk_bf16_f32 v250, v240, v241
    v_cvt_pk_bf16_f32 v251, v242, v243
    v_mfma_f32_16x16x32_bf16 a[156:159], a[220:223], v[84:87], a[156:159]
    s_mov_b32 s48, 0
    buffer_store_dwordx4 v[248:251], v7, s[28:31], s48 offen offset:1024 sc1
    v_mfma_f32_16x16x32_bf16 a[172:175], a[220:223], v[100:103], a[172:175]
    v_mfma_f32_16x16x32_bf16 a[188:191], a[220:223], v[116:119], a[188:191]
    s_waitcnt lgkmcnt(0)
    v_mfma_f32_16x16x32_bf16 a[96:99], a[224:227], v[40:43], a[96:99]
    ds_read_b64_tr_b16 a[240:241], v228 offset:20480
    ds_read_b64_tr_b16 a[242:243], v228 offset:22528
    v_mfma_f32_16x16x32_bf16 a[112:115], a[224:227], v[56:59], a[112:115]
    v_accvgpr_read_b32 v236, a16
    v_accvgpr_read_b32 v237, a17
    v_mfma_f32_16x16x32_bf16 a[128:131], a[224:227], v[72:75], a[128:131]
    v_accvgpr_read_b32 v238, a18
    v_accvgpr_read_b32 v239, a19
    v_mfma_f32_16x16x32_bf16 a[144:147], a[224:227], v[88:91], a[144:147]
    ds_read_b64_tr_b16 a[244:245], v229 offset:20480
    ds_read_b64_tr_b16 a[246:247], v229 offset:22528
    v_mfma_f32_16x16x32_bf16 a[160:163], a[224:227], v[104:107], a[160:163]
    v_accvgpr_read_b32 v240, a20
    v_accvgpr_read_b32 v241, a21
    v_mfma_f32_16x16x32_bf16 a[176:179], a[224:227], v[120:123], a[176:179]
    ds_read_b64_tr_b16 a[248:249], v230 offset:20480
    ds_read_b64_tr_b16 a[250:251], v230 offset:22528
    v_mfma_f32_16x16x32_bf16 a[100:103], a[228:231], v[40:43], a[100:103]
    v_accvgpr_read_b32 v242, a22
    v_accvgpr_read_b32 v243, a23
    v_mfma_f32_16x16x32_bf16 a[116:119], a[228:231], v[56:59], a[116:119]
    v_cvt_pk_bf16_f32 v244, v236, v237
    v_cvt_pk_bf16_f32 v245, v238, v239
    v_mfma_f32_16x16x32_bf16 a[132:135], a[228:231], v[72:75], a[132:135]
    ds_read_b64_tr_b16 a[252:253], v231 offset:20480
    ds_read_b64_tr_b16 a[254:255], v231 offset:22528
    v_mfma_f32_16x16x32_bf16 a[148:151], a[228:231], v[88:91], a[148:151]
    v_cvt_pk_bf16_f32 v246, v240, v241
    v_cvt_pk_bf16_f32 v247, v242, v243
    v_mfma_f32_16x16x32_bf16 a[164:167], a[228:231], v[104:107], a[164:167]
    s_mov_b32 s48, 16384
    buffer_store_dwordx4 v[244:247], v7, s[28:31], s48 offen offset:0 sc1
    v_mfma_f32_16x16x32_bf16 a[180:183], a[228:231], v[120:123], a[180:183]
    v_accvgpr_read_b32 v236, a24
    v_accvgpr_read_b32 v237, a25
    v_mfma_f32_16x16x32_bf16 a[104:107], a[232:235], v[40:43], a[104:107]
    v_accvgpr_read_b32 v238, a26
    v_accvgpr_read_b32 v239, a27
    v_mfma_f32_16x16x32_bf16 a[120:123], a[232:235], v[56:59], a[120:123]
    v_accvgpr_read_b32 v240, a28
    v_accvgpr_read_b32 v241, a29
    v_mfma_f32_16x16x32_bf16 a[136:139], a[232:235], v[72:75], a[136:139]
    v_accvgpr_read_b32 v242, a30
    v_accvgpr_read_b32 v243, a31
    v_mfma_f32_16x16x32_bf16 a[152:155], a[232:235], v[88:91], a[152:155]
    v_cvt_pk_bf16_f32 v248, v236, v237
    v_cvt_pk_bf16_f32 v249, v238, v239
    v_mfma_f32_16x16x32_bf16 a[168:171], a[232:235], v[104:107], a[168:171]
    v_mfma_f32_16x16x32_bf16 a[184:187], a[232:235], v[120:123], a[184:187]
    v_cvt_pk_bf16_f32 v250, v240, v241
    v_cvt_pk_bf16_f32 v251, v242, v243
    v_mfma_f32_16x16x32_bf16 a[108:111], a[236:239], v[40:43], a[108:111]
    s_mov_b32 s48, 16384
    v_mfma_f32_16x16x32_bf16 a[124:127], a[236:239], v[56:59], a[124:127]
    buffer_store_dwordx4 v[248:251], v7, s[28:31], s48 offen offset:1024 sc1
    v_mfma_f32_16x16x32_bf16 a[140:143], a[236:239], v[72:75], a[140:143]
    v_mfma_f32_16x16x32_bf16 a[156:159], a[236:239], v[88:91], a[156:159]
    v_mfma_f32_16x16x32_bf16 a[172:175], a[236:239], v[104:107], a[172:175]
    v_mfma_f32_16x16x32_bf16 a[188:191], a[236:239], v[120:123], a[188:191]
    s_waitcnt lgkmcnt(0)
    s_waitcnt vmcnt(28)
    s_barrier
    v_mfma_f32_16x16x32_bf16 a[96:99], a[240:243], v[44:47], a[96:99]
    ds_read_b64_tr_b16 a[192:193], v228 offset:32768
    ds_read_b64_tr_b16 a[194:195], v228 offset:34816
    v_mfma_f32_16x16x32_bf16 a[112:115], a[240:243], v[60:63], a[112:115]
    v_accvgpr_read_b32 v236, a32
    v_accvgpr_read_b32 v237, a33
    v_mfma_f32_16x16x32_bf16 a[128:131], a[240:243], v[76:79], a[128:131]
    v_accvgpr_read_b32 v238, a34
    v_accvgpr_read_b32 v239, a35
    v_mfma_f32_16x16x32_bf16 a[144:147], a[240:243], v[92:95], a[144:147]
    ds_read_b64_tr_b16 a[196:197], v229 offset:32768
    ds_read_b64_tr_b16 a[198:199], v229 offset:34816
    v_mfma_f32_16x16x32_bf16 a[160:163], a[240:243], v[108:111], a[160:163]
    v_accvgpr_read_b32 v240, a36
    v_accvgpr_read_b32 v241, a37
    v_mfma_f32_16x16x32_bf16 a[176:179], a[240:243], v[124:127], a[176:179]
    s_add_u32 m0, s52, 49152
    ds_read_b64_tr_b16 a[200:201], v230 offset:32768
    ds_read_b64_tr_b16 a[202:203], v230 offset:34816
    v_mfma_f32_16x16x32_bf16 a[100:103], a[244:247], v[44:47], a[100:103]
    s_add_u32 s46, s50, 65920
    v_accvgpr_read_b32 v242, a38
    v_accvgpr_read_b32 v243, a39
    v_mfma_f32_16x16x32_bf16 a[116:119], a[244:247], v[60:63], a[116:119]
    buffer_load_dwordx4 v27, s[20:23], s46 offen  lds
    v_mfma_f32_16x16x32_bf16 a[132:135], a[244:247], v[76:79], a[132:135]
    v_cvt_pk_bf16_f32 v244, v236, v237
    v_cvt_pk_bf16_f32 v245, v238, v239
    v_mfma_f32_16x16x32_bf16 a[148:151], a[244:247], v[92:95], a[148:151]
    ds_read_b64_tr_b16 a[204:205], v231 offset:32768
    ds_read_b64_tr_b16 a[206:207], v231 offset:34816
    v_mfma_f32_16x16x32_bf16 a[164:167], a[244:247], v[108:111], a[164:167]
    s_add_u32 m0, s52, 50176
    v_cvt_pk_bf16_f32 v246, v240, v241
    v_cvt_pk_bf16_f32 v247, v242, v243
    v_mfma_f32_16x16x32_bf16 a[180:183], a[244:247], v[124:127], a[180:183]
    s_add_u32 s46, s50, 74112
    s_mov_b32 s48, 32768
    buffer_store_dwordx4 v[244:247], v7, s[28:31], s48 offen offset:0 sc1
    v_mfma_f32_16x16x32_bf16 a[104:107], a[248:251], v[44:47], a[104:107]
    buffer_load_dwordx4 v27, s[20:23], s46 offen  lds
    v_mfma_f32_16x16x32_bf16 a[120:123], a[248:251], v[60:63], a[120:123]
    v_accvgpr_read_b32 v236, a40
    v_accvgpr_read_b32 v237, a41
    v_mfma_f32_16x16x32_bf16 a[136:139], a[248:251], v[76:79], a[136:139]
    s_add_u32 m0, s52, 51200
    v_accvgpr_read_b32 v238, a42
    v_accvgpr_read_b32 v239, a43
    v_mfma_f32_16x16x32_bf16 a[152:155], a[248:251], v[92:95], a[152:155]
    s_add_u32 s46, s50, 82304
    v_accvgpr_read_b32 v240, a44
    v_accvgpr_read_b32 v241, a45
    v_mfma_f32_16x16x32_bf16 a[168:171], a[248:251], v[108:111], a[168:171]
    buffer_load_dwordx4 v27, s[20:23], s46 offen  lds
    v_mfma_f32_16x16x32_bf16 a[184:187], a[248:251], v[124:127], a[184:187]
    s_add_u32 m0, s52, 52224
    v_accvgpr_read_b32 v242, a46
    v_accvgpr_read_b32 v243, a47
    v_mfma_f32_16x16x32_bf16 a[108:111], a[252:255], v[44:47], a[108:111]
    s_add_u32 s46, s50, 90496
    v_cvt_pk_bf16_f32 v248, v236, v237
    v_cvt_pk_bf16_f32 v249, v238, v239
    v_mfma_f32_16x16x32_bf16 a[124:127], a[252:255], v[60:63], a[124:127]
    buffer_load_dwordx4 v27, s[20:23], s46 offen  lds
    v_mfma_f32_16x16x32_bf16 a[140:143], a[252:255], v[76:79], a[140:143]
    v_cvt_pk_bf16_f32 v250, v240, v241
    v_cvt_pk_bf16_f32 v251, v242, v243
    v_mfma_f32_16x16x32_bf16 a[156:159], a[252:255], v[92:95], a[156:159]
    s_mov_b32 s48, 32768
    buffer_store_dwordx4 v[248:251], v7, s[28:31], s48 offen offset:1024 sc1
    v_mfma_f32_16x16x32_bf16 a[172:175], a[252:255], v[108:111], a[172:175]
    v_mfma_f32_16x16x32_bf16 a[188:191], a[252:255], v[124:127], a[188:191]
    s_waitcnt lgkmcnt(0)
    v_mfma_f32_16x16x32_bf16 a[96:99], a[192:195], v[128:131], a[96:99]
    ds_read_b64_tr_b16 a[208:209], v228 offset:36864
    ds_read_b64_tr_b16 a[210:211], v228 offset:38912
    v_mfma_f32_16x16x32_bf16 a[112:115], a[192:195], v[144:147], a[112:115]
    v_accvgpr_read_b32 v236, a48
    v_accvgpr_read_b32 v237, a49
    v_mfma_f32_16x16x32_bf16 a[128:131], a[192:195], v[160:163], a[128:131]
    v_accvgpr_read_b32 v238, a50
    v_accvgpr_read_b32 v239, a51
    v_mfma_f32_16x16x32_bf16 a[144:147], a[192:195], v[176:179], a[144:147]
    ds_read_b64_tr_b16 a[212:213], v229 offset:36864
    ds_read_b64_tr_b16 a[214:215], v229 offset:38912
    v_mfma_f32_16x16x32_bf16 a[160:163], a[192:195], v[192:195], a[160:163]
    v_accvgpr_read_b32 v240, a52
    v_accvgpr_read_b32 v241, a53
    v_mfma_f32_16x16x32_bf16 a[176:179], a[192:195], v[208:211], a[176:179]
    ds_read_b64_tr_b16 a[216:217], v230 offset:36864
    ds_read_b64_tr_b16 a[218:219], v230 offset:38912
    v_mfma_f32_16x16x32_bf16 a[100:103], a[196:199], v[128:131], a[100:103]
    v_accvgpr_read_b32 v242, a54
    v_accvgpr_read_b32 v243, a55
    v_mfma_f32_16x16x32_bf16 a[116:119], a[196:199], v[144:147], a[116:119]
    v_cvt_pk_bf16_f32 v244, v236, v237
    v_cvt_pk_bf16_f32 v245, v238, v239
    v_mfma_f32_16x16x32_bf16 a[132:135], a[196:199], v[160:163], a[132:135]
    ds_read_b64_tr_b16 a[220:221], v231 offset:36864
    ds_read_b64_tr_b16 a[222:223], v231 offset:38912
    v_mfma_f32_16x16x32_bf16 a[148:151], a[196:199], v[176:179], a[148:151]
    v_cvt_pk_bf16_f32 v246, v240, v241
    v_cvt_pk_bf16_f32 v247, v242, v243
    v_mfma_f32_16x16x32_bf16 a[164:167], a[196:199], v[192:195], a[164:167]
    s_mov_b32 s48, 49152
    buffer_store_dwordx4 v[244:247], v7, s[28:31], s48 offen offset:0 sc1
    v_mfma_f32_16x16x32_bf16 a[180:183], a[196:199], v[208:211], a[180:183]
    v_accvgpr_read_b32 v236, a56
    v_accvgpr_read_b32 v237, a57
    v_mfma_f32_16x16x32_bf16 a[104:107], a[200:203], v[128:131], a[104:107]
    v_accvgpr_read_b32 v238, a58
    v_accvgpr_read_b32 v239, a59
    v_mfma_f32_16x16x32_bf16 a[120:123], a[200:203], v[144:147], a[120:123]
    v_accvgpr_read_b32 v240, a60
    v_accvgpr_read_b32 v241, a61
    v_mfma_f32_16x16x32_bf16 a[136:139], a[200:203], v[160:163], a[136:139]
    v_accvgpr_read_b32 v242, a62
    v_accvgpr_read_b32 v243, a63
    v_mfma_f32_16x16x32_bf16 a[152:155], a[200:203], v[176:179], a[152:155]
    v_cvt_pk_bf16_f32 v248, v236, v237
    v_cvt_pk_bf16_f32 v249, v238, v239
    v_mfma_f32_16x16x32_bf16 a[168:171], a[200:203], v[192:195], a[168:171]
    v_mfma_f32_16x16x32_bf16 a[184:187], a[200:203], v[208:211], a[184:187]
    v_cvt_pk_bf16_f32 v250, v240, v241
    v_cvt_pk_bf16_f32 v251, v242, v243
    v_mfma_f32_16x16x32_bf16 a[108:111], a[204:207], v[128:131], a[108:111]
    s_mov_b32 s48, 49152
    v_mfma_f32_16x16x32_bf16 a[124:127], a[204:207], v[144:147], a[124:127]
    buffer_store_dwordx4 v[248:251], v7, s[28:31], s48 offen offset:1024 sc1
    v_mfma_f32_16x16x32_bf16 a[140:143], a[204:207], v[160:163], a[140:143]
    v_mfma_f32_16x16x32_bf16 a[156:159], a[204:207], v[176:179], a[156:159]
    v_mfma_f32_16x16x32_bf16 a[172:175], a[204:207], v[192:195], a[172:175]
    v_mfma_f32_16x16x32_bf16 a[188:191], a[204:207], v[208:211], a[188:191]
    s_waitcnt lgkmcnt(0)
    s_waitcnt vmcnt(32)
    s_barrier
    v_mfma_f32_16x16x32_bf16 a[96:99], a[208:211], v[132:135], a[96:99]
    ds_read_b64_tr_b16 a[224:225], v228 offset:49152
    ds_read_b64_tr_b16 a[226:227], v228 offset:51200
    v_mfma_f32_16x16x32_bf16 a[112:115], a[208:211], v[148:151], a[112:115]
    v_accvgpr_read_b32 v236, a64
    v_accvgpr_read_b32 v237, a65
    v_mfma_f32_16x16x32_bf16 a[128:131], a[208:211], v[164:167], a[128:131]
    v_accvgpr_read_b32 v238, a66
    v_accvgpr_read_b32 v239, a67
    v_mfma_f32_16x16x32_bf16 a[144:147], a[208:211], v[180:183], a[144:147]
    ds_read_b64_tr_b16 a[228:229], v229 offset:49152
    ds_read_b64_tr_b16 a[230:231], v229 offset:51200
    v_mfma_f32_16x16x32_bf16 a[160:163], a[208:211], v[196:199], a[160:163]
    v_accvgpr_read_b32 v240, a68
    v_accvgpr_read_b32 v241, a69
    v_mfma_f32_16x16x32_bf16 a[176:179], a[208:211], v[212:215], a[176:179]
    s_add_u32 m0, s52, 65536
    ds_read_b64_tr_b16 a[232:233], v230 offset:49152
    ds_read_b64_tr_b16 a[234:235], v230 offset:51200
    v_mfma_f32_16x16x32_bf16 a[100:103], a[212:215], v[132:135], a[100:103]
    s_add_u32 s46, s51, 384
    v_accvgpr_read_b32 v242, a70
    v_accvgpr_read_b32 v243, a71
    v_mfma_f32_16x16x32_bf16 a[116:119], a[212:215], v[148:151], a[116:119]
    buffer_load_dwordx4 v27, s[20:23], s46 offen  lds
    v_mfma_f32_16x16x32_bf16 a[132:135], a[212:215], v[164:167], a[132:135]
    v_cvt_pk_bf16_f32 v244, v236, v237
    v_cvt_pk_bf16_f32 v245, v238, v239
    v_mfma_f32_16x16x32_bf16 a[148:151], a[212:215], v[180:183], a[148:151]
    ds_read_b64_tr_b16 a[236:237], v231 offset:49152
    ds_read_b64_tr_b16 a[238:239], v231 offset:51200
    v_mfma_f32_16x16x32_bf16 a[164:167], a[212:215], v[196:199], a[164:167]
    s_add_u32 m0, s52, 66560
    v_cvt_pk_bf16_f32 v246, v240, v241
    v_cvt_pk_bf16_f32 v247, v242, v243
    v_mfma_f32_16x16x32_bf16 a[180:183], a[212:215], v[212:215], a[180:183]
    s_add_u32 s46, s51, 8576
    s_mov_b32 s48, 65536
    buffer_store_dwordx4 v[244:247], v7, s[28:31], s48 offen offset:0 sc1
    v_mfma_f32_16x16x32_bf16 a[104:107], a[216:219], v[132:135], a[104:107]
    buffer_load_dwordx4 v27, s[20:23], s46 offen  lds
    v_mfma_f32_16x16x32_bf16 a[120:123], a[216:219], v[148:151], a[120:123]
    v_accvgpr_read_b32 v236, a72
    v_accvgpr_read_b32 v237, a73
    v_mfma_f32_16x16x32_bf16 a[136:139], a[216:219], v[164:167], a[136:139]
    s_add_u32 m0, s52, 67584
    v_accvgpr_read_b32 v238, a74
    v_accvgpr_read_b32 v239, a75
    v_mfma_f32_16x16x32_bf16 a[152:155], a[216:219], v[180:183], a[152:155]
    s_add_u32 s46, s51, 16768
    v_accvgpr_read_b32 v240, a76
    v_accvgpr_read_b32 v241, a77
    v_mfma_f32_16x16x32_bf16 a[168:171], a[216:219], v[196:199], a[168:171]
    buffer_load_dwordx4 v27, s[20:23], s46 offen  lds
    v_mfma_f32_16x16x32_bf16 a[184:187], a[216:219], v[212:215], a[184:187]
    s_add_u32 m0, s52, 68608
    v_accvgpr_read_b32 v242, a78
    v_accvgpr_read_b32 v243, a79
    v_mfma_f32_16x16x32_bf16 a[108:111], a[220:223], v[132:135], a[108:111]
    s_add_u32 s46, s51, 24960
    v_cvt_pk_bf16_f32 v248, v236, v237
    v_cvt_pk_bf16_f32 v249, v238, v239
    v_mfma_f32_16x16x32_bf16 a[124:127], a[220:223], v[148:151], a[124:127]
    buffer_load_dwordx4 v27, s[20:23], s46 offen  lds
    v_mfma_f32_16x16x32_bf16 a[140:143], a[220:223], v[164:167], a[140:143]
    v_cvt_pk_bf16_f32 v250, v240, v241
    v_cvt_pk_bf16_f32 v251, v242, v243
    v_mfma_f32_16x16x32_bf16 a[156:159], a[220:223], v[180:183], a[156:159]
    s_mov_b32 s48, 65536
    buffer_store_dwordx4 v[248:251], v7, s[28:31], s48 offen offset:1024 sc1
    v_mfma_f32_16x16x32_bf16 a[172:175], a[220:223], v[196:199], a[172:175]
    v_mfma_f32_16x16x32_bf16 a[188:191], a[220:223], v[212:215], a[188:191]
    s_waitcnt lgkmcnt(0)
    v_mfma_f32_16x16x32_bf16 a[96:99], a[224:227], v[136:139], a[96:99]
    ds_read_b64_tr_b16 a[240:241], v228 offset:53248
    ds_read_b64_tr_b16 a[242:243], v228 offset:55296
    v_mfma_f32_16x16x32_bf16 a[112:115], a[224:227], v[152:155], a[112:115]
    v_accvgpr_read_b32 v236, a80
    v_accvgpr_read_b32 v237, a81
    v_mfma_f32_16x16x32_bf16 a[128:131], a[224:227], v[168:171], a[128:131]
    v_accvgpr_read_b32 v238, a82
    v_accvgpr_read_b32 v239, a83
    v_mfma_f32_16x16x32_bf16 a[144:147], a[224:227], v[184:187], a[144:147]
    ds_read_b64_tr_b16 a[244:245], v229 offset:53248
    ds_read_b64_tr_b16 a[246:247], v229 offset:55296
    v_mfma_f32_16x16x32_bf16 a[160:163], a[224:227], v[200:203], a[160:163]
    v_accvgpr_read_b32 v240, a84
    v_accvgpr_read_b32 v241, a85
    v_mfma_f32_16x16x32_bf16 a[176:179], a[224:227], v[216:219], a[176:179]
    ds_read_b64_tr_b16 a[248:249], v230 offset:53248
    ds_read_b64_tr_b16 a[250:251], v230 offset:55296
    v_mfma_f32_16x16x32_bf16 a[100:103], a[228:231], v[136:139], a[100:103]
    v_accvgpr_read_b32 v242, a86
    v_accvgpr_read_b32 v243, a87
    v_mfma_f32_16x16x32_bf16 a[116:119], a[228:231], v[152:155], a[116:119]
    v_cvt_pk_bf16_f32 v244, v236, v237
    v_cvt_pk_bf16_f32 v245, v238, v239
    v_mfma_f32_16x16x32_bf16 a[132:135], a[228:231], v[168:171], a[132:135]
    ds_read_b64_tr_b16 a[252:253], v231 offset:53248
    ds_read_b64_tr_b16 a[254:255], v231 offset:55296
    v_mfma_f32_16x16x32_bf16 a[148:151], a[228:231], v[184:187], a[148:151]
    v_cvt_pk_bf16_f32 v246, v240, v241
    v_cvt_pk_bf16_f32 v247, v242, v243
    v_mfma_f32_16x16x32_bf16 a[164:167], a[228:231], v[200:203], a[164:167]
    s_mov_b32 s48, 81920
    buffer_store_dwordx4 v[244:247], v7, s[28:31], s48 offen offset:0 sc1
    v_mfma_f32_16x16x32_bf16 a[180:183], a[228:231], v[216:219], a[180:183]
    v_accvgpr_read_b32 v236, a88
    v_accvgpr_read_b32 v237, a89
    v_mfma_f32_16x16x32_bf16 a[104:107], a[232:235], v[136:139], a[104:107]
    v_accvgpr_read_b32 v238, a90
    v_accvgpr_read_b32 v239, a91
    v_mfma_f32_16x16x32_bf16 a[120:123], a[232:235], v[152:155], a[120:123]
    v_accvgpr_read_b32 v240, a92
    v_accvgpr_read_b32 v241, a93
    v_mfma_f32_16x16x32_bf16 a[136:139], a[232:235], v[168:171], a[136:139]
    v_accvgpr_read_b32 v242, a94
    v_accvgpr_read_b32 v243, a95
    v_mfma_f32_16x16x32_bf16 a[152:155], a[232:235], v[184:187], a[152:155]
    v_cvt_pk_bf16_f32 v248, v236, v237
    v_cvt_pk_bf16_f32 v249, v238, v239
    v_mfma_f32_16x16x32_bf16 a[168:171], a[232:235], v[200:203], a[168:171]
    v_mfma_f32_16x16x32_bf16 a[184:187], a[232:235], v[216:219], a[184:187]
    v_cvt_pk_bf16_f32 v250, v240, v241
    v_cvt_pk_bf16_f32 v251, v242, v243
    v_mfma_f32_16x16x32_bf16 a[108:111], a[236:239], v[136:139], a[108:111]
    s_mov_b32 s48, 81920
    v_mfma_f32_16x16x32_bf16 a[124:127], a[236:239], v[152:155], a[124:127]
    buffer_store_dwordx4 v[248:251], v7, s[28:31], s48 offen offset:1024 sc1
    v_mfma_f32_16x16x32_bf16 a[140:143], a[236:239], v[168:171], a[140:143]
    v_mfma_f32_16x16x32_bf16 a[156:159], a[236:239], v[184:187], a[156:159]
    v_mfma_f32_16x16x32_bf16 a[172:175], a[236:239], v[200:203], a[172:175]
    v_mfma_f32_16x16x32_bf16 a[188:191], a[236:239], v[216:219], a[188:191]
    s_waitcnt lgkmcnt(0)
    s_waitcnt vmcnt(36)
    s_barrier
    v_mfma_f32_16x16x32_bf16 a[96:99], a[240:243], v[140:143], a[96:99]
    ds_read_b64_tr_b16 a[192:193], v232 offset:0
    ds_read_b64_tr_b16 a[194:195], v232 offset:2048
    v_mfma_f32_16x16x32_bf16 a[112:115], a[240:243], v[156:159], a[112:115]
    s_add_u32 m0, s52, 81920
    ds_read_b64_tr_b16 a[196:197], v233 offset:0
    ds_read_b64_tr_b16 a[198:199], v233 offset:2048
    v_mfma_f32_16x16x32_bf16 a[128:131], a[240:243], v[172:175], a[128:131]
    s_add_u32 s46, s51, 65920
    ds_read_b64_tr_b16 a[200:201], v234 offset:0
    ds_read_b64_tr_b16 a[202:203], v234 offset:2048
    v_mfma_f32_16x16x32_bf16 a[144:147], a[240:243], v[188:191], a[144:147]
    buffer_load_dwordx4 v27, s[20:23], s46 offen  lds
    v_mfma_f32_16x16x32_bf16 a[160:163], a[240:243], v[204:207], a[160:163]
    ds_read_b64_tr_b16 a[204:205], v235 offset:0
    ds_read_b64_tr_b16 a[206:207], v235 offset:2048
    v_mfma_f32_16x16x32_bf16 a[176:179], a[240:243], v[220:223], a[176:179]
    v_mfma_f32_16x16x32_bf16 a[100:103], a[244:247], v[140:143], a[100:103]
    s_add_u32 m0, s52, 82944
    v_mfma_f32_16x16x32_bf16 a[116:119], a[244:247], v[156:159], a[116:119]
    s_add_u32 s46, s51, 74112
    v_mfma_f32_16x16x32_bf16 a[132:135], a[244:247], v[172:175], a[132:135]
    buffer_load_dwordx4 v27, s[20:23], s46 offen  lds
    v_mfma_f32_16x16x32_bf16 a[148:151], a[244:247], v[188:191], a[148:151]
    v_mfma_f32_16x16x32_bf16 a[164:167], a[244:247], v[204:207], a[164:167]
    s_add_u32 m0, s52, 83968
    v_mfma_f32_16x16x32_bf16 a[180:183], a[244:247], v[220:223], a[180:183]
    s_add_u32 s46, s51, 82304
    v_mfma_f32_16x16x32_bf16 a[104:107], a[248:251], v[140:143], a[104:107]
    buffer_load_dwordx4 v27, s[20:23], s46 offen  lds
    v_mfma_f32_16x16x32_bf16 a[120:123], a[248:251], v[156:159], a[120:123]
    v_mfma_f32_16x16x32_bf16 a[136:139], a[248:251], v[172:175], a[136:139]
    v_mfma_f32_16x16x32_bf16 a[152:155], a[248:251], v[188:191], a[152:155]
    s_add_u32 m0, s52, 84992
    v_mfma_f32_16x16x32_bf16 a[168:171], a[248:251], v[204:207], a[168:171]
    s_add_u32 s46, s51, 90496
    v_mfma_f32_16x16x32_bf16 a[184:187], a[248:251], v[220:223], a[184:187]
    buffer_load_dwordx4 v27, s[20:23], s46 offen  lds
    v_mfma_f32_16x16x32_bf16 a[108:111], a[252:255], v[140:143], a[108:111]
    v_mfma_f32_16x16x32_bf16 a[124:127], a[252:255], v[156:159], a[124:127]
    v_mfma_f32_16x16x32_bf16 a[140:143], a[252:255], v[172:175], a[140:143]
    v_mfma_f32_16x16x32_bf16 a[156:159], a[252:255], v[188:191], a[156:159]
    v_mfma_f32_16x16x32_bf16 a[172:175], a[252:255], v[204:207], a[172:175]
    v_mfma_f32_16x16x32_bf16 a[188:191], a[252:255], v[220:223], a[188:191]
    s_waitcnt lgkmcnt(0)
    v_mfma_f32_16x16x32_bf16 a[0:3], a[192:195], v[32:35], 0
    ds_read_b64_tr_b16 a[208:209], v232 offset:4096
    ds_read_b64_tr_b16 a[210:211], v232 offset:6144
    v_mfma_f32_16x16x32_bf16 a[16:19], a[192:195], v[48:51], 0
    ds_read_b64_tr_b16 a[212:213], v233 offset:4096
    ds_read_b64_tr_b16 a[214:215], v233 offset:6144
    v_mfma_f32_16x16x32_bf16 a[32:35], a[192:195], v[64:67], 0
    ds_read_b64_tr_b16 a[216:217], v234 offset:4096
    ds_read_b64_tr_b16 a[218:219], v234 offset:6144
    v_mfma_f32_16x16x32_bf16 a[48:51], a[192:195], v[80:83], 0
    v_mfma_f32_16x16x32_bf16 a[64:67], a[192:195], v[96:99], 0
    ds_read_b64_tr_b16 a[220:221], v235 offset:4096
    ds_read_b64_tr_b16 a[222:223], v235 offset:6144
    v_mfma_f32_16x16x32_bf16 a[80:83], a[192:195], v[112:115], 0
    v_mfma_f32_16x16x32_bf16 a[4:7], a[196:199], v[32:35], 0
    v_mfma_f32_16x16x32_bf16 a[20:23], a[196:199], v[48:51], 0
    v_mfma_f32_16x16x32_bf16 a[36:39], a[196:199], v[64:67], 0
    v_mfma_f32_16x16x32_bf16 a[52:55], a[196:199], v[80:83], 0
    v_mfma_f32_16x16x32_bf16 a[68:71], a[196:199], v[96:99], 0
    v_mfma_f32_16x16x32_bf16 a[84:87], a[196:199], v[112:115], 0
    v_mfma_f32_16x16x32_bf16 a[8:11], a[200:203], v[32:35], 0
    v_mfma_f32_16x16x32_bf16 a[24:27], a[200:203], v[48:51], 0
    v_mfma_f32_16x16x32_bf16 a[40:43], a[200:203], v[64:67], 0
    v_mfma_f32_16x16x32_bf16 a[56:59], a[200:203], v[80:83], 0
    v_mfma_f32_16x16x32_bf16 a[72:75], a[200:203], v[96:99], 0
    v_mfma_f32_16x16x32_bf16 a[88:91], a[200:203], v[112:115], 0
    v_mfma_f32_16x16x32_bf16 a[12:15], a[204:207], v[32:35], 0
    v_mfma_f32_16x16x32_bf16 a[28:31], a[204:207], v[48:51], 0
    v_mfma_f32_16x16x32_bf16 a[44:47], a[204:207], v[64:67], 0
    v_mfma_f32_16x16x32_bf16 a[60:63], a[204:207], v[80:83], 0
    v_mfma_f32_16x16x32_bf16 a[76:79], a[204:207], v[96:99], 0
    v_mfma_f32_16x16x32_bf16 a[92:95], a[204:207], v[112:115], 0
    s_waitcnt lgkmcnt(0)
    s_waitcnt vmcnt(36)
    s_barrier
    v_mfma_f32_16x16x32_bf16 a[0:3], a[208:211], v[36:39], a[0:3]
    ds_read_b64_tr_b16 a[224:225], v232 offset:16384
    ds_read_b64_tr_b16 a[226:227], v232 offset:18432
    v_mfma_f32_16x16x32_bf16 a[16:19], a[208:211], v[52:55], a[16:19]
    v_accvgpr_read_b32 v236, a96
    v_accvgpr_read_b32 v237, a97
    v_mfma_f32_16x16x32_bf16 a[32:35], a[208:211], v[68:71], a[32:35]
    v_accvgpr_read_b32 v238, a98
    v_accvgpr_read_b32 v239, a99
    v_mfma_f32_16x16x32_bf16 a[48:51], a[208:211], v[84:87], a[48:51]
    ds_read_b64_tr_b16 a[228:229], v233 offset:16384
    ds_read_b64_tr_b16 a[230:231], v233 offset:18432
    v_mfma_f32_16x16x32_bf16 a[64:67], a[208:211], v[100:103], a[64:67]
    v_accvgpr_read_b32 v240, a100
    v_accvgpr_read_b32 v241, a101
    v_mfma_f32_16x16x32_bf16 a[80:83], a[208:211], v[116:119], a[80:83]
    ds_read_b64_tr_b16 a[232:233], v234 offset:16384
    ds_read_b64_tr_b16 a[234:235], v234 offset:18432
    v_mfma_f32_16x16x32_bf16 a[4:7], a[212:215], v[36:39], a[4:7]
    v_accvgpr_read_b32 v242, a102
    v_accvgpr_read_b32 v243, a103
    v_mfma_f32_16x16x32_bf16 a[20:23], a[212:215], v[52:55], a[20:23]
    v_cvt_pk_bf16_f32 v244, v236, v237
    v_cvt_pk_bf16_f32 v245, v238, v239
    v_mfma_f32_16x16x32_bf16 a[36:39], a[212:215], v[68:71], a[36:39]
    ds_read_b64_tr_b16 a[236:237], v235 offset:16384
    ds_read_b64_tr_b16 a[238:239], v235 offset:18432
    v_mfma_f32_16x16x32_bf16 a[52:55], a[212:215], v[84:87], a[52:55]
    v_cvt_pk_bf16_f32 v246, v240, v241
    v_cvt_pk_bf16_f32 v247, v242, v243
    v_mfma_f32_16x16x32_bf16 a[68:71], a[212:215], v[100:103], a[68:71]
    s_mov_b32 s48, 2048
    buffer_store_dwordx4 v[244:247], v7, s[28:31], s48 offen offset:0 sc1
    v_mfma_f32_16x16x32_bf16 a[84:87], a[212:215], v[116:119], a[84:87]
    v_accvgpr_read_b32 v236, a104
    v_accvgpr_read_b32 v237, a105
    v_mfma_f32_16x16x32_bf16 a[8:11], a[216:219], v[36:39], a[8:11]
    v_accvgpr_read_b32 v238, a106
    v_accvgpr_read_b32 v239, a107
    v_mfma_f32_16x16x32_bf16 a[24:27], a[216:219], v[52:55], a[24:27]
    v_accvgpr_read_b32 v240, a108
    v_accvgpr_read_b32 v241, a109
    v_mfma_f32_16x16x32_bf16 a[40:43], a[216:219], v[68:71], a[40:43]
    v_accvgpr_read_b32 v242, a110
    v_accvgpr_read_b32 v243, a111
    v_mfma_f32_16x16x32_bf16 a[56:59], a[216:219], v[84:87], a[56:59]
    v_cvt_pk_bf16_f32 v248, v236, v237
    v_cvt_pk_bf16_f32 v249, v238, v239
    v_mfma_f32_16x16x32_bf16 a[72:75], a[216:219], v[100:103], a[72:75]
    v_mfma_f32_16x16x32_bf16 a[88:91], a[216:219], v[116:119], a[88:91]
    v_cvt_pk_bf16_f32 v250, v240, v241
    v_cvt_pk_bf16_f32 v251, v242, v243
    v_mfma_f32_16x16x32_bf16 a[12:15], a[220:223], v[36:39], a[12:15]
    s_mov_b32 s48, 2048
    v_mfma_f32_16x16x32_bf16 a[28:31], a[220:223], v[52:55], a[28:31]
    buffer_store_dwordx4 v[248:251], v7, s[28:31], s48 offen offset:1024 sc1
    v_mfma_f32_16x16x32_bf16 a[44:47], a[220:223], v[68:71], a[44:47]
    v_mfma_f32_16x16x32_bf16 a[60:63], a[220:223], v[84:87], a[60:63]
    v_mfma_f32_16x16x32_bf16 a[76:79], a[220:223], v[100:103], a[76:79]
    v_mfma_f32_16x16x32_bf16 a[92:95], a[220:223], v[116:119], a[92:95]
    s_waitcnt lgkmcnt(0)
    v_mfma_f32_16x16x32_bf16 a[0:3], a[224:227], v[40:43], a[0:3]
    ds_read_b64_tr_b16 a[240:241], v232 offset:20480
    ds_read_b64_tr_b16 a[242:243], v232 offset:22528
    v_mfma_f32_16x16x32_bf16 a[16:19], a[224:227], v[56:59], a[16:19]
    v_accvgpr_read_b32 v236, a112
    v_accvgpr_read_b32 v237, a113
    v_mfma_f32_16x16x32_bf16 a[32:35], a[224:227], v[72:75], a[32:35]
    v_accvgpr_read_b32 v238, a114
    v_accvgpr_read_b32 v239, a115
    v_mfma_f32_16x16x32_bf16 a[48:51], a[224:227], v[88:91], a[48:51]
    ds_read_b64_tr_b16 a[244:245], v233 offset:20480
    ds_read_b64_tr_b16 a[246:247], v233 offset:22528
    v_mfma_f32_16x16x32_bf16 a[64:67], a[224:227], v[104:107], a[64:67]
    v_accvgpr_read_b32 v240, a116
    v_accvgpr_read_b32 v241, a117
    v_mfma_f32_16x16x32_bf16 a[80:83], a[224:227], v[120:123], a[80:83]
    ds_read_b64_tr_b16 a[248:249], v234 offset:20480
    ds_read_b64_tr_b16 a[250:251], v234 offset:22528
    v_mfma_f32_16x16x32_bf16 a[4:7], a[228:231], v[40:43], a[4:7]
    v_accvgpr_read_b32 v242, a118
    v_accvgpr_read_b32 v243, a119
    v_mfma_f32_16x16x32_bf16 a[20:23], a[228:231], v[56:59], a[20:23]
    v_cvt_pk_bf16_f32 v244, v236, v237
    v_cvt_pk_bf16_f32 v245, v238, v239
    v_mfma_f32_16x16x32_bf16 a[36:39], a[228:231], v[72:75], a[36:39]
    ds_read_b64_tr_b16 a[252:253], v235 offset:20480
    ds_read_b64_tr_b16 a[254:255], v235 offset:22528
    v_mfma_f32_16x16x32_bf16 a[52:55], a[228:231], v[88:91], a[52:55]
    v_cvt_pk_bf16_f32 v246, v240, v241
    v_cvt_pk_bf16_f32 v247, v242, v243
    v_mfma_f32_16x16x32_bf16 a[68:71], a[228:231], v[104:107], a[68:71]
    s_mov_b32 s48, 18432
    buffer_store_dwordx4 v[244:247], v7, s[28:31], s48 offen offset:0 sc1
    v_mfma_f32_16x16x32_bf16 a[84:87], a[228:231], v[120:123], a[84:87]
    v_accvgpr_read_b32 v236, a120
    v_accvgpr_read_b32 v237, a121
    v_mfma_f32_16x16x32_bf16 a[8:11], a[232:235], v[40:43], a[8:11]
    v_accvgpr_read_b32 v238, a122
    v_accvgpr_read_b32 v239, a123
    v_mfma_f32_16x16x32_bf16 a[24:27], a[232:235], v[56:59], a[24:27]
    v_accvgpr_read_b32 v240, a124
    v_accvgpr_read_b32 v241, a125
    v_mfma_f32_16x16x32_bf16 a[40:43], a[232:235], v[72:75], a[40:43]
    v_accvgpr_read_b32 v242, a126
    v_accvgpr_read_b32 v243, a127
    v_mfma_f32_16x16x32_bf16 a[56:59], a[232:235], v[88:91], a[56:59]
    v_cvt_pk_bf16_f32 v248, v236, v237
    v_cvt_pk_bf16_f32 v249, v238, v239
    v_mfma_f32_16x16x32_bf16 a[72:75], a[232:235], v[104:107], a[72:75]
    v_mfma_f32_16x16x32_bf16 a[88:91], a[232:235], v[120:123], a[88:91]
    v_cvt_pk_bf16_f32 v250, v240, v241
    v_cvt_pk_bf16_f32 v251, v242, v243
    v_mfma_f32_16x16x32_bf16 a[12:15], a[236:239], v[40:43], a[12:15]
    s_mov_b32 s48, 18432
    v_mfma_f32_16x16x32_bf16 a[28:31], a[236:239], v[56:59], a[28:31]
    buffer_store_dwordx4 v[248:251], v7, s[28:31], s48 offen offset:1024 sc1
    v_mfma_f32_16x16x32_bf16 a[44:47], a[236:239], v[72:75], a[44:47]
    v_mfma_f32_16x16x32_bf16 a[60:63], a[236:239], v[88:91], a[60:63]
    v_mfma_f32_16x16x32_bf16 a[76:79], a[236:239], v[104:107], a[76:79]
    v_mfma_f32_16x16x32_bf16 a[92:95], a[236:239], v[120:123], a[92:95]
    s_waitcnt lgkmcnt(0)
    s_waitcnt vmcnt(36)
    s_barrier
    v_mfma_f32_16x16x32_bf16 a[0:3], a[240:243], v[44:47], a[0:3]
    ds_read_b64_tr_b16 a[192:193], v224 offset:0
    ds_read_b64_tr_b16 a[194:195], v224 offset:2048
    v_mfma_f32_16x16x32_bf16 a[16:19], a[240:243], v[60:63], a[16:19]
    v_accvgpr_read_b32 v236, a128
    v_accvgpr_read_b32 v237, a129
    v_mfma_f32_16x16x32_bf16 a[32:35], a[240:243], v[76:79], a[32:35]
    v_accvgpr_read_b32 v238, a130
    v_accvgpr_read_b32 v239, a131
    v_mfma_f32_16x16x32_bf16 a[48:51], a[240:243], v[92:95], a[48:51]
    ds_read_b64_tr_b16 a[196:197], v225 offset:0
    ds_read_b64_tr_b16 a[198:199], v225 offset:2048
    v_mfma_f32_16x16x32_bf16 a[64:67], a[240:243], v[108:111], a[64:67]
    v_accvgpr_read_b32 v240, a132
    v_accvgpr_read_b32 v241, a133
    v_mfma_f32_16x16x32_bf16 a[80:83], a[240:243], v[124:127], a[80:83]
    ds_read_b64_tr_b16 a[200:201], v226 offset:0
    ds_read_b64_tr_b16 a[202:203], v226 offset:2048
    v_mfma_f32_16x16x32_bf16 a[4:7], a[244:247], v[44:47], a[4:7]
    v_accvgpr_read_b32 v242, a134
    v_accvgpr_read_b32 v243, a135
    v_mfma_f32_16x16x32_bf16 a[20:23], a[244:247], v[60:63], a[20:23]
    v_cvt_pk_bf16_f32 v244, v236, v237
    v_cvt_pk_bf16_f32 v245, v238, v239
    v_mfma_f32_16x16x32_bf16 a[36:39], a[244:247], v[76:79], a[36:39]
    ds_read_b64_tr_b16 a[204:205], v227 offset:0
    ds_read_b64_tr_b16 a[206:207], v227 offset:2048
    v_mfma_f32_16x16x32_bf16 a[52:55], a[244:247], v[92:95], a[52:55]
    v_cvt_pk_bf16_f32 v246, v240, v241
    v_cvt_pk_bf16_f32 v247, v242, v243
    v_mfma_f32_16x16x32_bf16 a[68:71], a[244:247], v[108:111], a[68:71]
    s_mov_b32 s48, 34816
    buffer_store_dwordx4 v[244:247], v7, s[28:31], s48 offen offset:0 sc1
    v_mfma_f32_16x16x32_bf16 a[84:87], a[244:247], v[124:127], a[84:87]
    v_accvgpr_read_b32 v236, a136
    v_accvgpr_read_b32 v237, a137
    v_mfma_f32_16x16x32_bf16 a[8:11], a[248:251], v[44:47], a[8:11]
    v_accvgpr_read_b32 v238, a138
    v_accvgpr_read_b32 v239, a139
    v_mfma_f32_16x16x32_bf16 a[24:27], a[248:251], v[60:63], a[24:27]
    v_accvgpr_read_b32 v240, a140
    v_accvgpr_read_b32 v241, a141
    v_mfma_f32_16x16x32_bf16 a[40:43], a[248:251], v[76:79], a[40:43]
    v_accvgpr_read_b32 v242, a142
    v_accvgpr_read_b32 v243, a143
    v_mfma_f32_16x16x32_bf16 a[56:59], a[248:251], v[92:95], a[56:59]
    v_cvt_pk_bf16_f32 v248, v236, v237
    v_cvt_pk_bf16_f32 v249, v238, v239
    v_mfma_f32_16x16x32_bf16 a[72:75], a[248:251], v[108:111], a[72:75]
    v_mfma_f32_16x16x32_bf16 a[88:91], a[248:251], v[124:127], a[88:91]
    v_cvt_pk_bf16_f32 v250, v240, v241
    v_cvt_pk_bf16_f32 v251, v242, v243
    v_mfma_f32_16x16x32_bf16 a[12:15], a[252:255], v[44:47], a[12:15]
    s_mov_b32 s48, 34816
    v_mfma_f32_16x16x32_bf16 a[28:31], a[252:255], v[60:63], a[28:31]
    buffer_store_dwordx4 v[248:251], v7, s[28:31], s48 offen offset:1024 sc1
    v_mfma_f32_16x16x32_bf16 a[44:47], a[252:255], v[76:79], a[44:47]
    v_mfma_f32_16x16x32_bf16 a[60:63], a[252:255], v[92:95], a[60:63]
    v_mfma_f32_16x16x32_bf16 a[76:79], a[252:255], v[108:111], a[76:79]
    v_mfma_f32_16x16x32_bf16 a[92:95], a[252:255], v[124:127], a[92:95]
    s_waitcnt lgkmcnt(0)
    v_mfma_f32_16x16x32_bf16 a[0:3], a[192:195], v[128:131], a[0:3]
    ds_read_b64_tr_b16 a[208:209], v224 offset:4096
    ds_read_b64_tr_b16 a[210:211], v224 offset:6144
    v_mfma_f32_16x16x32_bf16 a[16:19], a[192:195], v[144:147], a[16:19]
    v_accvgpr_read_b32 v236, a144
    v_accvgpr_read_b32 v237, a145
    v_mfma_f32_16x16x32_bf16 a[32:35], a[192:195], v[160:163], a[32:35]
    v_accvgpr_read_b32 v238, a146
    v_accvgpr_read_b32 v239, a147
    v_mfma_f32_16x16x32_bf16 a[48:51], a[192:195], v[176:179], a[48:51]
    ds_read_b64_tr_b16 a[212:213], v225 offset:4096
    ds_read_b64_tr_b16 a[214:215], v225 offset:6144
    v_mfma_f32_16x16x32_bf16 a[64:67], a[192:195], v[192:195], a[64:67]
    v_accvgpr_read_b32 v240, a148
    v_accvgpr_read_b32 v241, a149
    v_mfma_f32_16x16x32_bf16 a[80:83], a[192:195], v[208:211], a[80:83]
    ds_read_b64_tr_b16 a[216:217], v226 offset:4096
    ds_read_b64_tr_b16 a[218:219], v226 offset:6144
    v_mfma_f32_16x16x32_bf16 a[4:7], a[196:199], v[128:131], a[4:7]
    v_accvgpr_read_b32 v242, a150
    v_accvgpr_read_b32 v243, a151
    v_mfma_f32_16x16x32_bf16 a[20:23], a[196:199], v[144:147], a[20:23]
    v_cvt_pk_bf16_f32 v244, v236, v237
    v_cvt_pk_bf16_f32 v245, v238, v239
    v_mfma_f32_16x16x32_bf16 a[36:39], a[196:199], v[160:163], a[36:39]
    ds_read_b64_tr_b16 a[220:221], v227 offset:4096
    ds_read_b64_tr_b16 a[222:223], v227 offset:6144
    v_mfma_f32_16x16x32_bf16 a[52:55], a[196:199], v[176:179], a[52:55]
    v_cvt_pk_bf16_f32 v246, v240, v241
    v_cvt_pk_bf16_f32 v247, v242, v243
    v_mfma_f32_16x16x32_bf16 a[68:71], a[196:199], v[192:195], a[68:71]
    s_mov_b32 s48, 51200
    buffer_store_dwordx4 v[244:247], v7, s[28:31], s48 offen offset:0 sc1
    v_mfma_f32_16x16x32_bf16 a[84:87], a[196:199], v[208:211], a[84:87]
    v_accvgpr_read_b32 v236, a152
    v_accvgpr_read_b32 v237, a153
    v_mfma_f32_16x16x32_bf16 a[8:11], a[200:203], v[128:131], a[8:11]
    v_accvgpr_read_b32 v238, a154
    v_accvgpr_read_b32 v239, a155
    v_mfma_f32_16x16x32_bf16 a[24:27], a[200:203], v[144:147], a[24:27]
    v_accvgpr_read_b32 v240, a156
    v_accvgpr_read_b32 v241, a157
    v_mfma_f32_16x16x32_bf16 a[40:43], a[200:203], v[160:163], a[40:43]
    v_accvgpr_read_b32 v242, a158
    v_accvgpr_read_b32 v243, a159
    v_mfma_f32_16x16x32_bf16 a[56:59], a[200:203], v[176:179], a[56:59]
    v_cvt_pk_bf16_f32 v248, v236, v237
    v_cvt_pk_bf16_f32 v249, v238, v239
    v_mfma_f32_16x16x32_bf16 a[72:75], a[200:203], v[192:195], a[72:75]
    v_mfma_f32_16x16x32_bf16 a[88:91], a[200:203], v[208:211], a[88:91]
    v_cvt_pk_bf16_f32 v250, v240, v241
    v_cvt_pk_bf16_f32 v251, v242, v243
    v_mfma_f32_16x16x32_bf16 a[12:15], a[204:207], v[128:131], a[12:15]
    s_mov_b32 s48, 51200
    v_mfma_f32_16x16x32_bf16 a[28:31], a[204:207], v[144:147], a[28:31]
    buffer_store_dwordx4 v[248:251], v7, s[28:31], s48 offen offset:1024 sc1
    v_mfma_f32_16x16x32_bf16 a[44:47], a[204:207], v[160:163], a[44:47]
    v_mfma_f32_16x16x32_bf16 a[60:63], a[204:207], v[176:179], a[60:63]
    v_mfma_f32_16x16x32_bf16 a[76:79], a[204:207], v[192:195], a[76:79]
    v_mfma_f32_16x16x32_bf16 a[92:95], a[204:207], v[208:211], a[92:95]
    s_waitcnt lgkmcnt(0)
    s_waitcnt vmcnt(36)
    s_barrier
    v_mfma_f32_16x16x32_bf16 a[0:3], a[208:211], v[132:135], a[0:3]
    ds_read_b64_tr_b16 a[224:225], v224 offset:16384
    ds_read_b64_tr_b16 a[226:227], v224 offset:18432
    v_mfma_f32_16x16x32_bf16 a[16:19], a[208:211], v[148:151], a[16:19]
    v_accvgpr_read_b32 v236, a160
    v_accvgpr_read_b32 v237, a161
    v_mfma_f32_16x16x32_bf16 a[32:35], a[208:211], v[164:167], a[32:35]
    v_accvgpr_read_b32 v238, a162
    v_accvgpr_read_b32 v239, a163
    v_mfma_f32_16x16x32_bf16 a[48:51], a[208:211], v[180:183], a[48:51]
    ds_read_b64_tr_b16 a[228:229], v225 offset:16384
    ds_read_b64_tr_b16 a[230:231], v225 offset:18432
    v_mfma_f32_16x16x32_bf16 a[64:67], a[208:211], v[196:199], a[64:67]
    v_accvgpr_read_b32 v240, a164
    v_accvgpr_read_b32 v241, a165
    v_mfma_f32_16x16x32_bf16 a[80:83], a[208:211], v[212:215], a[80:83]
    ds_read_b64_tr_b16 a[232:233], v226 offset:16384
    ds_read_b64_tr_b16 a[234:235], v226 offset:18432
    v_mfma_f32_16x16x32_bf16 a[4:7], a[212:215], v[132:135], a[4:7]
    v_accvgpr_read_b32 v242, a166
    v_accvgpr_read_b32 v243, a167
    v_mfma_f32_16x16x32_bf16 a[20:23], a[212:215], v[148:151], a[20:23]
    v_cvt_pk_bf16_f32 v244, v236, v237
    v_cvt_pk_bf16_f32 v245, v238, v239
    v_mfma_f32_16x16x32_bf16 a[36:39], a[212:215], v[164:167], a[36:39]
    ds_read_b64_tr_b16 a[236:237], v227 offset:16384
    ds_read_b64_tr_b16 a[238:239], v227 offset:18432
    v_mfma_f32_16x16x32_bf16 a[52:55], a[212:215], v[180:183], a[52:55]
    v_cvt_pk_bf16_f32 v246, v240, v241
    v_cvt_pk_bf16_f32 v247, v242, v243
    v_mfma_f32_16x16x32_bf16 a[68:71], a[212:215], v[196:199], a[68:71]
    s_mov_b32 s48, 67584
    buffer_store_dwordx4 v[244:247], v7, s[28:31], s48 offen offset:0 sc1
    v_mfma_f32_16x16x32_bf16 a[84:87], a[212:215], v[212:215], a[84:87]
    v_accvgpr_read_b32 v236, a168
    v_accvgpr_read_b32 v237, a169
    v_mfma_f32_16x16x32_bf16 a[8:11], a[216:219], v[132:135], a[8:11]
    v_accvgpr_read_b32 v238, a170
    v_accvgpr_read_b32 v239, a171
    v_mfma_f32_16x16x32_bf16 a[24:27], a[216:219], v[148:151], a[24:27]
    v_accvgpr_read_b32 v240, a172
    v_accvgpr_read_b32 v241, a173
    v_mfma_f32_16x16x32_bf16 a[40:43], a[216:219], v[164:167], a[40:43]
    v_accvgpr_read_b32 v242, a174
    v_accvgpr_read_b32 v243, a175
    v_mfma_f32_16x16x32_bf16 a[56:59], a[216:219], v[180:183], a[56:59]
    v_cvt_pk_bf16_f32 v248, v236, v237
    v_cvt_pk_bf16_f32 v249, v238, v239
    v_mfma_f32_16x16x32_bf16 a[72:75], a[216:219], v[196:199], a[72:75]
    v_mfma_f32_16x16x32_bf16 a[88:91], a[216:219], v[212:215], a[88:91]
    v_cvt_pk_bf16_f32 v250, v240, v241
    v_cvt_pk_bf16_f32 v251, v242, v243
    v_mfma_f32_16x16x32_bf16 a[12:15], a[220:223], v[132:135], a[12:15]
    s_mov_b32 s48, 67584
    v_mfma_f32_16x16x32_bf16 a[28:31], a[220:223], v[148:151], a[28:31]
    buffer_store_dwordx4 v[248:251], v7, s[28:31], s48 offen offset:1024 sc1
    v_mfma_f32_16x16x32_bf16 a[44:47], a[220:223], v[164:167], a[44:47]
    v_mfma_f32_16x16x32_bf16 a[60:63], a[220:223], v[180:183], a[60:63]
    v_mfma_f32_16x16x32_bf16 a[76:79], a[220:223], v[196:199], a[76:79]
    v_mfma_f32_16x16x32_bf16 a[92:95], a[220:223], v[212:215], a[92:95]
    s_waitcnt lgkmcnt(0)
    v_mfma_f32_16x16x32_bf16 a[0:3], a[224:227], v[136:139], a[0:3]
    ds_read_b64_tr_b16 a[240:241], v224 offset:20480
    ds_read_b64_tr_b16 a[242:243], v224 offset:22528
    v_mfma_f32_16x16x32_bf16 a[16:19], a[224:227], v[152:155], a[16:19]
    v_accvgpr_read_b32 v236, a176
    v_accvgpr_read_b32 v237, a177
    v_mfma_f32_16x16x32_bf16 a[32:35], a[224:227], v[168:171], a[32:35]
    v_accvgpr_read_b32 v238, a178
    v_accvgpr_read_b32 v239, a179
    v_mfma_f32_16x16x32_bf16 a[48:51], a[224:227], v[184:187], a[48:51]
    ds_read_b64_tr_b16 a[244:245], v225 offset:20480
    ds_read_b64_tr_b16 a[246:247], v225 offset:22528
    v_mfma_f32_16x16x32_bf16 a[64:67], a[224:227], v[200:203], a[64:67]
    v_accvgpr_read_b32 v240, a180
    v_accvgpr_read_b32 v241, a181
    v_mfma_f32_16x16x32_bf16 a[80:83], a[224:227], v[216:219], a[80:83]
    ds_read_b64_tr_b16 a[248:249], v226 offset:20480
    ds_read_b64_tr_b16 a[250:251], v226 offset:22528
    v_mfma_f32_16x16x32_bf16 a[4:7], a[228:231], v[136:139], a[4:7]
    v_accvgpr_read_b32 v242, a182
    v_accvgpr_read_b32 v243, a183
    v_mfma_f32_16x16x32_bf16 a[20:23], a[228:231], v[152:155], a[20:23]
    v_cvt_pk_bf16_f32 v244, v236, v237
    v_cvt_pk_bf16_f32 v245, v238, v239
    v_mfma_f32_16x16x32_bf16 a[36:39], a[228:231], v[168:171], a[36:39]
    ds_read_b64_tr_b16 a[252:253], v227 offset:20480
    ds_read_b64_tr_b16 a[254:255], v227 offset:22528
    v_mfma_f32_16x16x32_bf16 a[52:55], a[228:231], v[184:187], a[52:55]
    v_cvt_pk_bf16_f32 v246, v240, v241
    v_cvt_pk_bf16_f32 v247, v242, v243
    v_mfma_f32_16x16x32_bf16 a[68:71], a[228:231], v[200:203], a[68:71]
    s_mov_b32 s48, 83968
    buffer_store_dwordx4 v[244:247], v7, s[28:31], s48 offen offset:0 sc1
    v_mfma_f32_16x16x32_bf16 a[84:87], a[228:231], v[216:219], a[84:87]
    v_accvgpr_read_b32 v236, a184
    v_accvgpr_read_b32 v237, a185
    v_mfma_f32_16x16x32_bf16 a[8:11], a[232:235], v[136:139], a[8:11]
    v_accvgpr_read_b32 v238, a186
    v_accvgpr_read_b32 v239, a187
    v_mfma_f32_16x16x32_bf16 a[24:27], a[232:235], v[152:155], a[24:27]
    v_accvgpr_read_b32 v240, a188
    v_accvgpr_read_b32 v241, a189
    v_mfma_f32_16x16x32_bf16 a[40:43], a[232:235], v[168:171], a[40:43]
    v_accvgpr_read_b32 v242, a190
    v_accvgpr_read_b32 v243, a191
    v_mfma_f32_16x16x32_bf16 a[56:59], a[232:235], v[184:187], a[56:59]
    v_cvt_pk_bf16_f32 v248, v236, v237
    v_cvt_pk_bf16_f32 v249, v238, v239
    v_mfma_f32_16x16x32_bf16 a[72:75], a[232:235], v[200:203], a[72:75]
    v_mfma_f32_16x16x32_bf16 a[88:91], a[232:235], v[216:219], a[88:91]
    v_cvt_pk_bf16_f32 v250, v240, v241
    v_cvt_pk_bf16_f32 v251, v242, v243
    v_mfma_f32_16x16x32_bf16 a[12:15], a[236:239], v[136:139], a[12:15]
    s_mov_b32 s48, 83968
    v_mfma_f32_16x16x32_bf16 a[28:31], a[236:239], v[152:155], a[28:31]
    buffer_store_dwordx4 v[248:251], v7, s[28:31], s48 offen offset:1024 sc1
    v_mfma_f32_16x16x32_bf16 a[44:47], a[236:239], v[168:171], a[44:47]
    v_mfma_f32_16x16x32_bf16 a[60:63], a[236:239], v[184:187], a[60:63]
    v_mfma_f32_16x16x32_bf16 a[76:79], a[236:239], v[200:203], a[76:79]
    v_mfma_f32_16x16x32_bf16 a[92:95], a[236:239], v[216:219], a[92:95]
    s_waitcnt lgkmcnt(0)
    s_waitcnt vmcnt(35)
    s_barrier
    v_mfma_f32_16x16x32_bf16 a[0:3], a[240:243], v[140:143], a[0:3]
    ds_read_b64_tr_b16 a[192:193], v224 offset:32768
    ds_read_b64_tr_b16 a[194:195], v224 offset:34816
    v_mfma_f32_16x16x32_bf16 a[16:19], a[240:243], v[156:159], a[16:19]
    ds_read_b64_tr_b16 a[196:197], v225 offset:32768
    ds_read_b64_tr_b16 a[198:199], v225 offset:34816
    v_mfma_f32_16x16x32_bf16 a[32:35], a[240:243], v[172:175], a[32:35]
    ds_read_b64_tr_b16 a[200:201], v226 offset:32768
    ds_read_b64_tr_b16 a[202:203], v226 offset:34816
    v_mfma_f32_16x16x32_bf16 a[48:51], a[240:243], v[188:191], a[48:51]
    v_mfma_f32_16x16x32_bf16 a[64:67], a[240:243], v[204:207], a[64:67]
    ds_read_b64_tr_b16 a[204:205], v227 offset:32768
    ds_read_b64_tr_b16 a[206:207], v227 offset:34816
    v_mfma_f32_16x16x32_bf16 a[80:83], a[240:243], v[220:223], a[80:83]
    v_mfma_f32_16x16x32_bf16 a[4:7], a[244:247], v[140:143], a[4:7]
    v_mfma_f32_16x16x32_bf16 a[20:23], a[244:247], v[156:159], a[20:23]
    v_mfma_f32_16x16x32_bf16 a[36:39], a[244:247], v[172:175], a[36:39]
    v_mfma_f32_16x16x32_bf16 a[52:55], a[244:247], v[188:191], a[52:55]
    v_mfma_f32_16x16x32_bf16 a[68:71], a[244:247], v[204:207], a[68:71]
    v_mfma_f32_16x16x32_bf16 a[84:87], a[244:247], v[220:223], a[84:87]
    v_mfma_f32_16x16x32_bf16 a[8:11], a[248:251], v[140:143], a[8:11]
    v_mfma_f32_16x16x32_bf16 a[24:27], a[248:251], v[156:159], a[24:27]
    v_mfma_f32_16x16x32_bf16 a[40:43], a[248:251], v[172:175], a[40:43]
    v_mfma_f32_16x16x32_bf16 a[56:59], a[248:251], v[188:191], a[56:59]
    v_mfma_f32_16x16x32_bf16 a[72:75], a[248:251], v[204:207], a[72:75]
    v_mfma_f32_16x16x32_bf16 a[88:91], a[248:251], v[220:223], a[88:91]
    v_mfma_f32_16x16x32_bf16 a[12:15], a[252:255], v[140:143], a[12:15]
    v_mfma_f32_16x16x32_bf16 a[28:31], a[252:255], v[156:159], a[28:31]
    v_mfma_f32_16x16x32_bf16 a[44:47], a[252:255], v[172:175], a[44:47]
    v_mfma_f32_16x16x32_bf16 a[60:63], a[252:255], v[188:191], a[60:63]
    v_mfma_f32_16x16x32_bf16 a[76:79], a[252:255], v[204:207], a[76:79]
    v_mfma_f32_16x16x32_bf16 a[92:95], a[252:255], v[220:223], a[92:95]
    s_waitcnt lgkmcnt(0)
    v_mfma_f32_16x16x32_bf16 a[96:99], a[192:195], v[32:35], 0
    ds_read_b64_tr_b16 a[208:209], v224 offset:36864
    ds_read_b64_tr_b16 a[210:211], v224 offset:38912
    v_mfma_f32_16x16x32_bf16 a[112:115], a[192:195], v[48:51], 0
    ds_read_b64_tr_b16 a[212:213], v225 offset:36864
    ds_read_b64_tr_b16 a[214:215], v225 offset:38912
    v_mfma_f32_16x16x32_bf16 a[128:131], a[192:195], v[64:67], 0
    ds_read_b64_tr_b16 a[216:217], v226 offset:36864
    ds_read_b64_tr_b16 a[218:219], v226 offset:38912
    v_mfma_f32_16x16x32_bf16 a[144:147], a[192:195], v[80:83], 0
    v_mfma_f32_16x16x32_bf16 a[160:163], a[192:195], v[96:99], 0
    ds_read_b64_tr_b16 a[220:221], v227 offset:36864
    ds_read_b64_tr_b16 a[222:223], v227 offset:38912
    v_mfma_f32_16x16x32_bf16 a[176:179], a[192:195], v[112:115], 0
    v_mfma_f32_16x16x32_bf16 a[100:103], a[196:199], v[32:35], 0
    v_mfma_f32_16x16x32_bf16 a[116:119], a[196:199], v[48:51], 0
    v_mfma_f32_16x16x32_bf16 a[132:135], a[196:199], v[64:67], 0
    v_mfma_f32_16x16x32_bf16 a[148:151], a[196:199], v[80:83], 0
    v_mfma_f32_16x16x32_bf16 a[164:167], a[196:199], v[96:99], 0
    v_mfma_f32_16x16x32_bf16 a[180:183], a[196:199], v[112:115], 0
    v_mfma_f32_16x16x32_bf16 a[104:107], a[200:203], v[32:35], 0
    v_mfma_f32_16x16x32_bf16 a[120:123], a[200:203], v[48:51], 0
    v_mfma_f32_16x16x32_bf16 a[136:139], a[200:203], v[64:67], 0
    v_mfma_f32_16x16x32_bf16 a[152:155], a[200:203], v[80:83], 0
    v_mfma_f32_16x16x32_bf16 a[168:171], a[200:203], v[96:99], 0
    v_mfma_f32_16x16x32_bf16 a[184:187], a[200:203], v[112:115], 0
    v_mfma_f32_16x16x32_bf16 a[108:111], a[204:207], v[32:35], 0
    v_mfma_f32_16x16x32_bf16 a[124:127], a[204:207], v[48:51], 0
    v_mfma_f32_16x16x32_bf16 a[140:143], a[204:207], v[64:67], 0
    v_mfma_f32_16x16x32_bf16 a[156:159], a[204:207], v[80:83], 0
    v_mfma_f32_16x16x32_bf16 a[172:175], a[204:207], v[96:99], 0
    v_mfma_f32_16x16x32_bf16 a[188:191], a[204:207], v[112:115], 0
    s_waitcnt lgkmcnt(0)
    s_waitcnt vmcnt(27)
    s_barrier
    v_mfma_f32_16x16x32_bf16 a[96:99], a[208:211], v[36:39], a[96:99]
    ds_read_b64_tr_b16 a[224:225], v224 offset:49152
    ds_read_b64_tr_b16 a[226:227], v224 offset:51200
    v_mfma_f32_16x16x32_bf16 a[112:115], a[208:211], v[52:55], a[112:115]
    v_accvgpr_read_b32 v236, a0
    v_accvgpr_read_b32 v237, a1
    v_mfma_f32_16x16x32_bf16 a[128:131], a[208:211], v[68:71], a[128:131]
    v_accvgpr_read_b32 v238, a2
    v_accvgpr_read_b32 v239, a3
    v_mfma_f32_16x16x32_bf16 a[144:147], a[208:211], v[84:87], a[144:147]
    ds_read_b64_tr_b16 a[228:229], v225 offset:49152
    ds_read_b64_tr_b16 a[230:231], v225 offset:51200
    v_mfma_f32_16x16x32_bf16 a[160:163], a[208:211], v[100:103], a[160:163]
    v_accvgpr_read_b32 v240, a4
    v_accvgpr_read_b32 v241, a5
    v_mfma_f32_16x16x32_bf16 a[176:179], a[208:211], v[116:119], a[176:179]
    ds_read_b64_tr_b16 a[232:233], v226 offset:49152
    ds_read_b64_tr_b16 a[234:235], v226 offset:51200
    v_mfma_f32_16x16x32_bf16 a[100:103], a[212:215], v[36:39], a[100:103]
    v_accvgpr_read_b32 v242, a6
    v_accvgpr_read_b32 v243, a7
    v_mfma_f32_16x16x32_bf16 a[116:119], a[212:215], v[52:55], a[116:119]
    v_cvt_pk_bf16_f32 v244, v236, v237
    v_cvt_pk_bf16_f32 v245, v238, v239
    v_mfma_f32_16x16x32_bf16 a[132:135], a[212:215], v[68:71], a[132:135]
    ds_read_b64_tr_b16 a[236:237], v227 offset:49152
    ds_read_b64_tr_b16 a[238:239], v227 offset:51200
    v_mfma_f32_16x16x32_bf16 a[148:151], a[212:215], v[84:87], a[148:151]
    v_cvt_pk_bf16_f32 v246, v240, v241
    v_cvt_pk_bf16_f32 v247, v242, v243
    v_mfma_f32_16x16x32_bf16 a[164:167], a[212:215], v[100:103], a[164:167]
    s_mov_b32 s48, 4096
    buffer_store_dwordx4 v[244:247], v7, s[28:31], s48 offen offset:0 sc1
    v_mfma_f32_16x16x32_bf16 a[180:183], a[212:215], v[116:119], a[180:183]
    v_accvgpr_read_b32 v236, a8
    v_accvgpr_read_b32 v237, a9
    v_mfma_f32_16x16x32_bf16 a[104:107], a[216:219], v[36:39], a[104:107]
    v_accvgpr_read_b32 v238, a10
    v_accvgpr_read_b32 v239, a11
    v_mfma_f32_16x16x32_bf16 a[120:123], a[216:219], v[52:55], a[120:123]
    v_accvgpr_read_b32 v240, a12
    v_accvgpr_read_b32 v241, a13
    v_mfma_f32_16x16x32_bf16 a[136:139], a[216:219], v[68:71], a[136:139]
    v_accvgpr_read_b32 v242, a14
    v_accvgpr_read_b32 v243, a15
    v_mfma_f32_16x16x32_bf16 a[152:155], a[216:219], v[84:87], a[152:155]
    v_cvt_pk_bf16_f32 v248, v236, v237
    v_cvt_pk_bf16_f32 v249, v238, v239
    v_mfma_f32_16x16x32_bf16 a[168:171], a[216:219], v[100:103], a[168:171]
    v_mfma_f32_16x16x32_bf16 a[184:187], a[216:219], v[116:119], a[184:187]
    v_cvt_pk_bf16_f32 v250, v240, v241
    v_cvt_pk_bf16_f32 v251, v242, v243
    v_mfma_f32_16x16x32_bf16 a[108:111], a[220:223], v[36:39], a[108:111]
    s_mov_b32 s48, 4096
    v_mfma_f32_16x16x32_bf16 a[124:127], a[220:223], v[52:55], a[124:127]
    buffer_store_dwordx4 v[248:251], v7, s[28:31], s48 offen offset:1024 sc1
    v_mfma_f32_16x16x32_bf16 a[140:143], a[220:223], v[68:71], a[140:143]
    v_mfma_f32_16x16x32_bf16 a[156:159], a[220:223], v[84:87], a[156:159]
    v_mfma_f32_16x16x32_bf16 a[172:175], a[220:223], v[100:103], a[172:175]
    v_mfma_f32_16x16x32_bf16 a[188:191], a[220:223], v[116:119], a[188:191]
    s_waitcnt lgkmcnt(0)
    v_mfma_f32_16x16x32_bf16 a[96:99], a[224:227], v[40:43], a[96:99]
    ds_read_b64_tr_b16 a[240:241], v224 offset:53248
    ds_read_b64_tr_b16 a[242:243], v224 offset:55296
    v_mfma_f32_16x16x32_bf16 a[112:115], a[224:227], v[56:59], a[112:115]
    v_accvgpr_read_b32 v236, a16
    v_accvgpr_read_b32 v237, a17
    v_mfma_f32_16x16x32_bf16 a[128:131], a[224:227], v[72:75], a[128:131]
    v_accvgpr_read_b32 v238, a18
    v_accvgpr_read_b32 v239, a19
    v_mfma_f32_16x16x32_bf16 a[144:147], a[224:227], v[88:91], a[144:147]
    ds_read_b64_tr_b16 a[244:245], v225 offset:53248
    ds_read_b64_tr_b16 a[246:247], v225 offset:55296
    v_mfma_f32_16x16x32_bf16 a[160:163], a[224:227], v[104:107], a[160:163]
    v_accvgpr_read_b32 v240, a20
    v_accvgpr_read_b32 v241, a21
    v_mfma_f32_16x16x32_bf16 a[176:179], a[224:227], v[120:123], a[176:179]
    ds_read_b64_tr_b16 a[248:249], v226 offset:53248
    ds_read_b64_tr_b16 a[250:251], v226 offset:55296
    v_mfma_f32_16x16x32_bf16 a[100:103], a[228:231], v[40:43], a[100:103]
    v_accvgpr_read_b32 v242, a22
    v_accvgpr_read_b32 v243, a23
    v_mfma_f32_16x16x32_bf16 a[116:119], a[228:231], v[56:59], a[116:119]
    v_cvt_pk_bf16_f32 v244, v236, v237
    v_cvt_pk_bf16_f32 v245, v238, v239
    v_mfma_f32_16x16x32_bf16 a[132:135], a[228:231], v[72:75], a[132:135]
    ds_read_b64_tr_b16 a[252:253], v227 offset:53248
    ds_read_b64_tr_b16 a[254:255], v227 offset:55296
    v_mfma_f32_16x16x32_bf16 a[148:151], a[228:231], v[88:91], a[148:151]
    v_cvt_pk_bf16_f32 v246, v240, v241
    v_cvt_pk_bf16_f32 v247, v242, v243
    v_mfma_f32_16x16x32_bf16 a[164:167], a[228:231], v[104:107], a[164:167]
    s_mov_b32 s48, 20480
    buffer_store_dwordx4 v[244:247], v7, s[28:31], s48 offen offset:0 sc1
    v_mfma_f32_16x16x32_bf16 a[180:183], a[228:231], v[120:123], a[180:183]
    v_accvgpr_read_b32 v236, a24
    v_accvgpr_read_b32 v237, a25
    v_mfma_f32_16x16x32_bf16 a[104:107], a[232:235], v[40:43], a[104:107]
    v_accvgpr_read_b32 v238, a26
    v_accvgpr_read_b32 v239, a27
    v_mfma_f32_16x16x32_bf16 a[120:123], a[232:235], v[56:59], a[120:123]
    v_accvgpr_read_b32 v240, a28
    v_accvgpr_read_b32 v241, a29
    v_mfma_f32_16x16x32_bf16 a[136:139], a[232:235], v[72:75], a[136:139]
    v_accvgpr_read_b32 v242, a30
    v_accvgpr_read_b32 v243, a31
    v_mfma_f32_16x16x32_bf16 a[152:155], a[232:235], v[88:91], a[152:155]
    v_cvt_pk_bf16_f32 v248, v236, v237
    v_cvt_pk_bf16_f32 v249, v238, v239
    v_mfma_f32_16x16x32_bf16 a[168:171], a[232:235], v[104:107], a[168:171]
    v_mfma_f32_16x16x32_bf16 a[184:187], a[232:235], v[120:123], a[184:187]
    v_cvt_pk_bf16_f32 v250, v240, v241
    v_cvt_pk_bf16_f32 v251, v242, v243
    v_mfma_f32_16x16x32_bf16 a[108:111], a[236:239], v[40:43], a[108:111]
    s_mov_b32 s48, 20480
    v_mfma_f32_16x16x32_bf16 a[124:127], a[236:239], v[56:59], a[124:127]
    buffer_store_dwordx4 v[248:251], v7, s[28:31], s48 offen offset:1024 sc1
    v_mfma_f32_16x16x32_bf16 a[140:143], a[236:239], v[72:75], a[140:143]
    v_mfma_f32_16x16x32_bf16 a[156:159], a[236:239], v[88:91], a[156:159]
    v_mfma_f32_16x16x32_bf16 a[172:175], a[236:239], v[104:107], a[172:175]
    v_mfma_f32_16x16x32_bf16 a[188:191], a[236:239], v[120:123], a[188:191]
    s_waitcnt lgkmcnt(0)
    s_waitcnt vmcnt(23)
    s_barrier
    v_mfma_f32_16x16x32_bf16 a[96:99], a[240:243], v[44:47], a[96:99]
    ds_read_b64_tr_b16 a[192:193], v228 offset:0
    ds_read_b64_tr_b16 a[194:195], v228 offset:2048
    v_mfma_f32_16x16x32_bf16 a[112:115], a[240:243], v[60:63], a[112:115]
    v_accvgpr_read_b32 v236, a32
    v_accvgpr_read_b32 v237, a33
    v_mfma_f32_16x16x32_bf16 a[128:131], a[240:243], v[76:79], a[128:131]
    v_accvgpr_read_b32 v238, a34
    v_accvgpr_read_b32 v239, a35
    v_mfma_f32_16x16x32_bf16 a[144:147], a[240:243], v[92:95], a[144:147]
    ds_read_b64_tr_b16 a[196:197], v229 offset:0
    ds_read_b64_tr_b16 a[198:199], v229 offset:2048
    v_mfma_f32_16x16x32_bf16 a[160:163], a[240:243], v[108:111], a[160:163]
    v_accvgpr_read_b32 v240, a36
    v_accvgpr_read_b32 v241, a37
    v_mfma_f32_16x16x32_bf16 a[176:179], a[240:243], v[124:127], a[176:179]
    ds_read_b64_tr_b16 a[200:201], v230 offset:0
    ds_read_b64_tr_b16 a[202:203], v230 offset:2048
    v_mfma_f32_16x16x32_bf16 a[100:103], a[244:247], v[44:47], a[100:103]
    v_accvgpr_read_b32 v242, a38
    v_accvgpr_read_b32 v243, a39
    v_mfma_f32_16x16x32_bf16 a[116:119], a[244:247], v[60:63], a[116:119]
    v_cvt_pk_bf16_f32 v244, v236, v237
    v_cvt_pk_bf16_f32 v245, v238, v239
    v_mfma_f32_16x16x32_bf16 a[132:135], a[244:247], v[76:79], a[132:135]
    ds_read_b64_tr_b16 a[204:205], v231 offset:0
    ds_read_b64_tr_b16 a[206:207], v231 offset:2048
    v_mfma_f32_16x16x32_bf16 a[148:151], a[244:247], v[92:95], a[148:151]
    v_cvt_pk_bf16_f32 v246, v240, v241
    v_cvt_pk_bf16_f32 v247, v242, v243
    v_mfma_f32_16x16x32_bf16 a[164:167], a[244:247], v[108:111], a[164:167]
    s_mov_b32 s48, 36864
    buffer_store_dwordx4 v[244:247], v7, s[28:31], s48 offen offset:0 sc1
    v_mfma_f32_16x16x32_bf16 a[180:183], a[244:247], v[124:127], a[180:183]
    v_accvgpr_read_b32 v236, a40
    v_accvgpr_read_b32 v237, a41
    v_mfma_f32_16x16x32_bf16 a[104:107], a[248:251], v[44:47], a[104:107]
    v_accvgpr_read_b32 v238, a42
    v_accvgpr_read_b32 v239, a43
    v_mfma_f32_16x16x32_bf16 a[120:123], a[248:251], v[60:63], a[120:123]
    v_accvgpr_read_b32 v240, a44
    v_accvgpr_read_b32 v241, a45
    v_mfma_f32_16x16x32_bf16 a[136:139], a[248:251], v[76:79], a[136:139]
    v_accvgpr_read_b32 v242, a46
    v_accvgpr_read_b32 v243, a47
    v_mfma_f32_16x16x32_bf16 a[152:155], a[248:251], v[92:95], a[152:155]
    v_cvt_pk_bf16_f32 v248, v236, v237
    v_cvt_pk_bf16_f32 v249, v238, v239
    v_mfma_f32_16x16x32_bf16 a[168:171], a[248:251], v[108:111], a[168:171]
    v_mfma_f32_16x16x32_bf16 a[184:187], a[248:251], v[124:127], a[184:187]
    v_cvt_pk_bf16_f32 v250, v240, v241
    v_cvt_pk_bf16_f32 v251, v242, v243
    v_mfma_f32_16x16x32_bf16 a[108:111], a[252:255], v[44:47], a[108:111]
    s_mov_b32 s48, 36864
    v_mfma_f32_16x16x32_bf16 a[124:127], a[252:255], v[60:63], a[124:127]
    buffer_store_dwordx4 v[248:251], v7, s[28:31], s48 offen offset:1024 sc1
    v_mfma_f32_16x16x32_bf16 a[140:143], a[252:255], v[76:79], a[140:143]
    v_mfma_f32_16x16x32_bf16 a[156:159], a[252:255], v[92:95], a[156:159]
    v_mfma_f32_16x16x32_bf16 a[172:175], a[252:255], v[108:111], a[172:175]
    v_mfma_f32_16x16x32_bf16 a[188:191], a[252:255], v[124:127], a[188:191]
    s_waitcnt lgkmcnt(0)
    v_mfma_f32_16x16x32_bf16 a[96:99], a[192:195], v[128:131], a[96:99]
    ds_read_b64_tr_b16 a[208:209], v228 offset:4096
    ds_read_b64_tr_b16 a[210:211], v228 offset:6144
    v_mfma_f32_16x16x32_bf16 a[112:115], a[192:195], v[144:147], a[112:115]
    v_accvgpr_read_b32 v236, a48
    v_accvgpr_read_b32 v237, a49
    v_mfma_f32_16x16x32_bf16 a[128:131], a[192:195], v[160:163], a[128:131]
    v_accvgpr_read_b32 v238, a50
    v_accvgpr_read_b32 v239, a51
    v_mfma_f32_16x16x32_bf16 a[144:147], a[192:195], v[176:179], a[144:147]
    ds_read_b64_tr_b16 a[212:213], v229 offset:4096
    ds_read_b64_tr_b16 a[214:215], v229 offset:6144
    v_mfma_f32_16x16x32_bf16 a[160:163], a[192:195], v[192:195], a[160:163]
    v_accvgpr_read_b32 v240, a52
    v_accvgpr_read_b32 v241, a53
    v_mfma_f32_16x16x32_bf16 a[176:179], a[192:195], v[208:211], a[176:179]
    ds_read_b64_tr_b16 a[216:217], v230 offset:4096
    ds_read_b64_tr_b16 a[218:219], v230 offset:6144
    v_mfma_f32_16x16x32_bf16 a[100:103], a[196:199], v[128:131], a[100:103]
    v_accvgpr_read_b32 v242, a54
    v_accvgpr_read_b32 v243, a55
    v_mfma_f32_16x16x32_bf16 a[116:119], a[196:199], v[144:147], a[116:119]
    v_cvt_pk_bf16_f32 v244, v236, v237
    v_cvt_pk_bf16_f32 v245, v238, v239
    v_mfma_f32_16x16x32_bf16 a[132:135], a[196:199], v[160:163], a[132:135]
    ds_read_b64_tr_b16 a[220:221], v231 offset:4096
    ds_read_b64_tr_b16 a[222:223], v231 offset:6144
    v_mfma_f32_16x16x32_bf16 a[148:151], a[196:199], v[176:179], a[148:151]
    v_cvt_pk_bf16_f32 v246, v240, v241
    v_cvt_pk_bf16_f32 v247, v242, v243
    v_mfma_f32_16x16x32_bf16 a[164:167], a[196:199], v[192:195], a[164:167]
    s_mov_b32 s48, 53248
    buffer_store_dwordx4 v[244:247], v7, s[28:31], s48 offen offset:0 sc1
    v_mfma_f32_16x16x32_bf16 a[180:183], a[196:199], v[208:211], a[180:183]
    v_accvgpr_read_b32 v236, a56
    v_accvgpr_read_b32 v237, a57
    v_mfma_f32_16x16x32_bf16 a[104:107], a[200:203], v[128:131], a[104:107]
    v_accvgpr_read_b32 v238, a58
    v_accvgpr_read_b32 v239, a59
    v_mfma_f32_16x16x32_bf16 a[120:123], a[200:203], v[144:147], a[120:123]
    v_accvgpr_read_b32 v240, a60
    v_accvgpr_read_b32 v241, a61
    v_mfma_f32_16x16x32_bf16 a[136:139], a[200:203], v[160:163], a[136:139]
    v_accvgpr_read_b32 v242, a62
    v_accvgpr_read_b32 v243, a63
    v_mfma_f32_16x16x32_bf16 a[152:155], a[200:203], v[176:179], a[152:155]
    v_cvt_pk_bf16_f32 v248, v236, v237
    v_cvt_pk_bf16_f32 v249, v238, v239
    v_mfma_f32_16x16x32_bf16 a[168:171], a[200:203], v[192:195], a[168:171]
    v_mfma_f32_16x16x32_bf16 a[184:187], a[200:203], v[208:211], a[184:187]
    v_cvt_pk_bf16_f32 v250, v240, v241
    v_cvt_pk_bf16_f32 v251, v242, v243
    v_mfma_f32_16x16x32_bf16 a[108:111], a[204:207], v[128:131], a[108:111]
    s_mov_b32 s48, 53248
    v_mfma_f32_16x16x32_bf16 a[124:127], a[204:207], v[144:147], a[124:127]
    buffer_store_dwordx4 v[248:251], v7, s[28:31], s48 offen offset:1024 sc1
    v_mfma_f32_16x16x32_bf16 a[140:143], a[204:207], v[160:163], a[140:143]
    v_mfma_f32_16x16x32_bf16 a[156:159], a[204:207], v[176:179], a[156:159]
    v_mfma_f32_16x16x32_bf16 a[172:175], a[204:207], v[192:195], a[172:175]
    v_mfma_f32_16x16x32_bf16 a[188:191], a[204:207], v[208:211], a[188:191]
    s_waitcnt lgkmcnt(0)
    s_waitcnt vmcnt(20)
    s_barrier
    v_mfma_f32_16x16x32_bf16 a[96:99], a[208:211], v[132:135], a[96:99]
    ds_read_b64_tr_b16 a[224:225], v228 offset:16384
    ds_read_b64_tr_b16 a[226:227], v228 offset:18432
    v_mfma_f32_16x16x32_bf16 a[112:115], a[208:211], v[148:151], a[112:115]
    v_accvgpr_read_b32 v236, a64
    v_accvgpr_read_b32 v237, a65
    v_mfma_f32_16x16x32_bf16 a[128:131], a[208:211], v[164:167], a[128:131]
    v_accvgpr_read_b32 v238, a66
    v_accvgpr_read_b32 v239, a67
    v_mfma_f32_16x16x32_bf16 a[144:147], a[208:211], v[180:183], a[144:147]
    ds_read_b64_tr_b16 a[228:229], v229 offset:16384
    ds_read_b64_tr_b16 a[230:231], v229 offset:18432
    v_mfma_f32_16x16x32_bf16 a[160:163], a[208:211], v[196:199], a[160:163]
    v_accvgpr_read_b32 v240, a68
    v_accvgpr_read_b32 v241, a69
    v_mfma_f32_16x16x32_bf16 a[176:179], a[208:211], v[212:215], a[176:179]
    ds_read_b64_tr_b16 a[232:233], v230 offset:16384
    ds_read_b64_tr_b16 a[234:235], v230 offset:18432
    v_mfma_f32_16x16x32_bf16 a[100:103], a[212:215], v[132:135], a[100:103]
    v_accvgpr_read_b32 v242, a70
    v_accvgpr_read_b32 v243, a71
    v_mfma_f32_16x16x32_bf16 a[116:119], a[212:215], v[148:151], a[116:119]
    v_cvt_pk_bf16_f32 v244, v236, v237
    v_cvt_pk_bf16_f32 v245, v238, v239
    v_mfma_f32_16x16x32_bf16 a[132:135], a[212:215], v[164:167], a[132:135]
    ds_read_b64_tr_b16 a[236:237], v231 offset:16384
    ds_read_b64_tr_b16 a[238:239], v231 offset:18432
    v_mfma_f32_16x16x32_bf16 a[148:151], a[212:215], v[180:183], a[148:151]
    v_cvt_pk_bf16_f32 v246, v240, v241
    v_cvt_pk_bf16_f32 v247, v242, v243
    v_mfma_f32_16x16x32_bf16 a[164:167], a[212:215], v[196:199], a[164:167]
    s_mov_b32 s48, 69632
    buffer_store_dwordx4 v[244:247], v7, s[28:31], s48 offen offset:0 sc1
    v_mfma_f32_16x16x32_bf16 a[180:183], a[212:215], v[212:215], a[180:183]
    v_accvgpr_read_b32 v236, a72
    v_accvgpr_read_b32 v237, a73
    v_mfma_f32_16x16x32_bf16 a[104:107], a[216:219], v[132:135], a[104:107]
    v_accvgpr_read_b32 v238, a74
    v_accvgpr_read_b32 v239, a75
    v_mfma_f32_16x16x32_bf16 a[120:123], a[216:219], v[148:151], a[120:123]
    v_accvgpr_read_b32 v240, a76
    v_accvgpr_read_b32 v241, a77
    v_mfma_f32_16x16x32_bf16 a[136:139], a[216:219], v[164:167], a[136:139]
    v_accvgpr_read_b32 v242, a78
    v_accvgpr_read_b32 v243, a79
    v_mfma_f32_16x16x32_bf16 a[152:155], a[216:219], v[180:183], a[152:155]
    v_cvt_pk_bf16_f32 v248, v236, v237
    v_cvt_pk_bf16_f32 v249, v238, v239
    v_mfma_f32_16x16x32_bf16 a[168:171], a[216:219], v[196:199], a[168:171]
    v_mfma_f32_16x16x32_bf16 a[184:187], a[216:219], v[212:215], a[184:187]
    v_cvt_pk_bf16_f32 v250, v240, v241
    v_cvt_pk_bf16_f32 v251, v242, v243
    v_mfma_f32_16x16x32_bf16 a[108:111], a[220:223], v[132:135], a[108:111]
    s_mov_b32 s48, 69632
    v_mfma_f32_16x16x32_bf16 a[124:127], a[220:223], v[148:151], a[124:127]
    buffer_store_dwordx4 v[248:251], v7, s[28:31], s48 offen offset:1024 sc1
    v_mfma_f32_16x16x32_bf16 a[140:143], a[220:223], v[164:167], a[140:143]
    v_mfma_f32_16x16x32_bf16 a[156:159], a[220:223], v[180:183], a[156:159]
    v_mfma_f32_16x16x32_bf16 a[172:175], a[220:223], v[196:199], a[172:175]
    v_mfma_f32_16x16x32_bf16 a[188:191], a[220:223], v[212:215], a[188:191]
    s_waitcnt lgkmcnt(0)
    v_mfma_f32_16x16x32_bf16 a[96:99], a[224:227], v[136:139], a[96:99]
    ds_read_b64_tr_b16 a[240:241], v228 offset:20480
    ds_read_b64_tr_b16 a[242:243], v228 offset:22528
    v_mfma_f32_16x16x32_bf16 a[112:115], a[224:227], v[152:155], a[112:115]
    v_accvgpr_read_b32 v236, a80
    v_accvgpr_read_b32 v237, a81
    v_mfma_f32_16x16x32_bf16 a[128:131], a[224:227], v[168:171], a[128:131]
    v_accvgpr_read_b32 v238, a82
    v_accvgpr_read_b32 v239, a83
    v_mfma_f32_16x16x32_bf16 a[144:147], a[224:227], v[184:187], a[144:147]
    ds_read_b64_tr_b16 a[244:245], v229 offset:20480
    ds_read_b64_tr_b16 a[246:247], v229 offset:22528
    v_mfma_f32_16x16x32_bf16 a[160:163], a[224:227], v[200:203], a[160:163]
    v_accvgpr_read_b32 v240, a84
    v_accvgpr_read_b32 v241, a85
    v_mfma_f32_16x16x32_bf16 a[176:179], a[224:227], v[216:219], a[176:179]
    ds_read_b64_tr_b16 a[248:249], v230 offset:20480
    ds_read_b64_tr_b16 a[250:251], v230 offset:22528
    v_mfma_f32_16x16x32_bf16 a[100:103], a[228:231], v[136:139], a[100:103]
    v_accvgpr_read_b32 v242, a86
    v_accvgpr_read_b32 v243, a87
    v_mfma_f32_16x16x32_bf16 a[116:119], a[228:231], v[152:155], a[116:119]
    v_cvt_pk_bf16_f32 v244, v236, v237
    v_cvt_pk_bf16_f32 v245, v238, v239
    v_mfma_f32_16x16x32_bf16 a[132:135], a[228:231], v[168:171], a[132:135]
    ds_read_b64_tr_b16 a[252:253], v231 offset:20480
    ds_read_b64_tr_b16 a[254:255], v231 offset:22528
    v_mfma_f32_16x16x32_bf16 a[148:151], a[228:231], v[184:187], a[148:151]
    v_cvt_pk_bf16_f32 v246, v240, v241
    v_cvt_pk_bf16_f32 v247, v242, v243
    v_mfma_f32_16x16x32_bf16 a[164:167], a[228:231], v[200:203], a[164:167]
    s_mov_b32 s48, 86016
    buffer_store_dwordx4 v[244:247], v7, s[28:31], s48 offen offset:0 sc1
    v_mfma_f32_16x16x32_bf16 a[180:183], a[228:231], v[216:219], a[180:183]
    v_accvgpr_read_b32 v236, a88
    v_accvgpr_read_b32 v237, a89
    v_mfma_f32_16x16x32_bf16 a[104:107], a[232:235], v[136:139], a[104:107]
    v_accvgpr_read_b32 v238, a90
    v_accvgpr_read_b32 v239, a91
    v_mfma_f32_16x16x32_bf16 a[120:123], a[232:235], v[152:155], a[120:123]
    v_accvgpr_read_b32 v240, a92
    v_accvgpr_read_b32 v241, a93
    v_mfma_f32_16x16x32_bf16 a[136:139], a[232:235], v[168:171], a[136:139]
    v_accvgpr_read_b32 v242, a94
    v_accvgpr_read_b32 v243, a95
    v_mfma_f32_16x16x32_bf16 a[152:155], a[232:235], v[184:187], a[152:155]
    v_cvt_pk_bf16_f32 v248, v236, v237
    v_cvt_pk_bf16_f32 v249, v238, v239
    v_mfma_f32_16x16x32_bf16 a[168:171], a[232:235], v[200:203], a[168:171]
    v_mfma_f32_16x16x32_bf16 a[184:187], a[232:235], v[216:219], a[184:187]
    v_cvt_pk_bf16_f32 v250, v240, v241
    v_cvt_pk_bf16_f32 v251, v242, v243
    v_mfma_f32_16x16x32_bf16 a[108:111], a[236:239], v[136:139], a[108:111]
    s_mov_b32 s48, 86016
    v_mfma_f32_16x16x32_bf16 a[124:127], a[236:239], v[152:155], a[124:127]
    buffer_store_dwordx4 v[248:251], v7, s[28:31], s48 offen offset:1024 sc1
    v_mfma_f32_16x16x32_bf16 a[140:143], a[236:239], v[168:171], a[140:143]
    v_mfma_f32_16x16x32_bf16 a[156:159], a[236:239], v[184:187], a[156:159]
    v_mfma_f32_16x16x32_bf16 a[172:175], a[236:239], v[200:203], a[172:175]
    v_mfma_f32_16x16x32_bf16 a[188:191], a[236:239], v[216:219], a[188:191]
    s_waitcnt lgkmcnt(0)
    v_mfma_f32_16x16x32_bf16 a[96:99], a[240:243], v[140:143], a[96:99]
    v_mfma_f32_16x16x32_bf16 a[112:115], a[240:243], v[156:159], a[112:115]
    v_mfma_f32_16x16x32_bf16 a[128:131], a[240:243], v[172:175], a[128:131]
    v_mfma_f32_16x16x32_bf16 a[144:147], a[240:243], v[188:191], a[144:147]
    v_mfma_f32_16x16x32_bf16 a[160:163], a[240:243], v[204:207], a[160:163]
    v_mfma_f32_16x16x32_bf16 a[176:179], a[240:243], v[220:223], a[176:179]
    v_mfma_f32_16x16x32_bf16 a[100:103], a[244:247], v[140:143], a[100:103]
    v_mfma_f32_16x16x32_bf16 a[116:119], a[244:247], v[156:159], a[116:119]
    v_mfma_f32_16x16x32_bf16 a[132:135], a[244:247], v[172:175], a[132:135]
    v_mfma_f32_16x16x32_bf16 a[148:151], a[244:247], v[188:191], a[148:151]
    v_mfma_f32_16x16x32_bf16 a[164:167], a[244:247], v[204:207], a[164:167]
    v_mfma_f32_16x16x32_bf16 a[180:183], a[244:247], v[220:223], a[180:183]
    v_mfma_f32_16x16x32_bf16 a[104:107], a[248:251], v[140:143], a[104:107]
    v_mfma_f32_16x16x32_bf16 a[120:123], a[248:251], v[156:159], a[120:123]
    v_mfma_f32_16x16x32_bf16 a[136:139], a[248:251], v[172:175], a[136:139]
    v_mfma_f32_16x16x32_bf16 a[152:155], a[248:251], v[188:191], a[152:155]
    v_mfma_f32_16x16x32_bf16 a[168:171], a[248:251], v[204:207], a[168:171]
    v_mfma_f32_16x16x32_bf16 a[184:187], a[248:251], v[220:223], a[184:187]
    v_mfma_f32_16x16x32_bf16 a[108:111], a[252:255], v[140:143], a[108:111]
    v_mfma_f32_16x16x32_bf16 a[124:127], a[252:255], v[156:159], a[124:127]
    v_mfma_f32_16x16x32_bf16 a[140:143], a[252:255], v[172:175], a[140:143]
    v_mfma_f32_16x16x32_bf16 a[156:159], a[252:255], v[188:191], a[156:159]
    v_mfma_f32_16x16x32_bf16 a[172:175], a[252:255], v[204:207], a[172:175]
    v_mfma_f32_16x16x32_bf16 a[188:191], a[252:255], v[220:223], a[188:191]
    s_nop 7
    v_accvgpr_read_b32 v236, a96
    v_accvgpr_read_b32 v237, a97
    v_accvgpr_read_b32 v238, a98
    v_accvgpr_read_b32 v239, a99
    v_accvgpr_read_b32 v240, a100
    v_accvgpr_read_b32 v241, a101
    v_accvgpr_read_b32 v242, a102
    v_accvgpr_read_b32 v243, a103
    v_cvt_pk_bf16_f32 v244, v236, v237
    v_cvt_pk_bf16_f32 v245, v238, v239
    v_cvt_pk_bf16_f32 v246, v240, v241
    v_cvt_pk_bf16_f32 v247, v242, v243
    s_mov_b32 s48, 6144
    buffer_store_dwordx4 v[244:247], v7, s[28:31], s48 offen offset:0 sc1
    v_accvgpr_read_b32 v236, a104
    v_accvgpr_read_b32 v237, a105
    v_accvgpr_read_b32 v238, a106
    v_accvgpr_read_b32 v239, a107
    v_accvgpr_read_b32 v240, a108
    v_accvgpr_read_b32 v241, a109
    v_accvgpr_read_b32 v242, a110
    v_accvgpr_read_b32 v243, a111
    v_cvt_pk_bf16_f32 v248, v236, v237
    v_cvt_pk_bf16_f32 v249, v238, v239
    v_cvt_pk_bf16_f32 v250, v240, v241
    v_cvt_pk_bf16_f32 v251, v242, v243
    s_mov_b32 s48, 6144
    buffer_store_dwordx4 v[248:251], v7, s[28:31], s48 offen offset:1024 sc1
    v_accvgpr_read_b32 v236, a112
    v_accvgpr_read_b32 v237, a113
    v_accvgpr_read_b32 v238, a114
    v_accvgpr_read_b32 v239, a115
    v_accvgpr_read_b32 v240, a116
    v_accvgpr_read_b32 v241, a117
    v_accvgpr_read_b32 v242, a118
    v_accvgpr_read_b32 v243, a119
    v_cvt_pk_bf16_f32 v244, v236, v237
    v_cvt_pk_bf16_f32 v245, v238, v239
    v_cvt_pk_bf16_f32 v246, v240, v241
    v_cvt_pk_bf16_f32 v247, v242, v243
    s_mov_b32 s48, 22528
    buffer_store_dwordx4 v[244:247], v7, s[28:31], s48 offen offset:0 sc1
    v_accvgpr_read_b32 v236, a120
    v_accvgpr_read_b32 v237, a121
    v_accvgpr_read_b32 v238, a122
    v_accvgpr_read_b32 v239, a123
    v_accvgpr_read_b32 v240, a124
    v_accvgpr_read_b32 v241, a125
    v_accvgpr_read_b32 v242, a126
    v_accvgpr_read_b32 v243, a127
    v_cvt_pk_bf16_f32 v248, v236, v237
    v_cvt_pk_bf16_f32 v249, v238, v239
    v_cvt_pk_bf16_f32 v250, v240, v241
    v_cvt_pk_bf16_f32 v251, v242, v243
    s_mov_b32 s48, 22528
    buffer_store_dwordx4 v[248:251], v7, s[28:31], s48 offen offset:1024 sc1
    v_accvgpr_read_b32 v236, a128
    v_accvgpr_read_b32 v237, a129
    v_accvgpr_read_b32 v238, a130
    v_accvgpr_read_b32 v239, a131
    v_accvgpr_read_b32 v240, a132
    v_accvgpr_read_b32 v241, a133
    v_accvgpr_read_b32 v242, a134
    v_accvgpr_read_b32 v243, a135
    v_cvt_pk_bf16_f32 v244, v236, v237
    v_cvt_pk_bf16_f32 v245, v238, v239
    v_cvt_pk_bf16_f32 v246, v240, v241
    v_cvt_pk_bf16_f32 v247, v242, v243
    s_mov_b32 s48, 38912
    buffer_store_dwordx4 v[244:247], v7, s[28:31], s48 offen offset:0 sc1
    v_accvgpr_read_b32 v236, a136
    v_accvgpr_read_b32 v237, a137
    v_accvgpr_read_b32 v238, a138
    v_accvgpr_read_b32 v239, a139
    v_accvgpr_read_b32 v240, a140
    v_accvgpr_read_b32 v241, a141
    v_accvgpr_read_b32 v242, a142
    v_accvgpr_read_b32 v243, a143
    v_cvt_pk_bf16_f32 v248, v236, v237
    v_cvt_pk_bf16_f32 v249, v238, v239
    v_cvt_pk_bf16_f32 v250, v240, v241
    v_cvt_pk_bf16_f32 v251, v242, v243
    s_mov_b32 s48, 38912
    buffer_store_dwordx4 v[248:251], v7, s[28:31], s48 offen offset:1024 sc1
    v_accvgpr_read_b32 v236, a144
    v_accvgpr_read_b32 v237, a145
    v_accvgpr_read_b32 v238, a146
    v_accvgpr_read_b32 v239, a147
    v_accvgpr_read_b32 v240, a148
    v_accvgpr_read_b32 v241, a149
    v_accvgpr_read_b32 v242, a150
    v_accvgpr_read_b32 v243, a151
    v_cvt_pk_bf16_f32 v244, v236, v237
    v_cvt_pk_bf16_f32 v245, v238, v239
    v_cvt_pk_bf16_f32 v246, v240, v241
    v_cvt_pk_bf16_f32 v247, v242, v243
    s_mov_b32 s48, 55296
    buffer_store_dwordx4 v[244:247], v7, s[28:31], s48 offen offset:0 sc1
    v_accvgpr_read_b32 v236, a152
    v_accvgpr_read_b32 v237, a153
    v_accvgpr_read_b32 v238, a154
    v_accvgpr_read_b32 v239, a155
    v_accvgpr_read_b32 v240, a156
    v_accvgpr_read_b32 v241, a157
    v_accvgpr_read_b32 v242, a158
    v_accvgpr_read_b32 v243, a159
    v_cvt_pk_bf16_f32 v248, v236, v237
    v_cvt_pk_bf16_f32 v249, v238, v239
    v_cvt_pk_bf16_f32 v250, v240, v241
    v_cvt_pk_bf16_f32 v251, v242, v243
    s_mov_b32 s48, 55296
    buffer_store_dwordx4 v[248:251], v7, s[28:31], s48 offen offset:1024 sc1
    v_accvgpr_read_b32 v236, a160
    v_accvgpr_read_b32 v237, a161
    v_accvgpr_read_b32 v238, a162
    v_accvgpr_read_b32 v239, a163
    v_accvgpr_read_b32 v240, a164
    v_accvgpr_read_b32 v241, a165
    v_accvgpr_read_b32 v242, a166
    v_accvgpr_read_b32 v243, a167
    v_cvt_pk_bf16_f32 v244, v236, v237
    v_cvt_pk_bf16_f32 v245, v238, v239
    v_cvt_pk_bf16_f32 v246, v240, v241
    v_cvt_pk_bf16_f32 v247, v242, v243
    s_mov_b32 s48, 71680
    buffer_store_dwordx4 v[244:247], v7, s[28:31], s48 offen offset:0 sc1
    v_accvgpr_read_b32 v236, a168
    v_accvgpr_read_b32 v237, a169
    v_accvgpr_read_b32 v238, a170
    v_accvgpr_read_b32 v239, a171
    v_accvgpr_read_b32 v240, a172
    v_accvgpr_read_b32 v241, a173
    v_accvgpr_read_b32 v242, a174
    v_accvgpr_read_b32 v243, a175
    v_cvt_pk_bf16_f32 v248, v236, v237
    v_cvt_pk_bf16_f32 v249, v238, v239
    v_cvt_pk_bf16_f32 v250, v240, v241
    v_cvt_pk_bf16_f32 v251, v242, v243
    s_mov_b32 s48, 71680
    buffer_store_dwordx4 v[248:251], v7, s[28:31], s48 offen offset:1024 sc1
    v_accvgpr_read_b32 v236, a176
    v_accvgpr_read_b32 v237, a177
    v_accvgpr_read_b32 v238, a178
    v_accvgpr_read_b32 v239, a179
    v_accvgpr_read_b32 v240, a180
    v_accvgpr_read_b32 v241, a181
    v_accvgpr_read_b32 v242, a182
    v_accvgpr_read_b32 v243, a183
    v_cvt_pk_bf16_f32 v244, v236, v237
    v_cvt_pk_bf16_f32 v245, v238, v239
    v_cvt_pk_bf16_f32 v246, v240, v241
    v_cvt_pk_bf16_f32 v247, v242, v243
    s_mov_b32 s48, 88064
    buffer_store_dwordx4 v[244:247], v7, s[28:31], s48 offen offset:0 sc1
    v_accvgpr_read_b32 v236, a184
    v_accvgpr_read_b32 v237, a185
    v_accvgpr_read_b32 v238, a186
    v_accvgpr_read_b32 v239, a187
    v_accvgpr_read_b32 v240, a188
    v_accvgpr_read_b32 v241, a189
    v_accvgpr_read_b32 v242, a190
    v_accvgpr_read_b32 v243, a191
    v_cvt_pk_bf16_f32 v248, v236, v237
    v_cvt_pk_bf16_f32 v249, v238, v239
    v_cvt_pk_bf16_f32 v250, v240, v241
    v_cvt_pk_bf16_f32 v251, v242, v243
    s_mov_b32 s48, 88064
    buffer_store_dwordx4 v[248:251], v7, s[28:31], s48 offen offset:1024 sc1
L_k1_end:
    s_endpgm
L_k1_hot_end:
L_fallback:
    s_waitcnt vmcnt(0) lgkmcnt(0)
    s_barrier
    s_lshl_b32 s39, s32, 11
    s_lshl_b32 s40, s32, 11
    s_add_u32 m0, s38, 0
    s_add_u32 s46, s39, 0
    buffer_load_dwordx4 v6, s[16:19], s46 offen offset:0 nt lds
    buffer_load_dwordx4 v7, s[16:19], s46 offen offset:1056 nt lds
    s_add_u32 m0, s38, 33792
    s_add_u32 s46, s39, 8192
    buffer_load_dwordx4 v6, s[16:19], s46 offen offset:0 nt lds
    buffer_load_dwordx4 v7, s[16:19], s46 offen offset:1056 nt lds
    s_add_u32 m0, s38, 16896
    s_add_u32 s46, s39, 262144
    buffer_load_dwordx4 v6, s[16:19], s46 offen offset:0 nt lds
    buffer_load_dwordx4 v7, s[16:19], s46 offen offset:1056 nt lds
    s_add_u32 m0, s38, 50688
    s_add_u32 s46, s39, 270336
    buffer_load_dwordx4 v6, s[16:19], s46 offen offset:0 nt lds
    buffer_load_dwordx4 v7, s[16:19], s46 offen offset:1056 nt lds
    s_add_u32 s39, s39, 16384
    s_add_u32 m0, s38, 8448
    s_add_u32 s46, s40, 0
    buffer_load_dwordx4 v6, s[96:99], s46 offen offset:0 nt lds
    buffer_load_dwordx4 v7, s[96:99], s46 offen offset:1056 nt lds
    s_add_u32 m0, s38, 42240
    s_add_u32 s46, s40, 8192
    buffer_load_dwordx4 v6, s[96:99], s46 offen offset:0 nt lds
    buffer_load_dwordx4 v7, s[96:99], s46 offen offset:1056 nt lds
    s_add_u32 m0, s38, 25344
    s_add_u32 s46, s40, 262144
    buffer_load_dwordx4 v6, s[96:99], s46 offen offset:0 nt lds
    buffer_load_dwordx4 v7, s[96:99], s46 offen offset:1056 nt lds
    s_add_u32 m0, s38, 59136
    s_add_u32 s46, s40, 270336
    buffer_load_dwordx4 v6, s[96:99], s46 offen offset:0 nt lds
    buffer_load_dwordx4 v7, s[96:99], s46 offen offset:1056 nt lds
    s_add_u32 s40, s40, 16384
    s_add_u32 m0, s38, 67584
    s_add_u32 s46, s39, 0
    buffer_load_dwordx4 v6, s[16:19], s46 offen offset:0 nt lds
    buffer_load_dwordx4 v7, s[16:19], s46 offen offset:1056 nt lds
    s_add_u32 m0, s38, 101376
    s_add_u32 s46, s39, 8192
    buffer_load_dwordx4 v6, s[16:19], s46 offen offset:0 nt lds
    buffer_load_dwordx4 v7, s[16:19], s46 offen offset:1056 nt lds
    s_add_u32 m0, s38, 84480
    s_add_u32 s46, s39, 262144
    buffer_load_dwordx4 v6, s[16:19], s46 offen offset:0 nt lds
    buffer_load_dwordx4 v7, s[16:19], s46 offen offset:1056 nt lds
    s_add_u32 m0, s38, 118272
    s_add_u32 s46, s39, 270336
    buffer_load_dwordx4 v6, s[16:19], s46 offen offset:0 nt lds
    buffer_load_dwordx4 v7, s[16:19], s46 offen offset:1056 nt lds
    s_add_u32 s39, s39, 16384
    s_add_u32 m0, s38, 76032
    s_add_u32 s46, s40, 0
    buffer_load_dwordx4 v6, s[96:99], s46 offen offset:0 nt lds
    buffer_load_dwordx4 v7, s[96:99], s46 offen offset:1056 nt lds
    s_add_u32 m0, s38, 109824
    s_add_u32 s46, s40, 8192
    buffer_load_dwordx4 v6, s[96:99], s46 offen offset:0 nt lds
    buffer_load_dwordx4 v7, s[96:99], s46 offen offset:1056 nt lds
    s_add_u32 m0, s38, 92928
    s_add_u32 s46, s40, 262144
    buffer_load_dwordx4 v6, s[96:99], s46 offen offset:0 nt lds
    buffer_load_dwordx4 v7, s[96:99], s46 offen offset:1056 nt lds
    s_add_u32 m0, s38, 126720
    s_add_u32 s46, s40, 270336
    buffer_load_dwordx4 v6, s[96:99], s46 offen offset:0 nt lds
    buffer_load_dwordx4 v7, s[96:99], s46 offen offset:1056 nt lds
    s_add_u32 s40, s40, 16384
    s_waitcnt vmcnt(16)
    s_barrier
    ds_read_b128 a[192:195], v2 offset:0
    ds_read_b128 a[196:199], v2 offset:64
    ds_read_b128 a[200:203], v2 offset:128
    ds_read_b128 a[204:207], v2 offset:192
    ds_read_b128 a[208:211], v2 offset:512
    ds_read_b128 a[212:215], v2 offset:576
    ds_read_b128 a[216:219], v2 offset:640
    ds_read_b128 a[220:223], v2 offset:704
    ds_read_b64_tr_b16 a[224:225], v4 offset:0
    ds_read_b64_tr_b16 a[226:227], v4 offset:512
    ds_read_b64_tr_b16 a[228:229], v4 offset:32
    ds_read_b64_tr_b16 a[230:231], v4 offset:544
    ds_read_b64_tr_b16 a[232:233], v4 offset:64
    ds_read_b64_tr_b16 a[234:235], v4 offset:576
    ds_read_b64_tr_b16 a[236:237], v4 offset:96
    ds_read_b64_tr_b16 a[238:239], v4 offset:608
    ds_read_b64_tr_b16 a[240:241], v4 offset:128
    ds_read_b64_tr_b16 a[242:243], v4 offset:640
    ds_read_b64_tr_b16 a[244:245], v4 offset:160
    ds_read_b64_tr_b16 a[246:247], v4 offset:672
    ds_read_b64_tr_b16 a[248:249], v4 offset:192
    ds_read_b64_tr_b16 a[250:251], v4 offset:704
    ds_read_b64_tr_b16 a[252:253], v4 offset:224
    ds_read_b64_tr_b16 a[254:255], v4 offset:736
    s_waitcnt lgkmcnt(0)
    v_mfma_f32_16x16x32_bf16 v[128:131], a[192:195], v[32:35], 0
    v_mfma_f32_16x16x32_bf16 v[136:139], a[192:195], v[48:51], 0
    v_mfma_f32_16x16x32_bf16 v[128:131], a[196:199], v[36:39], v[128:131]
    v_mfma_f32_16x16x32_bf16 v[136:139], a[196:199], v[52:55], v[136:139]
    v_mfma_f32_16x16x32_bf16 v[128:131], a[200:203], v[40:43], v[128:131]
    v_mfma_f32_16x16x32_bf16 v[136:139], a[200:203], v[56:59], v[136:139]
    v_mfma_f32_16x16x32_bf16 v[128:131], a[204:207], v[44:47], v[128:131]
    v_mfma_f32_16x16x32_bf16 v[136:139], a[204:207], v[60:63], v[136:139]
    v_mfma_f32_16x16x32_bf16 v[132:135], a[208:211], v[32:35], 0
    v_mfma_f32_16x16x32_bf16 v[140:143], a[208:211], v[48:51], 0
    v_mfma_f32_16x16x32_bf16 v[132:135], a[212:215], v[36:39], v[132:135]
    v_mfma_f32_16x16x32_bf16 v[140:143], a[212:215], v[52:55], v[140:143]
    v_mfma_f32_16x16x32_bf16 v[132:135], a[216:219], v[40:43], v[132:135]
    v_mfma_f32_16x16x32_bf16 v[140:143], a[216:219], v[56:59], v[140:143]
    v_mfma_f32_16x16x32_bf16 v[132:135], a[220:223], v[44:47], v[132:135]
    v_mfma_f32_16x16x32_bf16 v[140:143], a[220:223], v[60:63], v[140:143]
    s_nop 7
    v_max3_f32 v14, v128, v129, v130
    v_max3_f32 v15, v136, v137, v138
    v_max3_f32 v14, v14, v131, v132
    v_max3_f32 v15, v15, v139, v140
    v_max3_f32 v14, v14, v133, v134
    v_max3_f32 v15, v15, v141, v142
    v_max_f32 v14, v14, v135
    v_max_f32 v15, v15, v143
    v_mov_b32 v16, v14
    s_nop 1
    v_permlane16_swap_b32 v14, v16
    s_nop 1
    v_max_f32 v14, v14, v16
    v_mov_b32 v16, v14
    s_nop 1
    v_permlane32_swap_b32 v14, v16
    s_nop 1
    v_max_f32 v14, v14, v16
    v_sub_f32 v128, v128, v14
    v_sub_f32 v129, v129, v14
    v_sub_f32 v130, v130, v14
    v_sub_f32 v131, v131, v14
    v_sub_f32 v132, v132, v14
    v_sub_f32 v133, v133, v14
    v_sub_f32 v134, v134, v14
    v_sub_f32 v135, v135, v14
    v_sub_f32 v176, 0, v14
    v_sub_f32 v177, 0, v14
    v_sub_f32 v178, 0, v14
    v_sub_f32 v179, 0, v14
    v_mov_b32 v8, 0
    v_mov_b32 v16, v15
    s_nop 1
    v_permlane16_swap_b32 v15, v16
    s_nop 1
    v_max_f32 v15, v15, v16
    v_mov_b32 v16, v15
    s_nop 1
    v_permlane32_swap_b32 v15, v16
    s_nop 1
    v_max_f32 v15, v15, v16
    v_sub_f32 v136, v136, v15
    v_sub_f32 v137, v137, v15
    v_sub_f32 v138, v138, v15
    v_sub_f32 v139, v139, v15
    v_sub_f32 v140, v140, v15
    v_sub_f32 v141, v141, v15
    v_sub_f32 v142, v142, v15
    v_sub_f32 v143, v143, v15
    v_sub_f32 v180, 0, v15
    v_sub_f32 v181, 0, v15
    v_sub_f32 v182, 0, v15
    v_sub_f32 v183, 0, v15
    v_mov_b32 v9, 0
    v_exp_f32 v128, v128
    v_exp_f32 v129, v129
    v_exp_f32 v130, v130
    v_add_f32 v8, v8, v128
    v_add_f32 v8, v8, v129
    v_exp_f32 v131, v131
    v_exp_f32 v136, v136
    v_add_f32 v8, v8, v130
    v_cvt_pk_bf16_f32 v200, v128, v129
    v_add_f32 v8, v8, v131
    v_cvt_pk_bf16_f32 v201, v130, v131
    v_exp_f32 v137, v137
    v_exp_f32 v138, v138
    v_add_f32 v9, v9, v136
    v_add_f32 v9, v9, v137
    v_mfma_f32_16x16x32_bf16 v[144:147], a[192:195], v[64:67], 0
    v_exp_f32 v139, v139
    v_mfma_f32_16x16x32_bf16 v[152:155], a[192:195], v[80:83], 0
    v_exp_f32 v132, v132
    v_mfma_f32_16x16x32_bf16 v[144:147], a[196:199], v[68:71], v[144:147]
    v_add_f32 v9, v9, v138
    v_cvt_pk_bf16_f32 v204, v136, v137
    v_mfma_f32_16x16x32_bf16 v[152:155], a[196:199], v[84:87], v[152:155]
    v_add_f32 v9, v9, v139
    v_cvt_pk_bf16_f32 v205, v138, v139
    v_mfma_f32_16x16x32_bf16 v[144:147], a[200:203], v[72:75], v[144:147]
    v_exp_f32 v133, v133
    v_mfma_f32_16x16x32_bf16 v[152:155], a[200:203], v[88:91], v[152:155]
    v_exp_f32 v134, v134
    v_mfma_f32_16x16x32_bf16 v[144:147], a[204:207], v[76:79], v[144:147]
    v_add_f32 v8, v8, v132
    v_add_f32 v8, v8, v133
    v_mfma_f32_16x16x32_bf16 v[152:155], a[204:207], v[92:95], v[152:155]
    v_exp_f32 v135, v135
    v_mfma_f32_16x16x32_bf16 v[148:151], a[208:211], v[64:67], 0
    v_exp_f32 v140, v140
    v_mfma_f32_16x16x32_bf16 v[156:159], a[208:211], v[80:83], 0
    v_add_f32 v8, v8, v134
    v_cvt_pk_bf16_f32 v202, v132, v133
    v_mfma_f32_16x16x32_bf16 v[148:151], a[212:215], v[68:71], v[148:151]
    v_add_f32 v8, v8, v135
    v_cvt_pk_bf16_f32 v203, v134, v135
    v_mfma_f32_16x16x32_bf16 v[156:159], a[212:215], v[84:87], v[156:159]
    v_exp_f32 v141, v141
    v_mfma_f32_16x16x32_bf16 v[148:151], a[216:219], v[72:75], v[148:151]
    v_exp_f32 v142, v142
    v_add_f32 v9, v9, v140
    v_add_f32 v9, v9, v141
    v_mfma_f32_16x16x32_bf16 v[156:159], a[216:219], v[88:91], v[156:159]
    v_exp_f32 v143, v143
    s_nop 0
    v_add_f32 v9, v9, v142
    v_cvt_pk_bf16_f32 v206, v140, v141
    v_add_f32 v9, v9, v143
    v_cvt_pk_bf16_f32 v207, v142, v143
    v_mfma_f32_16x16x32_bf16 v[148:151], a[220:223], v[76:79], v[148:151]
    v_mfma_f32_16x16x32_bf16 v[156:159], a[220:223], v[92:95], v[156:159]
    s_waitcnt lgkmcnt(0)
    v_mfma_f32_16x16x32_bf16 a[0:3], a[224:227], v[200:203], 0
    v_mfma_f32_16x16x32_bf16 a[32:35], a[224:227], v[204:207], 0
    v_mfma_f32_16x16x32_bf16 a[4:7], a[228:231], v[200:203], 0
    v_max3_f32 v14, v144, v145, v146
    v_max3_f32 v15, v152, v153, v154
    v_mfma_f32_16x16x32_bf16 a[36:39], a[228:231], v[204:207], 0
    v_max3_f32 v14, v14, v147, v148
    v_max3_f32 v15, v15, v155, v156
    v_mfma_f32_16x16x32_bf16 a[8:11], a[232:235], v[200:203], 0
    v_max3_f32 v14, v14, v149, v150
    v_max3_f32 v15, v15, v157, v158
    v_mfma_f32_16x16x32_bf16 a[40:43], a[232:235], v[204:207], 0
    v_max_f32 v14, v14, v151
    v_max_f32 v15, v15, v159
    v_mfma_f32_16x16x32_bf16 a[12:15], a[236:239], v[200:203], 0
    v_mov_b32 v16, v14
    s_nop 1
    v_permlane16_swap_b32 v14, v16
    s_nop 1
    v_max_f32 v14, v14, v16
    v_mov_b32 v16, v14
    s_nop 1
    v_permlane32_swap_b32 v14, v16
    s_nop 1
    v_max_f32 v14, v14, v16
    v_mfma_f32_16x16x32_bf16 a[44:47], a[236:239], v[204:207], 0
    v_sub_f32 v144, v144, v14
    v_sub_f32 v145, v145, v14
    v_sub_f32 v146, v146, v14
    v_sub_f32 v147, v147, v14
    v_sub_f32 v148, v148, v14
    v_sub_f32 v149, v149, v14
    v_sub_f32 v150, v150, v14
    v_sub_f32 v151, v151, v14
    v_sub_f32 v184, 0, v14
    v_sub_f32 v185, 0, v14
    v_sub_f32 v186, 0, v14
    v_sub_f32 v187, 0, v14
    v_mov_b32 v10, 0
    v_mov_b32 v16, v15
    s_nop 1
    v_permlane16_swap_b32 v15, v16
    s_nop 1
    v_max_f32 v15, v15, v16
    v_mov_b32 v16, v15
    s_nop 1
    v_permlane32_swap_b32 v15, v16
    s_nop 1
    v_max_f32 v15, v15, v16
    v_mfma_f32_16x16x32_bf16 a[16:19], a[240:243], v[200:203], 0
    v_sub_f32 v152, v152, v15
    v_sub_f32 v153, v153, v15
    v_mfma_f32_16x16x32_bf16 a[48:51], a[240:243], v[204:207], 0
    v_sub_f32 v154, v154, v15
    v_sub_f32 v155, v155, v15
    v_mfma_f32_16x16x32_bf16 a[20:23], a[244:247], v[200:203], 0
    v_sub_f32 v156, v156, v15
    v_sub_f32 v157, v157, v15
    v_mfma_f32_16x16x32_bf16 a[52:55], a[244:247], v[204:207], 0
    v_sub_f32 v158, v158, v15
    v_sub_f32 v159, v159, v15
    v_mfma_f32_16x16x32_bf16 a[24:27], a[248:251], v[200:203], 0
    v_sub_f32 v188, 0, v15
    v_sub_f32 v189, 0, v15
    v_mfma_f32_16x16x32_bf16 a[56:59], a[248:251], v[204:207], 0
    v_sub_f32 v190, 0, v15
    v_sub_f32 v191, 0, v15
    v_mfma_f32_16x16x32_bf16 a[28:31], a[252:255], v[200:203], 0
    v_mov_b32 v11, 0
    v_exp_f32 v144, v144
    v_mfma_f32_16x16x32_bf16 a[60:63], a[252:255], v[204:207], 0
    v_exp_f32 v145, v145
    v_exp_f32 v146, v146
    s_waitcnt vmcnt(16)
    s_barrier
    v_mfma_f32_16x16x32_bf16 v[160:163], a[192:195], v[96:99], 0
    v_add_f32 v10, v10, v144
    v_add_f32 v10, v10, v145
    v_exp_f32 v147, v147
    v_mfma_f32_16x16x32_bf16 v[168:171], a[192:195], v[112:115], 0
    v_exp_f32 v152, v152
    v_mfma_f32_16x16x32_bf16 v[160:163], a[196:199], v[100:103], v[160:163]
    v_add_f32 v10, v10, v146
    v_cvt_pk_bf16_f32 v208, v144, v145
    v_add_f32 v10, v10, v147
    v_cvt_pk_bf16_f32 v209, v146, v147
    v_mfma_f32_16x16x32_bf16 v[168:171], a[196:199], v[116:119], v[168:171]
    v_exp_f32 v153, v153
    v_exp_f32 v154, v154
    v_mfma_f32_16x16x32_bf16 v[160:163], a[200:203], v[104:107], v[160:163]
    v_add_f32 v11, v11, v152
    v_add_f32 v11, v11, v153
    v_mfma_f32_16x16x32_bf16 v[168:171], a[200:203], v[120:123], v[168:171]
    v_exp_f32 v155, v155
    v_exp_f32 v148, v148
    v_mfma_f32_16x16x32_bf16 v[160:163], a[204:207], v[108:111], v[160:163]
    ds_read_b128 a[192:195], v2 offset:33792
    ds_read_b128 a[196:199], v2 offset:33856
    v_add_f32 v11, v11, v154
    v_cvt_pk_bf16_f32 v212, v152, v153
    v_add_f32 v11, v11, v155
    v_cvt_pk_bf16_f32 v213, v154, v155
    v_mfma_f32_16x16x32_bf16 v[168:171], a[204:207], v[124:127], v[168:171]
    v_exp_f32 v149, v149
    v_exp_f32 v150, v150
    v_mfma_f32_16x16x32_bf16 v[164:167], a[208:211], v[96:99], 0
    v_add_f32 v10, v10, v148
    v_add_f32 v10, v10, v149
    ds_read_b128 a[200:203], v2 offset:33920
    ds_read_b128 a[204:207], v2 offset:33984
    v_mfma_f32_16x16x32_bf16 v[172:175], a[208:211], v[112:115], 0
    v_exp_f32 v151, v151
    v_exp_f32 v156, v156
    v_mfma_f32_16x16x32_bf16 v[164:167], a[212:215], v[100:103], v[164:167]
    v_add_f32 v10, v10, v150
    v_cvt_pk_bf16_f32 v210, v148, v149
    v_add_f32 v10, v10, v151
    v_cvt_pk_bf16_f32 v211, v150, v151
    v_mfma_f32_16x16x32_bf16 v[172:175], a[212:215], v[116:119], v[172:175]
    v_exp_f32 v157, v157
    v_mfma_f32_16x16x32_bf16 v[164:167], a[216:219], v[104:107], v[164:167]
    v_exp_f32 v158, v158
    v_add_f32 v11, v11, v156
    v_add_f32 v11, v11, v157
    v_mfma_f32_16x16x32_bf16 v[172:175], a[216:219], v[120:123], v[172:175]
    s_sub_u32 s40, s40, 8192
    v_exp_f32 v159, v159
    s_nop 0
    v_add_f32 v11, v11, v158
    v_cvt_pk_bf16_f32 v214, v156, v157
    v_add_f32 v11, v11, v159
    v_cvt_pk_bf16_f32 v215, v158, v159
    v_mfma_f32_16x16x32_bf16 v[164:167], a[220:223], v[108:111], v[164:167]
    s_add_u32 m0, s38, 8448
    ds_read_b128 a[208:211], v2 offset:34304
    ds_read_b128 a[212:215], v2 offset:34368
    v_mfma_f32_16x16x32_bf16 v[172:175], a[220:223], v[124:127], v[172:175]
    s_add_u32 s46, s40, 8192
    ds_read_b128 a[216:219], v2 offset:34432
    ds_read_b128 a[220:223], v2 offset:34496
    v_mfma_f32_16x16x32_bf16 a[64:67], a[224:227], v[208:211], 0
    s_waitcnt vmcnt(4)
    buffer_load_dwordx4 v6, s[96:99], s46 offen offset:0 nt lds
    buffer_load_dwordx4 v7, s[96:99], s46 offen offset:1056 nt lds
    v_mfma_f32_16x16x32_bf16 a[96:99], a[224:227], v[212:215], 0
    v_mfma_f32_16x16x32_bf16 a[68:71], a[228:231], v[208:211], 0
    v_max3_f32 v14, v160, v161, v162
    v_max3_f32 v15, v168, v169, v170
    v_mfma_f32_16x16x32_bf16 a[100:103], a[228:231], v[212:215], 0
    v_max3_f32 v14, v14, v163, v164
    v_max3_f32 v15, v15, v171, v172
    v_mfma_f32_16x16x32_bf16 a[72:75], a[232:235], v[208:211], 0
    v_max3_f32 v14, v14, v165, v166
    v_max3_f32 v15, v15, v173, v174
    v_mfma_f32_16x16x32_bf16 a[104:107], a[232:235], v[212:215], 0
    v_max_f32 v14, v14, v167
    v_max_f32 v15, v15, v175
    v_mfma_f32_16x16x32_bf16 a[76:79], a[236:239], v[208:211], 0
    v_mov_b32 v16, v14
    s_nop 1
    v_permlane16_swap_b32 v14, v16
    s_nop 1
    v_max_f32 v14, v14, v16
    v_mov_b32 v16, v14
    s_nop 1
    v_permlane32_swap_b32 v14, v16
    s_nop 1
    v_max_f32 v14, v14, v16
    v_mfma_f32_16x16x32_bf16 a[108:111], a[236:239], v[212:215], 0
    v_sub_f32 v160, v160, v14
    v_sub_f32 v161, v161, v14
    v_sub_f32 v162, v162, v14
    v_sub_f32 v163, v163, v14
    v_sub_f32 v164, v164, v14
    v_sub_f32 v165, v165, v14
    v_sub_f32 v166, v166, v14
    v_sub_f32 v167, v167, v14
    v_sub_f32 v192, 0, v14
    v_sub_f32 v193, 0, v14
    v_sub_f32 v194, 0, v14
    v_sub_f32 v195, 0, v14
    v_mov_b32 v12, 0
    v_mov_b32 v16, v15
    s_nop 1
    v_permlane16_swap_b32 v15, v16
    s_nop 1
    v_max_f32 v15, v15, v16
    v_mov_b32 v16, v15
    s_nop 1
    v_permlane32_swap_b32 v15, v16
    s_nop 1
    v_max_f32 v15, v15, v16
    v_mfma_f32_16x16x32_bf16 a[80:83], a[240:243], v[208:211], 0
    v_sub_f32 v168, v168, v15
    v_sub_f32 v169, v169, v15
    v_mfma_f32_16x16x32_bf16 a[112:115], a[240:243], v[212:215], 0
    v_sub_f32 v170, v170, v15
    v_sub_f32 v171, v171, v15
    v_mfma_f32_16x16x32_bf16 a[84:87], a[244:247], v[208:211], 0
    v_sub_f32 v172, v172, v15
    v_sub_f32 v173, v173, v15
    v_mfma_f32_16x16x32_bf16 a[116:119], a[244:247], v[212:215], 0
    v_sub_f32 v174, v174, v15
    v_sub_f32 v175, v175, v15
    v_mfma_f32_16x16x32_bf16 a[88:91], a[248:251], v[208:211], 0
    v_sub_f32 v196, 0, v15
    v_sub_f32 v197, 0, v15
    v_mfma_f32_16x16x32_bf16 a[120:123], a[248:251], v[212:215], 0
    v_sub_f32 v198, 0, v15
    v_sub_f32 v199, 0, v15
    v_mfma_f32_16x16x32_bf16 a[92:95], a[252:255], v[208:211], 0
    v_mov_b32 v13, 0
    v_exp_f32 v160, v160
    v_mfma_f32_16x16x32_bf16 a[124:127], a[252:255], v[212:215], 0
    v_exp_f32 v161, v161
    v_exp_f32 v162, v162
    s_waitcnt lgkmcnt(0)
    v_mfma_f32_16x16x32_bf16 v[128:131], a[192:195], v[32:35], v[176:179]
    v_add_f32 v12, v12, v160
    v_add_f32 v12, v12, v161
    v_exp_f32 v163, v163
    v_mfma_f32_16x16x32_bf16 v[136:139], a[192:195], v[48:51], v[180:183]
    v_exp_f32 v168, v168
    v_mfma_f32_16x16x32_bf16 v[128:131], a[196:199], v[36:39], v[128:131]
    v_add_f32 v12, v12, v162
    v_cvt_pk_bf16_f32 v216, v160, v161
    v_add_f32 v12, v12, v163
    v_cvt_pk_bf16_f32 v217, v162, v163
    v_mfma_f32_16x16x32_bf16 v[136:139], a[196:199], v[52:55], v[136:139]
    v_exp_f32 v169, v169
    v_exp_f32 v170, v170
    v_mfma_f32_16x16x32_bf16 v[128:131], a[200:203], v[40:43], v[128:131]
    v_add_f32 v13, v13, v168
    v_add_f32 v13, v13, v169
    v_mfma_f32_16x16x32_bf16 v[136:139], a[200:203], v[56:59], v[136:139]
    v_exp_f32 v171, v171
    v_exp_f32 v164, v164
    v_mfma_f32_16x16x32_bf16 v[128:131], a[204:207], v[44:47], v[128:131]
    v_add_f32 v13, v13, v170
    v_cvt_pk_bf16_f32 v220, v168, v169
    v_add_f32 v13, v13, v171
    v_cvt_pk_bf16_f32 v221, v170, v171
    v_mfma_f32_16x16x32_bf16 v[136:139], a[204:207], v[60:63], v[136:139]
    v_exp_f32 v165, v165
    v_exp_f32 v166, v166
    v_mfma_f32_16x16x32_bf16 v[132:135], a[208:211], v[32:35], v[176:179]
    v_add_f32 v12, v12, v164
    v_add_f32 v12, v12, v165
    v_mfma_f32_16x16x32_bf16 v[140:143], a[208:211], v[48:51], v[180:183]
    v_exp_f32 v167, v167
    v_exp_f32 v172, v172
    v_mfma_f32_16x16x32_bf16 v[132:135], a[212:215], v[36:39], v[132:135]
    v_add_f32 v12, v12, v166
    v_cvt_pk_bf16_f32 v218, v164, v165
    v_add_f32 v12, v12, v167
    v_cvt_pk_bf16_f32 v219, v166, v167
    v_mfma_f32_16x16x32_bf16 v[140:143], a[212:215], v[52:55], v[140:143]
    v_exp_f32 v173, v173
    v_mfma_f32_16x16x32_bf16 v[132:135], a[216:219], v[40:43], v[132:135]
    v_exp_f32 v174, v174
    v_add_f32 v13, v13, v172
    v_add_f32 v13, v13, v173
    v_mfma_f32_16x16x32_bf16 v[140:143], a[216:219], v[56:59], v[140:143]
    v_exp_f32 v175, v175
    s_nop 0
    v_add_f32 v13, v13, v174
    v_cvt_pk_bf16_f32 v222, v172, v173
    v_add_f32 v13, v13, v175
    v_cvt_pk_bf16_f32 v223, v174, v175
    v_mfma_f32_16x16x32_bf16 v[132:135], a[220:223], v[44:47], v[132:135]
    v_mfma_f32_16x16x32_bf16 v[140:143], a[220:223], v[60:63], v[140:143]
    v_mfma_f32_16x16x32_bf16 a[128:131], a[224:227], v[216:219], 0
    v_mfma_f32_16x16x32_bf16 a[160:163], a[224:227], v[220:223], 0
    ds_read_b64_tr_b16 a[224:225], v4 offset:33792
    ds_read_b64_tr_b16 a[226:227], v4 offset:34304
    v_mfma_f32_16x16x32_bf16 a[132:135], a[228:231], v[216:219], 0
    v_max3_f32 v14, v128, v129, v130
    v_max3_f32 v15, v136, v137, v138
    v_mfma_f32_16x16x32_bf16 a[164:167], a[228:231], v[220:223], 0
    v_max3_f32 v14, v14, v131, v132
    v_max3_f32 v15, v15, v139, v140
    v_mfma_f32_16x16x32_bf16 a[136:139], a[232:235], v[216:219], 0
    v_max3_f32 v14, v14, v133, v134
    v_max3_f32 v15, v15, v141, v142
    v_mfma_f32_16x16x32_bf16 a[168:171], a[232:235], v[220:223], 0
    v_max_f32 v14, v14, v135
    v_max_f32 v15, v15, v143
    v_mfma_f32_16x16x32_bf16 a[140:143], a[236:239], v[216:219], 0
    v_max_f32 v16, v14, v15
    v_mfma_f32_16x16x32_bf16 a[172:175], a[236:239], v[220:223], 0
    v_cmp_lt_f32 vcc, 0x41000000, v16
    s_nop 0
    s_cbranch_vccnz L_st_sp0_0
L_st_sp0_0_ret:
    v_exp_f32 v128, v128
    v_exp_f32 v129, v129
    v_exp_f32 v130, v130
    v_add_f32 v8, v8, v128
    v_add_f32 v8, v8, v129
    v_mfma_f32_16x16x32_bf16 a[144:147], a[240:243], v[216:219], 0
    v_exp_f32 v131, v131
    v_exp_f32 v136, v136
    v_mfma_f32_16x16x32_bf16 a[176:179], a[240:243], v[220:223], 0
    v_add_f32 v8, v8, v130
    v_cvt_pk_bf16_f32 v200, v128, v129
    v_add_f32 v8, v8, v131
    v_cvt_pk_bf16_f32 v201, v130, v131
    v_mfma_f32_16x16x32_bf16 a[148:151], a[244:247], v[216:219], 0
    ds_read_b64_tr_b16 a[228:229], v4 offset:33824
    ds_read_b64_tr_b16 a[230:231], v4 offset:34336
    v_mfma_f32_16x16x32_bf16 a[180:183], a[244:247], v[220:223], 0
    v_exp_f32 v137, v137
    v_mfma_f32_16x16x32_bf16 a[152:155], a[248:251], v[216:219], 0
    v_exp_f32 v138, v138
    v_mfma_f32_16x16x32_bf16 a[184:187], a[248:251], v[220:223], 0
    v_add_f32 v9, v9, v136
    v_add_f32 v9, v9, v137
    v_exp_f32 v139, v139
    v_mfma_f32_16x16x32_bf16 a[156:159], a[252:255], v[216:219], 0
    ds_read_b64_tr_b16 a[232:233], v4 offset:33856
    ds_read_b64_tr_b16 a[234:235], v4 offset:34368
    ds_read_b64_tr_b16 a[236:237], v4 offset:33888
    ds_read_b64_tr_b16 a[238:239], v4 offset:34400
    v_mfma_f32_16x16x32_bf16 a[188:191], a[252:255], v[220:223], 0
    v_exp_f32 v132, v132
    v_add_f32 v9, v9, v138
    v_cvt_pk_bf16_f32 v204, v136, v137
    v_add_f32 v9, v9, v139
    v_cvt_pk_bf16_f32 v205, v138, v139
    v_exp_f32 v133, v133
    v_exp_f32 v134, v134
    v_add_f32 v8, v8, v132
    v_add_f32 v8, v8, v133
    s_mov_b32 s41, 0
    .p2align 6
L_loop_s:
    v_mfma_f32_16x16x32_bf16 v[144:147], a[192:195], v[64:67], v[184:187]
    ds_read_b64_tr_b16 a[240:241], v4 offset:33920
    ds_read_b64_tr_b16 a[242:243], v4 offset:34432
    v_mfma_f32_16x16x32_bf16 v[152:155], a[192:195], v[80:83], v[188:191]
    v_exp_f32 v135, v135
    v_mfma_f32_16x16x32_bf16 v[144:147], a[196:199], v[68:71], v[144:147]
    v_exp_f32 v140, v140
    v_mfma_f32_16x16x32_bf16 v[152:155], a[196:199], v[84:87], v[152:155]
    ds_read_b64_tr_b16 a[244:245], v4 offset:33952
    ds_read_b64_tr_b16 a[246:247], v4 offset:34464
    v_mfma_f32_16x16x32_bf16 v[144:147], a[200:203], v[72:75], v[144:147]
    v_add_f32 v8, v8, v134
    v_cvt_pk_bf16_f32 v202, v132, v133
    v_mfma_f32_16x16x32_bf16 v[152:155], a[200:203], v[88:91], v[152:155]
    v_add_f32 v8, v8, v135
    v_cvt_pk_bf16_f32 v203, v134, v135
    v_mfma_f32_16x16x32_bf16 v[144:147], a[204:207], v[76:79], v[144:147]
    v_exp_f32 v141, v141
    v_mfma_f32_16x16x32_bf16 v[152:155], a[204:207], v[92:95], v[152:155]
    ds_read_b64_tr_b16 a[248:249], v4 offset:33984
    ds_read_b64_tr_b16 a[250:251], v4 offset:34496
    v_mfma_f32_16x16x32_bf16 v[148:151], a[208:211], v[64:67], v[184:187]
    v_exp_f32 v142, v142
    v_mfma_f32_16x16x32_bf16 v[156:159], a[208:211], v[80:83], v[188:191]
    v_add_f32 v9, v9, v140
    v_add_f32 v9, v9, v141
    v_mfma_f32_16x16x32_bf16 v[148:151], a[212:215], v[68:71], v[148:151]
    ds_read_b64_tr_b16 a[252:253], v4 offset:34016
    ds_read_b64_tr_b16 a[254:255], v4 offset:34528
    v_mfma_f32_16x16x32_bf16 v[156:159], a[212:215], v[84:87], v[156:159]
    v_exp_f32 v143, v143
    v_mfma_f32_16x16x32_bf16 v[148:151], a[216:219], v[72:75], v[148:151]
    s_add_u32 m0, s38, 25344
    s_nop 0
    v_add_f32 v9, v9, v142
    v_cvt_pk_bf16_f32 v206, v140, v141
    v_mfma_f32_16x16x32_bf16 v[156:159], a[216:219], v[88:91], v[156:159]
    s_add_u32 s46, s40, 270336
    v_add_f32 v9, v9, v143
    v_cvt_pk_bf16_f32 v207, v142, v143
    v_mfma_f32_16x16x32_bf16 v[148:151], a[220:223], v[76:79], v[148:151]
    s_waitcnt vmcnt(4)
    buffer_load_dwordx4 v6, s[96:99], s46 offen offset:0 nt lds
    buffer_load_dwordx4 v7, s[96:99], s46 offen offset:1056 nt lds
    v_mfma_f32_16x16x32_bf16 v[156:159], a[220:223], v[92:95], v[156:159]
    s_waitcnt lgkmcnt(0)
    v_mfma_f32_16x16x32_bf16 a[0:3], a[224:227], v[200:203], a[0:3]
    v_mfma_f32_16x16x32_bf16 a[32:35], a[224:227], v[204:207], a[32:35]
    v_mfma_f32_16x16x32_bf16 a[4:7], a[228:231], v[200:203], a[4:7]
    v_max3_f32 v14, v144, v145, v146
    v_max3_f32 v15, v152, v153, v154
    v_mfma_f32_16x16x32_bf16 a[36:39], a[228:231], v[204:207], a[36:39]
    v_max3_f32 v14, v14, v147, v148
    v_max3_f32 v15, v15, v155, v156
    v_mfma_f32_16x16x32_bf16 a[8:11], a[232:235], v[200:203], a[8:11]
    v_max3_f32 v14, v14, v149, v150
    v_max3_f32 v15, v15, v157, v158
    v_mfma_f32_16x16x32_bf16 a[40:43], a[232:235], v[204:207], a[40:43]
    v_max_f32 v14, v14, v151
    v_max_f32 v15, v15, v159
    v_mfma_f32_16x16x32_bf16 a[12:15], a[236:239], v[200:203], a[12:15]
    v_max_f32 v16, v14, v15
    v_mfma_f32_16x16x32_bf16 a[44:47], a[236:239], v[204:207], a[44:47]
    v_cmp_lt_f32 vcc, 0x41000000, v16
    s_nop 0
    s_cbranch_vccnz L_st_sl0_1
L_st_sl0_1_ret:
    v_exp_f32 v144, v144
    v_exp_f32 v145, v145
    v_exp_f32 v146, v146
    v_add_f32 v10, v10, v144
    v_add_f32 v10, v10, v145
    v_mfma_f32_16x16x32_bf16 a[16:19], a[240:243], v[200:203], a[16:19]
    v_exp_f32 v147, v147
    v_exp_f32 v152, v152
    v_mfma_f32_16x16x32_bf16 a[48:51], a[240:243], v[204:207], a[48:51]
    v_add_f32 v10, v10, v146
    v_cvt_pk_bf16_f32 v208, v144, v145
    v_mfma_f32_16x16x32_bf16 a[20:23], a[244:247], v[200:203], a[20:23]
    v_add_f32 v10, v10, v147
    v_cvt_pk_bf16_f32 v209, v146, v147
    v_mfma_f32_16x16x32_bf16 a[52:55], a[244:247], v[204:207], a[52:55]
    v_exp_f32 v153, v153
    v_mfma_f32_16x16x32_bf16 a[24:27], a[248:251], v[200:203], a[24:27]
    v_exp_f32 v154, v154
    v_mfma_f32_16x16x32_bf16 a[56:59], a[248:251], v[204:207], a[56:59]
    v_add_f32 v11, v11, v152
    v_add_f32 v11, v11, v153
    v_mfma_f32_16x16x32_bf16 a[28:31], a[252:255], v[200:203], a[28:31]
    v_exp_f32 v155, v155
    v_mfma_f32_16x16x32_bf16 a[60:63], a[252:255], v[204:207], a[60:63]
    v_exp_f32 v148, v148
    s_waitcnt vmcnt(6)
    s_barrier
    v_mfma_f32_16x16x32_bf16 v[160:163], a[192:195], v[96:99], v[192:195]
    s_add_u32 s40, s40, 16384
    v_add_f32 v11, v11, v154
    v_cvt_pk_bf16_f32 v212, v152, v153
    v_mfma_f32_16x16x32_bf16 v[168:171], a[192:195], v[112:115], v[196:199]
    v_add_f32 v11, v11, v155
    v_cvt_pk_bf16_f32 v213, v154, v155
    s_add_u32 m0, s38, 0
    s_add_u32 s46, s39, 0
    s_waitcnt vmcnt(2)
    buffer_load_dwordx4 v6, s[16:19], s46 offen offset:0 nt lds
    buffer_load_dwordx4 v7, s[16:19], s46 offen offset:1056 nt lds
    v_mfma_f32_16x16x32_bf16 v[160:163], a[196:199], v[100:103], v[160:163]
    v_exp_f32 v149, v149
    v_mfma_f32_16x16x32_bf16 v[168:171], a[196:199], v[116:119], v[168:171]
    v_exp_f32 v150, v150
    v_mfma_f32_16x16x32_bf16 v[160:163], a[200:203], v[104:107], v[160:163]
    v_add_f32 v10, v10, v148
    v_add_f32 v10, v10, v149
    v_mfma_f32_16x16x32_bf16 v[168:171], a[200:203], v[120:123], v[168:171]
    v_exp_f32 v151, v151
    v_exp_f32 v156, v156
    v_mfma_f32_16x16x32_bf16 v[160:163], a[204:207], v[108:111], v[160:163]
    ds_read_b128 a[192:195], v3 offset:0
    ds_read_b128 a[196:199], v3 offset:64
    v_mfma_f32_16x16x32_bf16 v[168:171], a[204:207], v[124:127], v[168:171]
    v_add_f32 v10, v10, v150
    v_cvt_pk_bf16_f32 v210, v148, v149
    ds_read_b128 a[200:203], v3 offset:128
    ds_read_b128 a[204:207], v3 offset:192
    v_mfma_f32_16x16x32_bf16 v[164:167], a[208:211], v[96:99], v[192:195]
    v_add_f32 v10, v10, v151
    v_cvt_pk_bf16_f32 v211, v150, v151
    v_mfma_f32_16x16x32_bf16 v[172:175], a[208:211], v[112:115], v[196:199]
    v_exp_f32 v157, v157
    v_mfma_f32_16x16x32_bf16 v[164:167], a[212:215], v[100:103], v[164:167]
    v_exp_f32 v158, v158
    v_mfma_f32_16x16x32_bf16 v[172:175], a[212:215], v[116:119], v[172:175]
    v_add_f32 v11, v11, v156
    v_add_f32 v11, v11, v157
    v_mfma_f32_16x16x32_bf16 v[164:167], a[216:219], v[104:107], v[164:167]
    v_exp_f32 v159, v159
    v_mfma_f32_16x16x32_bf16 v[172:175], a[216:219], v[120:123], v[172:175]
    s_nop 0
    v_add_f32 v11, v11, v158
    v_cvt_pk_bf16_f32 v214, v156, v157
    v_add_f32 v11, v11, v159
    v_cvt_pk_bf16_f32 v215, v158, v159
    v_mfma_f32_16x16x32_bf16 v[164:167], a[220:223], v[108:111], v[164:167]
    ds_read_b128 a[208:211], v3 offset:512
    ds_read_b128 a[212:215], v3 offset:576
    v_mfma_f32_16x16x32_bf16 v[172:175], a[220:223], v[124:127], v[172:175]
    ds_read_b128 a[216:219], v3 offset:640
    ds_read_b128 a[220:223], v3 offset:704
    v_mfma_f32_16x16x32_bf16 a[64:67], a[224:227], v[208:211], a[64:67]
    v_mfma_f32_16x16x32_bf16 a[96:99], a[224:227], v[212:215], a[96:99]
    v_mfma_f32_16x16x32_bf16 a[68:71], a[228:231], v[208:211], a[68:71]
    v_max3_f32 v14, v160, v161, v162
    v_max3_f32 v15, v168, v169, v170
    v_mfma_f32_16x16x32_bf16 a[100:103], a[228:231], v[212:215], a[100:103]
    v_max3_f32 v14, v14, v163, v164
    v_max3_f32 v15, v15, v171, v172
    v_mfma_f32_16x16x32_bf16 a[72:75], a[232:235], v[208:211], a[72:75]
    v_max3_f32 v14, v14, v165, v166
    v_max3_f32 v15, v15, v173, v174
    v_mfma_f32_16x16x32_bf16 a[104:107], a[232:235], v[212:215], a[104:107]
    v_max_f32 v14, v14, v167
    v_max_f32 v15, v15, v175
    v_mfma_f32_16x16x32_bf16 a[76:79], a[236:239], v[208:211], a[76:79]
    v_max_f32 v16, v14, v15
    v_mfma_f32_16x16x32_bf16 a[108:111], a[236:239], v[212:215], a[108:111]
    s_add_u32 m0, s38, 33792
    v_cmp_lt_f32 vcc, 0x41000000, v16
    s_nop 0
    s_cbranch_vccnz L_st_sl0_2
L_st_sl0_2_ret:
    v_exp_f32 v160, v160
    v_exp_f32 v161, v161
    v_exp_f32 v162, v162
    v_add_f32 v12, v12, v160
    v_add_f32 v12, v12, v161
    v_mfma_f32_16x16x32_bf16 a[80:83], a[240:243], v[208:211], a[80:83]
    s_add_u32 s46, s39, 8192
    v_exp_f32 v163, v163
    v_exp_f32 v168, v168
    v_mfma_f32_16x16x32_bf16 a[112:115], a[240:243], v[212:215], a[112:115]
    v_add_f32 v12, v12, v162
    v_cvt_pk_bf16_f32 v216, v160, v161
    s_waitcnt vmcnt(4)
    buffer_load_dwordx4 v6, s[16:19], s46 offen offset:0 nt lds
    buffer_load_dwordx4 v7, s[16:19], s46 offen offset:1056 nt lds
    v_mfma_f32_16x16x32_bf16 a[84:87], a[244:247], v[208:211], a[84:87]
    v_add_f32 v12, v12, v163
    v_cvt_pk_bf16_f32 v217, v162, v163
    v_mfma_f32_16x16x32_bf16 a[116:119], a[244:247], v[212:215], a[116:119]
    v_exp_f32 v169, v169
    v_mfma_f32_16x16x32_bf16 a[88:91], a[248:251], v[208:211], a[88:91]
    v_exp_f32 v170, v170
    v_mfma_f32_16x16x32_bf16 a[120:123], a[248:251], v[212:215], a[120:123]
    v_add_f32 v13, v13, v168
    v_add_f32 v13, v13, v169
    v_mfma_f32_16x16x32_bf16 a[92:95], a[252:255], v[208:211], a[92:95]
    v_exp_f32 v171, v171
    v_mfma_f32_16x16x32_bf16 a[124:127], a[252:255], v[212:215], a[124:127]
    v_exp_f32 v164, v164
    s_waitcnt lgkmcnt(0)
    v_mfma_f32_16x16x32_bf16 v[128:131], a[192:195], v[32:35], v[176:179]
    v_add_f32 v13, v13, v170
    v_cvt_pk_bf16_f32 v220, v168, v169
    v_mfma_f32_16x16x32_bf16 v[136:139], a[192:195], v[48:51], v[180:183]
    v_add_f32 v13, v13, v171
    v_cvt_pk_bf16_f32 v221, v170, v171
    v_mfma_f32_16x16x32_bf16 v[128:131], a[196:199], v[36:39], v[128:131]
    v_exp_f32 v165, v165
    v_mfma_f32_16x16x32_bf16 v[136:139], a[196:199], v[52:55], v[136:139]
    v_exp_f32 v166, v166
    v_mfma_f32_16x16x32_bf16 v[128:131], a[200:203], v[40:43], v[128:131]
    v_add_f32 v12, v12, v164
    v_add_f32 v12, v12, v165
    v_mfma_f32_16x16x32_bf16 v[136:139], a[200:203], v[56:59], v[136:139]
    v_exp_f32 v167, v167
    v_mfma_f32_16x16x32_bf16 v[128:131], a[204:207], v[44:47], v[128:131]
    v_exp_f32 v172, v172
    v_mfma_f32_16x16x32_bf16 v[136:139], a[204:207], v[60:63], v[136:139]
    v_add_f32 v12, v12, v166
    v_cvt_pk_bf16_f32 v218, v164, v165
    v_mfma_f32_16x16x32_bf16 v[132:135], a[208:211], v[32:35], v[176:179]
    v_add_f32 v12, v12, v167
    v_cvt_pk_bf16_f32 v219, v166, v167
    v_mfma_f32_16x16x32_bf16 v[140:143], a[208:211], v[48:51], v[180:183]
    v_exp_f32 v173, v173
    v_mfma_f32_16x16x32_bf16 v[132:135], a[212:215], v[36:39], v[132:135]
    v_exp_f32 v174, v174
    v_mfma_f32_16x16x32_bf16 v[140:143], a[212:215], v[52:55], v[140:143]
    v_add_f32 v13, v13, v172
    v_add_f32 v13, v13, v173
    v_mfma_f32_16x16x32_bf16 v[132:135], a[216:219], v[40:43], v[132:135]
    v_exp_f32 v175, v175
    v_mfma_f32_16x16x32_bf16 v[140:143], a[216:219], v[56:59], v[140:143]
    s_nop 0
    v_add_f32 v13, v13, v174
    v_cvt_pk_bf16_f32 v222, v172, v173
    v_add_f32 v13, v13, v175
    v_cvt_pk_bf16_f32 v223, v174, v175
    v_mfma_f32_16x16x32_bf16 v[132:135], a[220:223], v[44:47], v[132:135]
    v_mfma_f32_16x16x32_bf16 v[140:143], a[220:223], v[60:63], v[140:143]
    v_mfma_f32_16x16x32_bf16 a[128:131], a[224:227], v[216:219], a[128:131]
    v_mfma_f32_16x16x32_bf16 a[160:163], a[224:227], v[220:223], a[160:163]
    ds_read_b64_tr_b16 a[224:225], v5 offset:0
    ds_read_b64_tr_b16 a[226:227], v5 offset:512
    v_mfma_f32_16x16x32_bf16 a[132:135], a[228:231], v[216:219], a[132:135]
    v_max3_f32 v14, v128, v129, v130
    v_max3_f32 v15, v136, v137, v138
    v_mfma_f32_16x16x32_bf16 a[164:167], a[228:231], v[220:223], a[164:167]
    v_max3_f32 v14, v14, v131, v132
    v_max3_f32 v15, v15, v139, v140
    v_mfma_f32_16x16x32_bf16 a[136:139], a[232:235], v[216:219], a[136:139]
    v_max3_f32 v14, v14, v133, v134
    v_max3_f32 v15, v15, v141, v142
    v_mfma_f32_16x16x32_bf16 a[168:171], a[232:235], v[220:223], a[168:171]
    v_max_f32 v14, v14, v135
    v_max_f32 v15, v15, v143
    v_mfma_f32_16x16x32_bf16 a[140:143], a[236:239], v[216:219], a[140:143]
    v_max_f32 v16, v14, v15
    v_mfma_f32_16x16x32_bf16 a[172:175], a[236:239], v[220:223], a[172:175]
    s_add_u32 m0, s38, 16896
    v_cmp_lt_f32 vcc, 0x41000000, v16
    s_nop 0
    s_cbranch_vccnz L_st_sl0_0
L_st_sl0_0_ret:
    v_exp_f32 v128, v128
    v_exp_f32 v129, v129
    v_exp_f32 v130, v130
    v_add_f32 v8, v8, v128
    v_add_f32 v8, v8, v129
    v_mfma_f32_16x16x32_bf16 a[144:147], a[240:243], v[216:219], a[144:147]
    s_add_u32 s46, s39, 262144
    v_exp_f32 v131, v131
    v_exp_f32 v136, v136
    v_mfma_f32_16x16x32_bf16 a[176:179], a[240:243], v[220:223], a[176:179]
    s_waitcnt vmcnt(2)
    buffer_load_dwordx4 v6, s[16:19], s46 offen offset:0 nt lds
    buffer_load_dwordx4 v7, s[16:19], s46 offen offset:1056 nt lds
    v_add_f32 v8, v8, v130
    v_cvt_pk_bf16_f32 v200, v128, v129
    v_mfma_f32_16x16x32_bf16 a[148:151], a[244:247], v[216:219], a[148:151]
    ds_read_b64_tr_b16 a[228:229], v5 offset:32
    ds_read_b64_tr_b16 a[230:231], v5 offset:544
    v_add_f32 v8, v8, v131
    v_cvt_pk_bf16_f32 v201, v130, v131
    v_mfma_f32_16x16x32_bf16 a[180:183], a[244:247], v[220:223], a[180:183]
    v_exp_f32 v137, v137
    v_mfma_f32_16x16x32_bf16 a[152:155], a[248:251], v[216:219], a[152:155]
    v_exp_f32 v138, v138
    v_mfma_f32_16x16x32_bf16 a[184:187], a[248:251], v[220:223], a[184:187]
    v_add_f32 v9, v9, v136
    v_add_f32 v9, v9, v137
    v_exp_f32 v139, v139
    v_mfma_f32_16x16x32_bf16 a[156:159], a[252:255], v[216:219], a[156:159]
    ds_read_b64_tr_b16 a[232:233], v5 offset:64
    ds_read_b64_tr_b16 a[234:235], v5 offset:576
    ds_read_b64_tr_b16 a[236:237], v5 offset:96
    ds_read_b64_tr_b16 a[238:239], v5 offset:608
    v_mfma_f32_16x16x32_bf16 a[188:191], a[252:255], v[220:223], a[188:191]
    v_exp_f32 v132, v132
    v_add_f32 v9, v9, v138
    v_cvt_pk_bf16_f32 v204, v136, v137
    v_add_f32 v9, v9, v139
    v_cvt_pk_bf16_f32 v205, v138, v139
    v_exp_f32 v133, v133
    v_exp_f32 v134, v134
    v_add_f32 v8, v8, v132
    v_add_f32 v8, v8, v133
    v_mfma_f32_16x16x32_bf16 v[144:147], a[192:195], v[64:67], v[184:187]
    ds_read_b64_tr_b16 a[240:241], v5 offset:128
    ds_read_b64_tr_b16 a[242:243], v5 offset:640
    v_mfma_f32_16x16x32_bf16 v[152:155], a[192:195], v[80:83], v[188:191]
    v_exp_f32 v135, v135
    v_mfma_f32_16x16x32_bf16 v[144:147], a[196:199], v[68:71], v[144:147]
    v_exp_f32 v140, v140
    v_mfma_f32_16x16x32_bf16 v[152:155], a[196:199], v[84:87], v[152:155]
    ds_read_b64_tr_b16 a[244:245], v5 offset:160
    ds_read_b64_tr_b16 a[246:247], v5 offset:672
    v_mfma_f32_16x16x32_bf16 v[144:147], a[200:203], v[72:75], v[144:147]
    v_add_f32 v8, v8, v134
    v_cvt_pk_bf16_f32 v202, v132, v133
    v_mfma_f32_16x16x32_bf16 v[152:155], a[200:203], v[88:91], v[152:155]
    v_add_f32 v8, v8, v135
    v_cvt_pk_bf16_f32 v203, v134, v135
    v_mfma_f32_16x16x32_bf16 v[144:147], a[204:207], v[76:79], v[144:147]
    v_exp_f32 v141, v141
    v_mfma_f32_16x16x32_bf16 v[152:155], a[204:207], v[92:95], v[152:155]
    ds_read_b64_tr_b16 a[248:249], v5 offset:192
    ds_read_b64_tr_b16 a[250:251], v5 offset:704
    v_mfma_f32_16x16x32_bf16 v[148:151], a[208:211], v[64:67], v[184:187]
    v_exp_f32 v142, v142
    v_mfma_f32_16x16x32_bf16 v[156:159], a[208:211], v[80:83], v[188:191]
    v_add_f32 v9, v9, v140
    v_add_f32 v9, v9, v141
    v_mfma_f32_16x16x32_bf16 v[148:151], a[212:215], v[68:71], v[148:151]
    ds_read_b64_tr_b16 a[252:253], v5 offset:224
    ds_read_b64_tr_b16 a[254:255], v5 offset:736
    v_mfma_f32_16x16x32_bf16 v[156:159], a[212:215], v[84:87], v[156:159]
    v_exp_f32 v143, v143
    v_mfma_f32_16x16x32_bf16 v[148:151], a[216:219], v[72:75], v[148:151]
    s_add_u32 m0, s38, 50688
    s_nop 0
    v_add_f32 v9, v9, v142
    v_cvt_pk_bf16_f32 v206, v140, v141
    v_mfma_f32_16x16x32_bf16 v[156:159], a[216:219], v[88:91], v[156:159]
    s_add_u32 s46, s39, 270336
    v_add_f32 v9, v9, v143
    v_cvt_pk_bf16_f32 v207, v142, v143
    v_mfma_f32_16x16x32_bf16 v[148:151], a[220:223], v[76:79], v[148:151]
    s_waitcnt vmcnt(4)
    buffer_load_dwordx4 v6, s[16:19], s46 offen offset:0 nt lds
    buffer_load_dwordx4 v7, s[16:19], s46 offen offset:1056 nt lds
    v_mfma_f32_16x16x32_bf16 v[156:159], a[220:223], v[92:95], v[156:159]
    s_waitcnt lgkmcnt(0)
    v_mfma_f32_16x16x32_bf16 a[0:3], a[224:227], v[200:203], a[0:3]
    v_mfma_f32_16x16x32_bf16 a[32:35], a[224:227], v[204:207], a[32:35]
    v_mfma_f32_16x16x32_bf16 a[4:7], a[228:231], v[200:203], a[4:7]
    v_max3_f32 v14, v144, v145, v146
    v_max3_f32 v15, v152, v153, v154
    v_mfma_f32_16x16x32_bf16 a[36:39], a[228:231], v[204:207], a[36:39]
    v_max3_f32 v14, v14, v147, v148
    v_max3_f32 v15, v15, v155, v156
    v_mfma_f32_16x16x32_bf16 a[8:11], a[232:235], v[200:203], a[8:11]
    v_max3_f32 v14, v14, v149, v150
    v_max3_f32 v15, v15, v157, v158
    v_mfma_f32_16x16x32_bf16 a[40:43], a[232:235], v[204:207], a[40:43]
    v_max_f32 v14, v14, v151
    v_max_f32 v15, v15, v159
    v_mfma_f32_16x16x32_bf16 a[12:15], a[236:239], v[200:203], a[12:15]
    v_max_f32 v16, v14, v15
    v_mfma_f32_16x16x32_bf16 a[44:47], a[236:239], v[204:207], a[44:47]
    v_cmp_lt_f32 vcc, 0x41000000, v16
    s_nop 0
    s_cbranch_vccnz L_st_sl1_1
L_st_sl1_1_ret:
    v_exp_f32 v144, v144
    v_exp_f32 v145, v145
    v_exp_f32 v146, v146
    v_add_f32 v10, v10, v144
    v_add_f32 v10, v10, v145
    v_mfma_f32_16x16x32_bf16 a[16:19], a[240:243], v[200:203], a[16:19]
    v_exp_f32 v147, v147
    v_exp_f32 v152, v152
    v_mfma_f32_16x16x32_bf16 a[48:51], a[240:243], v[204:207], a[48:51]
    v_add_f32 v10, v10, v146
    v_cvt_pk_bf16_f32 v208, v144, v145
    v_mfma_f32_16x16x32_bf16 a[20:23], a[244:247], v[200:203], a[20:23]
    v_add_f32 v10, v10, v147
    v_cvt_pk_bf16_f32 v209, v146, v147
    v_mfma_f32_16x16x32_bf16 a[52:55], a[244:247], v[204:207], a[52:55]
    v_exp_f32 v153, v153
    v_mfma_f32_16x16x32_bf16 a[24:27], a[248:251], v[200:203], a[24:27]
    v_exp_f32 v154, v154
    v_mfma_f32_16x16x32_bf16 a[56:59], a[248:251], v[204:207], a[56:59]
    v_add_f32 v11, v11, v152
    v_add_f32 v11, v11, v153
    v_mfma_f32_16x16x32_bf16 a[28:31], a[252:255], v[200:203], a[28:31]
    v_exp_f32 v155, v155
    v_mfma_f32_16x16x32_bf16 a[60:63], a[252:255], v[204:207], a[60:63]
    v_exp_f32 v148, v148
    s_waitcnt vmcnt(10)
    s_barrier
    v_mfma_f32_16x16x32_bf16 v[160:163], a[192:195], v[96:99], v[192:195]
    s_add_u32 s39, s39, 16384
    v_add_f32 v11, v11, v154
    v_cvt_pk_bf16_f32 v212, v152, v153
    v_mfma_f32_16x16x32_bf16 v[168:171], a[192:195], v[112:115], v[196:199]
    v_add_f32 v11, v11, v155
    v_cvt_pk_bf16_f32 v213, v154, v155
    s_add_u32 m0, s38, 42240
    s_add_u32 s46, s40, 0
    s_waitcnt vmcnt(2)
    buffer_load_dwordx4 v6, s[96:99], s46 offen offset:0 nt lds
    buffer_load_dwordx4 v7, s[96:99], s46 offen offset:1056 nt lds
    v_mfma_f32_16x16x32_bf16 v[160:163], a[196:199], v[100:103], v[160:163]
    v_exp_f32 v149, v149
    v_mfma_f32_16x16x32_bf16 v[168:171], a[196:199], v[116:119], v[168:171]
    v_exp_f32 v150, v150
    v_mfma_f32_16x16x32_bf16 v[160:163], a[200:203], v[104:107], v[160:163]
    v_add_f32 v10, v10, v148
    v_add_f32 v10, v10, v149
    v_mfma_f32_16x16x32_bf16 v[168:171], a[200:203], v[120:123], v[168:171]
    v_exp_f32 v151, v151
    v_exp_f32 v156, v156
    v_mfma_f32_16x16x32_bf16 v[160:163], a[204:207], v[108:111], v[160:163]
    ds_read_b128 a[192:195], v3 offset:33792
    ds_read_b128 a[196:199], v3 offset:33856
    v_mfma_f32_16x16x32_bf16 v[168:171], a[204:207], v[124:127], v[168:171]
    v_add_f32 v10, v10, v150
    v_cvt_pk_bf16_f32 v210, v148, v149
    ds_read_b128 a[200:203], v3 offset:33920
    ds_read_b128 a[204:207], v3 offset:33984
    v_mfma_f32_16x16x32_bf16 v[164:167], a[208:211], v[96:99], v[192:195]
    v_add_f32 v10, v10, v151
    v_cvt_pk_bf16_f32 v211, v150, v151
    v_mfma_f32_16x16x32_bf16 v[172:175], a[208:211], v[112:115], v[196:199]
    v_exp_f32 v157, v157
    v_mfma_f32_16x16x32_bf16 v[164:167], a[212:215], v[100:103], v[164:167]
    v_exp_f32 v158, v158
    v_mfma_f32_16x16x32_bf16 v[172:175], a[212:215], v[116:119], v[172:175]
    v_add_f32 v11, v11, v156
    v_add_f32 v11, v11, v157
    v_mfma_f32_16x16x32_bf16 v[164:167], a[216:219], v[104:107], v[164:167]
    v_exp_f32 v159, v159
    v_mfma_f32_16x16x32_bf16 v[172:175], a[216:219], v[120:123], v[172:175]
    s_nop 0
    v_add_f32 v11, v11, v158
    v_cvt_pk_bf16_f32 v214, v156, v157
    v_add_f32 v11, v11, v159
    v_cvt_pk_bf16_f32 v215, v158, v159
    v_mfma_f32_16x16x32_bf16 v[164:167], a[220:223], v[108:111], v[164:167]
    ds_read_b128 a[208:211], v3 offset:34304
    ds_read_b128 a[212:215], v3 offset:34368
    v_mfma_f32_16x16x32_bf16 v[172:175], a[220:223], v[124:127], v[172:175]
    ds_read_b128 a[216:219], v3 offset:34432
    ds_read_b128 a[220:223], v3 offset:34496
    v_mfma_f32_16x16x32_bf16 a[64:67], a[224:227], v[208:211], a[64:67]
    v_mfma_f32_16x16x32_bf16 a[96:99], a[224:227], v[212:215], a[96:99]
    v_mfma_f32_16x16x32_bf16 a[68:71], a[228:231], v[208:211], a[68:71]
    v_max3_f32 v14, v160, v161, v162
    v_max3_f32 v15, v168, v169, v170
    v_mfma_f32_16x16x32_bf16 a[100:103], a[228:231], v[212:215], a[100:103]
    v_max3_f32 v14, v14, v163, v164
    v_max3_f32 v15, v15, v171, v172
    v_mfma_f32_16x16x32_bf16 a[72:75], a[232:235], v[208:211], a[72:75]
    v_max3_f32 v14, v14, v165, v166
    v_max3_f32 v15, v15, v173, v174
    v_mfma_f32_16x16x32_bf16 a[104:107], a[232:235], v[212:215], a[104:107]
    v_max_f32 v14, v14, v167
    v_max_f32 v15, v15, v175
    v_mfma_f32_16x16x32_bf16 a[76:79], a[236:239], v[208:211], a[76:79]
    v_max_f32 v16, v14, v15
    v_mfma_f32_16x16x32_bf16 a[108:111], a[236:239], v[212:215], a[108:111]
    s_add_u32 m0, s38, 76032
    v_cmp_lt_f32 vcc, 0x41000000, v16
    s_nop 0
    s_cbranch_vccnz L_st_sl1_2
L_st_sl1_2_ret:
    v_exp_f32 v160, v160
    v_exp_f32 v161, v161
    v_exp_f32 v162, v162
    v_add_f32 v12, v12, v160
    v_add_f32 v12, v12, v161
    v_mfma_f32_16x16x32_bf16 a[80:83], a[240:243], v[208:211], a[80:83]
    s_add_u32 s46, s40, 8192
    v_exp_f32 v163, v163
    v_exp_f32 v168, v168
    v_mfma_f32_16x16x32_bf16 a[112:115], a[240:243], v[212:215], a[112:115]
    v_add_f32 v12, v12, v162
    v_cvt_pk_bf16_f32 v216, v160, v161
    s_waitcnt vmcnt(4)
    buffer_load_dwordx4 v6, s[96:99], s46 offen offset:0 nt lds
    buffer_load_dwordx4 v7, s[96:99], s46 offen offset:1056 nt lds
    v_mfma_f32_16x16x32_bf16 a[84:87], a[244:247], v[208:211], a[84:87]
    v_add_f32 v12, v12, v163
    v_cvt_pk_bf16_f32 v217, v162, v163
    v_mfma_f32_16x16x32_bf16 a[116:119], a[244:247], v[212:215], a[116:119]
    v_exp_f32 v169, v169
    v_mfma_f32_16x16x32_bf16 a[88:91], a[248:251], v[208:211], a[88:91]
    v_exp_f32 v170, v170
    v_mfma_f32_16x16x32_bf16 a[120:123], a[248:251], v[212:215], a[120:123]
    v_add_f32 v13, v13, v168
    v_add_f32 v13, v13, v169
    v_mfma_f32_16x16x32_bf16 a[92:95], a[252:255], v[208:211], a[92:95]
    v_exp_f32 v171, v171
    v_mfma_f32_16x16x32_bf16 a[124:127], a[252:255], v[212:215], a[124:127]
    v_exp_f32 v164, v164
    s_waitcnt lgkmcnt(0)
    v_mfma_f32_16x16x32_bf16 v[128:131], a[192:195], v[32:35], v[176:179]
    v_add_f32 v13, v13, v170
    v_cvt_pk_bf16_f32 v220, v168, v169
    v_mfma_f32_16x16x32_bf16 v[136:139], a[192:195], v[48:51], v[180:183]
    v_add_f32 v13, v13, v171
    v_cvt_pk_bf16_f32 v221, v170, v171
    v_mfma_f32_16x16x32_bf16 v[128:131], a[196:199], v[36:39], v[128:131]
    v_exp_f32 v165, v165
    v_mfma_f32_16x16x32_bf16 v[136:139], a[196:199], v[52:55], v[136:139]
    v_exp_f32 v166, v166
    v_mfma_f32_16x16x32_bf16 v[128:131], a[200:203], v[40:43], v[128:131]
    v_add_f32 v12, v12, v164
    v_add_f32 v12, v12, v165
    v_mfma_f32_16x16x32_bf16 v[136:139], a[200:203], v[56:59], v[136:139]
    v_exp_f32 v167, v167
    v_mfma_f32_16x16x32_bf16 v[128:131], a[204:207], v[44:47], v[128:131]
    v_exp_f32 v172, v172
    v_mfma_f32_16x16x32_bf16 v[136:139], a[204:207], v[60:63], v[136:139]
    v_add_f32 v12, v12, v166
    v_cvt_pk_bf16_f32 v218, v164, v165
    v_mfma_f32_16x16x32_bf16 v[132:135], a[208:211], v[32:35], v[176:179]
    v_add_f32 v12, v12, v167
    v_cvt_pk_bf16_f32 v219, v166, v167
    v_mfma_f32_16x16x32_bf16 v[140:143], a[208:211], v[48:51], v[180:183]
    v_exp_f32 v173, v173
    v_mfma_f32_16x16x32_bf16 v[132:135], a[212:215], v[36:39], v[132:135]
    v_exp_f32 v174, v174
    v_mfma_f32_16x16x32_bf16 v[140:143], a[212:215], v[52:55], v[140:143]
    v_add_f32 v13, v13, v172
    v_add_f32 v13, v13, v173
    v_mfma_f32_16x16x32_bf16 v[132:135], a[216:219], v[40:43], v[132:135]
    v_exp_f32 v175, v175
    v_mfma_f32_16x16x32_bf16 v[140:143], a[216:219], v[56:59], v[140:143]
    s_nop 0
    v_add_f32 v13, v13, v174
    v_cvt_pk_bf16_f32 v222, v172, v173
    v_add_f32 v13, v13, v175
    v_cvt_pk_bf16_f32 v223, v174, v175
    v_mfma_f32_16x16x32_bf16 v[132:135], a[220:223], v[44:47], v[132:135]
    v_mfma_f32_16x16x32_bf16 v[140:143], a[220:223], v[60:63], v[140:143]
    v_mfma_f32_16x16x32_bf16 a[128:131], a[224:227], v[216:219], a[128:131]
    v_mfma_f32_16x16x32_bf16 a[160:163], a[224:227], v[220:223], a[160:163]
    ds_read_b64_tr_b16 a[224:225], v5 offset:33792
    ds_read_b64_tr_b16 a[226:227], v5 offset:34304
    v_mfma_f32_16x16x32_bf16 a[132:135], a[228:231], v[216:219], a[132:135]
    v_max3_f32 v14, v128, v129, v130
    v_max3_f32 v15, v136, v137, v138
    v_mfma_f32_16x16x32_bf16 a[164:167], a[228:231], v[220:223], a[164:167]
    v_max3_f32 v14, v14, v131, v132
    v_max3_f32 v15, v15, v139, v140
    v_mfma_f32_16x16x32_bf16 a[136:139], a[232:235], v[216:219], a[136:139]
    v_max3_f32 v14, v14, v133, v134
    v_max3_f32 v15, v15, v141, v142
    v_mfma_f32_16x16x32_bf16 a[168:171], a[232:235], v[220:223], a[168:171]
    v_max_f32 v14, v14, v135
    v_max_f32 v15, v15, v143
    v_mfma_f32_16x16x32_bf16 a[140:143], a[236:239], v[216:219], a[140:143]
    v_max_f32 v16, v14, v15
    v_mfma_f32_16x16x32_bf16 a[172:175], a[236:239], v[220:223], a[172:175]
    s_add_u32 m0, s38, 59136
    v_cmp_lt_f32 vcc, 0x41000000, v16
    s_nop 0
    s_cbranch_vccnz L_st_sl1_0
L_st_sl1_0_ret:
    v_exp_f32 v128, v128
    v_exp_f32 v129, v129
    v_exp_f32 v130, v130
    v_add_f32 v8, v8, v128
    v_add_f32 v8, v8, v129
    v_mfma_f32_16x16x32_bf16 a[144:147], a[240:243], v[216:219], a[144:147]
    s_add_u32 s46, s40, 262144
    v_exp_f32 v131, v131
    v_exp_f32 v136, v136
    v_mfma_f32_16x16x32_bf16 a[176:179], a[240:243], v[220:223], a[176:179]
    s_waitcnt vmcnt(2)
    buffer_load_dwordx4 v6, s[96:99], s46 offen offset:0 nt lds
    buffer_load_dwordx4 v7, s[96:99], s46 offen offset:1056 nt lds
    v_add_f32 v8, v8, v130
    v_cvt_pk_bf16_f32 v200, v128, v129
    v_mfma_f32_16x16x32_bf16 a[148:151], a[244:247], v[216:219], a[148:151]
    ds_read_b64_tr_b16 a[228:229], v5 offset:33824
    ds_read_b64_tr_b16 a[230:231], v5 offset:34336
    v_add_f32 v8, v8, v131
    v_cvt_pk_bf16_f32 v201, v130, v131
    v_mfma_f32_16x16x32_bf16 a[180:183], a[244:247], v[220:223], a[180:183]
    v_exp_f32 v137, v137
    v_mfma_f32_16x16x32_bf16 a[152:155], a[248:251], v[216:219], a[152:155]
    v_exp_f32 v138, v138
    v_mfma_f32_16x16x32_bf16 a[184:187], a[248:251], v[220:223], a[184:187]
    v_add_f32 v9, v9, v136
    v_add_f32 v9, v9, v137
    v_exp_f32 v139, v139
    v_mfma_f32_16x16x32_bf16 a[156:159], a[252:255], v[216:219], a[156:159]
    ds_read_b64_tr_b16 a[232:233], v5 offset:33856
    ds_read_b64_tr_b16 a[234:235], v5 offset:34368
    ds_read_b64_tr_b16 a[236:237], v5 offset:33888
    ds_read_b64_tr_b16 a[238:239], v5 offset:34400
    v_mfma_f32_16x16x32_bf16 a[188:191], a[252:255], v[220:223], a[188:191]
    v_exp_f32 v132, v132
    v_add_f32 v9, v9, v138
    v_cvt_pk_bf16_f32 v204, v136, v137
    v_add_f32 v9, v9, v139
    v_cvt_pk_bf16_f32 v205, v138, v139
    v_exp_f32 v133, v133
    v_exp_f32 v134, v134
    v_add_f32 v8, v8, v132
    v_add_f32 v8, v8, v133
    v_mfma_f32_16x16x32_bf16 v[144:147], a[192:195], v[64:67], v[184:187]
    ds_read_b64_tr_b16 a[240:241], v5 offset:33920
    ds_read_b64_tr_b16 a[242:243], v5 offset:34432
    v_mfma_f32_16x16x32_bf16 v[152:155], a[192:195], v[80:83], v[188:191]
    v_exp_f32 v135, v135
    v_mfma_f32_16x16x32_bf16 v[144:147], a[196:199], v[68:71], v[144:147]
    v_exp_f32 v140, v140
    v_mfma_f32_16x16x32_bf16 v[152:155], a[196:199], v[84:87], v[152:155]
    ds_read_b64_tr_b16 a[244:245], v5 offset:33952
    ds_read_b64_tr_b16 a[246:247], v5 offset:34464
    v_mfma_f32_16x16x32_bf16 v[144:147], a[200:203], v[72:75], v[144:147]
    v_add_f32 v8, v8, v134
    v_cvt_pk_bf16_f32 v202, v132, v133
    v_mfma_f32_16x16x32_bf16 v[152:155], a[200:203], v[88:91], v[152:155]
    v_add_f32 v8, v8, v135
    v_cvt_pk_bf16_f32 v203, v134, v135
    v_mfma_f32_16x16x32_bf16 v[144:147], a[204:207], v[76:79], v[144:147]
    v_exp_f32 v141, v141
    v_mfma_f32_16x16x32_bf16 v[152:155], a[204:207], v[92:95], v[152:155]
    ds_read_b64_tr_b16 a[248:249], v5 offset:33984
    ds_read_b64_tr_b16 a[250:251], v5 offset:34496
    v_mfma_f32_16x16x32_bf16 v[148:151], a[208:211], v[64:67], v[184:187]
    v_exp_f32 v142, v142
    v_mfma_f32_16x16x32_bf16 v[156:159], a[208:211], v[80:83], v[188:191]
    v_add_f32 v9, v9, v140
    v_add_f32 v9, v9, v141
    v_mfma_f32_16x16x32_bf16 v[148:151], a[212:215], v[68:71], v[148:151]
    ds_read_b64_tr_b16 a[252:253], v5 offset:34016
    ds_read_b64_tr_b16 a[254:255], v5 offset:34528
    v_mfma_f32_16x16x32_bf16 v[156:159], a[212:215], v[84:87], v[156:159]
    v_exp_f32 v143, v143
    v_mfma_f32_16x16x32_bf16 v[148:151], a[216:219], v[72:75], v[148:151]
    s_add_u32 m0, s38, 92928
    s_nop 0
    v_add_f32 v9, v9, v142
    v_cvt_pk_bf16_f32 v206, v140, v141
    v_mfma_f32_16x16x32_bf16 v[156:159], a[216:219], v[88:91], v[156:159]
    s_add_u32 s46, s40, 270336
    v_add_f32 v9, v9, v143
    v_cvt_pk_bf16_f32 v207, v142, v143
    v_mfma_f32_16x16x32_bf16 v[148:151], a[220:223], v[76:79], v[148:151]
    s_waitcnt vmcnt(4)
    buffer_load_dwordx4 v6, s[96:99], s46 offen offset:0 nt lds
    buffer_load_dwordx4 v7, s[96:99], s46 offen offset:1056 nt lds
    v_mfma_f32_16x16x32_bf16 v[156:159], a[220:223], v[92:95], v[156:159]
    s_waitcnt lgkmcnt(0)
    v_mfma_f32_16x16x32_bf16 a[0:3], a[224:227], v[200:203], a[0:3]
    v_mfma_f32_16x16x32_bf16 a[32:35], a[224:227], v[204:207], a[32:35]
    v_mfma_f32_16x16x32_bf16 a[4:7], a[228:231], v[200:203], a[4:7]
    v_max3_f32 v14, v144, v145, v146
    v_max3_f32 v15, v152, v153, v154
    v_mfma_f32_16x16x32_bf16 a[36:39], a[228:231], v[204:207], a[36:39]
    v_max3_f32 v14, v14, v147, v148
    v_max3_f32 v15, v15, v155, v156
    v_mfma_f32_16x16x32_bf16 a[8:11], a[232:235], v[200:203], a[8:11]
    v_max3_f32 v14, v14, v149, v150
    v_max3_f32 v15, v15, v157, v158
    v_mfma_f32_16x16x32_bf16 a[40:43], a[232:235], v[204:207], a[40:43]
    v_max_f32 v14, v14, v151
    v_max_f32 v15, v15, v159
    v_mfma_f32_16x16x32_bf16 a[12:15], a[236:239], v[200:203], a[12:15]
    v_max_f32 v16, v14, v15
    v_mfma_f32_16x16x32_bf16 a[44:47], a[236:239], v[204:207], a[44:47]
    v_cmp_lt_f32 vcc, 0x41000000, v16
    s_nop 0
    s_cbranch_vccnz L_st_sl2_1
L_st_sl2_1_ret:
    v_exp_f32 v144, v144
    v_exp_f32 v145, v145
    v_exp_f32 v146, v146
    v_add_f32 v10, v10, v144
    v_add_f32 v10, v10, v145
    v_mfma_f32_16x16x32_bf16 a[16:19], a[240:243], v[200:203], a[16:19]
    v_exp_f32 v147, v147
    v_exp_f32 v152, v152
    v_mfma_f32_16x16x32_bf16 a[48:51], a[240:243], v[204:207], a[48:51]
    v_add_f32 v10, v10, v146
    v_cvt_pk_bf16_f32 v208, v144, v145
    v_mfma_f32_16x16x32_bf16 a[20:23], a[244:247], v[200:203], a[20:23]
    v_add_f32 v10, v10, v147
    v_cvt_pk_bf16_f32 v209, v146, v147
    v_mfma_f32_16x16x32_bf16 a[52:55], a[244:247], v[204:207], a[52:55]
    v_exp_f32 v153, v153
    v_mfma_f32_16x16x32_bf16 a[24:27], a[248:251], v[200:203], a[24:27]
    v_exp_f32 v154, v154
    v_mfma_f32_16x16x32_bf16 a[56:59], a[248:251], v[204:207], a[56:59]
    v_add_f32 v11, v11, v152
    v_add_f32 v11, v11, v153
    v_mfma_f32_16x16x32_bf16 a[28:31], a[252:255], v[200:203], a[28:31]
    v_exp_f32 v155, v155
    v_mfma_f32_16x16x32_bf16 a[60:63], a[252:255], v[204:207], a[60:63]
    v_exp_f32 v148, v148
    s_waitcnt vmcnt(10)
    s_barrier
    v_mfma_f32_16x16x32_bf16 v[160:163], a[192:195], v[96:99], v[192:195]
    s_add_u32 s40, s40, 16384
    v_add_f32 v11, v11, v154
    v_cvt_pk_bf16_f32 v212, v152, v153
    v_mfma_f32_16x16x32_bf16 v[168:171], a[192:195], v[112:115], v[196:199]
    v_add_f32 v11, v11, v155
    v_cvt_pk_bf16_f32 v213, v154, v155
    s_add_u32 m0, s38, 67584
    s_add_u32 s46, s39, 0
    s_waitcnt vmcnt(2)
    buffer_load_dwordx4 v6, s[16:19], s46 offen offset:0 nt lds
    buffer_load_dwordx4 v7, s[16:19], s46 offen offset:1056 nt lds
    v_mfma_f32_16x16x32_bf16 v[160:163], a[196:199], v[100:103], v[160:163]
    v_exp_f32 v149, v149
    v_mfma_f32_16x16x32_bf16 v[168:171], a[196:199], v[116:119], v[168:171]
    v_exp_f32 v150, v150
    v_mfma_f32_16x16x32_bf16 v[160:163], a[200:203], v[104:107], v[160:163]
    v_add_f32 v10, v10, v148
    v_add_f32 v10, v10, v149
    v_mfma_f32_16x16x32_bf16 v[168:171], a[200:203], v[120:123], v[168:171]
    v_exp_f32 v151, v151
    v_exp_f32 v156, v156
    v_mfma_f32_16x16x32_bf16 v[160:163], a[204:207], v[108:111], v[160:163]
    ds_read_b128 a[192:195], v2 offset:0
    ds_read_b128 a[196:199], v2 offset:64
    v_mfma_f32_16x16x32_bf16 v[168:171], a[204:207], v[124:127], v[168:171]
    v_add_f32 v10, v10, v150
    v_cvt_pk_bf16_f32 v210, v148, v149
    ds_read_b128 a[200:203], v2 offset:128
    ds_read_b128 a[204:207], v2 offset:192
    v_mfma_f32_16x16x32_bf16 v[164:167], a[208:211], v[96:99], v[192:195]
    v_add_f32 v10, v10, v151
    v_cvt_pk_bf16_f32 v211, v150, v151
    v_mfma_f32_16x16x32_bf16 v[172:175], a[208:211], v[112:115], v[196:199]
    v_exp_f32 v157, v157
    v_mfma_f32_16x16x32_bf16 v[164:167], a[212:215], v[100:103], v[164:167]
    v_exp_f32 v158, v158
    v_mfma_f32_16x16x32_bf16 v[172:175], a[212:215], v[116:119], v[172:175]
    v_add_f32 v11, v11, v156
    v_add_f32 v11, v11, v157
    v_mfma_f32_16x16x32_bf16 v[164:167], a[216:219], v[104:107], v[164:167]
    v_exp_f32 v159, v159
    v_mfma_f32_16x16x32_bf16 v[172:175], a[216:219], v[120:123], v[172:175]
    s_nop 0
    v_add_f32 v11, v11, v158
    v_cvt_pk_bf16_f32 v214, v156, v157
    v_add_f32 v11, v11, v159
    v_cvt_pk_bf16_f32 v215, v158, v159
    v_mfma_f32_16x16x32_bf16 v[164:167], a[220:223], v[108:111], v[164:167]
    ds_read_b128 a[208:211], v2 offset:512
    ds_read_b128 a[212:215], v2 offset:576
    v_mfma_f32_16x16x32_bf16 v[172:175], a[220:223], v[124:127], v[172:175]
    ds_read_b128 a[216:219], v2 offset:640
    ds_read_b128 a[220:223], v2 offset:704
    v_mfma_f32_16x16x32_bf16 a[64:67], a[224:227], v[208:211], a[64:67]
    v_mfma_f32_16x16x32_bf16 a[96:99], a[224:227], v[212:215], a[96:99]
    v_mfma_f32_16x16x32_bf16 a[68:71], a[228:231], v[208:211], a[68:71]
    v_max3_f32 v14, v160, v161, v162
    v_max3_f32 v15, v168, v169, v170
    v_mfma_f32_16x16x32_bf16 a[100:103], a[228:231], v[212:215], a[100:103]
    v_max3_f32 v14, v14, v163, v164
    v_max3_f32 v15, v15, v171, v172
    v_mfma_f32_16x16x32_bf16 a[72:75], a[232:235], v[208:211], a[72:75]
    v_max3_f32 v14, v14, v165, v166
    v_max3_f32 v15, v15, v173, v174
    v_mfma_f32_16x16x32_bf16 a[104:107], a[232:235], v[212:215], a[104:107]
    v_max_f32 v14, v14, v167
    v_max_f32 v15, v15, v175
    v_mfma_f32_16x16x32_bf16 a[76:79], a[236:239], v[208:211], a[76:79]
    v_max_f32 v16, v14, v15
    v_mfma_f32_16x16x32_bf16 a[108:111], a[236:239], v[212:215], a[108:111]
    s_add_u32 m0, s38, 101376
    v_cmp_lt_f32 vcc, 0x41000000, v16
    s_nop 0
    s_cbranch_vccnz L_st_sl2_2
L_st_sl2_2_ret:
    v_exp_f32 v160, v160
    v_exp_f32 v161, v161
    v_exp_f32 v162, v162
    v_add_f32 v12, v12, v160
    v_add_f32 v12, v12, v161
    v_mfma_f32_16x16x32_bf16 a[80:83], a[240:243], v[208:211], a[80:83]
    s_add_u32 s46, s39, 8192
    v_exp_f32 v163, v163
    v_exp_f32 v168, v168
    v_mfma_f32_16x16x32_bf16 a[112:115], a[240:243], v[212:215], a[112:115]
    v_add_f32 v12, v12, v162
    v_cvt_pk_bf16_f32 v216, v160, v161
    s_waitcnt vmcnt(4)
    buffer_load_dwordx4 v6, s[16:19], s46 offen offset:0 nt lds
    buffer_load_dwordx4 v7, s[16:19], s46 offen offset:1056 nt lds
    v_mfma_f32_16x16x32_bf16 a[84:87], a[244:247], v[208:211], a[84:87]
    v_add_f32 v12, v12, v163
    v_cvt_pk_bf16_f32 v217, v162, v163
    v_mfma_f32_16x16x32_bf16 a[116:119], a[244:247], v[212:215], a[116:119]
    v_exp_f32 v169, v169
    v_mfma_f32_16x16x32_bf16 a[88:91], a[248:251], v[208:211], a[88:91]
    v_exp_f32 v170, v170
    v_mfma_f32_16x16x32_bf16 a[120:123], a[248:251], v[212:215], a[120:123]
    v_add_f32 v13, v13, v168
    v_add_f32 v13, v13, v169
    v_mfma_f32_16x16x32_bf16 a[92:95], a[252:255], v[208:211], a[92:95]
    v_exp_f32 v171, v171
    v_mfma_f32_16x16x32_bf16 a[124:127], a[252:255], v[212:215], a[124:127]
    v_exp_f32 v164, v164
    s_waitcnt lgkmcnt(0)
    v_mfma_f32_16x16x32_bf16 v[128:131], a[192:195], v[32:35], v[176:179]
    v_add_f32 v13, v13, v170
    v_cvt_pk_bf16_f32 v220, v168, v169
    v_mfma_f32_16x16x32_bf16 v[136:139], a[192:195], v[48:51], v[180:183]
    v_add_f32 v13, v13, v171
    v_cvt_pk_bf16_f32 v221, v170, v171
    v_mfma_f32_16x16x32_bf16 v[128:131], a[196:199], v[36:39], v[128:131]
    v_exp_f32 v165, v165
    v_mfma_f32_16x16x32_bf16 v[136:139], a[196:199], v[52:55], v[136:139]
    v_exp_f32 v166, v166
    v_mfma_f32_16x16x32_bf16 v[128:131], a[200:203], v[40:43], v[128:131]
    v_add_f32 v12, v12, v164
    v_add_f32 v12, v12, v165
    v_mfma_f32_16x16x32_bf16 v[136:139], a[200:203], v[56:59], v[136:139]
    v_exp_f32 v167, v167
    v_mfma_f32_16x16x32_bf16 v[128:131], a[204:207], v[44:47], v[128:131]
    v_exp_f32 v172, v172
    v_mfma_f32_16x16x32_bf16 v[136:139], a[204:207], v[60:63], v[136:139]
    v_add_f32 v12, v12, v166
    v_cvt_pk_bf16_f32 v218, v164, v165
    v_mfma_f32_16x16x32_bf16 v[132:135], a[208:211], v[32:35], v[176:179]
    v_add_f32 v12, v12, v167
    v_cvt_pk_bf16_f32 v219, v166, v167
    v_mfma_f32_16x16x32_bf16 v[140:143], a[208:211], v[48:51], v[180:183]
    v_exp_f32 v173, v173
    v_mfma_f32_16x16x32_bf16 v[132:135], a[212:215], v[36:39], v[132:135]
    v_exp_f32 v174, v174
    v_mfma_f32_16x16x32_bf16 v[140:143], a[212:215], v[52:55], v[140:143]
    v_add_f32 v13, v13, v172
    v_add_f32 v13, v13, v173
    v_mfma_f32_16x16x32_bf16 v[132:135], a[216:219], v[40:43], v[132:135]
    v_exp_f32 v175, v175
    v_mfma_f32_16x16x32_bf16 v[140:143], a[216:219], v[56:59], v[140:143]
    s_nop 0
    v_add_f32 v13, v13, v174
    v_cvt_pk_bf16_f32 v222, v172, v173
    v_add_f32 v13, v13, v175
    v_cvt_pk_bf16_f32 v223, v174, v175
    v_mfma_f32_16x16x32_bf16 v[132:135], a[220:223], v[44:47], v[132:135]
    v_mfma_f32_16x16x32_bf16 v[140:143], a[220:223], v[60:63], v[140:143]
    v_mfma_f32_16x16x32_bf16 a[128:131], a[224:227], v[216:219], a[128:131]
    v_mfma_f32_16x16x32_bf16 a[160:163], a[224:227], v[220:223], a[160:163]
    ds_read_b64_tr_b16 a[224:225], v4 offset:0
    ds_read_b64_tr_b16 a[226:227], v4 offset:512
    v_mfma_f32_16x16x32_bf16 a[132:135], a[228:231], v[216:219], a[132:135]
    v_max3_f32 v14, v128, v129, v130
    v_max3_f32 v15, v136, v137, v138
    v_mfma_f32_16x16x32_bf16 a[164:167], a[228:231], v[220:223], a[164:167]
    v_max3_f32 v14, v14, v131, v132
    v_max3_f32 v15, v15, v139, v140
    v_mfma_f32_16x16x32_bf16 a[136:139], a[232:235], v[216:219], a[136:139]
    v_max3_f32 v14, v14, v133, v134
    v_max3_f32 v15, v15, v141, v142
    v_mfma_f32_16x16x32_bf16 a[168:171], a[232:235], v[220:223], a[168:171]
    v_max_f32 v14, v14, v135
    v_max_f32 v15, v15, v143
    v_mfma_f32_16x16x32_bf16 a[140:143], a[236:239], v[216:219], a[140:143]
    v_max_f32 v16, v14, v15
    v_mfma_f32_16x16x32_bf16 a[172:175], a[236:239], v[220:223], a[172:175]
    s_add_u32 m0, s38, 84480
    v_cmp_lt_f32 vcc, 0x41000000, v16
    s_nop 0
    s_cbranch_vccnz L_st_sl2_0
L_st_sl2_0_ret:
    v_exp_f32 v128, v128
    v_exp_f32 v129, v129
    v_exp_f32 v130, v130
    v_add_f32 v8, v8, v128
    v_add_f32 v8, v8, v129
    v_mfma_f32_16x16x32_bf16 a[144:147], a[240:243], v[216:219], a[144:147]
    s_add_u32 s46, s39, 262144
    v_exp_f32 v131, v131
    v_exp_f32 v136, v136
    v_mfma_f32_16x16x32_bf16 a[176:179], a[240:243], v[220:223], a[176:179]
    s_waitcnt vmcnt(2)
    buffer_load_dwordx4 v6, s[16:19], s46 offen offset:0 nt lds
    buffer_load_dwordx4 v7, s[16:19], s46 offen offset:1056 nt lds
    v_add_f32 v8, v8, v130
    v_cvt_pk_bf16_f32 v200, v128, v129
    v_mfma_f32_16x16x32_bf16 a[148:151], a[244:247], v[216:219], a[148:151]
    ds_read_b64_tr_b16 a[228:229], v4 offset:32
    ds_read_b64_tr_b16 a[230:231], v4 offset:544
    v_add_f32 v8, v8, v131
    v_cvt_pk_bf16_f32 v201, v130, v131
    v_mfma_f32_16x16x32_bf16 a[180:183], a[244:247], v[220:223], a[180:183]
    v_exp_f32 v137, v137
    v_mfma_f32_16x16x32_bf16 a[152:155], a[248:251], v[216:219], a[152:155]
    v_exp_f32 v138, v138
    v_mfma_f32_16x16x32_bf16 a[184:187], a[248:251], v[220:223], a[184:187]
    v_add_f32 v9, v9, v136
    v_add_f32 v9, v9, v137
    v_exp_f32 v139, v139
    v_mfma_f32_16x16x32_bf16 a[156:159], a[252:255], v[216:219], a[156:159]
    ds_read_b64_tr_b16 a[232:233], v4 offset:64
    ds_read_b64_tr_b16 a[234:235], v4 offset:576
    ds_read_b64_tr_b16 a[236:237], v4 offset:96
    ds_read_b64_tr_b16 a[238:239], v4 offset:608
    v_mfma_f32_16x16x32_bf16 a[188:191], a[252:255], v[220:223], a[188:191]
    v_exp_f32 v132, v132
    v_add_f32 v9, v9, v138
    v_cvt_pk_bf16_f32 v204, v136, v137
    v_add_f32 v9, v9, v139
    v_cvt_pk_bf16_f32 v205, v138, v139
    v_exp_f32 v133, v133
    v_exp_f32 v134, v134
    v_add_f32 v8, v8, v132
    v_add_f32 v8, v8, v133
    v_mfma_f32_16x16x32_bf16 v[144:147], a[192:195], v[64:67], v[184:187]
    ds_read_b64_tr_b16 a[240:241], v4 offset:128
    ds_read_b64_tr_b16 a[242:243], v4 offset:640
    v_mfma_f32_16x16x32_bf16 v[152:155], a[192:195], v[80:83], v[188:191]
    v_exp_f32 v135, v135
    v_mfma_f32_16x16x32_bf16 v[144:147], a[196:199], v[68:71], v[144:147]
    v_exp_f32 v140, v140
    v_mfma_f32_16x16x32_bf16 v[152:155], a[196:199], v[84:87], v[152:155]
    ds_read_b64_tr_b16 a[244:245], v4 offset:160
    ds_read_b64_tr_b16 a[246:247], v4 offset:672
    v_mfma_f32_16x16x32_bf16 v[144:147], a[200:203], v[72:75], v[144:147]
    v_add_f32 v8, v8, v134
    v_cvt_pk_bf16_f32 v202, v132, v133
    v_mfma_f32_16x16x32_bf16 v[152:155], a[200:203], v[88:91], v[152:155]
    v_add_f32 v8, v8, v135
    v_cvt_pk_bf16_f32 v203, v134, v135
    v_mfma_f32_16x16x32_bf16 v[144:147], a[204:207], v[76:79], v[144:147]
    v_exp_f32 v141, v141
    v_mfma_f32_16x16x32_bf16 v[152:155], a[204:207], v[92:95], v[152:155]
    ds_read_b64_tr_b16 a[248:249], v4 offset:192
    ds_read_b64_tr_b16 a[250:251], v4 offset:704
    v_mfma_f32_16x16x32_bf16 v[148:151], a[208:211], v[64:67], v[184:187]
    v_exp_f32 v142, v142
    v_mfma_f32_16x16x32_bf16 v[156:159], a[208:211], v[80:83], v[188:191]
    v_add_f32 v9, v9, v140
    v_add_f32 v9, v9, v141
    v_mfma_f32_16x16x32_bf16 v[148:151], a[212:215], v[68:71], v[148:151]
    ds_read_b64_tr_b16 a[252:253], v4 offset:224
    ds_read_b64_tr_b16 a[254:255], v4 offset:736
    v_mfma_f32_16x16x32_bf16 v[156:159], a[212:215], v[84:87], v[156:159]
    v_exp_f32 v143, v143
    v_mfma_f32_16x16x32_bf16 v[148:151], a[216:219], v[72:75], v[148:151]
    s_add_u32 m0, s38, 118272
    s_nop 0
    v_add_f32 v9, v9, v142
    v_cvt_pk_bf16_f32 v206, v140, v141
    v_mfma_f32_16x16x32_bf16 v[156:159], a[216:219], v[88:91], v[156:159]
    s_add_u32 s46, s39, 270336
    v_add_f32 v9, v9, v143
    v_cvt_pk_bf16_f32 v207, v142, v143
    v_mfma_f32_16x16x32_bf16 v[148:151], a[220:223], v[76:79], v[148:151]
    s_waitcnt vmcnt(4)
    buffer_load_dwordx4 v6, s[16:19], s46 offen offset:0 nt lds
    buffer_load_dwordx4 v7, s[16:19], s46 offen offset:1056 nt lds
    v_mfma_f32_16x16x32_bf16 v[156:159], a[220:223], v[92:95], v[156:159]
    s_waitcnt lgkmcnt(0)
    v_mfma_f32_16x16x32_bf16 a[0:3], a[224:227], v[200:203], a[0:3]
    v_mfma_f32_16x16x32_bf16 a[32:35], a[224:227], v[204:207], a[32:35]
    v_mfma_f32_16x16x32_bf16 a[4:7], a[228:231], v[200:203], a[4:7]
    v_max3_f32 v14, v144, v145, v146
    v_max3_f32 v15, v152, v153, v154
    v_mfma_f32_16x16x32_bf16 a[36:39], a[228:231], v[204:207], a[36:39]
    v_max3_f32 v14, v14, v147, v148
    v_max3_f32 v15, v15, v155, v156
    v_mfma_f32_16x16x32_bf16 a[8:11], a[232:235], v[200:203], a[8:11]
    v_max3_f32 v14, v14, v149, v150
    v_max3_f32 v15, v15, v157, v158
    v_mfma_f32_16x16x32_bf16 a[40:43], a[232:235], v[204:207], a[40:43]
    v_max_f32 v14, v14, v151
    v_max_f32 v15, v15, v159
    v_mfma_f32_16x16x32_bf16 a[12:15], a[236:239], v[200:203], a[12:15]
    v_max_f32 v16, v14, v15
    v_mfma_f32_16x16x32_bf16 a[44:47], a[236:239], v[204:207], a[44:47]
    v_cmp_lt_f32 vcc, 0x41000000, v16
    s_nop 0
    s_cbranch_vccnz L_st_sl3_1
L_st_sl3_1_ret:
    v_exp_f32 v144, v144
    v_exp_f32 v145, v145
    v_exp_f32 v146, v146
    v_add_f32 v10, v10, v144
    v_add_f32 v10, v10, v145
    v_mfma_f32_16x16x32_bf16 a[16:19], a[240:243], v[200:203], a[16:19]
    v_exp_f32 v147, v147
    v_exp_f32 v152, v152
    v_mfma_f32_16x16x32_bf16 a[48:51], a[240:243], v[204:207], a[48:51]
    v_add_f32 v10, v10, v146
    v_cvt_pk_bf16_f32 v208, v144, v145
    v_mfma_f32_16x16x32_bf16 a[20:23], a[244:247], v[200:203], a[20:23]
    v_add_f32 v10, v10, v147
    v_cvt_pk_bf16_f32 v209, v146, v147
    v_mfma_f32_16x16x32_bf16 a[52:55], a[244:247], v[204:207], a[52:55]
    v_exp_f32 v153, v153
    v_mfma_f32_16x16x32_bf16 a[24:27], a[248:251], v[200:203], a[24:27]
    v_exp_f32 v154, v154
    v_mfma_f32_16x16x32_bf16 a[56:59], a[248:251], v[204:207], a[56:59]
    v_add_f32 v11, v11, v152
    v_add_f32 v11, v11, v153
    v_mfma_f32_16x16x32_bf16 a[28:31], a[252:255], v[200:203], a[28:31]
    v_exp_f32 v155, v155
    v_mfma_f32_16x16x32_bf16 a[60:63], a[252:255], v[204:207], a[60:63]
    v_exp_f32 v148, v148
    s_waitcnt vmcnt(10)
    s_barrier
    v_mfma_f32_16x16x32_bf16 v[160:163], a[192:195], v[96:99], v[192:195]
    s_add_u32 s39, s39, 16384
    v_add_f32 v11, v11, v154
    v_cvt_pk_bf16_f32 v212, v152, v153
    v_mfma_f32_16x16x32_bf16 v[168:171], a[192:195], v[112:115], v[196:199]
    v_add_f32 v11, v11, v155
    v_cvt_pk_bf16_f32 v213, v154, v155
    s_add_u32 m0, s38, 109824
    s_add_u32 s46, s40, 0
    s_waitcnt vmcnt(2)
    buffer_load_dwordx4 v6, s[96:99], s46 offen offset:0 nt lds
    buffer_load_dwordx4 v7, s[96:99], s46 offen offset:1056 nt lds
    v_mfma_f32_16x16x32_bf16 v[160:163], a[196:199], v[100:103], v[160:163]
    v_exp_f32 v149, v149
    v_mfma_f32_16x16x32_bf16 v[168:171], a[196:199], v[116:119], v[168:171]
    v_exp_f32 v150, v150
    v_mfma_f32_16x16x32_bf16 v[160:163], a[200:203], v[104:107], v[160:163]
    v_add_f32 v10, v10, v148
    v_add_f32 v10, v10, v149
    v_mfma_f32_16x16x32_bf16 v[168:171], a[200:203], v[120:123], v[168:171]
    v_exp_f32 v151, v151
    v_exp_f32 v156, v156
    v_mfma_f32_16x16x32_bf16 v[160:163], a[204:207], v[108:111], v[160:163]
    ds_read_b128 a[192:195], v2 offset:33792
    ds_read_b128 a[196:199], v2 offset:33856
    v_mfma_f32_16x16x32_bf16 v[168:171], a[204:207], v[124:127], v[168:171]
    v_add_f32 v10, v10, v150
    v_cvt_pk_bf16_f32 v210, v148, v149
    ds_read_b128 a[200:203], v2 offset:33920
    ds_read_b128 a[204:207], v2 offset:33984
    v_mfma_f32_16x16x32_bf16 v[164:167], a[208:211], v[96:99], v[192:195]
    v_add_f32 v10, v10, v151
    v_cvt_pk_bf16_f32 v211, v150, v151
    v_mfma_f32_16x16x32_bf16 v[172:175], a[208:211], v[112:115], v[196:199]
    v_exp_f32 v157, v157
    v_mfma_f32_16x16x32_bf16 v[164:167], a[212:215], v[100:103], v[164:167]
    v_exp_f32 v158, v158
    v_mfma_f32_16x16x32_bf16 v[172:175], a[212:215], v[116:119], v[172:175]
    v_add_f32 v11, v11, v156
    v_add_f32 v11, v11, v157
    v_mfma_f32_16x16x32_bf16 v[164:167], a[216:219], v[104:107], v[164:167]
    v_exp_f32 v159, v159
    v_mfma_f32_16x16x32_bf16 v[172:175], a[216:219], v[120:123], v[172:175]
    s_nop 0
    v_add_f32 v11, v11, v158
    v_cvt_pk_bf16_f32 v214, v156, v157
    v_add_f32 v11, v11, v159
    v_cvt_pk_bf16_f32 v215, v158, v159
    v_mfma_f32_16x16x32_bf16 v[164:167], a[220:223], v[108:111], v[164:167]
    ds_read_b128 a[208:211], v2 offset:34304
    ds_read_b128 a[212:215], v2 offset:34368
    v_mfma_f32_16x16x32_bf16 v[172:175], a[220:223], v[124:127], v[172:175]
    ds_read_b128 a[216:219], v2 offset:34432
    ds_read_b128 a[220:223], v2 offset:34496
    v_mfma_f32_16x16x32_bf16 a[64:67], a[224:227], v[208:211], a[64:67]
    v_mfma_f32_16x16x32_bf16 a[96:99], a[224:227], v[212:215], a[96:99]
    v_mfma_f32_16x16x32_bf16 a[68:71], a[228:231], v[208:211], a[68:71]
    v_max3_f32 v14, v160, v161, v162
    v_max3_f32 v15, v168, v169, v170
    v_mfma_f32_16x16x32_bf16 a[100:103], a[228:231], v[212:215], a[100:103]
    v_max3_f32 v14, v14, v163, v164
    v_max3_f32 v15, v15, v171, v172
    v_mfma_f32_16x16x32_bf16 a[72:75], a[232:235], v[208:211], a[72:75]
    v_max3_f32 v14, v14, v165, v166
    v_max3_f32 v15, v15, v173, v174
    v_mfma_f32_16x16x32_bf16 a[104:107], a[232:235], v[212:215], a[104:107]
    v_max_f32 v14, v14, v167
    v_max_f32 v15, v15, v175
    v_mfma_f32_16x16x32_bf16 a[76:79], a[236:239], v[208:211], a[76:79]
    v_max_f32 v16, v14, v15
    v_mfma_f32_16x16x32_bf16 a[108:111], a[236:239], v[212:215], a[108:111]
    s_add_u32 m0, s38, 8448
    v_cmp_lt_f32 vcc, 0x41000000, v16
    s_nop 0
    s_cbranch_vccnz L_st_sl3_2
L_st_sl3_2_ret:
    v_exp_f32 v160, v160
    v_exp_f32 v161, v161
    v_exp_f32 v162, v162
    v_add_f32 v12, v12, v160
    v_add_f32 v12, v12, v161
    v_mfma_f32_16x16x32_bf16 a[80:83], a[240:243], v[208:211], a[80:83]
    s_add_u32 s46, s40, 8192
    v_exp_f32 v163, v163
    v_exp_f32 v168, v168
    v_mfma_f32_16x16x32_bf16 a[112:115], a[240:243], v[212:215], a[112:115]
    v_add_f32 v12, v12, v162
    v_cvt_pk_bf16_f32 v216, v160, v161
    s_waitcnt vmcnt(4)
    buffer_load_dwordx4 v6, s[96:99], s46 offen offset:0 nt lds
    buffer_load_dwordx4 v7, s[96:99], s46 offen offset:1056 nt lds
    v_mfma_f32_16x16x32_bf16 a[84:87], a[244:247], v[208:211], a[84:87]
    v_add_f32 v12, v12, v163
    v_cvt_pk_bf16_f32 v217, v162, v163
    v_mfma_f32_16x16x32_bf16 a[116:119], a[244:247], v[212:215], a[116:119]
    v_exp_f32 v169, v169
    v_mfma_f32_16x16x32_bf16 a[88:91], a[248:251], v[208:211], a[88:91]
    v_exp_f32 v170, v170
    v_mfma_f32_16x16x32_bf16 a[120:123], a[248:251], v[212:215], a[120:123]
    v_add_f32 v13, v13, v168
    v_add_f32 v13, v13, v169
    v_mfma_f32_16x16x32_bf16 a[92:95], a[252:255], v[208:211], a[92:95]
    v_exp_f32 v171, v171
    v_mfma_f32_16x16x32_bf16 a[124:127], a[252:255], v[212:215], a[124:127]
    v_exp_f32 v164, v164
    s_waitcnt lgkmcnt(0)
    v_mfma_f32_16x16x32_bf16 v[128:131], a[192:195], v[32:35], v[176:179]
    v_add_f32 v13, v13, v170
    v_cvt_pk_bf16_f32 v220, v168, v169
    v_mfma_f32_16x16x32_bf16 v[136:139], a[192:195], v[48:51], v[180:183]
    v_add_f32 v13, v13, v171
    v_cvt_pk_bf16_f32 v221, v170, v171
    v_mfma_f32_16x16x32_bf16 v[128:131], a[196:199], v[36:39], v[128:131]
    v_exp_f32 v165, v165
    v_mfma_f32_16x16x32_bf16 v[136:139], a[196:199], v[52:55], v[136:139]
    v_exp_f32 v166, v166
    v_mfma_f32_16x16x32_bf16 v[128:131], a[200:203], v[40:43], v[128:131]
    v_add_f32 v12, v12, v164
    v_add_f32 v12, v12, v165
    v_mfma_f32_16x16x32_bf16 v[136:139], a[200:203], v[56:59], v[136:139]
    v_exp_f32 v167, v167
    v_mfma_f32_16x16x32_bf16 v[128:131], a[204:207], v[44:47], v[128:131]
    v_exp_f32 v172, v172
    v_mfma_f32_16x16x32_bf16 v[136:139], a[204:207], v[60:63], v[136:139]
    v_add_f32 v12, v12, v166
    v_cvt_pk_bf16_f32 v218, v164, v165
    v_mfma_f32_16x16x32_bf16 v[132:135], a[208:211], v[32:35], v[176:179]
    v_add_f32 v12, v12, v167
    v_cvt_pk_bf16_f32 v219, v166, v167
    v_mfma_f32_16x16x32_bf16 v[140:143], a[208:211], v[48:51], v[180:183]
    v_exp_f32 v173, v173
    v_mfma_f32_16x16x32_bf16 v[132:135], a[212:215], v[36:39], v[132:135]
    v_exp_f32 v174, v174
    v_mfma_f32_16x16x32_bf16 v[140:143], a[212:215], v[52:55], v[140:143]
    v_add_f32 v13, v13, v172
    v_add_f32 v13, v13, v173
    v_mfma_f32_16x16x32_bf16 v[132:135], a[216:219], v[40:43], v[132:135]
    v_exp_f32 v175, v175
    v_mfma_f32_16x16x32_bf16 v[140:143], a[216:219], v[56:59], v[140:143]
    s_nop 0
    v_add_f32 v13, v13, v174
    v_cvt_pk_bf16_f32 v222, v172, v173
    v_add_f32 v13, v13, v175
    v_cvt_pk_bf16_f32 v223, v174, v175
    v_mfma_f32_16x16x32_bf16 v[132:135], a[220:223], v[44:47], v[132:135]
    v_mfma_f32_16x16x32_bf16 v[140:143], a[220:223], v[60:63], v[140:143]
    v_mfma_f32_16x16x32_bf16 a[128:131], a[224:227], v[216:219], a[128:131]
    v_mfma_f32_16x16x32_bf16 a[160:163], a[224:227], v[220:223], a[160:163]
    ds_read_b64_tr_b16 a[224:225], v4 offset:33792
    ds_read_b64_tr_b16 a[226:227], v4 offset:34304
    v_mfma_f32_16x16x32_bf16 a[132:135], a[228:231], v[216:219], a[132:135]
    v_max3_f32 v14, v128, v129, v130
    v_max3_f32 v15, v136, v137, v138
    v_mfma_f32_16x16x32_bf16 a[164:167], a[228:231], v[220:223], a[164:167]
    v_max3_f32 v14, v14, v131, v132
    v_max3_f32 v15, v15, v139, v140
    v_mfma_f32_16x16x32_bf16 a[136:139], a[232:235], v[216:219], a[136:139]
    v_max3_f32 v14, v14, v133, v134
    v_max3_f32 v15, v15, v141, v142
    v_mfma_f32_16x16x32_bf16 a[168:171], a[232:235], v[220:223], a[168:171]
    v_max_f32 v14, v14, v135
    v_max_f32 v15, v15, v143
    v_mfma_f32_16x16x32_bf16 a[140:143], a[236:239], v[216:219], a[140:143]
    v_max_f32 v16, v14, v15
    v_mfma_f32_16x16x32_bf16 a[172:175], a[236:239], v[220:223], a[172:175]
    s_add_u32 m0, s38, 126720
    v_cmp_lt_f32 vcc, 0x41000000, v16
    s_nop 0
    s_cbranch_vccnz L_st_sl3_0
L_st_sl3_0_ret:
    v_exp_f32 v128, v128
    v_exp_f32 v129, v129
    v_exp_f32 v130, v130
    v_add_f32 v8, v8, v128
    v_add_f32 v8, v8, v129
    v_mfma_f32_16x16x32_bf16 a[144:147], a[240:243], v[216:219], a[144:147]
    s_add_u32 s46, s40, 262144
    v_exp_f32 v131, v131
    v_exp_f32 v136, v136
    v_mfma_f32_16x16x32_bf16 a[176:179], a[240:243], v[220:223], a[176:179]
    s_waitcnt vmcnt(2)
    buffer_load_dwordx4 v6, s[96:99], s46 offen offset:0 nt lds
    buffer_load_dwordx4 v7, s[96:99], s46 offen offset:1056 nt lds
    v_add_f32 v8, v8, v130
    v_cvt_pk_bf16_f32 v200, v128, v129
    v_mfma_f32_16x16x32_bf16 a[148:151], a[244:247], v[216:219], a[148:151]
    ds_read_b64_tr_b16 a[228:229], v4 offset:33824
    ds_read_b64_tr_b16 a[230:231], v4 offset:34336
    v_add_f32 v8, v8, v131
    v_cvt_pk_bf16_f32 v201, v130, v131
    v_mfma_f32_16x16x32_bf16 a[180:183], a[244:247], v[220:223], a[180:183]
    v_exp_f32 v137, v137
    v_mfma_f32_16x16x32_bf16 a[152:155], a[248:251], v[216:219], a[152:155]
    v_exp_f32 v138, v138
    v_mfma_f32_16x16x32_bf16 a[184:187], a[248:251], v[220:223], a[184:187]
    v_add_f32 v9, v9, v136
    v_add_f32 v9, v9, v137
    v_exp_f32 v139, v139
    v_mfma_f32_16x16x32_bf16 a[156:159], a[252:255], v[216:219], a[156:159]
    ds_read_b64_tr_b16 a[232:233], v4 offset:33856
    ds_read_b64_tr_b16 a[234:235], v4 offset:34368
    ds_read_b64_tr_b16 a[236:237], v4 offset:33888
    ds_read_b64_tr_b16 a[238:239], v4 offset:34400
    v_mfma_f32_16x16x32_bf16 a[188:191], a[252:255], v[220:223], a[188:191]
    v_exp_f32 v132, v132
    v_add_f32 v9, v9, v138
    v_cvt_pk_bf16_f32 v204, v136, v137
    v_add_f32 v9, v9, v139
    v_cvt_pk_bf16_f32 v205, v138, v139
    v_exp_f32 v133, v133
    v_exp_f32 v134, v134
    v_add_f32 v8, v8, v132
    v_add_f32 v8, v8, v133
    s_add_u32 s41, s41, 1
    s_cmp_lt_u32 s41, 7
    s_cbranch_scc1 L_loop_s
    v_mfma_f32_16x16x32_bf16 v[144:147], a[192:195], v[64:67], v[184:187]
    ds_read_b64_tr_b16 a[240:241], v4 offset:33920
    ds_read_b64_tr_b16 a[242:243], v4 offset:34432
    v_mfma_f32_16x16x32_bf16 v[152:155], a[192:195], v[80:83], v[188:191]
    v_exp_f32 v135, v135
    v_mfma_f32_16x16x32_bf16 v[144:147], a[196:199], v[68:71], v[144:147]
    v_exp_f32 v140, v140
    v_mfma_f32_16x16x32_bf16 v[152:155], a[196:199], v[84:87], v[152:155]
    ds_read_b64_tr_b16 a[244:245], v4 offset:33952
    ds_read_b64_tr_b16 a[246:247], v4 offset:34464
    v_mfma_f32_16x16x32_bf16 v[144:147], a[200:203], v[72:75], v[144:147]
    v_add_f32 v8, v8, v134
    v_cvt_pk_bf16_f32 v202, v132, v133
    v_mfma_f32_16x16x32_bf16 v[152:155], a[200:203], v[88:91], v[152:155]
    v_add_f32 v8, v8, v135
    v_cvt_pk_bf16_f32 v203, v134, v135
    v_mfma_f32_16x16x32_bf16 v[144:147], a[204:207], v[76:79], v[144:147]
    v_exp_f32 v141, v141
    v_mfma_f32_16x16x32_bf16 v[152:155], a[204:207], v[92:95], v[152:155]
    ds_read_b64_tr_b16 a[248:249], v4 offset:33984
    ds_read_b64_tr_b16 a[250:251], v4 offset:34496
    v_mfma_f32_16x16x32_bf16 v[148:151], a[208:211], v[64:67], v[184:187]
    v_exp_f32 v142, v142
    v_mfma_f32_16x16x32_bf16 v[156:159], a[208:211], v[80:83], v[188:191]
    v_add_f32 v9, v9, v140
    v_add_f32 v9, v9, v141
    v_mfma_f32_16x16x32_bf16 v[148:151], a[212:215], v[68:71], v[148:151]
    ds_read_b64_tr_b16 a[252:253], v4 offset:34016
    ds_read_b64_tr_b16 a[254:255], v4 offset:34528
    v_mfma_f32_16x16x32_bf16 v[156:159], a[212:215], v[84:87], v[156:159]
    v_exp_f32 v143, v143
    v_mfma_f32_16x16x32_bf16 v[148:151], a[216:219], v[72:75], v[148:151]
    s_add_u32 m0, s38, 25344
    s_nop 0
    v_add_f32 v9, v9, v142
    v_cvt_pk_bf16_f32 v206, v140, v141
    v_mfma_f32_16x16x32_bf16 v[156:159], a[216:219], v[88:91], v[156:159]
    s_add_u32 s46, s40, 270336
    v_add_f32 v9, v9, v143
    v_cvt_pk_bf16_f32 v207, v142, v143
    v_mfma_f32_16x16x32_bf16 v[148:151], a[220:223], v[76:79], v[148:151]
    s_waitcnt vmcnt(4)
    buffer_load_dwordx4 v6, s[96:99], s46 offen offset:0 nt lds
    buffer_load_dwordx4 v7, s[96:99], s46 offen offset:1056 nt lds
    v_mfma_f32_16x16x32_bf16 v[156:159], a[220:223], v[92:95], v[156:159]
    s_waitcnt lgkmcnt(0)
    v_mfma_f32_16x16x32_bf16 a[0:3], a[224:227], v[200:203], a[0:3]
    v_mfma_f32_16x16x32_bf16 a[32:35], a[224:227], v[204:207], a[32:35]
    v_mfma_f32_16x16x32_bf16 a[4:7], a[228:231], v[200:203], a[4:7]
    v_max3_f32 v14, v144, v145, v146
    v_max3_f32 v15, v152, v153, v154
    v_mfma_f32_16x16x32_bf16 a[36:39], a[228:231], v[204:207], a[36:39]
    v_max3_f32 v14, v14, v147, v148
    v_max3_f32 v15, v15, v155, v156
    v_mfma_f32_16x16x32_bf16 a[8:11], a[232:235], v[200:203], a[8:11]
    v_max3_f32 v14, v14, v149, v150
    v_max3_f32 v15, v15, v157, v158
    v_mfma_f32_16x16x32_bf16 a[40:43], a[232:235], v[204:207], a[40:43]
    v_max_f32 v14, v14, v151
    v_max_f32 v15, v15, v159
    v_mfma_f32_16x16x32_bf16 a[12:15], a[236:239], v[200:203], a[12:15]
    v_max_f32 v16, v14, v15
    v_mfma_f32_16x16x32_bf16 a[44:47], a[236:239], v[204:207], a[44:47]
    v_cmp_lt_f32 vcc, 0x41000000, v16
    s_nop 0
    s_cbranch_vccnz L_st_se29_1
L_st_se29_1_ret:
    v_exp_f32 v144, v144
    v_exp_f32 v145, v145
    v_exp_f32 v146, v146
    v_add_f32 v10, v10, v144
    v_add_f32 v10, v10, v145
    v_mfma_f32_16x16x32_bf16 a[16:19], a[240:243], v[200:203], a[16:19]
    v_exp_f32 v147, v147
    v_exp_f32 v152, v152
    v_mfma_f32_16x16x32_bf16 a[48:51], a[240:243], v[204:207], a[48:51]
    v_add_f32 v10, v10, v146
    v_cvt_pk_bf16_f32 v208, v144, v145
    v_mfma_f32_16x16x32_bf16 a[20:23], a[244:247], v[200:203], a[20:23]
    v_add_f32 v10, v10, v147
    v_cvt_pk_bf16_f32 v209, v146, v147
    v_mfma_f32_16x16x32_bf16 a[52:55], a[244:247], v[204:207], a[52:55]
    v_exp_f32 v153, v153
    v_mfma_f32_16x16x32_bf16 a[24:27], a[248:251], v[200:203], a[24:27]
    v_exp_f32 v154, v154
    v_mfma_f32_16x16x32_bf16 a[56:59], a[248:251], v[204:207], a[56:59]
    v_add_f32 v11, v11, v152
    v_add_f32 v11, v11, v153
    v_mfma_f32_16x16x32_bf16 a[28:31], a[252:255], v[200:203], a[28:31]
    v_exp_f32 v155, v155
    v_mfma_f32_16x16x32_bf16 a[60:63], a[252:255], v[204:207], a[60:63]
    v_exp_f32 v148, v148
    s_waitcnt vmcnt(10)
    s_barrier
    v_mfma_f32_16x16x32_bf16 v[160:163], a[192:195], v[96:99], v[192:195]
    v_add_f32 v11, v11, v154
    v_cvt_pk_bf16_f32 v212, v152, v153
    v_mfma_f32_16x16x32_bf16 v[168:171], a[192:195], v[112:115], v[196:199]
    v_add_f32 v11, v11, v155
    v_cvt_pk_bf16_f32 v213, v154, v155
    v_mfma_f32_16x16x32_bf16 v[160:163], a[196:199], v[100:103], v[160:163]
    v_exp_f32 v149, v149
    v_mfma_f32_16x16x32_bf16 v[168:171], a[196:199], v[116:119], v[168:171]
    v_exp_f32 v150, v150
    v_mfma_f32_16x16x32_bf16 v[160:163], a[200:203], v[104:107], v[160:163]
    v_add_f32 v10, v10, v148
    v_add_f32 v10, v10, v149
    v_mfma_f32_16x16x32_bf16 v[168:171], a[200:203], v[120:123], v[168:171]
    v_exp_f32 v151, v151
    v_exp_f32 v156, v156
    v_mfma_f32_16x16x32_bf16 v[160:163], a[204:207], v[108:111], v[160:163]
    s_add_u32 s40, s40, 16384
    ds_read_b128 a[192:195], v3 offset:0
    ds_read_b128 a[196:199], v3 offset:64
    v_add_f32 v10, v10, v150
    v_cvt_pk_bf16_f32 v210, v148, v149
    v_mfma_f32_16x16x32_bf16 v[168:171], a[204:207], v[124:127], v[168:171]
    s_and_b32 s44, s2, 127
    s_lshl_b32 s44, s44, 15
    s_lshl_b32 s45, s32, 13
    s_add_u32 s44, s44, s45
    v_lshlrev_b32 v246, 7, v1
    s_and_b32 s57, s57, 0xffff
    s_mov_b32 s58, 4194304
    s_mov_b32 s59, 0x20000
    buffer_load_dword v245, v246, s[56:59], s44 offen
    ds_read_b128 a[200:203], v3 offset:128
    ds_read_b128 a[204:207], v3 offset:192
    v_mfma_f32_16x16x32_bf16 v[164:167], a[208:211], v[96:99], v[192:195]
    v_add_f32 v10, v10, v151
    v_cvt_pk_bf16_f32 v211, v150, v151
    v_mfma_f32_16x16x32_bf16 v[172:175], a[208:211], v[112:115], v[196:199]
    v_exp_f32 v157, v157
    v_mfma_f32_16x16x32_bf16 v[164:167], a[212:215], v[100:103], v[164:167]
    v_exp_f32 v158, v158
    v_mfma_f32_16x16x32_bf16 v[172:175], a[212:215], v[116:119], v[172:175]
    v_add_f32 v11, v11, v156
    v_add_f32 v11, v11, v157
    v_mfma_f32_16x16x32_bf16 v[164:167], a[216:219], v[104:107], v[164:167]
    v_exp_f32 v159, v159
    v_mfma_f32_16x16x32_bf16 v[172:175], a[216:219], v[120:123], v[172:175]
    s_nop 0
    v_add_f32 v11, v11, v158
    v_cvt_pk_bf16_f32 v214, v156, v157
    v_add_f32 v11, v11, v159
    v_cvt_pk_bf16_f32 v215, v158, v159
    v_mfma_f32_16x16x32_bf16 v[164:167], a[220:223], v[108:111], v[164:167]
    ds_read_b128 a[208:211], v3 offset:512
    ds_read_b128 a[212:215], v3 offset:576
    v_mfma_f32_16x16x32_bf16 v[172:175], a[220:223], v[124:127], v[172:175]
    ds_read_b128 a[216:219], v3 offset:640
    ds_read_b128 a[220:223], v3 offset:704
    v_mfma_f32_16x16x32_bf16 a[64:67], a[224:227], v[208:211], a[64:67]
    v_mfma_f32_16x16x32_bf16 a[96:99], a[224:227], v[212:215], a[96:99]
    v_mfma_f32_16x16x32_bf16 a[68:71], a[228:231], v[208:211], a[68:71]
    v_max3_f32 v14, v160, v161, v162
    v_max3_f32 v15, v168, v169, v170
    v_mfma_f32_16x16x32_bf16 a[100:103], a[228:231], v[212:215], a[100:103]
    v_max3_f32 v14, v14, v163, v164
    v_max3_f32 v15, v15, v171, v172
    v_mfma_f32_16x16x32_bf16 a[72:75], a[232:235], v[208:211], a[72:75]
    v_max3_f32 v14, v14, v165, v166
    v_max3_f32 v15, v15, v173, v174
    v_mfma_f32_16x16x32_bf16 a[104:107], a[232:235], v[212:215], a[104:107]
    v_max_f32 v14, v14, v167
    v_max_f32 v15, v15, v175
    v_mfma_f32_16x16x32_bf16 a[76:79], a[236:239], v[208:211], a[76:79]
    v_max_f32 v16, v14, v15
    v_mfma_f32_16x16x32_bf16 a[108:111], a[236:239], v[212:215], a[108:111]
    v_cmp_lt_f32 vcc, 0x41000000, v16
    s_nop 0
    s_cbranch_vccnz L_st_se29_2
L_st_se29_2_ret:
    v_exp_f32 v160, v160
    v_exp_f32 v161, v161
    v_exp_f32 v162, v162
    v_add_f32 v12, v12, v160
    v_add_f32 v12, v12, v161
    v_mfma_f32_16x16x32_bf16 a[80:83], a[240:243], v[208:211], a[80:83]
    v_exp_f32 v163, v163
    v_exp_f32 v168, v168
    v_mfma_f32_16x16x32_bf16 a[112:115], a[240:243], v[212:215], a[112:115]
    v_add_f32 v12, v12, v162
    v_cvt_pk_bf16_f32 v216, v160, v161
    v_mfma_f32_16x16x32_bf16 a[84:87], a[244:247], v[208:211], a[84:87]
    v_add_f32 v12, v12, v163
    v_cvt_pk_bf16_f32 v217, v162, v163
    v_mfma_f32_16x16x32_bf16 a[116:119], a[244:247], v[212:215], a[116:119]
    v_exp_f32 v169, v169
    v_mfma_f32_16x16x32_bf16 a[88:91], a[248:251], v[208:211], a[88:91]
    v_exp_f32 v170, v170
    v_mfma_f32_16x16x32_bf16 a[120:123], a[248:251], v[212:215], a[120:123]
    v_add_f32 v13, v13, v168
    v_add_f32 v13, v13, v169
    v_mfma_f32_16x16x32_bf16 a[92:95], a[252:255], v[208:211], a[92:95]
    v_exp_f32 v171, v171
    v_mfma_f32_16x16x32_bf16 a[124:127], a[252:255], v[212:215], a[124:127]
    v_exp_f32 v164, v164
    s_waitcnt lgkmcnt(0)
    v_mfma_f32_16x16x32_bf16 v[128:131], a[192:195], v[32:35], v[176:179]
    v_add_f32 v13, v13, v170
    v_cvt_pk_bf16_f32 v220, v168, v169
    v_mfma_f32_16x16x32_bf16 v[136:139], a[192:195], v[48:51], v[180:183]
    v_add_f32 v13, v13, v171
    v_cvt_pk_bf16_f32 v221, v170, v171
    v_mfma_f32_16x16x32_bf16 v[128:131], a[196:199], v[36:39], v[128:131]
    v_exp_f32 v165, v165
    v_mfma_f32_16x16x32_bf16 v[136:139], a[196:199], v[52:55], v[136:139]
    v_exp_f32 v166, v166
    v_mfma_f32_16x16x32_bf16 v[128:131], a[200:203], v[40:43], v[128:131]
    v_add_f32 v12, v12, v164
    v_add_f32 v12, v12, v165
    v_mfma_f32_16x16x32_bf16 v[136:139], a[200:203], v[56:59], v[136:139]
    v_exp_f32 v167, v167
    v_mfma_f32_16x16x32_bf16 v[128:131], a[204:207], v[44:47], v[128:131]
    v_exp_f32 v172, v172
    v_mfma_f32_16x16x32_bf16 v[136:139], a[204:207], v[60:63], v[136:139]
    v_add_f32 v12, v12, v166
    v_cvt_pk_bf16_f32 v218, v164, v165
    v_mfma_f32_16x16x32_bf16 v[132:135], a[208:211], v[32:35], v[176:179]
    v_add_f32 v12, v12, v167
    v_cvt_pk_bf16_f32 v219, v166, v167
    v_mfma_f32_16x16x32_bf16 v[140:143], a[208:211], v[48:51], v[180:183]
    v_exp_f32 v173, v173
    v_mfma_f32_16x16x32_bf16 v[132:135], a[212:215], v[36:39], v[132:135]
    v_exp_f32 v174, v174
    v_mfma_f32_16x16x32_bf16 v[140:143], a[212:215], v[52:55], v[140:143]
    v_add_f32 v13, v13, v172
    v_add_f32 v13, v13, v173
    v_mfma_f32_16x16x32_bf16 v[132:135], a[216:219], v[40:43], v[132:135]
    v_exp_f32 v175, v175
    v_mfma_f32_16x16x32_bf16 v[140:143], a[216:219], v[56:59], v[140:143]
    s_nop 0
    v_add_f32 v13, v13, v174
    v_cvt_pk_bf16_f32 v222, v172, v173
    v_add_f32 v13, v13, v175
    v_cvt_pk_bf16_f32 v223, v174, v175
    v_mfma_f32_16x16x32_bf16 v[132:135], a[220:223], v[44:47], v[132:135]
    v_mfma_f32_16x16x32_bf16 v[140:143], a[220:223], v[60:63], v[140:143]
    v_mfma_f32_16x16x32_bf16 a[128:131], a[224:227], v[216:219], a[128:131]
    v_mfma_f32_16x16x32_bf16 a[160:163], a[224:227], v[220:223], a[160:163]
    ds_read_b64_tr_b16 a[224:225], v5 offset:0
    ds_read_b64_tr_b16 a[226:227], v5 offset:512
    v_mfma_f32_16x16x32_bf16 a[132:135], a[228:231], v[216:219], a[132:135]
    v_max3_f32 v14, v128, v129, v130
    v_max3_f32 v15, v136, v137, v138
    v_mfma_f32_16x16x32_bf16 a[164:167], a[228:231], v[220:223], a[164:167]
    v_max3_f32 v14, v14, v131, v132
    v_max3_f32 v15, v15, v139, v140
    v_mfma_f32_16x16x32_bf16 a[136:139], a[232:235], v[216:219], a[136:139]
    v_max3_f32 v14, v14, v133, v134
    v_max3_f32 v15, v15, v141, v142
    v_mfma_f32_16x16x32_bf16 a[168:171], a[232:235], v[220:223], a[168:171]
    v_max_f32 v14, v14, v135
    v_max_f32 v15, v15, v143
    v_mfma_f32_16x16x32_bf16 a[140:143], a[236:239], v[216:219], a[140:143]
    v_max_f32 v16, v14, v15
    v_mfma_f32_16x16x32_bf16 a[172:175], a[236:239], v[220:223], a[172:175]
    v_cmp_lt_f32 vcc, 0x41000000, v16
    s_nop 0
    s_cbranch_vccnz L_st_se29_0
L_st_se29_0_ret:
    v_exp_f32 v128, v128
    v_exp_f32 v129, v129
    v_exp_f32 v130, v130
    v_add_f32 v8, v8, v128
    v_add_f32 v8, v8, v129
    v_mfma_f32_16x16x32_bf16 a[144:147], a[240:243], v[216:219], a[144:147]
    v_exp_f32 v131, v131
    v_exp_f32 v136, v136
    v_mfma_f32_16x16x32_bf16 a[176:179], a[240:243], v[220:223], a[176:179]
    v_add_f32 v8, v8, v130
    v_cvt_pk_bf16_f32 v200, v128, v129
    v_add_f32 v8, v8, v131
    v_cvt_pk_bf16_f32 v201, v130, v131
    v_mfma_f32_16x16x32_bf16 a[148:151], a[244:247], v[216:219], a[148:151]
    ds_read_b64_tr_b16 a[228:229], v5 offset:32
    ds_read_b64_tr_b16 a[230:231], v5 offset:544
    v_mfma_f32_16x16x32_bf16 a[180:183], a[244:247], v[220:223], a[180:183]
    v_exp_f32 v137, v137
    v_mfma_f32_16x16x32_bf16 a[152:155], a[248:251], v[216:219], a[152:155]
    v_exp_f32 v138, v138
    v_mfma_f32_16x16x32_bf16 a[184:187], a[248:251], v[220:223], a[184:187]
    v_add_f32 v9, v9, v136
    v_add_f32 v9, v9, v137
    v_exp_f32 v139, v139
    v_mfma_f32_16x16x32_bf16 a[156:159], a[252:255], v[216:219], a[156:159]
    ds_read_b64_tr_b16 a[232:233], v5 offset:64
    ds_read_b64_tr_b16 a[234:235], v5 offset:576
    ds_read_b64_tr_b16 a[236:237], v5 offset:96
    ds_read_b64_tr_b16 a[238:239], v5 offset:608
    v_mfma_f32_16x16x32_bf16 a[188:191], a[252:255], v[220:223], a[188:191]
    v_exp_f32 v132, v132
    v_add_f32 v9, v9, v138
    v_cvt_pk_bf16_f32 v204, v136, v137
    v_add_f32 v9, v9, v139
    v_cvt_pk_bf16_f32 v205, v138, v139
    v_exp_f32 v133, v133
    v_exp_f32 v134, v134
    v_add_f32 v8, v8, v132
    v_add_f32 v8, v8, v133
    v_mfma_f32_16x16x32_bf16 v[144:147], a[192:195], v[64:67], v[184:187]
    ds_read_b64_tr_b16 a[240:241], v5 offset:128
    ds_read_b64_tr_b16 a[242:243], v5 offset:640
    v_mfma_f32_16x16x32_bf16 v[152:155], a[192:195], v[80:83], v[188:191]
    v_exp_f32 v135, v135
    v_mfma_f32_16x16x32_bf16 v[144:147], a[196:199], v[68:71], v[144:147]
    v_exp_f32 v140, v140
    v_mfma_f32_16x16x32_bf16 v[152:155], a[196:199], v[84:87], v[152:155]
    ds_read_b64_tr_b16 a[244:245], v5 offset:160
    ds_read_b64_tr_b16 a[246:247], v5 offset:672
    v_mfma_f32_16x16x32_bf16 v[144:147], a[200:203], v[72:75], v[144:147]
    v_add_f32 v8, v8, v134
    v_cvt_pk_bf16_f32 v202, v132, v133
    v_mfma_f32_16x16x32_bf16 v[152:155], a[200:203], v[88:91], v[152:155]
    v_add_f32 v8, v8, v135
    v_cvt_pk_bf16_f32 v203, v134, v135
    v_mfma_f32_16x16x32_bf16 v[144:147], a[204:207], v[76:79], v[144:147]
    v_exp_f32 v141, v141
    v_mfma_f32_16x16x32_bf16 v[152:155], a[204:207], v[92:95], v[152:155]
    ds_read_b64_tr_b16 a[248:249], v5 offset:192
    ds_read_b64_tr_b16 a[250:251], v5 offset:704
    v_mfma_f32_16x16x32_bf16 v[148:151], a[208:211], v[64:67], v[184:187]
    v_exp_f32 v142, v142
    v_mfma_f32_16x16x32_bf16 v[156:159], a[208:211], v[80:83], v[188:191]
    v_add_f32 v9, v9, v140
    v_add_f32 v9, v9, v141
    v_mfma_f32_16x16x32_bf16 v[148:151], a[212:215], v[68:71], v[148:151]
    ds_read_b64_tr_b16 a[252:253], v5 offset:224
    ds_read_b64_tr_b16 a[254:255], v5 offset:736
    v_mfma_f32_16x16x32_bf16 v[156:159], a[212:215], v[84:87], v[156:159]
    v_exp_f32 v143, v143
    v_mfma_f32_16x16x32_bf16 v[148:151], a[216:219], v[72:75], v[148:151]
    s_nop 0
    v_add_f32 v9, v9, v142
    v_cvt_pk_bf16_f32 v206, v140, v141
    v_mfma_f32_16x16x32_bf16 v[156:159], a[216:219], v[88:91], v[156:159]
    v_add_f32 v9, v9, v143
    v_cvt_pk_bf16_f32 v207, v142, v143
    v_mfma_f32_16x16x32_bf16 v[148:151], a[220:223], v[76:79], v[148:151]
    v_mfma_f32_16x16x32_bf16 v[156:159], a[220:223], v[92:95], v[156:159]
    s_waitcnt lgkmcnt(0)
    v_mfma_f32_16x16x32_bf16 a[0:3], a[224:227], v[200:203], a[0:3]
    v_mfma_f32_16x16x32_bf16 a[32:35], a[224:227], v[204:207], a[32:35]
    v_mfma_f32_16x16x32_bf16 a[4:7], a[228:231], v[200:203], a[4:7]
    v_max3_f32 v14, v144, v145, v146
    v_max3_f32 v15, v152, v153, v154
    v_mfma_f32_16x16x32_bf16 a[36:39], a[228:231], v[204:207], a[36:39]
    v_max3_f32 v14, v14, v147, v148
    v_max3_f32 v15, v15, v155, v156
    v_mfma_f32_16x16x32_bf16 a[8:11], a[232:235], v[200:203], a[8:11]
    v_max3_f32 v14, v14, v149, v150
    v_max3_f32 v15, v15, v157, v158
    v_mfma_f32_16x16x32_bf16 a[40:43], a[232:235], v[204:207], a[40:43]
    v_max_f32 v14, v14, v151
    v_max_f32 v15, v15, v159
    v_mfma_f32_16x16x32_bf16 a[12:15], a[236:239], v[200:203], a[12:15]
    v_max_f32 v16, v14, v15
    v_mfma_f32_16x16x32_bf16 a[44:47], a[236:239], v[204:207], a[44:47]
    v_cmp_lt_f32 vcc, 0x41000000, v16
    s_nop 0
    s_cbranch_vccnz L_st_se30_1
L_st_se30_1_ret:
    v_exp_f32 v144, v144
    v_exp_f32 v145, v145
    v_exp_f32 v146, v146
    v_add_f32 v10, v10, v144
    v_add_f32 v10, v10, v145
    v_mfma_f32_16x16x32_bf16 a[16:19], a[240:243], v[200:203], a[16:19]
    v_exp_f32 v147, v147
    v_exp_f32 v152, v152
    v_mfma_f32_16x16x32_bf16 a[48:51], a[240:243], v[204:207], a[48:51]
    v_add_f32 v10, v10, v146
    v_cvt_pk_bf16_f32 v208, v144, v145
    v_mfma_f32_16x16x32_bf16 a[20:23], a[244:247], v[200:203], a[20:23]
    v_add_f32 v10, v10, v147
    v_cvt_pk_bf16_f32 v209, v146, v147
    v_mfma_f32_16x16x32_bf16 a[52:55], a[244:247], v[204:207], a[52:55]
    v_exp_f32 v153, v153
    v_mfma_f32_16x16x32_bf16 a[24:27], a[248:251], v[200:203], a[24:27]
    v_exp_f32 v154, v154
    v_mfma_f32_16x16x32_bf16 a[56:59], a[248:251], v[204:207], a[56:59]
    v_add_f32 v11, v11, v152
    v_add_f32 v11, v11, v153
    v_mfma_f32_16x16x32_bf16 a[28:31], a[252:255], v[200:203], a[28:31]
    v_exp_f32 v155, v155
    v_mfma_f32_16x16x32_bf16 a[60:63], a[252:255], v[204:207], a[60:63]
    v_exp_f32 v148, v148
    s_waitcnt vmcnt(1)
    s_barrier
    v_mfma_f32_16x16x32_bf16 v[160:163], a[192:195], v[96:99], v[192:195]
    v_add_f32 v11, v11, v154
    v_cvt_pk_bf16_f32 v212, v152, v153
    s_add_u32 m0, s52, 0
    s_add_u32 s46, s50, 0
    buffer_load_dwordx4 v27, s[20:23], s46 offen  lds
    v_mfma_f32_16x16x32_bf16 v[168:171], a[192:195], v[112:115], v[196:199]
    v_add_f32 v11, v11, v155
    v_cvt_pk_bf16_f32 v213, v154, v155
    v_mfma_f32_16x16x32_bf16 v[160:163], a[196:199], v[100:103], v[160:163]
    s_add_u32 m0, s52, 1024
    v_exp_f32 v149, v149
    v_mfma_f32_16x16x32_bf16 v[168:171], a[196:199], v[116:119], v[168:171]
    s_add_u32 s46, s50, 8192
    v_exp_f32 v150, v150
    v_mfma_f32_16x16x32_bf16 v[160:163], a[200:203], v[104:107], v[160:163]
    v_add_f32 v10, v10, v148
    v_add_f32 v10, v10, v149
    buffer_load_dwordx4 v27, s[20:23], s46 offen  lds
    v_mfma_f32_16x16x32_bf16 v[168:171], a[200:203], v[120:123], v[168:171]
    v_exp_f32 v151, v151
    v_exp_f32 v156, v156
    v_mfma_f32_16x16x32_bf16 v[160:163], a[204:207], v[108:111], v[160:163]
    ds_read_b128 a[192:195], v3 offset:33792
    ds_read_b128 a[196:199], v3 offset:33856
    v_mfma_f32_16x16x32_bf16 v[168:171], a[204:207], v[124:127], v[168:171]
    v_add_f32 v10, v10, v150
    v_cvt_pk_bf16_f32 v210, v148, v149
    ds_read_b128 a[200:203], v3 offset:33920
    ds_read_b128 a[204:207], v3 offset:33984
    v_mfma_f32_16x16x32_bf16 v[164:167], a[208:211], v[96:99], v[192:195]
    v_add_f32 v10, v10, v151
    v_cvt_pk_bf16_f32 v211, v150, v151
    v_mfma_f32_16x16x32_bf16 v[172:175], a[208:211], v[112:115], v[196:199]
    v_exp_f32 v157, v157
    v_mfma_f32_16x16x32_bf16 v[164:167], a[212:215], v[100:103], v[164:167]
    v_exp_f32 v158, v158
    v_mfma_f32_16x16x32_bf16 v[172:175], a[212:215], v[116:119], v[172:175]
    v_add_f32 v11, v11, v156
    v_add_f32 v11, v11, v157
    v_mfma_f32_16x16x32_bf16 v[164:167], a[216:219], v[104:107], v[164:167]
    v_exp_f32 v159, v159
    v_mfma_f32_16x16x32_bf16 v[172:175], a[216:219], v[120:123], v[172:175]
    s_add_u32 m0, s52, 2048
    s_nop 0
    v_add_f32 v11, v11, v158
    v_cvt_pk_bf16_f32 v214, v156, v157
    v_add_f32 v11, v11, v159
    v_cvt_pk_bf16_f32 v215, v158, v159
    v_mfma_f32_16x16x32_bf16 v[164:167], a[220:223], v[108:111], v[164:167]
    s_add_u32 s46, s50, 16384
    ds_read_b128 a[208:211], v3 offset:34304
    ds_read_b128 a[212:215], v3 offset:34368
    v_mfma_f32_16x16x32_bf16 v[172:175], a[220:223], v[124:127], v[172:175]
    buffer_load_dwordx4 v27, s[20:23], s46 offen  lds
    v_mfma_f32_16x16x32_bf16 a[64:67], a[224:227], v[208:211], a[64:67]
    s_add_u32 m0, s52, 3072
    ds_read_b128 a[216:219], v3 offset:34432
    ds_read_b128 a[220:223], v3 offset:34496
    v_mfma_f32_16x16x32_bf16 a[96:99], a[224:227], v[212:215], a[96:99]
    s_add_u32 s46, s50, 24576
    buffer_load_dwordx4 v27, s[20:23], s46 offen  lds
    v_mfma_f32_16x16x32_bf16 a[68:71], a[228:231], v[208:211], a[68:71]
    v_max3_f32 v14, v160, v161, v162
    v_max3_f32 v15, v168, v169, v170
    v_mfma_f32_16x16x32_bf16 a[100:103], a[228:231], v[212:215], a[100:103]
    v_max3_f32 v14, v14, v163, v164
    v_max3_f32 v15, v15, v171, v172
    v_mfma_f32_16x16x32_bf16 a[72:75], a[232:235], v[208:211], a[72:75]
    v_max3_f32 v14, v14, v165, v166
    v_max3_f32 v15, v15, v173, v174
    v_mfma_f32_16x16x32_bf16 a[104:107], a[232:235], v[212:215], a[104:107]
    v_max_f32 v14, v14, v167
    v_max_f32 v15, v15, v175
    v_mfma_f32_16x16x32_bf16 a[76:79], a[236:239], v[208:211], a[76:79]
    v_max_f32 v16, v14, v15
    v_mfma_f32_16x16x32_bf16 a[108:111], a[236:239], v[212:215], a[108:111]
    s_add_u32 m0, s52, 16384
    v_cmp_lt_f32 vcc, 0x41000000, v16
    s_nop 0
    s_cbranch_vccnz L_st_se30_2
L_st_se30_2_ret:
    v_exp_f32 v160, v160
    v_exp_f32 v161, v161
    v_exp_f32 v162, v162
    v_add_f32 v12, v12, v160
    v_add_f32 v12, v12, v161
    v_mfma_f32_16x16x32_bf16 a[80:83], a[240:243], v[208:211], a[80:83]
    s_add_u32 s46, s50, 65536
    v_exp_f32 v163, v163
    v_exp_f32 v168, v168
    v_mfma_f32_16x16x32_bf16 a[112:115], a[240:243], v[212:215], a[112:115]
    buffer_load_dwordx4 v27, s[20:23], s46 offen  lds
    v_add_f32 v12, v12, v162
    v_cvt_pk_bf16_f32 v216, v160, v161
    v_mfma_f32_16x16x32_bf16 a[84:87], a[244:247], v[208:211], a[84:87]
    v_add_f32 v12, v12, v163
    v_cvt_pk_bf16_f32 v217, v162, v163
    v_mfma_f32_16x16x32_bf16 a[116:119], a[244:247], v[212:215], a[116:119]
    v_exp_f32 v169, v169
    v_mfma_f32_16x16x32_bf16 a[88:91], a[248:251], v[208:211], a[88:91]
    s_add_u32 m0, s52, 17408
    v_exp_f32 v170, v170
    v_mfma_f32_16x16x32_bf16 a[120:123], a[248:251], v[212:215], a[120:123]
    s_add_u32 s46, s50, 73728
    v_add_f32 v13, v13, v168
    v_add_f32 v13, v13, v169
    v_mfma_f32_16x16x32_bf16 a[92:95], a[252:255], v[208:211], a[92:95]
    buffer_load_dwordx4 v27, s[20:23], s46 offen  lds
    v_exp_f32 v171, v171
    v_mfma_f32_16x16x32_bf16 a[124:127], a[252:255], v[212:215], a[124:127]
    v_exp_f32 v164, v164
    s_add_u32 m0, s52, 18432
    s_add_u32 s46, s50, 81920
    buffer_load_dwordx4 v27, s[20:23], s46 offen  lds
    s_waitcnt lgkmcnt(0)
    v_mfma_f32_16x16x32_bf16 v[128:131], a[192:195], v[32:35], v[176:179]
    v_add_f32 v13, v13, v170
    v_cvt_pk_bf16_f32 v220, v168, v169
    v_mfma_f32_16x16x32_bf16 v[136:139], a[192:195], v[48:51], v[180:183]
    v_add_f32 v13, v13, v171
    v_cvt_pk_bf16_f32 v221, v170, v171
    v_mfma_f32_16x16x32_bf16 v[128:131], a[196:199], v[36:39], v[128:131]
    v_exp_f32 v165, v165
    v_mfma_f32_16x16x32_bf16 v[136:139], a[196:199], v[52:55], v[136:139]
    v_exp_f32 v166, v166
    v_mfma_f32_16x16x32_bf16 v[128:131], a[200:203], v[40:43], v[128:131]
    v_add_f32 v12, v12, v164
    v_add_f32 v12, v12, v165
    v_mfma_f32_16x16x32_bf16 v[136:139], a[200:203], v[56:59], v[136:139]
    s_add_u32 m0, s52, 19456
    v_exp_f32 v167, v167
    v_mfma_f32_16x16x32_bf16 v[128:131], a[204:207], v[44:47], v[128:131]
    s_add_u32 s46, s50, 90112
    v_exp_f32 v172, v172
    v_mfma_f32_16x16x32_bf16 v[136:139], a[204:207], v[60:63], v[136:139]
    buffer_load_dwordx4 v27, s[20:23], s46 offen  lds
    v_add_f32 v12, v12, v166
    v_cvt_pk_bf16_f32 v218, v164, v165
    v_mfma_f32_16x16x32_bf16 v[132:135], a[208:211], v[32:35], v[176:179]
    v_add_f32 v12, v12, v167
    v_cvt_pk_bf16_f32 v219, v166, v167
    s_add_u32 m0, s52, 32768
    s_add_u32 s46, s51, 0
    buffer_load_dwordx4 v27, s[20:23], s46 offen  lds
    v_mfma_f32_16x16x32_bf16 v[140:143], a[208:211], v[48:51], v[180:183]
    v_exp_f32 v173, v173
    v_mfma_f32_16x16x32_bf16 v[132:135], a[212:215], v[36:39], v[132:135]
    v_exp_f32 v174, v174
    v_mfma_f32_16x16x32_bf16 v[140:143], a[212:215], v[52:55], v[140:143]
    v_add_f32 v13, v13, v172
    v_add_f32 v13, v13, v173
    v_mfma_f32_16x16x32_bf16 v[132:135], a[216:219], v[40:43], v[132:135]
    s_add_u32 m0, s52, 33792
    v_exp_f32 v175, v175
    v_mfma_f32_16x16x32_bf16 v[140:143], a[216:219], v[56:59], v[140:143]
    s_add_u32 s46, s51, 8192
    s_nop 0
    v_add_f32 v13, v13, v174
    v_cvt_pk_bf16_f32 v222, v172, v173
    v_add_f32 v13, v13, v175
    v_cvt_pk_bf16_f32 v223, v174, v175
    v_mfma_f32_16x16x32_bf16 v[132:135], a[220:223], v[44:47], v[132:135]
    buffer_load_dwordx4 v27, s[20:23], s46 offen  lds
    v_mfma_f32_16x16x32_bf16 v[140:143], a[220:223], v[60:63], v[140:143]
    s_add_u32 m0, s52, 34816
    s_add_u32 s46, s51, 16384
    buffer_load_dwordx4 v27, s[20:23], s46 offen  lds
    v_mfma_f32_16x16x32_bf16 a[128:131], a[224:227], v[216:219], a[128:131]
    v_mfma_f32_16x16x32_bf16 a[160:163], a[224:227], v[220:223], a[160:163]
    ds_read_b64_tr_b16 a[224:225], v5 offset:33792
    ds_read_b64_tr_b16 a[226:227], v5 offset:34304
    v_mfma_f32_16x16x32_bf16 a[132:135], a[228:231], v[216:219], a[132:135]
    v_max3_f32 v14, v128, v129, v130
    v_max3_f32 v15, v136, v137, v138
    v_mfma_f32_16x16x32_bf16 a[164:167], a[228:231], v[220:223], a[164:167]
    v_max3_f32 v14, v14, v131, v132
    v_max3_f32 v15, v15, v139, v140
    v_mfma_f32_16x16x32_bf16 a[136:139], a[232:235], v[216:219], a[136:139]
    v_max3_f32 v14, v14, v133, v134
    v_max3_f32 v15, v15, v141, v142
    v_mfma_f32_16x16x32_bf16 a[168:171], a[232:235], v[220:223], a[168:171]
    v_max_f32 v14, v14, v135
    v_max_f32 v15, v15, v143
    v_mfma_f32_16x16x32_bf16 a[140:143], a[236:239], v[216:219], a[140:143]
    v_max_f32 v16, v14, v15
    v_mfma_f32_16x16x32_bf16 a[172:175], a[236:239], v[220:223], a[172:175]
    s_add_u32 m0, s52, 35840
    v_cmp_lt_f32 vcc, 0x41000000, v16
    s_nop 0
    s_cbranch_vccnz L_st_se30_0
L_st_se30_0_ret:
    v_exp_f32 v128, v128
    v_exp_f32 v129, v129
    v_exp_f32 v130, v130
    v_add_f32 v8, v8, v128
    v_add_f32 v8, v8, v129
    v_mfma_f32_16x16x32_bf16 a[144:147], a[240:243], v[216:219], a[144:147]
    s_add_u32 s46, s51, 24576
    v_exp_f32 v131, v131
    v_exp_f32 v136, v136
    v_mfma_f32_16x16x32_bf16 a[176:179], a[240:243], v[220:223], a[176:179]
    buffer_load_dwordx4 v27, s[20:23], s46 offen  lds
    v_add_f32 v8, v8, v130
    v_cvt_pk_bf16_f32 v200, v128, v129
    v_mfma_f32_16x16x32_bf16 a[148:151], a[244:247], v[216:219], a[148:151]
    ds_read_b64_tr_b16 a[228:229], v5 offset:33824
    ds_read_b64_tr_b16 a[230:231], v5 offset:34336
    v_add_f32 v8, v8, v131
    v_cvt_pk_bf16_f32 v201, v130, v131
    v_mfma_f32_16x16x32_bf16 a[180:183], a[244:247], v[220:223], a[180:183]
    s_add_u32 m0, s52, 49152
    v_exp_f32 v137, v137
    v_mfma_f32_16x16x32_bf16 a[152:155], a[248:251], v[216:219], a[152:155]
    s_add_u32 s46, s51, 65536
    v_exp_f32 v138, v138
    v_mfma_f32_16x16x32_bf16 a[184:187], a[248:251], v[220:223], a[184:187]
    buffer_load_dwordx4 v27, s[20:23], s46 offen  lds
    v_add_f32 v9, v9, v136
    v_add_f32 v9, v9, v137
    s_add_u32 m0, s52, 50176
    s_add_u32 s46, s51, 73728
    buffer_load_dwordx4 v27, s[20:23], s46 offen  lds
    v_mfma_f32_16x16x32_bf16 a[156:159], a[252:255], v[216:219], a[156:159]
    ds_read_b64_tr_b16 a[232:233], v5 offset:33856
    ds_read_b64_tr_b16 a[234:235], v5 offset:34368
    v_exp_f32 v139, v139
    ds_read_b64_tr_b16 a[236:237], v5 offset:33888
    ds_read_b64_tr_b16 a[238:239], v5 offset:34400
    s_add_u32 m0, s52, 51200
    s_add_u32 s46, s51, 81920
    buffer_load_dwordx4 v27, s[20:23], s46 offen  lds
    s_add_u32 m0, s52, 52224
    s_add_u32 s46, s51, 90112
    buffer_load_dwordx4 v27, s[20:23], s46 offen  lds
    v_mfma_f32_16x16x32_bf16 a[188:191], a[252:255], v[220:223], a[188:191]
    v_exp_f32 v132, v132
    v_add_f32 v9, v9, v138
    v_cvt_pk_bf16_f32 v204, v136, v137
    v_add_f32 v9, v9, v139
    v_cvt_pk_bf16_f32 v205, v138, v139
    v_exp_f32 v133, v133
    v_exp_f32 v134, v134
    v_add_f32 v8, v8, v132
    v_add_f32 v8, v8, v133
    v_mfma_f32_16x16x32_bf16 v[144:147], a[192:195], v[64:67], v[184:187]
    ds_read_b64_tr_b16 a[240:241], v5 offset:33920
    ds_read_b64_tr_b16 a[242:243], v5 offset:34432
    v_mfma_f32_16x16x32_bf16 v[152:155], a[192:195], v[80:83], v[188:191]
    v_exp_f32 v135, v135
    v_mfma_f32_16x16x32_bf16 v[144:147], a[196:199], v[68:71], v[144:147]
    v_exp_f32 v140, v140
    v_mfma_f32_16x16x32_bf16 v[152:155], a[196:199], v[84:87], v[152:155]
    ds_read_b64_tr_b16 a[244:245], v5 offset:33952
    ds_read_b64_tr_b16 a[246:247], v5 offset:34464
    v_mfma_f32_16x16x32_bf16 v[144:147], a[200:203], v[72:75], v[144:147]
    v_add_f32 v8, v8, v134
    v_cvt_pk_bf16_f32 v202, v132, v133
    v_mfma_f32_16x16x32_bf16 v[152:155], a[200:203], v[88:91], v[152:155]
    v_add_f32 v8, v8, v135
    v_cvt_pk_bf16_f32 v203, v134, v135
    v_mfma_f32_16x16x32_bf16 v[144:147], a[204:207], v[76:79], v[144:147]
    v_exp_f32 v141, v141
    v_mfma_f32_16x16x32_bf16 v[152:155], a[204:207], v[92:95], v[152:155]
    ds_read_b64_tr_b16 a[248:249], v5 offset:33984
    ds_read_b64_tr_b16 a[250:251], v5 offset:34496
    v_mfma_f32_16x16x32_bf16 v[148:151], a[208:211], v[64:67], v[184:187]
    v_exp_f32 v142, v142
    v_mfma_f32_16x16x32_bf16 v[156:159], a[208:211], v[80:83], v[188:191]
    v_add_f32 v9, v9, v140
    v_add_f32 v9, v9, v141
    v_mfma_f32_16x16x32_bf16 v[148:151], a[212:215], v[68:71], v[148:151]
    ds_read_b64_tr_b16 a[252:253], v5 offset:34016
    ds_read_b64_tr_b16 a[254:255], v5 offset:34528
    v_mfma_f32_16x16x32_bf16 v[156:159], a[212:215], v[84:87], v[156:159]
    v_exp_f32 v143, v143
    v_mfma_f32_16x16x32_bf16 v[148:151], a[216:219], v[72:75], v[148:151]
    s_nop 0
    v_add_f32 v9, v9, v142
    v_cvt_pk_bf16_f32 v206, v140, v141
    v_mfma_f32_16x16x32_bf16 v[156:159], a[216:219], v[88:91], v[156:159]
    v_add_f32 v9, v9, v143
    v_cvt_pk_bf16_f32 v207, v142, v143
    v_mfma_f32_16x16x32_bf16 v[148:151], a[220:223], v[76:79], v[148:151]
    v_mfma_f32_16x16x32_bf16 v[156:159], a[220:223], v[92:95], v[156:159]
    s_waitcnt lgkmcnt(0)
    v_mfma_f32_16x16x32_bf16 a[0:3], a[224:227], v[200:203], a[0:3]
    v_mfma_f32_16x16x32_bf16 a[32:35], a[224:227], v[204:207], a[32:35]
    v_mfma_f32_16x16x32_bf16 a[4:7], a[228:231], v[200:203], a[4:7]
    v_max3_f32 v14, v144, v145, v146
    v_max3_f32 v15, v152, v153, v154
    v_mfma_f32_16x16x32_bf16 a[36:39], a[228:231], v[204:207], a[36:39]
    v_max3_f32 v14, v14, v147, v148
    v_max3_f32 v15, v15, v155, v156
    v_mfma_f32_16x16x32_bf16 a[8:11], a[232:235], v[200:203], a[8:11]
    v_max3_f32 v14, v14, v149, v150
    v_max3_f32 v15, v15, v157, v158
    v_mfma_f32_16x16x32_bf16 a[40:43], a[232:235], v[204:207], a[40:43]
    v_max_f32 v14, v14, v151
    v_max_f32 v15, v15, v159
    v_mfma_f32_16x16x32_bf16 a[12:15], a[236:239], v[200:203], a[12:15]
    v_max_f32 v16, v14, v15
    v_mfma_f32_16x16x32_bf16 a[44:47], a[236:239], v[204:207], a[44:47]
    v_cmp_lt_f32 vcc, 0x41000000, v16
    s_nop 0
    s_cbranch_vccnz L_st_se31_1
L_st_se31_1_ret:
    v_exp_f32 v144, v144
    v_exp_f32 v145, v145
    v_exp_f32 v146, v146
    v_add_f32 v10, v10, v144
    v_add_f32 v10, v10, v145
    v_mfma_f32_16x16x32_bf16 a[16:19], a[240:243], v[200:203], a[16:19]
    v_exp_f32 v147, v147
    v_exp_f32 v152, v152
    v_mfma_f32_16x16x32_bf16 a[48:51], a[240:243], v[204:207], a[48:51]
    v_add_f32 v10, v10, v146
    v_cvt_pk_bf16_f32 v208, v144, v145
    v_mfma_f32_16x16x32_bf16 a[20:23], a[244:247], v[200:203], a[20:23]
    v_add_f32 v10, v10, v147
    v_cvt_pk_bf16_f32 v209, v146, v147
    v_mfma_f32_16x16x32_bf16 a[52:55], a[244:247], v[204:207], a[52:55]
    v_exp_f32 v153, v153
    v_mfma_f32_16x16x32_bf16 a[24:27], a[248:251], v[200:203], a[24:27]
    v_exp_f32 v154, v154
    v_mfma_f32_16x16x32_bf16 a[56:59], a[248:251], v[204:207], a[56:59]
    v_add_f32 v11, v11, v152
    v_add_f32 v11, v11, v153
    v_mfma_f32_16x16x32_bf16 a[28:31], a[252:255], v[200:203], a[28:31]
    v_exp_f32 v155, v155
    v_mfma_f32_16x16x32_bf16 a[60:63], a[252:255], v[204:207], a[60:63]
    v_exp_f32 v148, v148
    s_barrier
    v_mfma_f32_16x16x32_bf16 v[160:163], a[192:195], v[96:99], v[192:195]
    v_add_f32 v11, v11, v154
    v_cvt_pk_bf16_f32 v212, v152, v153
    v_mfma_f32_16x16x32_bf16 v[168:171], a[192:195], v[112:115], v[196:199]
    v_add_f32 v11, v11, v155
    v_cvt_pk_bf16_f32 v213, v154, v155
    v_mfma_f32_16x16x32_bf16 v[160:163], a[196:199], v[100:103], v[160:163]
    v_exp_f32 v149, v149
    v_mfma_f32_16x16x32_bf16 v[168:171], a[196:199], v[116:119], v[168:171]
    v_exp_f32 v150, v150
    v_mfma_f32_16x16x32_bf16 v[160:163], a[200:203], v[104:107], v[160:163]
    v_add_f32 v10, v10, v148
    v_add_f32 v10, v10, v149
    v_mfma_f32_16x16x32_bf16 v[168:171], a[200:203], v[120:123], v[168:171]
    v_exp_f32 v151, v151
    v_mfma_f32_16x16x32_bf16 v[160:163], a[204:207], v[108:111], v[160:163]
    v_exp_f32 v156, v156
    v_mfma_f32_16x16x32_bf16 v[168:171], a[204:207], v[124:127], v[168:171]
    v_add_f32 v10, v10, v150
    v_cvt_pk_bf16_f32 v210, v148, v149
    v_mfma_f32_16x16x32_bf16 v[164:167], a[208:211], v[96:99], v[192:195]
    v_add_f32 v10, v10, v151
    v_cvt_pk_bf16_f32 v211, v150, v151
    v_mfma_f32_16x16x32_bf16 v[172:175], a[208:211], v[112:115], v[196:199]
    v_exp_f32 v157, v157
    v_mfma_f32_16x16x32_bf16 v[164:167], a[212:215], v[100:103], v[164:167]
    v_exp_f32 v158, v158
    v_mfma_f32_16x16x32_bf16 v[172:175], a[212:215], v[116:119], v[172:175]
    v_add_f32 v11, v11, v156
    v_add_f32 v11, v11, v157
    v_mfma_f32_16x16x32_bf16 v[164:167], a[216:219], v[104:107], v[164:167]
    v_exp_f32 v159, v159
    v_mfma_f32_16x16x32_bf16 v[172:175], a[216:219], v[120:123], v[172:175]
    s_nop 0
    v_add_f32 v11, v11, v158
    v_cvt_pk_bf16_f32 v214, v156, v157
    v_add_f32 v11, v11, v159
    v_cvt_pk_bf16_f32 v215, v158, v159
    v_mfma_f32_16x16x32_bf16 v[164:167], a[220:223], v[108:111], v[164:167]
    v_mfma_f32_16x16x32_bf16 v[172:175], a[220:223], v[124:127], v[172:175]
    v_mfma_f32_16x16x32_bf16 a[64:67], a[224:227], v[208:211], a[64:67]
    v_mfma_f32_16x16x32_bf16 a[96:99], a[224:227], v[212:215], a[96:99]
    v_mfma_f32_16x16x32_bf16 a[68:71], a[228:231], v[208:211], a[68:71]
    v_max3_f32 v14, v160, v161, v162
    v_max3_f32 v15, v168, v169, v170
    v_mfma_f32_16x16x32_bf16 a[100:103], a[228:231], v[212:215], a[100:103]
    v_max3_f32 v14, v14, v163, v164
    v_max3_f32 v15, v15, v171, v172
    v_mfma_f32_16x16x32_bf16 a[72:75], a[232:235], v[208:211], a[72:75]
    v_max3_f32 v14, v14, v165, v166
    v_max3_f32 v15, v15, v173, v174
    v_mfma_f32_16x16x32_bf16 a[104:107], a[232:235], v[212:215], a[104:107]
    v_max_f32 v14, v14, v167
    v_max_f32 v15, v15, v175
    v_mfma_f32_16x16x32_bf16 a[76:79], a[236:239], v[208:211], a[76:79]
    v_max_f32 v16, v14, v15
    v_mfma_f32_16x16x32_bf16 a[108:111], a[236:239], v[212:215], a[108:111]
    v_cmp_lt_f32 vcc, 0x41000000, v16
    s_nop 0
    s_cbranch_vccnz L_st_se31_2
L_st_se31_2_ret:
    v_exp_f32 v160, v160
    v_exp_f32 v161, v161
    v_exp_f32 v162, v162
    v_add_f32 v12, v12, v160
    v_add_f32 v12, v12, v161
    v_exp_f32 v163, v163
    v_exp_f32 v168, v168
    v_add_f32 v12, v12, v162
    v_cvt_pk_bf16_f32 v216, v160, v161
    v_add_f32 v12, v12, v163
    v_cvt_pk_bf16_f32 v217, v162, v163
    v_exp_f32 v169, v169
    v_mfma_f32_16x16x32_bf16 a[80:83], a[240:243], v[208:211], a[80:83]
    v_exp_f32 v170, v170
    v_mfma_f32_16x16x32_bf16 a[112:115], a[240:243], v[212:215], a[112:115]
    v_add_f32 v13, v13, v168
    v_add_f32 v13, v13, v169
    v_exp_f32 v171, v171
    v_mfma_f32_16x16x32_bf16 a[84:87], a[244:247], v[208:211], a[84:87]
    v_exp_f32 v164, v164
    v_mfma_f32_16x16x32_bf16 a[116:119], a[244:247], v[212:215], a[116:119]
    v_add_f32 v13, v13, v170
    v_cvt_pk_bf16_f32 v220, v168, v169
    v_add_f32 v13, v13, v171
    v_cvt_pk_bf16_f32 v221, v170, v171
    v_mfma_f32_16x16x32_bf16 a[88:91], a[248:251], v[208:211], a[88:91]
    v_exp_f32 v165, v165
    v_mfma_f32_16x16x32_bf16 a[120:123], a[248:251], v[212:215], a[120:123]
    v_exp_f32 v166, v166
    v_add_f32 v12, v12, v164
    v_add_f32 v12, v12, v165
    v_mfma_f32_16x16x32_bf16 a[92:95], a[252:255], v[208:211], a[92:95]
    v_exp_f32 v167, v167
    v_mfma_f32_16x16x32_bf16 a[124:127], a[252:255], v[212:215], a[124:127]
    v_exp_f32 v172, v172
    v_add_f32 v12, v12, v166
    v_cvt_pk_bf16_f32 v218, v164, v165
    v_add_f32 v12, v12, v167
    v_cvt_pk_bf16_f32 v219, v166, v167
    v_exp_f32 v173, v173
    v_exp_f32 v174, v174
    v_add_f32 v13, v13, v172
    v_add_f32 v13, v13, v173
    v_exp_f32 v175, v175
    s_nop 0
    v_add_f32 v13, v13, v174
    v_cvt_pk_bf16_f32 v222, v172, v173
    v_add_f32 v13, v13, v175
    v_cvt_pk_bf16_f32 v223, v174, v175
    s_nop 1
    v_mfma_f32_16x16x32_bf16 a[128:131], a[224:227], v[216:219], a[128:131]
    v_mfma_f32_16x16x32_bf16 a[160:163], a[224:227], v[220:223], a[160:163]
    v_mfma_f32_16x16x32_bf16 a[132:135], a[228:231], v[216:219], a[132:135]
    v_mfma_f32_16x16x32_bf16 a[164:167], a[228:231], v[220:223], a[164:167]
    v_mfma_f32_16x16x32_bf16 a[136:139], a[232:235], v[216:219], a[136:139]
    v_mfma_f32_16x16x32_bf16 a[168:171], a[232:235], v[220:223], a[168:171]
    v_mfma_f32_16x16x32_bf16 a[140:143], a[236:239], v[216:219], a[140:143]
    v_mfma_f32_16x16x32_bf16 a[172:175], a[236:239], v[220:223], a[172:175]
    v_mfma_f32_16x16x32_bf16 a[144:147], a[240:243], v[216:219], a[144:147]
    v_mfma_f32_16x16x32_bf16 a[176:179], a[240:243], v[220:223], a[176:179]
    v_mfma_f32_16x16x32_bf16 a[148:151], a[244:247], v[216:219], a[148:151]
    v_mfma_f32_16x16x32_bf16 a[180:183], a[244:247], v[220:223], a[180:183]
    v_mfma_f32_16x16x32_bf16 a[152:155], a[248:251], v[216:219], a[152:155]
    v_mfma_f32_16x16x32_bf16 a[184:187], a[248:251], v[220:223], a[184:187]
    v_mfma_f32_16x16x32_bf16 a[156:159], a[252:255], v[216:219], a[156:159]
    v_mfma_f32_16x16x32_bf16 a[188:191], a[252:255], v[220:223], a[188:191]
    v_mov_b32 v16, v8
    s_nop 1
    v_permlane16_swap_b32 v8, v16
    s_nop 1
    v_add_f32 v8, v8, v16
    v_mov_b32 v16, v8
    s_nop 1
    v_permlane32_swap_b32 v8, v16
    s_nop 1
    v_add_f32 v8, v8, v16
    v_mov_b32 v16, v9
    s_nop 1
    v_permlane16_swap_b32 v9, v16
    s_nop 1
    v_add_f32 v9, v9, v16
    v_mov_b32 v16, v9
    s_nop 1
    v_permlane32_swap_b32 v9, v16
    s_nop 1
    v_add_f32 v9, v9, v16
    v_mov_b32 v16, v10
    s_nop 1
    v_permlane16_swap_b32 v10, v16
    s_nop 1
    v_add_f32 v10, v10, v16
    v_mov_b32 v16, v10
    s_nop 1
    v_permlane32_swap_b32 v10, v16
    s_nop 1
    v_add_f32 v10, v10, v16
    v_mov_b32 v16, v11
    s_nop 1
    v_permlane16_swap_b32 v11, v16
    s_nop 1
    v_add_f32 v11, v11, v16
    v_mov_b32 v16, v11
    s_nop 1
    v_permlane32_swap_b32 v11, v16
    s_nop 1
    v_add_f32 v11, v11, v16
    v_mov_b32 v16, v12
    s_nop 1
    v_permlane16_swap_b32 v12, v16
    s_nop 1
    v_add_f32 v12, v12, v16
    v_mov_b32 v16, v12
    s_nop 1
    v_permlane32_swap_b32 v12, v16
    s_nop 1
    v_add_f32 v12, v12, v16
    v_mov_b32 v16, v13
    s_nop 1
    v_permlane16_swap_b32 v13, v16
    s_nop 1
    v_add_f32 v13, v13, v16
    v_mov_b32 v16, v13
    s_nop 1
    v_permlane32_swap_b32 v13, v16
    s_nop 1
    v_add_f32 v13, v13, v16
    s_branch L_join
L_st_sp0_0:
    s_call_b64 s[42:43], L_rare_0
    s_branch L_st_sp0_0_ret
L_st_sl0_1:
    s_call_b64 s[42:43], L_rare_1
    s_branch L_st_sl0_1_ret
L_st_sl0_2:
    s_call_b64 s[42:43], L_rare_2
    s_branch L_st_sl0_2_ret
L_st_sl0_0:
    s_call_b64 s[42:43], L_rare_0
    s_branch L_st_sl0_0_ret
L_st_sl1_1:
    s_call_b64 s[42:43], L_rare_1
    s_branch L_st_sl1_1_ret
L_st_sl1_2:
    s_call_b64 s[42:43], L_rare_2
    s_branch L_st_sl1_2_ret
L_st_sl1_0:
    s_call_b64 s[42:43], L_rare_0
    s_branch L_st_sl1_0_ret
L_st_sl2_1:
    s_call_b64 s[42:43], L_rare_1
    s_branch L_st_sl2_1_ret
L_st_sl2_2:
    s_call_b64 s[42:43], L_rare_2
    s_branch L_st_sl2_2_ret
L_st_sl2_0:
    s_call_b64 s[42:43], L_rare_0
    s_branch L_st_sl2_0_ret
L_st_sl3_1:
    s_call_b64 s[42:43], L_rare_1
    s_branch L_st_sl3_1_ret
L_st_sl3_2:
    s_call_b64 s[42:43], L_rare_2
    s_branch L_st_sl3_2_ret
L_st_sl3_0:
    s_call_b64 s[42:43], L_rare_0
    s_branch L_st_sl3_0_ret
L_st_se29_1:
    s_call_b64 s[42:43], L_rare_1
    s_branch L_st_se29_1_ret
L_st_se29_2:
    s_call_b64 s[42:43], L_rare_2
    s_branch L_st_se29_2_ret
L_st_se29_0:
    s_call_b64 s[42:43], L_rare_0
    s_branch L_st_se29_0_ret
L_st_se30_1:
    s_call_b64 s[42:43], L_rare_1
    s_branch L_st_se30_1_ret
L_st_se30_2:
    s_call_b64 s[42:43], L_rare_2
    s_branch L_st_se30_2_ret
L_st_se30_0:
    s_call_b64 s[42:43], L_rare_0
    s_branch L_st_se30_0_ret
L_st_se31_1:
    s_call_b64 s[42:43], L_rare_1
    s_branch L_st_se31_1_ret
L_st_se31_2:
    s_call_b64 s[42:43], L_rare_2
    s_branch L_st_se31_2_ret
L_rare_0:
    v_mov_b32 v16, v14
    s_nop 1
    v_permlane16_swap_b32 v14, v16
    s_nop 1
    v_max_f32 v14, v14, v16
    v_mov_b32 v16, v14
    s_nop 1
    v_permlane32_swap_b32 v14, v16
    s_nop 1
    v_max_f32 v14, v14, v16
    v_max_f32 v14, 0, v14
    v_sub_f32 v16, 0, v14
    v_exp_f32 v16, v16
    v_sub_f32 v128, v128, v14
    v_sub_f32 v129, v129, v14
    v_sub_f32 v130, v130, v14
    v_sub_f32 v131, v131, v14
    v_sub_f32 v132, v132, v14
    v_sub_f32 v133, v133, v14
    v_sub_f32 v134, v134, v14
    v_sub_f32 v135, v135, v14
    v_sub_f32 v176, v176, v14
    v_sub_f32 v177, v177, v14
    v_sub_f32 v178, v178, v14
    v_sub_f32 v179, v179, v14
    v_mul_f32 v8, v8, v16
    v_accvgpr_read_b32 v17, a0
    v_accvgpr_read_b32 v18, a1
    v_accvgpr_read_b32 v19, a2
    v_accvgpr_read_b32 v20, a3
    v_mul_f32 v17, v17, v16
    v_mul_f32 v18, v18, v16
    v_mul_f32 v19, v19, v16
    v_mul_f32 v20, v20, v16
    v_accvgpr_write_b32 a0, v17
    v_accvgpr_write_b32 a1, v18
    v_accvgpr_write_b32 a2, v19
    v_accvgpr_write_b32 a3, v20
    v_accvgpr_read_b32 v17, a4
    v_accvgpr_read_b32 v18, a5
    v_accvgpr_read_b32 v19, a6
    v_accvgpr_read_b32 v20, a7
    v_mul_f32 v17, v17, v16
    v_mul_f32 v18, v18, v16
    v_mul_f32 v19, v19, v16
    v_mul_f32 v20, v20, v16
    v_accvgpr_write_b32 a4, v17
    v_accvgpr_write_b32 a5, v18
    v_accvgpr_write_b32 a6, v19
    v_accvgpr_write_b32 a7, v20
    v_accvgpr_read_b32 v17, a8
    v_accvgpr_read_b32 v18, a9
    v_accvgpr_read_b32 v19, a10
    v_accvgpr_read_b32 v20, a11
    v_mul_f32 v17, v17, v16
    v_mul_f32 v18, v18, v16
    v_mul_f32 v19, v19, v16
    v_mul_f32 v20, v20, v16
    v_accvgpr_write_b32 a8, v17
    v_accvgpr_write_b32 a9, v18
    v_accvgpr_write_b32 a10, v19
    v_accvgpr_write_b32 a11, v20
    v_accvgpr_read_b32 v17, a12
    v_accvgpr_read_b32 v18, a13
    v_accvgpr_read_b32 v19, a14
    v_accvgpr_read_b32 v20, a15
    v_mul_f32 v17, v17, v16
    v_mul_f32 v18, v18, v16
    v_mul_f32 v19, v19, v16
    v_mul_f32 v20, v20, v16
    v_accvgpr_write_b32 a12, v17
    v_accvgpr_write_b32 a13, v18
    v_accvgpr_write_b32 a14, v19
    v_accvgpr_write_b32 a15, v20
    v_accvgpr_read_b32 v17, a16
    v_accvgpr_read_b32 v18, a17
    v_accvgpr_read_b32 v19, a18
    v_accvgpr_read_b32 v20, a19
    v_mul_f32 v17, v17, v16
    v_mul_f32 v18, v18, v16
    v_mul_f32 v19, v19, v16
    v_mul_f32 v20, v20, v16
    v_accvgpr_write_b32 a16, v17
    v_accvgpr_write_b32 a17, v18
    v_accvgpr_write_b32 a18, v19
    v_accvgpr_write_b32 a19, v20
    v_accvgpr_read_b32 v17, a20
    v_accvgpr_read_b32 v18, a21
    v_accvgpr_read_b32 v19, a22
    v_accvgpr_read_b32 v20, a23
    v_mul_f32 v17, v17, v16
    v_mul_f32 v18, v18, v16
    v_mul_f32 v19, v19, v16
    v_mul_f32 v20, v20, v16
    v_accvgpr_write_b32 a20, v17
    v_accvgpr_write_b32 a21, v18
    v_accvgpr_write_b32 a22, v19
    v_accvgpr_write_b32 a23, v20
    v_accvgpr_read_b32 v17, a24
    v_accvgpr_read_b32 v18, a25
    v_accvgpr_read_b32 v19, a26
    v_accvgpr_read_b32 v20, a27
    v_mul_f32 v17, v17, v16
    v_mul_f32 v18, v18, v16
    v_mul_f32 v19, v19, v16
    v_mul_f32 v20, v20, v16
    v_accvgpr_write_b32 a24, v17
    v_accvgpr_write_b32 a25, v18
    v_accvgpr_write_b32 a26, v19
    v_accvgpr_write_b32 a27, v20
    v_accvgpr_read_b32 v17, a28
    v_accvgpr_read_b32 v18, a29
    v_accvgpr_read_b32 v19, a30
    v_accvgpr_read_b32 v20, a31
    v_mul_f32 v17, v17, v16
    v_mul_f32 v18, v18, v16
    v_mul_f32 v19, v19, v16
    v_mul_f32 v20, v20, v16
    v_accvgpr_write_b32 a28, v17
    v_accvgpr_write_b32 a29, v18
    v_accvgpr_write_b32 a30, v19
    v_accvgpr_write_b32 a31, v20
    v_mov_b32 v16, v15
    s_nop 1
    v_permlane16_swap_b32 v15, v16
    s_nop 1
    v_max_f32 v15, v15, v16
    v_mov_b32 v16, v15
    s_nop 1
    v_permlane32_swap_b32 v15, v16
    s_nop 1
    v_max_f32 v15, v15, v16
    v_max_f32 v15, 0, v15
    v_sub_f32 v16, 0, v15
    v_exp_f32 v16, v16
    v_sub_f32 v136, v136, v15
    v_sub_f32 v137, v137, v15
    v_sub_f32 v138, v138, v15
    v_sub_f32 v139, v139, v15
    v_sub_f32 v140, v140, v15
    v_sub_f32 v141, v141, v15
    v_sub_f32 v142, v142, v15
    v_sub_f32 v143, v143, v15
    v_sub_f32 v180, v180, v15
    v_sub_f32 v181, v181, v15
    v_sub_f32 v182, v182, v15
    v_sub_f32 v183, v183, v15
    v_mul_f32 v9, v9, v16
    v_accvgpr_read_b32 v17, a32
    v_accvgpr_read_b32 v18, a33
    v_accvgpr_read_b32 v19, a34
    v_accvgpr_read_b32 v20, a35
    v_mul_f32 v17, v17, v16
    v_mul_f32 v18, v18, v16
    v_mul_f32 v19, v19, v16
    v_mul_f32 v20, v20, v16
    v_accvgpr_write_b32 a32, v17
    v_accvgpr_write_b32 a33, v18
    v_accvgpr_write_b32 a34, v19
    v_accvgpr_write_b32 a35, v20
    v_accvgpr_read_b32 v17, a36
    v_accvgpr_read_b32 v18, a37
    v_accvgpr_read_b32 v19, a38
    v_accvgpr_read_b32 v20, a39
    v_mul_f32 v17, v17, v16
    v_mul_f32 v18, v18, v16
    v_mul_f32 v19, v19, v16
    v_mul_f32 v20, v20, v16
    v_accvgpr_write_b32 a36, v17
    v_accvgpr_write_b32 a37, v18
    v_accvgpr_write_b32 a38, v19
    v_accvgpr_write_b32 a39, v20
    v_accvgpr_read_b32 v17, a40
    v_accvgpr_read_b32 v18, a41
    v_accvgpr_read_b32 v19, a42
    v_accvgpr_read_b32 v20, a43
    v_mul_f32 v17, v17, v16
    v_mul_f32 v18, v18, v16
    v_mul_f32 v19, v19, v16
    v_mul_f32 v20, v20, v16
    v_accvgpr_write_b32 a40, v17
    v_accvgpr_write_b32 a41, v18
    v_accvgpr_write_b32 a42, v19
    v_accvgpr_write_b32 a43, v20
    v_accvgpr_read_b32 v17, a44
    v_accvgpr_read_b32 v18, a45
    v_accvgpr_read_b32 v19, a46
    v_accvgpr_read_b32 v20, a47
    v_mul_f32 v17, v17, v16
    v_mul_f32 v18, v18, v16
    v_mul_f32 v19, v19, v16
    v_mul_f32 v20, v20, v16
    v_accvgpr_write_b32 a44, v17
    v_accvgpr_write_b32 a45, v18
    v_accvgpr_write_b32 a46, v19
    v_accvgpr_write_b32 a47, v20
    v_accvgpr_read_b32 v17, a48
    v_accvgpr_read_b32 v18, a49
    v_accvgpr_read_b32 v19, a50
    v_accvgpr_read_b32 v20, a51
    v_mul_f32 v17, v17, v16
    v_mul_f32 v18, v18, v16
    v_mul_f32 v19, v19, v16
    v_mul_f32 v20, v20, v16
    v_accvgpr_write_b32 a48, v17
    v_accvgpr_write_b32 a49, v18
    v_accvgpr_write_b32 a50, v19
    v_accvgpr_write_b32 a51, v20
    v_accvgpr_read_b32 v17, a52
    v_accvgpr_read_b32 v18, a53
    v_accvgpr_read_b32 v19, a54
    v_accvgpr_read_b32 v20, a55
    v_mul_f32 v17, v17, v16
    v_mul_f32 v18, v18, v16
    v_mul_f32 v19, v19, v16
    v_mul_f32 v20, v20, v16
    v_accvgpr_write_b32 a52, v17
    v_accvgpr_write_b32 a53, v18
    v_accvgpr_write_b32 a54, v19
    v_accvgpr_write_b32 a55, v20
    v_accvgpr_read_b32 v17, a56
    v_accvgpr_read_b32 v18, a57
    v_accvgpr_read_b32 v19, a58
    v_accvgpr_read_b32 v20, a59
    v_mul_f32 v17, v17, v16
    v_mul_f32 v18, v18, v16
    v_mul_f32 v19, v19, v16
    v_mul_f32 v20, v20, v16
    v_accvgpr_write_b32 a56, v17
    v_accvgpr_write_b32 a57, v18
    v_accvgpr_write_b32 a58, v19
    v_accvgpr_write_b32 a59, v20
    v_accvgpr_read_b32 v17, a60
    v_accvgpr_read_b32 v18, a61
    v_accvgpr_read_b32 v19, a62
    v_accvgpr_read_b32 v20, a63
    v_mul_f32 v17, v17, v16
    v_mul_f32 v18, v18, v16
    v_mul_f32 v19, v19, v16
    v_mul_f32 v20, v20, v16
    v_accvgpr_write_b32 a60, v17
    v_accvgpr_write_b32 a61, v18
    v_accvgpr_write_b32 a62, v19
    v_accvgpr_write_b32 a63, v20
    s_nop 1
    s_setpc_b64 s[42:43]
L_rare_1:
    v_mov_b32 v16, v14
    s_nop 1
    v_permlane16_swap_b32 v14, v16
    s_nop 1
    v_max_f32 v14, v14, v16
    v_mov_b32 v16, v14
    s_nop 1
    v_permlane32_swap_b32 v14, v16
    s_nop 1
    v_max_f32 v14, v14, v16
    v_max_f32 v14, 0, v14
    v_sub_f32 v16, 0, v14
    v_exp_f32 v16, v16
    v_sub_f32 v144, v144, v14
    v_sub_f32 v145, v145, v14
    v_sub_f32 v146, v146, v14
    v_sub_f32 v147, v147, v14
    v_sub_f32 v148, v148, v14
    v_sub_f32 v149, v149, v14
    v_sub_f32 v150, v150, v14
    v_sub_f32 v151, v151, v14
    v_sub_f32 v184, v184, v14
    v_sub_f32 v185, v185, v14
    v_sub_f32 v186, v186, v14
    v_sub_f32 v187, v187, v14
    v_mul_f32 v10, v10, v16
    v_accvgpr_read_b32 v17, a64
    v_accvgpr_read_b32 v18, a65
    v_accvgpr_read_b32 v19, a66
    v_accvgpr_read_b32 v20, a67
    v_mul_f32 v17, v17, v16
    v_mul_f32 v18, v18, v16
    v_mul_f32 v19, v19, v16
    v_mul_f32 v20, v20, v16
    v_accvgpr_write_b32 a64, v17
    v_accvgpr_write_b32 a65, v18
    v_accvgpr_write_b32 a66, v19
    v_accvgpr_write_b32 a67, v20
    v_accvgpr_read_b32 v17, a68
    v_accvgpr_read_b32 v18, a69
    v_accvgpr_read_b32 v19, a70
    v_accvgpr_read_b32 v20, a71
    v_mul_f32 v17, v17, v16
    v_mul_f32 v18, v18, v16
    v_mul_f32 v19, v19, v16
    v_mul_f32 v20, v20, v16
    v_accvgpr_write_b32 a68, v17
    v_accvgpr_write_b32 a69, v18
    v_accvgpr_write_b32 a70, v19
    v_accvgpr_write_b32 a71, v20
    v_accvgpr_read_b32 v17, a72
    v_accvgpr_read_b32 v18, a73
    v_accvgpr_read_b32 v19, a74
    v_accvgpr_read_b32 v20, a75
    v_mul_f32 v17, v17, v16
    v_mul_f32 v18, v18, v16
    v_mul_f32 v19, v19, v16
    v_mul_f32 v20, v20, v16
    v_accvgpr_write_b32 a72, v17
    v_accvgpr_write_b32 a73, v18
    v_accvgpr_write_b32 a74, v19
    v_accvgpr_write_b32 a75, v20
    v_accvgpr_read_b32 v17, a76
    v_accvgpr_read_b32 v18, a77
    v_accvgpr_read_b32 v19, a78
    v_accvgpr_read_b32 v20, a79
    v_mul_f32 v17, v17, v16
    v_mul_f32 v18, v18, v16
    v_mul_f32 v19, v19, v16
    v_mul_f32 v20, v20, v16
    v_accvgpr_write_b32 a76, v17
    v_accvgpr_write_b32 a77, v18
    v_accvgpr_write_b32 a78, v19
    v_accvgpr_write_b32 a79, v20
    v_accvgpr_read_b32 v17, a80
    v_accvgpr_read_b32 v18, a81
    v_accvgpr_read_b32 v19, a82
    v_accvgpr_read_b32 v20, a83
    v_mul_f32 v17, v17, v16
    v_mul_f32 v18, v18, v16
    v_mul_f32 v19, v19, v16
    v_mul_f32 v20, v20, v16
    v_accvgpr_write_b32 a80, v17
    v_accvgpr_write_b32 a81, v18
    v_accvgpr_write_b32 a82, v19
    v_accvgpr_write_b32 a83, v20
    v_accvgpr_read_b32 v17, a84
    v_accvgpr_read_b32 v18, a85
    v_accvgpr_read_b32 v19, a86
    v_accvgpr_read_b32 v20, a87
    v_mul_f32 v17, v17, v16
    v_mul_f32 v18, v18, v16
    v_mul_f32 v19, v19, v16
    v_mul_f32 v20, v20, v16
    v_accvgpr_write_b32 a84, v17
    v_accvgpr_write_b32 a85, v18
    v_accvgpr_write_b32 a86, v19
    v_accvgpr_write_b32 a87, v20
    v_accvgpr_read_b32 v17, a88
    v_accvgpr_read_b32 v18, a89
    v_accvgpr_read_b32 v19, a90
    v_accvgpr_read_b32 v20, a91
    v_mul_f32 v17, v17, v16
    v_mul_f32 v18, v18, v16
    v_mul_f32 v19, v19, v16
    v_mul_f32 v20, v20, v16
    v_accvgpr_write_b32 a88, v17
    v_accvgpr_write_b32 a89, v18
    v_accvgpr_write_b32 a90, v19
    v_accvgpr_write_b32 a91, v20
    v_accvgpr_read_b32 v17, a92
    v_accvgpr_read_b32 v18, a93
    v_accvgpr_read_b32 v19, a94
    v_accvgpr_read_b32 v20, a95
    v_mul_f32 v17, v17, v16
    v_mul_f32 v18, v18, v16
    v_mul_f32 v19, v19, v16
    v_mul_f32 v20, v20, v16
    v_accvgpr_write_b32 a92, v17
    v_accvgpr_write_b32 a93, v18
    v_accvgpr_write_b32 a94, v19
    v_accvgpr_write_b32 a95, v20
    v_mov_b32 v16, v15
    s_nop 1
    v_permlane16_swap_b32 v15, v16
    s_nop 1
    v_max_f32 v15, v15, v16
    v_mov_b32 v16, v15
    s_nop 1
    v_permlane32_swap_b32 v15, v16
    s_nop 1
    v_max_f32 v15, v15, v16
    v_max_f32 v15, 0, v15
    v_sub_f32 v16, 0, v15
    v_exp_f32 v16, v16
    v_sub_f32 v152, v152, v15
    v_sub_f32 v153, v153, v15
    v_sub_f32 v154, v154, v15
    v_sub_f32 v155, v155, v15
    v_sub_f32 v156, v156, v15
    v_sub_f32 v157, v157, v15
    v_sub_f32 v158, v158, v15
    v_sub_f32 v159, v159, v15
    v_sub_f32 v188, v188, v15
    v_sub_f32 v189, v189, v15
    v_sub_f32 v190, v190, v15
    v_sub_f32 v191, v191, v15
    v_mul_f32 v11, v11, v16
    v_accvgpr_read_b32 v17, a96
    v_accvgpr_read_b32 v18, a97
    v_accvgpr_read_b32 v19, a98
    v_accvgpr_read_b32 v20, a99
    v_mul_f32 v17, v17, v16
    v_mul_f32 v18, v18, v16
    v_mul_f32 v19, v19, v16
    v_mul_f32 v20, v20, v16
    v_accvgpr_write_b32 a96, v17
    v_accvgpr_write_b32 a97, v18
    v_accvgpr_write_b32 a98, v19
    v_accvgpr_write_b32 a99, v20
    v_accvgpr_read_b32 v17, a100
    v_accvgpr_read_b32 v18, a101
    v_accvgpr_read_b32 v19, a102
    v_accvgpr_read_b32 v20, a103
    v_mul_f32 v17, v17, v16
    v_mul_f32 v18, v18, v16
    v_mul_f32 v19, v19, v16
    v_mul_f32 v20, v20, v16
    v_accvgpr_write_b32 a100, v17
    v_accvgpr_write_b32 a101, v18
    v_accvgpr_write_b32 a102, v19
    v_accvgpr_write_b32 a103, v20
    v_accvgpr_read_b32 v17, a104
    v_accvgpr_read_b32 v18, a105
    v_accvgpr_read_b32 v19, a106
    v_accvgpr_read_b32 v20, a107
    v_mul_f32 v17, v17, v16
    v_mul_f32 v18, v18, v16
    v_mul_f32 v19, v19, v16
    v_mul_f32 v20, v20, v16
    v_accvgpr_write_b32 a104, v17
    v_accvgpr_write_b32 a105, v18
    v_accvgpr_write_b32 a106, v19
    v_accvgpr_write_b32 a107, v20
    v_accvgpr_read_b32 v17, a108
    v_accvgpr_read_b32 v18, a109
    v_accvgpr_read_b32 v19, a110
    v_accvgpr_read_b32 v20, a111
    v_mul_f32 v17, v17, v16
    v_mul_f32 v18, v18, v16
    v_mul_f32 v19, v19, v16
    v_mul_f32 v20, v20, v16
    v_accvgpr_write_b32 a108, v17
    v_accvgpr_write_b32 a109, v18
    v_accvgpr_write_b32 a110, v19
    v_accvgpr_write_b32 a111, v20
    v_accvgpr_read_b32 v17, a112
    v_accvgpr_read_b32 v18, a113
    v_accvgpr_read_b32 v19, a114
    v_accvgpr_read_b32 v20, a115
    v_mul_f32 v17, v17, v16
    v_mul_f32 v18, v18, v16
    v_mul_f32 v19, v19, v16
    v_mul_f32 v20, v20, v16
    v_accvgpr_write_b32 a112, v17
    v_accvgpr_write_b32 a113, v18
    v_accvgpr_write_b32 a114, v19
    v_accvgpr_write_b32 a115, v20
    v_accvgpr_read_b32 v17, a116
    v_accvgpr_read_b32 v18, a117
    v_accvgpr_read_b32 v19, a118
    v_accvgpr_read_b32 v20, a119
    v_mul_f32 v17, v17, v16
    v_mul_f32 v18, v18, v16
    v_mul_f32 v19, v19, v16
    v_mul_f32 v20, v20, v16
    v_accvgpr_write_b32 a116, v17
    v_accvgpr_write_b32 a117, v18
    v_accvgpr_write_b32 a118, v19
    v_accvgpr_write_b32 a119, v20
    v_accvgpr_read_b32 v17, a120
    v_accvgpr_read_b32 v18, a121
    v_accvgpr_read_b32 v19, a122
    v_accvgpr_read_b32 v20, a123
    v_mul_f32 v17, v17, v16
    v_mul_f32 v18, v18, v16
    v_mul_f32 v19, v19, v16
    v_mul_f32 v20, v20, v16
    v_accvgpr_write_b32 a120, v17
    v_accvgpr_write_b32 a121, v18
    v_accvgpr_write_b32 a122, v19
    v_accvgpr_write_b32 a123, v20
    v_accvgpr_read_b32 v17, a124
    v_accvgpr_read_b32 v18, a125
    v_accvgpr_read_b32 v19, a126
    v_accvgpr_read_b32 v20, a127
    v_mul_f32 v17, v17, v16
    v_mul_f32 v18, v18, v16
    v_mul_f32 v19, v19, v16
    v_mul_f32 v20, v20, v16
    v_accvgpr_write_b32 a124, v17
    v_accvgpr_write_b32 a125, v18
    v_accvgpr_write_b32 a126, v19
    v_accvgpr_write_b32 a127, v20
    s_nop 1
    s_setpc_b64 s[42:43]
L_rare_2:
    v_mov_b32 v16, v14
    s_nop 1
    v_permlane16_swap_b32 v14, v16
    s_nop 1
    v_max_f32 v14, v14, v16
    v_mov_b32 v16, v14
    s_nop 1
    v_permlane32_swap_b32 v14, v16
    s_nop 1
    v_max_f32 v14, v14, v16
    v_max_f32 v14, 0, v14
    v_sub_f32 v16, 0, v14
    v_exp_f32 v16, v16
    v_sub_f32 v160, v160, v14
    v_sub_f32 v161, v161, v14
    v_sub_f32 v162, v162, v14
    v_sub_f32 v163, v163, v14
    v_sub_f32 v164, v164, v14
    v_sub_f32 v165, v165, v14
    v_sub_f32 v166, v166, v14
    v_sub_f32 v167, v167, v14
    v_sub_f32 v192, v192, v14
    v_sub_f32 v193, v193, v14
    v_sub_f32 v194, v194, v14
    v_sub_f32 v195, v195, v14
    v_mul_f32 v12, v12, v16
    v_accvgpr_read_b32 v17, a128
    v_accvgpr_read_b32 v18, a129
    v_accvgpr_read_b32 v19, a130
    v_accvgpr_read_b32 v20, a131
    v_mul_f32 v17, v17, v16
    v_mul_f32 v18, v18, v16
    v_mul_f32 v19, v19, v16
    v_mul_f32 v20, v20, v16
    v_accvgpr_write_b32 a128, v17
    v_accvgpr_write_b32 a129, v18
    v_accvgpr_write_b32 a130, v19
    v_accvgpr_write_b32 a131, v20
    v_accvgpr_read_b32 v17, a132
    v_accvgpr_read_b32 v18, a133
    v_accvgpr_read_b32 v19, a134
    v_accvgpr_read_b32 v20, a135
    v_mul_f32 v17, v17, v16
    v_mul_f32 v18, v18, v16
    v_mul_f32 v19, v19, v16
    v_mul_f32 v20, v20, v16
    v_accvgpr_write_b32 a132, v17
    v_accvgpr_write_b32 a133, v18
    v_accvgpr_write_b32 a134, v19
    v_accvgpr_write_b32 a135, v20
    v_accvgpr_read_b32 v17, a136
    v_accvgpr_read_b32 v18, a137
    v_accvgpr_read_b32 v19, a138
    v_accvgpr_read_b32 v20, a139
    v_mul_f32 v17, v17, v16
    v_mul_f32 v18, v18, v16
    v_mul_f32 v19, v19, v16
    v_mul_f32 v20, v20, v16
    v_accvgpr_write_b32 a136, v17
    v_accvgpr_write_b32 a137, v18
    v_accvgpr_write_b32 a138, v19
    v_accvgpr_write_b32 a139, v20
    v_accvgpr_read_b32 v17, a140
    v_accvgpr_read_b32 v18, a141
    v_accvgpr_read_b32 v19, a142
    v_accvgpr_read_b32 v20, a143
    v_mul_f32 v17, v17, v16
    v_mul_f32 v18, v18, v16
    v_mul_f32 v19, v19, v16
    v_mul_f32 v20, v20, v16
    v_accvgpr_write_b32 a140, v17
    v_accvgpr_write_b32 a141, v18
    v_accvgpr_write_b32 a142, v19
    v_accvgpr_write_b32 a143, v20
    v_accvgpr_read_b32 v17, a144
    v_accvgpr_read_b32 v18, a145
    v_accvgpr_read_b32 v19, a146
    v_accvgpr_read_b32 v20, a147
    v_mul_f32 v17, v17, v16
    v_mul_f32 v18, v18, v16
    v_mul_f32 v19, v19, v16
    v_mul_f32 v20, v20, v16
    v_accvgpr_write_b32 a144, v17
    v_accvgpr_write_b32 a145, v18
    v_accvgpr_write_b32 a146, v19
    v_accvgpr_write_b32 a147, v20
    v_accvgpr_read_b32 v17, a148
    v_accvgpr_read_b32 v18, a149
    v_accvgpr_read_b32 v19, a150
    v_accvgpr_read_b32 v20, a151
    v_mul_f32 v17, v17, v16
    v_mul_f32 v18, v18, v16
    v_mul_f32 v19, v19, v16
    v_mul_f32 v20, v20, v16
    v_accvgpr_write_b32 a148, v17
    v_accvgpr_write_b32 a149, v18
    v_accvgpr_write_b32 a150, v19
    v_accvgpr_write_b32 a151, v20
    v_accvgpr_read_b32 v17, a152
    v_accvgpr_read_b32 v18, a153
    v_accvgpr_read_b32 v19, a154
    v_accvgpr_read_b32 v20, a155
    v_mul_f32 v17, v17, v16
    v_mul_f32 v18, v18, v16
    v_mul_f32 v19, v19, v16
    v_mul_f32 v20, v20, v16
    v_accvgpr_write_b32 a152, v17
    v_accvgpr_write_b32 a153, v18
    v_accvgpr_write_b32 a154, v19
    v_accvgpr_write_b32 a155, v20
    v_accvgpr_read_b32 v17, a156
    v_accvgpr_read_b32 v18, a157
    v_accvgpr_read_b32 v19, a158
    v_accvgpr_read_b32 v20, a159
    v_mul_f32 v17, v17, v16
    v_mul_f32 v18, v18, v16
    v_mul_f32 v19, v19, v16
    v_mul_f32 v20, v20, v16
    v_accvgpr_write_b32 a156, v17
    v_accvgpr_write_b32 a157, v18
    v_accvgpr_write_b32 a158, v19
    v_accvgpr_write_b32 a159, v20
    v_mov_b32 v16, v15
    s_nop 1
    v_permlane16_swap_b32 v15, v16
    s_nop 1
    v_max_f32 v15, v15, v16
    v_mov_b32 v16, v15
    s_nop 1
    v_permlane32_swap_b32 v15, v16
    s_nop 1
    v_max_f32 v15, v15, v16
    v_max_f32 v15, 0, v15
    v_sub_f32 v16, 0, v15
    v_exp_f32 v16, v16
    v_sub_f32 v168, v168, v15
    v_sub_f32 v169, v169, v15
    v_sub_f32 v170, v170, v15
    v_sub_f32 v171, v171, v15
    v_sub_f32 v172, v172, v15
    v_sub_f32 v173, v173, v15
    v_sub_f32 v174, v174, v15
    v_sub_f32 v175, v175, v15
    v_sub_f32 v196, v196, v15
    v_sub_f32 v197, v197, v15
    v_sub_f32 v198, v198, v15
    v_sub_f32 v199, v199, v15
    v_mul_f32 v13, v13, v16
    v_accvgpr_read_b32 v17, a160
    v_accvgpr_read_b32 v18, a161
    v_accvgpr_read_b32 v19, a162
    v_accvgpr_read_b32 v20, a163
    v_mul_f32 v17, v17, v16
    v_mul_f32 v18, v18, v16
    v_mul_f32 v19, v19, v16
    v_mul_f32 v20, v20, v16
    v_accvgpr_write_b32 a160, v17
    v_accvgpr_write_b32 a161, v18
    v_accvgpr_write_b32 a162, v19
    v_accvgpr_write_b32 a163, v20
    v_accvgpr_read_b32 v17, a164
    v_accvgpr_read_b32 v18, a165
    v_accvgpr_read_b32 v19, a166
    v_accvgpr_read_b32 v20, a167
    v_mul_f32 v17, v17, v16
    v_mul_f32 v18, v18, v16
    v_mul_f32 v19, v19, v16
    v_mul_f32 v20, v20, v16
    v_accvgpr_write_b32 a164, v17
    v_accvgpr_write_b32 a165, v18
    v_accvgpr_write_b32 a166, v19
    v_accvgpr_write_b32 a167, v20
    v_accvgpr_read_b32 v17, a168
    v_accvgpr_read_b32 v18, a169
    v_accvgpr_read_b32 v19, a170
    v_accvgpr_read_b32 v20, a171
    v_mul_f32 v17, v17, v16
    v_mul_f32 v18, v18, v16
    v_mul_f32 v19, v19, v16
    v_mul_f32 v20, v20, v16
    v_accvgpr_write_b32 a168, v17
    v_accvgpr_write_b32 a169, v18
    v_accvgpr_write_b32 a170, v19
    v_accvgpr_write_b32 a171, v20
    v_accvgpr_read_b32 v17, a172
    v_accvgpr_read_b32 v18, a173
    v_accvgpr_read_b32 v19, a174
    v_accvgpr_read_b32 v20, a175
    v_mul_f32 v17, v17, v16
    v_mul_f32 v18, v18, v16
    v_mul_f32 v19, v19, v16
    v_mul_f32 v20, v20, v16
    v_accvgpr_write_b32 a172, v17
    v_accvgpr_write_b32 a173, v18
    v_accvgpr_write_b32 a174, v19
    v_accvgpr_write_b32 a175, v20
    v_accvgpr_read_b32 v17, a176
    v_accvgpr_read_b32 v18, a177
    v_accvgpr_read_b32 v19, a178
    v_accvgpr_read_b32 v20, a179
    v_mul_f32 v17, v17, v16
    v_mul_f32 v18, v18, v16
    v_mul_f32 v19, v19, v16
    v_mul_f32 v20, v20, v16
    v_accvgpr_write_b32 a176, v17
    v_accvgpr_write_b32 a177, v18
    v_accvgpr_write_b32 a178, v19
    v_accvgpr_write_b32 a179, v20
    v_accvgpr_read_b32 v17, a180
    v_accvgpr_read_b32 v18, a181
    v_accvgpr_read_b32 v19, a182
    v_accvgpr_read_b32 v20, a183
    v_mul_f32 v17, v17, v16
    v_mul_f32 v18, v18, v16
    v_mul_f32 v19, v19, v16
    v_mul_f32 v20, v20, v16
    v_accvgpr_write_b32 a180, v17
    v_accvgpr_write_b32 a181, v18
    v_accvgpr_write_b32 a182, v19
    v_accvgpr_write_b32 a183, v20
    v_accvgpr_read_b32 v17, a184
    v_accvgpr_read_b32 v18, a185
    v_accvgpr_read_b32 v19, a186
    v_accvgpr_read_b32 v20, a187
    v_mul_f32 v17, v17, v16
    v_mul_f32 v18, v18, v16
    v_mul_f32 v19, v19, v16
    v_mul_f32 v20, v20, v16
    v_accvgpr_write_b32 a184, v17
    v_accvgpr_write_b32 a185, v18
    v_accvgpr_write_b32 a186, v19
    v_accvgpr_write_b32 a187, v20
    v_accvgpr_read_b32 v17, a188
    v_accvgpr_read_b32 v18, a189
    v_accvgpr_read_b32 v19, a190
    v_accvgpr_read_b32 v20, a191
    v_mul_f32 v17, v17, v16
    v_mul_f32 v18, v18, v16
    v_mul_f32 v19, v19, v16
    v_mul_f32 v20, v20, v16
    v_accvgpr_write_b32 a188, v17
    v_accvgpr_write_b32 a189, v18
    v_accvgpr_write_b32 a190, v19
    v_accvgpr_write_b32 a191, v20
    s_nop 1
    s_setpc_b64 s[42:43]
    .globl reduce_kernel
    .p2align 8
    .type reduce_kernel,@function
reduce_kernel:
    s_cmp_ge_u32 s2, 256
    s_cbranch_scc1 L_k2_end
    s_load_dwordx2 s[6:7], s[0:1], 80
    s_load_dwordx2 s[12:13], s[0:1], 96
    v_lshrrev_b32 v2, 6, v0
    v_and_b32 v1, 63, v0
    v_readfirstlane_b32 s32, v2
    v_lshlrev_b32 v3, 4, v1
    s_lshr_b32 s36, s2, 4
    s_and_b32 s37, s2, 15
    s_mul_i32 s37, s37, 12
    s_add_u32 s37, s37, s32
    s_mul_i32 s46, s36, 3145728
    s_lshl_b32 s47, s37, 10
    s_add_u32 s46, s46, s47
    s_waitcnt lgkmcnt(0)
    s_add_u32 s16, s12, s46
    s_addc_u32 s17, s13, 0
    s_and_b32 s17, s17, 0xffff
    s_mov_b32 s18, 2950144
    s_mov_b32 s19, 0x20000
    s_mov_b32 s40, 0
    buffer_load_dwordx4 v[16:19], v3, s[16:19], s40 offen
    s_add_u32 s40, s40, 196608
    buffer_load_dwordx4 v[20:23], v3, s[16:19], s40 offen
    s_add_u32 s40, s40, 196608
    buffer_load_dwordx4 v[24:27], v3, s[16:19], s40 offen
    s_add_u32 s40, s40, 196608
    buffer_load_dwordx4 v[28:31], v3, s[16:19], s40 offen
    s_add_u32 s40, s40, 196608
    buffer_load_dwordx4 v[32:35], v3, s[16:19], s40 offen
    s_add_u32 s40, s40, 196608
    buffer_load_dwordx4 v[36:39], v3, s[16:19], s40 offen
    s_add_u32 s40, s40, 196608
    buffer_load_dwordx4 v[40:43], v3, s[16:19], s40 offen
    s_add_u32 s40, s40, 196608
    buffer_load_dwordx4 v[44:47], v3, s[16:19], s40 offen
    s_add_u32 s40, s40, 196608
    buffer_load_dwordx4 v[48:51], v3, s[16:19], s40 offen
    s_add_u32 s40, s40, 196608
    buffer_load_dwordx4 v[52:55], v3, s[16:19], s40 offen
    s_add_u32 s40, s40, 196608
    buffer_load_dwordx4 v[56:59], v3, s[16:19], s40 offen
    s_add_u32 s40, s40, 196608
    buffer_load_dwordx4 v[60:63], v3, s[16:19], s40 offen
    s_add_u32 s40, s40, 196608
    buffer_load_dwordx4 v[64:67], v3, s[16:19], s40 offen
    s_add_u32 s40, s40, 196608
    buffer_load_dwordx4 v[68:71], v3, s[16:19], s40 offen
    s_add_u32 s40, s40, 196608
    buffer_load_dwordx4 v[72:75], v3, s[16:19], s40 offen
    s_add_u32 s40, s40, 196608
    buffer_load_dwordx4 v[76:79], v3, s[16:19], s40 offen
    s_and_b32 s46, s36, 7
    s_mul_i32 s46, s46, 192
    s_lshr_b32 s47, s37, 4
    s_lshl_b32 s47, s47, 4
    s_add_u32 s46, s46, s47
    s_lshl_b32 s46, s46, 11
    s_lshr_b32 s47, s36, 3
    s_lshl_b32 s47, s47, 10
    s_add_u32 s46, s46, s47
    s_and_b32 s47, s37, 15
    s_lshl_b32 s47, s47, 6
    s_add_u32 s46, s46, s47
    s_mov_b32 s24, s6
    s_and_b32 s25, s7, 0xffff
    s_mov_b32 s26, 3145728
    s_mov_b32 s27, 0x20000
    v_and_b32 v4, 15, v1
    v_lshlrev_b32 v4, 11, v4
    v_lshrrev_b32 v5, 4, v1
    v_lshl_add_u32 v4, v5, 3, v4
    s_mov_b32 s41, 0xffff0000
    s_waitcnt vmcnt(15)
    v_lshlrev_b32 v8, 16, v16
    v_and_b32 v9, s41, v16
    v_lshlrev_b32 v10, 16, v17
    v_and_b32 v11, s41, v17
    v_lshlrev_b32 v12, 16, v18
    v_and_b32 v13, s41, v18
    v_lshlrev_b32 v14, 16, v19
    v_and_b32 v15, s41, v19
    s_waitcnt vmcnt(14)
    v_lshlrev_b32 v6, 16, v20
    v_and_b32 v7, s41, v20
    v_add_f32 v8, v8, v6
    v_add_f32 v9, v9, v7
    v_lshlrev_b32 v6, 16, v21
    v_and_b32 v7, s41, v21
    v_add_f32 v10, v10, v6
    v_add_f32 v11, v11, v7
    v_lshlrev_b32 v6, 16, v22
    v_and_b32 v7, s41, v22
    v_add_f32 v12, v12, v6
    v_add_f32 v13, v13, v7
    v_lshlrev_b32 v6, 16, v23
    v_and_b32 v7, s41, v23
    v_add_f32 v14, v14, v6
    v_add_f32 v15, v15, v7
    s_waitcnt vmcnt(13)
    v_lshlrev_b32 v6, 16, v24
    v_and_b32 v7, s41, v24
    v_add_f32 v8, v8, v6
    v_add_f32 v9, v9, v7
    v_lshlrev_b32 v6, 16, v25
    v_and_b32 v7, s41, v25
    v_add_f32 v10, v10, v6
    v_add_f32 v11, v11, v7
    v_lshlrev_b32 v6, 16, v26
    v_and_b32 v7, s41, v26
    v_add_f32 v12, v12, v6
    v_add_f32 v13, v13, v7
    v_lshlrev_b32 v6, 16, v27
    v_and_b32 v7, s41, v27
    v_add_f32 v14, v14, v6
    v_add_f32 v15, v15, v7
    s_waitcnt vmcnt(12)
    v_lshlrev_b32 v6, 16, v28
    v_and_b32 v7, s41, v28
    v_add_f32 v8, v8, v6
    v_add_f32 v9, v9, v7
    v_lshlrev_b32 v6, 16, v29
    v_and_b32 v7, s41, v29
    v_add_f32 v10, v10, v6
    v_add_f32 v11, v11, v7
    v_lshlrev_b32 v6, 16, v30
    v_and_b32 v7, s41, v30
    v_add_f32 v12, v12, v6
    v_add_f32 v13, v13, v7
    v_lshlrev_b32 v6, 16, v31
    v_and_b32 v7, s41, v31
    v_add_f32 v14, v14, v6
    v_add_f32 v15, v15, v7
    s_waitcnt vmcnt(11)
    v_lshlrev_b32 v6, 16, v32
    v_and_b32 v7, s41, v32
    v_add_f32 v8, v8, v6
    v_add_f32 v9, v9, v7
    v_lshlrev_b32 v6, 16, v33
    v_and_b32 v7, s41, v33
    v_add_f32 v10, v10, v6
    v_add_f32 v11, v11, v7
    v_lshlrev_b32 v6, 16, v34
    v_and_b32 v7, s41, v34
    v_add_f32 v12, v12, v6
    v_add_f32 v13, v13, v7
    v_lshlrev_b32 v6, 16, v35
    v_and_b32 v7, s41, v35
    v_add_f32 v14, v14, v6
    v_add_f32 v15, v15, v7
    s_waitcnt vmcnt(10)
    v_lshlrev_b32 v6, 16, v36
    v_and_b32 v7, s41, v36
    v_add_f32 v8, v8, v6
    v_add_f32 v9, v9, v7
    v_lshlrev_b32 v6, 16, v37
    v_and_b32 v7, s41, v37
    v_add_f32 v10, v10, v6
    v_add_f32 v11, v11, v7
    v_lshlrev_b32 v6, 16, v38
    v_and_b32 v7, s41, v38
    v_add_f32 v12, v12, v6
    v_add_f32 v13, v13, v7
    v_lshlrev_b32 v6, 16, v39
    v_and_b32 v7, s41, v39
    v_add_f32 v14, v14, v6
    v_add_f32 v15, v15, v7
    s_waitcnt vmcnt(9)
    v_lshlrev_b32 v6, 16, v40
    v_and_b32 v7, s41, v40
    v_add_f32 v8, v8, v6
    v_add_f32 v9, v9, v7
    v_lshlrev_b32 v6, 16, v41
    v_and_b32 v7, s41, v41
    v_add_f32 v10, v10, v6
    v_add_f32 v11, v11, v7
    v_lshlrev_b32 v6, 16, v42
    v_and_b32 v7, s41, v42
    v_add_f32 v12, v12, v6
    v_add_f32 v13, v13, v7
    v_lshlrev_b32 v6, 16, v43
    v_and_b32 v7, s41, v43
    v_add_f32 v14, v14, v6
    v_add_f32 v15, v15, v7
    s_waitcnt vmcnt(8)
    v_lshlrev_b32 v6, 16, v44
    v_and_b32 v7, s41, v44
    v_add_f32 v8, v8, v6
    v_add_f32 v9, v9, v7
    v_lshlrev_b32 v6, 16, v45
    v_and_b32 v7, s41, v45
    v_add_f32 v10, v10, v6
    v_add_f32 v11, v11, v7
    v_lshlrev_b32 v6, 16, v46
    v_and_b32 v7, s41, v46
    v_add_f32 v12, v12, v6
    v_add_f32 v13, v13, v7
    v_lshlrev_b32 v6, 16, v47
    v_and_b32 v7, s41, v47
    v_add_f32 v14, v14, v6
    v_add_f32 v15, v15, v7
    s_waitcnt vmcnt(7)
    v_lshlrev_b32 v6, 16, v48
    v_and_b32 v7, s41, v48
    v_add_f32 v8, v8, v6
    v_add_f32 v9, v9, v7
    v_lshlrev_b32 v6, 16, v49
    v_and_b32 v7, s41, v49
    v_add_f32 v10, v10, v6
    v_add_f32 v11, v11, v7
    v_lshlrev_b32 v6, 16, v50
    v_and_b32 v7, s41, v50
    v_add_f32 v12, v12, v6
    v_add_f32 v13, v13, v7
    v_lshlrev_b32 v6, 16, v51
    v_and_b32 v7, s41, v51
    v_add_f32 v14, v14, v6
    v_add_f32 v15, v15, v7
    s_waitcnt vmcnt(6)
    v_lshlrev_b32 v6, 16, v52
    v_and_b32 v7, s41, v52
    v_add_f32 v8, v8, v6
    v_add_f32 v9, v9, v7
    v_lshlrev_b32 v6, 16, v53
    v_and_b32 v7, s41, v53
    v_add_f32 v10, v10, v6
    v_add_f32 v11, v11, v7
    v_lshlrev_b32 v6, 16, v54
    v_and_b32 v7, s41, v54
    v_add_f32 v12, v12, v6
    v_add_f32 v13, v13, v7
    v_lshlrev_b32 v6, 16, v55
    v_and_b32 v7, s41, v55
    v_add_f32 v14, v14, v6
    v_add_f32 v15, v15, v7
    s_waitcnt vmcnt(5)
    v_lshlrev_b32 v6, 16, v56
    v_and_b32 v7, s41, v56
    v_add_f32 v8, v8, v6
    v_add_f32 v9, v9, v7
    v_lshlrev_b32 v6, 16, v57
    v_and_b32 v7, s41, v57
    v_add_f32 v10, v10, v6
    v_add_f32 v11, v11, v7
    v_lshlrev_b32 v6, 16, v58
    v_and_b32 v7, s41, v58
    v_add_f32 v12, v12, v6
    v_add_f32 v13, v13, v7
    v_lshlrev_b32 v6, 16, v59
    v_and_b32 v7, s41, v59
    v_add_f32 v14, v14, v6
    v_add_f32 v15, v15, v7
    s_waitcnt vmcnt(4)
    v_lshlrev_b32 v6, 16, v60
    v_and_b32 v7, s41, v60
    v_add_f32 v8, v8, v6
    v_add_f32 v9, v9, v7
    v_lshlrev_b32 v6, 16, v61
    v_and_b32 v7, s41, v61
    v_add_f32 v10, v10, v6
    v_add_f32 v11, v11, v7
    v_lshlrev_b32 v6, 16, v62
    v_and_b32 v7, s41, v62
    v_add_f32 v12, v12, v6
    v_add_f32 v13, v13, v7
    v_lshlrev_b32 v6, 16, v63
    v_and_b32 v7, s41, v63
    v_add_f32 v14, v14, v6
    v_add_f32 v15, v15, v7
    s_waitcnt vmcnt(3)
    v_lshlrev_b32 v6, 16, v64
    v_and_b32 v7, s41, v64
    v_add_f32 v8, v8, v6
    v_add_f32 v9, v9, v7
    v_lshlrev_b32 v6, 16, v65
    v_and_b32 v7, s41, v65
    v_add_f32 v10, v10, v6
    v_add_f32 v11, v11, v7
    v_lshlrev_b32 v6, 16, v66
    v_and_b32 v7, s41, v66
    v_add_f32 v12, v12, v6
    v_add_f32 v13, v13, v7
    v_lshlrev_b32 v6, 16, v67
    v_and_b32 v7, s41, v67
    v_add_f32 v14, v14, v6
    v_add_f32 v15, v15, v7
    s_waitcnt vmcnt(2)
    v_lshlrev_b32 v6, 16, v68
    v_and_b32 v7, s41, v68
    v_add_f32 v8, v8, v6
    v_add_f32 v9, v9, v7
    v_lshlrev_b32 v6, 16, v69
    v_and_b32 v7, s41, v69
    v_add_f32 v10, v10, v6
    v_add_f32 v11, v11, v7
    v_lshlrev_b32 v6, 16, v70
    v_and_b32 v7, s41, v70
    v_add_f32 v12, v12, v6
    v_add_f32 v13, v13, v7
    v_lshlrev_b32 v6, 16, v71
    v_and_b32 v7, s41, v71
    v_add_f32 v14, v14, v6
    v_add_f32 v15, v15, v7
    s_waitcnt vmcnt(1)
    v_lshlrev_b32 v6, 16, v72
    v_and_b32 v7, s41, v72
    v_add_f32 v8, v8, v6
    v_add_f32 v9, v9, v7
    v_lshlrev_b32 v6, 16, v73
    v_and_b32 v7, s41, v73
    v_add_f32 v10, v10, v6
    v_add_f32 v11, v11, v7
    v_lshlrev_b32 v6, 16, v74
    v_and_b32 v7, s41, v74
    v_add_f32 v12, v12, v6
    v_add_f32 v13, v13, v7
    v_lshlrev_b32 v6, 16, v75
    v_and_b32 v7, s41, v75
    v_add_f32 v14, v14, v6
    v_add_f32 v15, v15, v7
    s_waitcnt vmcnt(0)
    v_lshlrev_b32 v6, 16, v76
    v_and_b32 v7, s41, v76
    v_add_f32 v8, v8, v6
    v_add_f32 v9, v9, v7
    v_lshlrev_b32 v6, 16, v77
    v_and_b32 v7, s41, v77
    v_add_f32 v10, v10, v6
    v_add_f32 v11, v11, v7
    v_lshlrev_b32 v6, 16, v78
    v_and_b32 v7, s41, v78
    v_add_f32 v12, v12, v6
    v_add_f32 v13, v13, v7
    v_lshlrev_b32 v6, 16, v79
    v_and_b32 v7, s41, v79
    v_add_f32 v14, v14, v6
    v_add_f32 v15, v15, v7
    v_cvt_pk_bf16_f32 v16, v8, v9
    v_cvt_pk_bf16_f32 v17, v10, v11
    v_cvt_pk_bf16_f32 v18, v12, v13
    v_cvt_pk_bf16_f32 v19, v14, v15
    buffer_store_dwordx2 v[16:17], v4, s[24:27], s46 offen
    buffer_store_dwordx2 v[18:19], v4, s[24:27], s46 offen offset:32
L_k2_end:
    s_endpgm
.section .rodata,"a"
.p2align 6
.amdhsa_kernel attn_kernel
  .amdhsa_next_free_vgpr 512
  .amdhsa_next_free_sgpr 100
  .amdhsa_accum_offset 256
  .amdhsa_group_segment_fixed_size 0
  .amdhsa_kernarg_size 104
  .amdhsa_user_sgpr_count 2
  .amdhsa_user_sgpr_kernarg_segment_ptr 1
  .amdhsa_system_sgpr_workgroup_id_x 1
.end_amdhsa_kernel
.p2align 6
.amdhsa_kernel reduce_kernel
  .amdhsa_next_free_vgpr 80
  .amdhsa_next_free_sgpr 100
  .amdhsa_accum_offset 80
  .amdhsa_group_segment_fixed_size 0
  .amdhsa_kernarg_size 104
  .amdhsa_user_sgpr_count 2
  .amdhsa_user_sgpr_kernarg_segment_ptr 1
  .amdhsa_system_sgpr_workgroup_id_x 1
.end_amdhsa_kernel
```
